```python
import torch

def _softmax(x, axis=-1):
    return torch.softmax(x, dim=axis)
def _gelu(x):
    return torch.nn.functional.gelu(x, approximate="tanh")
def _silu(x):
    return torch.nn.functional.silu(x)
def _sigmoid(x):
    return torch.sigmoid(x)
def _layernorm(x, axis=-1, eps=1e-5):
    m = x.mean(dim=axis, keepdim=True)
    v = x.var(dim=axis, keepdim=True, unbiased=False)
    return (x - m) / torch.sqrt(v + eps)
def _scatter_add(tgt, idx, src, axis=0):
    return tgt.clone().index_add_(axis, idx, src)
def _segment_sum(src, seg, n):
    out = torch.zeros((n,) + src.shape[1:], dtype=src.dtype)
    return out.index_add_(0, seg, src)
def _pad(x, pw):
    flat = tuple(v for pair in reversed(pw) for v in pair)
    return torch.nn.functional.pad(x, flat)

kernel_name = 'parallel_sum__ssm_conv_s5__geglu_ffn__prompt'

def setup_inputs():

    _w = (lambda a: (lambda t: t.to(torch.bfloat16) if t.is_floating_point() else t)(torch.as_tensor(a)))
    def _A_setup():
        B, S, D = 1, 2048, 576
        P = D
        Lambda_re = -0.5 * (lambda _x: torch.exp(torch.as_tensor(_x)))((lambda *s: torch.randn(*s, dtype=torch.bfloat16) * 0.8)(P))
        Lambda_im = (lambda *s: torch.randn(*s, dtype=torch.bfloat16) * 0.8)(P) * 1.0
        B_re = (lambda *s: torch.randn(*s, dtype=torch.bfloat16) * 0.8)(P, D) * (D ** -0.5)
        B_im = (lambda *s: torch.randn(*s, dtype=torch.bfloat16) * 0.8)(P, D) * (D ** -0.5)
        C_re = (lambda *s: torch.randn(*s, dtype=torch.bfloat16) * 0.8)(D, P) * (P ** -0.5)
        C_im = (lambda *s: torch.randn(*s, dtype=torch.bfloat16) * 0.8)(D, P) * (P ** -0.5)
        log_dt = (lambda *s: torch.randn(*s, dtype=torch.bfloat16) * 0.8)(P) * 0.3 - 2.0
        Dskip = (lambda *s: torch.randn(*s, dtype=torch.bfloat16) * 0.8)(D)
        return {
            "x": _w((lambda *s: torch.randn(*s, dtype=torch.bfloat16) * 0.05)(B, S, D)),
            "Lambda_re": _w(Lambda_re),
            "Lambda_im": _w(Lambda_im),
            "B_re": _w(B_re),
            "B_im": _w(B_im),
            "C_re": _w(C_re),
            "C_im": _w(C_im),
            "log_dt": _w(log_dt),
            "Dskip": _w(Dskip),
        }
    _A_in = _A_setup()

    def _B_setup():
        B, S, D, F = 1, 2048, 576, 4608
        return {
            "x": _w((lambda *s: torch.randn(*s, dtype=torch.bfloat16) * 0.05)(B, S, D)),
            "w_gate": _w((lambda *s: torch.randn(*s, dtype=torch.bfloat16) * 0.05)(D, F)),
            "w_up": _w((lambda *s: torch.randn(*s, dtype=torch.bfloat16) * 0.05)(D, F)),
            "w_down": _w((lambda *s: torch.randn(*s, dtype=torch.bfloat16) * 0.05)(F, D)),
        }
    _B_in = _B_setup()

    return {
        "A_x": _A_in["x"],
        "A_Lambda_re": _A_in["Lambda_re"],
        "A_Lambda_im": _A_in["Lambda_im"],
        "A_B_re": _A_in["B_re"],
        "A_B_im": _A_in["B_im"],
        "A_C_re": _A_in["C_re"],
        "A_C_im": _A_in["C_im"],
        "A_log_dt": _A_in["log_dt"],
        "A_Dskip": _A_in["Dskip"],
        "B_x": _B_in["x"],
        "B_w_gate": _B_in["w_gate"],
        "B_w_up": _B_in["w_up"],
        "B_w_down": _B_in["w_down"],
    }

def reference(A_x, A_Lambda_re, A_Lambda_im, A_B_re, A_B_im, A_C_re, A_C_im, A_log_dt, A_Dskip, B_x, B_w_gate, B_w_up, B_w_down):
    def _A_ref(x, Lambda_re, Lambda_im, B_re, B_im, C_re, C_im, log_dt, Dskip):
        Bsz, L, H = x.shape
        Lam = Lambda_re + 1j * Lambda_im
        Bmat = B_re + 1j * B_im
        Cmat = C_re + 1j * C_im
        dt = torch.exp(log_dt)
        Lam_bar = torch.exp(dt * Lam)
        B_bar = ((Lam_bar - 1.0) / Lam)[:, None] * Bmat
        Bu = torch.einsum("bld,pd->blp", x + 0j, B_bar)
        h = torch.zeros_like(Bu[:, 0, :])
        hs = []
        for t in range(L):
            h = Lam_bar[None, :] * h + Bu[:, t, :]
            hs.append(h)
        hseq = torch.stack(hs, 1)
        y = 2.0 * torch.einsum("blp,dp->bld", hseq, Cmat).real + x * Dskip[None, None, :]
        return y

    def _B_ref(x, w_gate, w_up, w_down):
        return (_gelu(x @ w_gate) * (x @ w_up)) @ w_down

    x = A_x
    xn = _layernorm(x, axis=-1)
    return x + _A_ref(xn, A_Lambda_re, A_Lambda_im, A_B_re, A_B_im, A_C_re, A_C_im, A_log_dt, A_Dskip) + _B_ref(xn, B_w_gate, B_w_up, B_w_down)
```

```asm
; @launch grid=(256,1,1) block=(256,1,1) lds=163840
.amdgcn_target "amdgcn-amd-amdhsa--gfx950"

.text
.globl parallel_sum__ssm_conv_s5__geglu_ffn__prompt_kernel
.p2align 8
.type parallel_sum__ssm_conv_s5__geglu_ffn__prompt_kernel,@function
parallel_sum__ssm_conv_s5__geglu_ffn__prompt_kernel:
    s_cmp_ge_u32 s2, 256
    s_cbranch_scc1 K3_END
    s_load_dwordx2 s[88:89], s[0:1], 0
    s_lshr_b32 s57, s2, 3
    s_lshl_b32 s57, s57, 2
    s_getpc_b64 s[92:93]
K2_PC0:
    s_sub_u32 s92, s92, K2_PC0-parallel_sum__ssm_conv_s5__geglu_ffn__prompt_kernel
    s_subb_u32 s93, s93, 0
    s_and_b32 s93, s93, 0xffff
    s_mov_b32 s94, CODE_END-parallel_sum__ssm_conv_s5__geglu_ffn__prompt_kernel
    s_mov_b32 s95, 0x00020000
    v_lshlrev_b32 v198, 7, v0
    s_lshl_b32 s57, s57, 13
    v_add_u32 v198, s57, v198
    buffer_load_dword v199, v198, s[92:95], 0 offen
    s_and_b32 s57, s2, 4
    s_bfe_u32 s58, s2, 0x20003
    s_add_u32 s57, s57, s58
    s_lshl_b32 s57, s57, 3
    s_and_b32 s58, s2, 3
    s_lshl_b32 s58, s58, 1
    s_add_u32 s57, s57, s58
    s_lshr_b32 s58, s2, 7
    s_add_u32 s57, s57, s58
    s_lshl_b32 s57, s57, 5
    s_bfe_u32 s58, s2, 0x20005
    s_lshl_b32 s58, s58, 2
    s_add_u32 s57, s57, s58
    s_mul_i32 s58, s57, 1152
    v_bfe_u32 v176, v0, 3, 2
    v_bfe_u32 v177, v0, 5, 1
    v_lshl_add_u32 v176, v177, 4, v176
    v_mul_u32_u24 v178, 1152, v176
    v_and_b32 v177, 7, v0
    v_lshl_add_u32 v178, v177, 4, v178
    v_cmp_gt_u32 vcc, 64, v0
    s_nop 1
    v_cndmask_b32 v178, 2.0, v178, vcc
    s_mov_b32 s90, 2359296
    s_mov_b32 s91, 0x00020000
    s_waitcnt lgkmcnt(0)
    s_and_b32 s89, s89, 0xffff
    buffer_load_dwordx4 v[48:51], v178, s[88:91], s58 offen offset:0
    buffer_load_dwordx4 v[52:55], v178, s[88:91], s58 offen offset:128
    buffer_load_dwordx4 v[56:59], v178, s[88:91], s58 offen offset:256
    buffer_load_dwordx4 v[60:63], v178, s[88:91], s58 offen offset:384
    buffer_load_dwordx4 v[64:67], v178, s[88:91], s58 offen offset:512
    buffer_load_dwordx4 v[68:71], v178, s[88:91], s58 offen offset:640
    buffer_load_dwordx4 v[72:75], v178, s[88:91], s58 offen offset:768
    buffer_load_dwordx4 v[76:79], v178, s[88:91], s58 offen offset:896
    buffer_load_dwordx4 v[80:83], v178, s[88:91], s58 offen offset:1024
    s_load_dwordx4 s[36:39], s[0:1], 80
    s_load_dwordx2 s[48:49], s[0:1], 120
    s_load_dwordx4 s[40:43], s[0:1], 8
    s_load_dwordx2 s[46:47], s[0:1], 56
    s_load_dwordx2 s[100:101], s[0:1], 24
    s_load_dwordx2 s[82:83], s[0:1], 32
    v_lshrrev_b32 v2, 6, v0
    v_and_b32 v0, 63, v0
    v_readfirstlane_b32 s53, v2
    s_and_b32 s52, s2, 3
    s_lshr_b32 s50, s2, 5
    s_lshl_b32 s51, s52, 3
    s_add_u32 s50, s50, s51
    s_and_b32 s51, s2, 4
    s_bfe_u32 s54, s2, 0x20003
    s_add_u32 s51, s51, s54
    s_mov_b32 s79, s53
    v_lshlrev_b32 v1, 4, v0
    s_lshl_b32 s54, s51, 3
    s_lshl_b32 s55, s53, 1
    s_add_u32 s54, s54, s55
    s_mul_i32 s64, s54, 36864
    s_mul_i32 s55, s52, 0
    s_add_u32 s64, s64, s55
    s_add_u32 s65, s64, 36864
    s_lshr_b32 s57, s50, 2
    s_and_b32 s58, s50, 3
    s_mul_i32 s66, s54, 368640
    s_add_u32 s66, s66, 9437184
    s_add_u32 s73, s66, 294912
    s_mul_i32 s55, s57, 36864
    s_add_u32 s66, s66, s55
    s_lshl_b32 s55, s58, 10
    s_add_u32 s68, s66, s55
    s_add_u32 s68, s68, 32768
    s_add_u32 s69, s68, 368640
    s_lshl_b32 s55, s58, 13
    s_add_u32 s66, s66, s55
    s_add_u32 s67, s66, 368640
    s_mul_i32 s56, s57, 1152
    s_lshl_b32 s55, s58, 5
    s_add_u32 s72, s56, s55
    s_add_u32 s72, s72, 1024
    s_lshl_b32 s55, s58, 8
    s_add_u32 s56, s56, s55
    s_mov_b32 s70, 0xbdd2d3e8
    v_mov_b32 v10, 0xc0135761
    v_lshrrev_b32 v14, 3, v0
    v_and_b32 v15, 2, v14
    v_bfe_u32 v2, v0, 1, 2
    v_xor_b32 v2, v2, v15
    v_lshlrev_b32 v2, 5, v2
    v_and_b32 v15, 1, v0
    v_lshl_add_u32 v2, v15, 4, v2
    s_lshl_b32 s57, s53, 4
    v_add_u32 v14, s57, v14
    v_mul_u32_u24 v14, 9216, v14
    v_add_u32 v2, v2, v14
    v_xor_b32 v3, 32, v2
    v_lshrrev_b32 v14, 1, v0
    s_lshl_b32 s57, s53, 1
    s_and_b32 s57, s57, 4
    v_xor_b32 v14, s57, v14
    v_mul_u32_u24 v14, 9216, v14
    v_lshl_add_u32 v4, v15, 4, v14
    s_lshl_b32 s61, s53, 11
    s_waitcnt lgkmcnt(0)
    s_mov_b32 s8, s36
    s_and_b32 s9, s37, 0xffff
    s_mov_b32 s10, 5308416
    s_mov_b32 s11, 0x00020000
    s_mov_b32 s12, s38
    s_and_b32 s13, s39, 0xffff
    s_mov_b32 s14, 5308416
    s_mov_b32 s15, 0x00020000
    s_mov_b32 s20, s48
    s_and_b32 s21, s49, 0xffff
    s_mov_b32 s22, 268435456
    s_mov_b32 s23, 0x00020000
    s_mov_b32 s24, s40
    s_and_b32 s25, s41, 0xffff
    s_mov_b32 s26, 1152
    s_mov_b32 s27, 0x00020000
    s_mov_b32 s28, s42
    s_and_b32 s29, s43, 0xffff
    s_mov_b32 s30, 1152
    s_mov_b32 s31, 0x00020000
    s_mov_b32 s32, s46
    s_and_b32 s33, s47, 0xffff
    s_mov_b32 s34, 1152
    s_mov_b32 s35, 0x00020000
    s_cmp_lt_u32 s53, 2
    s_cselect_b32 s16, s8, s12
    s_cselect_b32 s17, s9, s13
    s_cselect_b32 s44, s100, s82
    s_cselect_b32 s45, s101, s83
    s_and_b32 s45, s45, 0xffff
    s_mov_b32 s46, 663552
    s_mov_b32 s47, 0x00020000
    s_mov_b32 s18, 5308416
    s_mov_b32 s19, 0x00020000
    s_and_b32 s57, s53, 1
    s_mul_i32 s55, s57, 294912
    s_add_u32 s72, s72, s55
    s_lshl_b32 s60, s53, 10
    s_add_u32 s60, s60, 147456
    s_mul_i32 s63, s50, 18432
    v_lshrrev_b32 v14, 3, v0
    v_lshrrev_b32 v15, 4, v0
    s_lshl_b32 s55, s57, 2
    v_add_u32 v15, s55, v15
    v_and_b32 v13, 7, v0
    v_xor_b32 v13, v13, v15
    s_lshl_b32 s55, s57, 3
    v_add_u32 v14, s55, v14
    v_mul_u32_u24 v14, 1152, v14
    v_lshl_add_u32 v252, v13, 4, v14
    v_and_b32 v14, 1, v0
    v_lshlrev_b32 v14, 4, v14
    v_bfe_u32 v15, v0, 1, 1
    v_lshl_add_u32 v14, v15, 3, v14
    v_lshrrev_b32 v15, 5, v0
    v_lshlrev_b32 v15, 3, v15
    v_bfe_u32 v208, v0, 2, 2
    v_add_u32 v15, v15, v208
    v_bfe_u32 v209, v0, 4, 1
    v_and_b32 v208, 2, v208
    v_xor_b32 v208, v208, v209
    v_lshl_add_u32 v5, v15, 7, v14
    v_lshl_add_u32 v5, v209, 13, v5
    v_lshl_add_u32 v5, v208, 5, v5
    v_xor_b32 v6, 32, v5
    v_xor_b32 v7, 64, v5
    v_xor_b32 v8, 96, v5
    v_lshl_add_u32 v9, v15, 5, v14
    v_lshl_add_u32 v9, v209, 11, v9
    v_lshl_add_u32 v9, v209, 7, v9
    v_add_u32 v9, 147456, v9
    v_xor_b32 v15, 128, v9
    v_and_b32 v13, 31, v0
    v_bfe_u32 v208, v13, 1, 3
    v_lshrrev_b32 v209, 5, v0
    v_xor_b32 v208, v208, v209
    v_lshlrev_b32 v208, 4, v208
    v_lshl_add_u32 v14, v13, 7, v208
    v_add_u32 v14, 147456, v14
    s_lshl_b32 s76, s51, 2
    s_add_u32 s76, s76, s53
    s_lshl_b32 s75, s50, 5
    s_add_u32 s75, s75, s76
    s_lshl_b32 s75, s75, 8
    s_add_u32 s75, s75, 50331648
    s_lshl_b32 s55, s50, 10
    s_add_u32 s40, s73, s55
    s_add_u32 s41, s40, 368640
    s_lshl_b32 s100, s76, 2
    s_add_u32 s100, s100, s52
    s_add_u32 s100, s100, 192
    s_mul_i32 s100, s100, 64
    s_add_u32 s100, s100, 53477376
    s_add_u32 s83, s100, 10240
    s_lshr_b32 s101, s76, 1
    s_add_u32 s101, s101, 320
    s_mul_i32 s101, s101, 64
    s_add_u32 s101, s101, 53477376
    v_cmp_eq_u32 vcc, 0, v0
    v_mov_b32 v233, 1
    s_nop 0
    v_cndmask_b32 v232, 2.0, v0, vcc
    s_lshr_b32 s57, s2, 5
    s_bfe_u32 s58, s2, 0x20003
    s_lshl_b32 s58, s58, 1
    s_add_u32 s57, s57, s58
    s_cmp_ge_u32 s57, 9
    s_cselect_b32 s58, 9, 0
    s_sub_u32 s57, s57, s58
    s_mul_i32 s57, s57, 1
    s_sub_u32 s3, 9, s57
    s_mul_i32 s58, s57, 589824
    s_add_u32 s56, s56, s58
    s_add_u32 s72, s72, s58
    s_sub_u32 s4, s56, 5308416
    s_sub_u32 s5, s72, 5308416
    s_lshl_b32 s58, s57, 7
    s_add_u32 s63, s63, s58
    s_sub_u32 s6, s63, 1152
    s_lshl_b32 s58, s57, 12
    s_add_u32 s64, s64, s58
    s_add_u32 s65, s65, s58
    s_sub_u32 s7, s64, 36864
    s_sub_u32 s78, s65, 36864
    s_load_dwordx2 s[48:49], s[0:1], 112
    s_waitcnt lgkmcnt(0)
    s_mov_b32 s36, s48
    s_and_b32 s37, s49, 0xffff
    s_mov_b32 s38, 256
    s_mov_b32 s39, 0x00020000
    s_cmp_lg_u32 s53, 0
    s_cbranch_scc1 K2_NOLN
    v_mov_b32 v184, 0
    v_mov_b32 v185, 0
    v_mov_b32 v186, 0
    v_mov_b32 v187, 0
    v_mov_b32 v188, 0
    v_mov_b32 v189, 0
    v_mov_b32 v190, 1.0
    v_mov_b32 v191, 1.0
    s_mul_i32 s58, s2, 320
    s_add_u32 s58, s58, 53477376
    v_mul_u32_u24 v192, 64, v0
    v_cmp_gt_u32 vcc, 5, v0
    s_nop 1
    v_cndmask_b32 v192, 2.0, v192, vcc
    buffer_store_dword v184, v192, s[20:23], s58 offen sc0 sc1
    s_mul_i32 s58, s2, 1152
    s_add_u32 s58, s58, 50331648
    v_cmp_gt_u32 vcc, 8, v0
    s_nop 1
    v_cndmask_b32 v192, 2.0, v1, vcc
    buffer_store_dwordx4 v[184:187], v1, s[20:23], s58 offen sc0 sc1
    buffer_store_dwordx4 v[184:187], v192, s[20:23], s58 offen offset:1024 sc0 sc1
    s_lshl_b32 s57, s51, 5
    s_add_u32 s57, s57, s50
    s_lshl_b32 s42, s57, 7
    s_add_u32 s42, s42, 50724864
    buffer_store_dword v184, v232, s[20:23], s42 offen sc0 sc1
    s_cmp_eq_u32 s2, 0
    s_cselect_b32 s58, 0, 0x40000000
    s_add_u32 s58, s58, 50659328
    buffer_store_dwordx4 v[188:191], v232, s[20:23], s58 offen sc0 sc1
    s_and_b32 s58, s50, 3
    s_lshl_b32 s58, s58, 3
    v_lshrrev_b32 v178, 3, v0
    v_add_u32 v178, s58, v178
    v_lshrrev_b32 v176, 1, v177
    v_lshlrev_b32 v176, 10, v176
    v_and_b32 v179, 1, v177
    v_lshl_add_u32 v176, v179, 9, v176
    v_lshl_add_u32 v176, v178, 4, v176
    s_lshr_b32 s58, s57, 2
    s_mul_i32 s58, s58, 36864
    s_waitcnt vmcnt(13)
    v_lshlrev_b32 v88, 16, v48
    v_and_b32 v89, 0xffff0000, v48
    v_lshlrev_b32 v90, 16, v49
    v_and_b32 v91, 0xffff0000, v49
    v_pk_add_f32 v[168:169], v[88:89], v[90:91]
    v_lshlrev_b32 v92, 16, v50
    v_and_b32 v93, 0xffff0000, v50
    v_pk_add_f32 v[168:169], v[168:169], v[92:93]
    v_lshlrev_b32 v94, 16, v51
    v_and_b32 v95, 0xffff0000, v51
    v_pk_add_f32 v[168:169], v[168:169], v[94:95]
    s_waitcnt vmcnt(12)
    v_lshlrev_b32 v96, 16, v52
    v_and_b32 v97, 0xffff0000, v52
    v_pk_add_f32 v[168:169], v[168:169], v[96:97]
    v_lshlrev_b32 v98, 16, v53
    v_and_b32 v99, 0xffff0000, v53
    v_pk_add_f32 v[168:169], v[168:169], v[98:99]
    v_lshlrev_b32 v100, 16, v54
    v_and_b32 v101, 0xffff0000, v54
    v_pk_add_f32 v[168:169], v[168:169], v[100:101]
    v_lshlrev_b32 v102, 16, v55
    v_and_b32 v103, 0xffff0000, v55
    v_pk_add_f32 v[168:169], v[168:169], v[102:103]
    s_waitcnt vmcnt(11)
    v_lshlrev_b32 v104, 16, v56
    v_and_b32 v105, 0xffff0000, v56
    v_pk_add_f32 v[168:169], v[168:169], v[104:105]
    v_lshlrev_b32 v106, 16, v57
    v_and_b32 v107, 0xffff0000, v57
    v_pk_add_f32 v[168:169], v[168:169], v[106:107]
    v_lshlrev_b32 v108, 16, v58
    v_and_b32 v109, 0xffff0000, v58
    v_pk_add_f32 v[168:169], v[168:169], v[108:109]
    v_lshlrev_b32 v110, 16, v59
    v_and_b32 v111, 0xffff0000, v59
    v_pk_add_f32 v[168:169], v[168:169], v[110:111]
    s_waitcnt vmcnt(10)
    v_lshlrev_b32 v112, 16, v60
    v_and_b32 v113, 0xffff0000, v60
    v_pk_add_f32 v[168:169], v[168:169], v[112:113]
    v_lshlrev_b32 v114, 16, v61
    v_and_b32 v115, 0xffff0000, v61
    v_pk_add_f32 v[168:169], v[168:169], v[114:115]
    v_lshlrev_b32 v116, 16, v62
    v_and_b32 v117, 0xffff0000, v62
    v_pk_add_f32 v[168:169], v[168:169], v[116:117]
    v_lshlrev_b32 v118, 16, v63
    v_and_b32 v119, 0xffff0000, v63
    v_pk_add_f32 v[168:169], v[168:169], v[118:119]
    s_waitcnt vmcnt(9)
    v_lshlrev_b32 v120, 16, v64
    v_and_b32 v121, 0xffff0000, v64
    v_pk_add_f32 v[168:169], v[168:169], v[120:121]
    v_lshlrev_b32 v122, 16, v65
    v_and_b32 v123, 0xffff0000, v65
    v_pk_add_f32 v[168:169], v[168:169], v[122:123]
    v_lshlrev_b32 v124, 16, v66
    v_and_b32 v125, 0xffff0000, v66
    v_pk_add_f32 v[168:169], v[168:169], v[124:125]
    v_lshlrev_b32 v126, 16, v67
    v_and_b32 v127, 0xffff0000, v67
    v_pk_add_f32 v[168:169], v[168:169], v[126:127]
    s_waitcnt vmcnt(8)
    v_lshlrev_b32 v128, 16, v68
    v_and_b32 v129, 0xffff0000, v68
    v_pk_add_f32 v[168:169], v[168:169], v[128:129]
    v_lshlrev_b32 v130, 16, v69
    v_and_b32 v131, 0xffff0000, v69
    v_pk_add_f32 v[168:169], v[168:169], v[130:131]
    v_lshlrev_b32 v132, 16, v70
    v_and_b32 v133, 0xffff0000, v70
    v_pk_add_f32 v[168:169], v[168:169], v[132:133]
    v_lshlrev_b32 v134, 16, v71
    v_and_b32 v135, 0xffff0000, v71
    v_pk_add_f32 v[168:169], v[168:169], v[134:135]
    s_waitcnt vmcnt(7)
    v_lshlrev_b32 v136, 16, v72
    v_and_b32 v137, 0xffff0000, v72
    v_pk_add_f32 v[168:169], v[168:169], v[136:137]
    v_lshlrev_b32 v138, 16, v73
    v_and_b32 v139, 0xffff0000, v73
    v_pk_add_f32 v[168:169], v[168:169], v[138:139]
    v_lshlrev_b32 v140, 16, v74
    v_and_b32 v141, 0xffff0000, v74
    v_pk_add_f32 v[168:169], v[168:169], v[140:141]
    v_lshlrev_b32 v142, 16, v75
    v_and_b32 v143, 0xffff0000, v75
    v_pk_add_f32 v[168:169], v[168:169], v[142:143]
    s_waitcnt vmcnt(6)
    v_lshlrev_b32 v144, 16, v76
    v_and_b32 v145, 0xffff0000, v76
    v_pk_add_f32 v[168:169], v[168:169], v[144:145]
    v_lshlrev_b32 v146, 16, v77
    v_and_b32 v147, 0xffff0000, v77
    v_pk_add_f32 v[168:169], v[168:169], v[146:147]
    v_lshlrev_b32 v148, 16, v78
    v_and_b32 v149, 0xffff0000, v78
    v_pk_add_f32 v[168:169], v[168:169], v[148:149]
    v_lshlrev_b32 v150, 16, v79
    v_and_b32 v151, 0xffff0000, v79
    v_pk_add_f32 v[168:169], v[168:169], v[150:151]
    s_waitcnt vmcnt(5)
    v_lshlrev_b32 v152, 16, v80
    v_and_b32 v153, 0xffff0000, v80
    v_pk_add_f32 v[168:169], v[168:169], v[152:153]
    v_lshlrev_b32 v154, 16, v81
    v_and_b32 v155, 0xffff0000, v81
    v_pk_add_f32 v[168:169], v[168:169], v[154:155]
    v_lshlrev_b32 v156, 16, v82
    v_and_b32 v157, 0xffff0000, v82
    v_pk_add_f32 v[168:169], v[168:169], v[156:157]
    v_lshlrev_b32 v158, 16, v83
    v_and_b32 v159, 0xffff0000, v83
    v_pk_add_f32 v[168:169], v[168:169], v[158:159]
    v_add_f32 v168, v168, v169
    s_nop 1
    v_add_f32_dpp v168, v168, v168 quad_perm:[1,0,3,2] row_mask:0xf bank_mask:0xf
    s_nop 1
    v_add_f32_dpp v168, v168, v168 quad_perm:[2,3,0,1] row_mask:0xf bank_mask:0xf
    s_nop 1
    v_add_f32_dpp v168, v168, v168 row_half_mirror row_mask:0xf bank_mask:0xf
    v_mul_f32 v170, 0xbae38e39, v168
    v_pk_add_f32 v[172:173], v[88:89], v[170:171] op_sel_hi:[1,0]
    v_pk_mul_f32 v[168:169], v[172:173], v[172:173]
    v_pk_add_f32 v[172:173], v[90:91], v[170:171] op_sel_hi:[1,0]
    v_pk_fma_f32 v[168:169], v[172:173], v[172:173], v[168:169]
    v_pk_add_f32 v[172:173], v[92:93], v[170:171] op_sel_hi:[1,0]
    v_pk_fma_f32 v[168:169], v[172:173], v[172:173], v[168:169]
    v_pk_add_f32 v[172:173], v[94:95], v[170:171] op_sel_hi:[1,0]
    v_pk_fma_f32 v[168:169], v[172:173], v[172:173], v[168:169]
    v_pk_add_f32 v[172:173], v[96:97], v[170:171] op_sel_hi:[1,0]
    v_pk_fma_f32 v[168:169], v[172:173], v[172:173], v[168:169]
    v_pk_add_f32 v[172:173], v[98:99], v[170:171] op_sel_hi:[1,0]
    v_pk_fma_f32 v[168:169], v[172:173], v[172:173], v[168:169]
    v_pk_add_f32 v[172:173], v[100:101], v[170:171] op_sel_hi:[1,0]
    v_pk_fma_f32 v[168:169], v[172:173], v[172:173], v[168:169]
    v_pk_add_f32 v[172:173], v[102:103], v[170:171] op_sel_hi:[1,0]
    v_pk_fma_f32 v[168:169], v[172:173], v[172:173], v[168:169]
    v_pk_add_f32 v[172:173], v[104:105], v[170:171] op_sel_hi:[1,0]
    v_pk_fma_f32 v[168:169], v[172:173], v[172:173], v[168:169]
    v_pk_add_f32 v[172:173], v[106:107], v[170:171] op_sel_hi:[1,0]
    v_pk_fma_f32 v[168:169], v[172:173], v[172:173], v[168:169]
    v_pk_add_f32 v[172:173], v[108:109], v[170:171] op_sel_hi:[1,0]
    v_pk_fma_f32 v[168:169], v[172:173], v[172:173], v[168:169]
    v_pk_add_f32 v[172:173], v[110:111], v[170:171] op_sel_hi:[1,0]
    v_pk_fma_f32 v[168:169], v[172:173], v[172:173], v[168:169]
    v_pk_add_f32 v[172:173], v[112:113], v[170:171] op_sel_hi:[1,0]
    v_pk_fma_f32 v[168:169], v[172:173], v[172:173], v[168:169]
    v_pk_add_f32 v[172:173], v[114:115], v[170:171] op_sel_hi:[1,0]
    v_pk_fma_f32 v[168:169], v[172:173], v[172:173], v[168:169]
    v_pk_add_f32 v[172:173], v[116:117], v[170:171] op_sel_hi:[1,0]
    v_pk_fma_f32 v[168:169], v[172:173], v[172:173], v[168:169]
    v_pk_add_f32 v[172:173], v[118:119], v[170:171] op_sel_hi:[1,0]
    v_pk_fma_f32 v[168:169], v[172:173], v[172:173], v[168:169]
    v_pk_add_f32 v[172:173], v[120:121], v[170:171] op_sel_hi:[1,0]
    v_pk_fma_f32 v[168:169], v[172:173], v[172:173], v[168:169]
    v_pk_add_f32 v[172:173], v[122:123], v[170:171] op_sel_hi:[1,0]
    v_pk_fma_f32 v[168:169], v[172:173], v[172:173], v[168:169]
    v_pk_add_f32 v[172:173], v[124:125], v[170:171] op_sel_hi:[1,0]
    v_pk_fma_f32 v[168:169], v[172:173], v[172:173], v[168:169]
    v_pk_add_f32 v[172:173], v[126:127], v[170:171] op_sel_hi:[1,0]
    v_pk_fma_f32 v[168:169], v[172:173], v[172:173], v[168:169]
    v_pk_add_f32 v[172:173], v[128:129], v[170:171] op_sel_hi:[1,0]
    v_pk_fma_f32 v[168:169], v[172:173], v[172:173], v[168:169]
    v_pk_add_f32 v[172:173], v[130:131], v[170:171] op_sel_hi:[1,0]
    v_pk_fma_f32 v[168:169], v[172:173], v[172:173], v[168:169]
    v_pk_add_f32 v[172:173], v[132:133], v[170:171] op_sel_hi:[1,0]
    v_pk_fma_f32 v[168:169], v[172:173], v[172:173], v[168:169]
    v_pk_add_f32 v[172:173], v[134:135], v[170:171] op_sel_hi:[1,0]
    v_pk_fma_f32 v[168:169], v[172:173], v[172:173], v[168:169]
    v_pk_add_f32 v[172:173], v[136:137], v[170:171] op_sel_hi:[1,0]
    v_pk_fma_f32 v[168:169], v[172:173], v[172:173], v[168:169]
    v_pk_add_f32 v[172:173], v[138:139], v[170:171] op_sel_hi:[1,0]
    v_pk_fma_f32 v[168:169], v[172:173], v[172:173], v[168:169]
    v_pk_add_f32 v[172:173], v[140:141], v[170:171] op_sel_hi:[1,0]
    v_pk_fma_f32 v[168:169], v[172:173], v[172:173], v[168:169]
    v_pk_add_f32 v[172:173], v[142:143], v[170:171] op_sel_hi:[1,0]
    v_pk_fma_f32 v[168:169], v[172:173], v[172:173], v[168:169]
    v_pk_add_f32 v[172:173], v[144:145], v[170:171] op_sel_hi:[1,0]
    v_pk_fma_f32 v[168:169], v[172:173], v[172:173], v[168:169]
    v_pk_add_f32 v[172:173], v[146:147], v[170:171] op_sel_hi:[1,0]
    v_pk_fma_f32 v[168:169], v[172:173], v[172:173], v[168:169]
    v_pk_add_f32 v[172:173], v[148:149], v[170:171] op_sel_hi:[1,0]
    v_pk_fma_f32 v[168:169], v[172:173], v[172:173], v[168:169]
    v_pk_add_f32 v[172:173], v[150:151], v[170:171] op_sel_hi:[1,0]
    v_pk_fma_f32 v[168:169], v[172:173], v[172:173], v[168:169]
    v_pk_add_f32 v[172:173], v[152:153], v[170:171] op_sel_hi:[1,0]
    v_pk_fma_f32 v[168:169], v[172:173], v[172:173], v[168:169]
    v_pk_add_f32 v[172:173], v[154:155], v[170:171] op_sel_hi:[1,0]
    v_pk_fma_f32 v[168:169], v[172:173], v[172:173], v[168:169]
    v_pk_add_f32 v[172:173], v[156:157], v[170:171] op_sel_hi:[1,0]
    v_pk_fma_f32 v[168:169], v[172:173], v[172:173], v[168:169]
    v_pk_add_f32 v[172:173], v[158:159], v[170:171] op_sel_hi:[1,0]
    v_pk_fma_f32 v[168:169], v[172:173], v[172:173], v[168:169]
    v_add_f32 v168, v168, v169
    s_nop 1
    v_add_f32_dpp v168, v168, v168 quad_perm:[1,0,3,2] row_mask:0xf bank_mask:0xf
    s_nop 1
    v_add_f32_dpp v168, v168, v168 quad_perm:[2,3,0,1] row_mask:0xf bank_mask:0xf
    s_nop 1
    v_add_f32_dpp v168, v168, v168 row_half_mirror row_mask:0xf bank_mask:0xf
    v_mul_f32 v174, 0x3ae38e39, v168
    v_cvt_pk_bf16_f32 v170, v170, v170
    v_lshlrev_b32 v170, 16, v170
    v_cvt_pk_bf16_f32 v174, v174, v174
    v_lshlrev_b32 v174, 16, v174
    v_add_f32 v174, 0x3727c5ac, v174
    v_cvt_pk_bf16_f32 v174, v174, v174
    v_lshlrev_b32 v174, 16, v174
    v_sqrt_f32 v174, v174
    s_nop 0
    v_cvt_pk_bf16_f32 v174, v174, v174
    v_lshlrev_b32 v174, 16, v174
    v_rcp_f32 v174, v174
    v_pk_add_f32 v[88:89], v[88:89], v[170:171] op_sel_hi:[1,0]
    v_cvt_pk_bf16_f32 v89, v88, v89
    v_lshlrev_b32 v88, 16, v89
    v_and_b32 v89, 0xffff0000, v89
    v_pk_mul_f32 v[88:89], v[88:89], v[174:175] op_sel_hi:[1,0]
    v_cvt_pk_bf16_f32 v48, v88, v89
    v_pk_add_f32 v[90:91], v[90:91], v[170:171] op_sel_hi:[1,0]
    v_cvt_pk_bf16_f32 v91, v90, v91
    v_lshlrev_b32 v90, 16, v91
    v_and_b32 v91, 0xffff0000, v91
    v_pk_mul_f32 v[90:91], v[90:91], v[174:175] op_sel_hi:[1,0]
    v_cvt_pk_bf16_f32 v49, v90, v91
    v_pk_add_f32 v[92:93], v[92:93], v[170:171] op_sel_hi:[1,0]
    v_cvt_pk_bf16_f32 v93, v92, v93
    v_lshlrev_b32 v92, 16, v93
    v_and_b32 v93, 0xffff0000, v93
    v_pk_mul_f32 v[92:93], v[92:93], v[174:175] op_sel_hi:[1,0]
    v_cvt_pk_bf16_f32 v50, v92, v93
    v_pk_add_f32 v[94:95], v[94:95], v[170:171] op_sel_hi:[1,0]
    v_cvt_pk_bf16_f32 v95, v94, v95
    v_lshlrev_b32 v94, 16, v95
    v_and_b32 v95, 0xffff0000, v95
    v_pk_mul_f32 v[94:95], v[94:95], v[174:175] op_sel_hi:[1,0]
    v_cvt_pk_bf16_f32 v51, v94, v95
    s_add_u32 s59, s58, 0
    buffer_store_dwordx4 v[48:51], v176, s[20:23], s59 offen sc1
    v_pk_add_f32 v[96:97], v[96:97], v[170:171] op_sel_hi:[1,0]
    v_cvt_pk_bf16_f32 v97, v96, v97
    v_lshlrev_b32 v96, 16, v97
    v_and_b32 v97, 0xffff0000, v97
    v_pk_mul_f32 v[96:97], v[96:97], v[174:175] op_sel_hi:[1,0]
    v_cvt_pk_bf16_f32 v52, v96, v97
    v_pk_add_f32 v[98:99], v[98:99], v[170:171] op_sel_hi:[1,0]
    v_cvt_pk_bf16_f32 v99, v98, v99
    v_lshlrev_b32 v98, 16, v99
    v_and_b32 v99, 0xffff0000, v99
    v_pk_mul_f32 v[98:99], v[98:99], v[174:175] op_sel_hi:[1,0]
    v_cvt_pk_bf16_f32 v53, v98, v99
    v_pk_add_f32 v[100:101], v[100:101], v[170:171] op_sel_hi:[1,0]
    v_cvt_pk_bf16_f32 v101, v100, v101
    v_lshlrev_b32 v100, 16, v101
    v_and_b32 v101, 0xffff0000, v101
    v_pk_mul_f32 v[100:101], v[100:101], v[174:175] op_sel_hi:[1,0]
    v_cvt_pk_bf16_f32 v54, v100, v101
    v_pk_add_f32 v[102:103], v[102:103], v[170:171] op_sel_hi:[1,0]
    v_cvt_pk_bf16_f32 v103, v102, v103
    v_lshlrev_b32 v102, 16, v103
    v_and_b32 v103, 0xffff0000, v103
    v_pk_mul_f32 v[102:103], v[102:103], v[174:175] op_sel_hi:[1,0]
    v_cvt_pk_bf16_f32 v55, v102, v103
    s_add_u32 s59, s58, 4096
    buffer_store_dwordx4 v[52:55], v176, s[20:23], s59 offen sc1
    v_pk_add_f32 v[104:105], v[104:105], v[170:171] op_sel_hi:[1,0]
    v_cvt_pk_bf16_f32 v105, v104, v105
    v_lshlrev_b32 v104, 16, v105
    v_and_b32 v105, 0xffff0000, v105
    v_pk_mul_f32 v[104:105], v[104:105], v[174:175] op_sel_hi:[1,0]
    v_cvt_pk_bf16_f32 v56, v104, v105
    v_pk_add_f32 v[106:107], v[106:107], v[170:171] op_sel_hi:[1,0]
    v_cvt_pk_bf16_f32 v107, v106, v107
    v_lshlrev_b32 v106, 16, v107
    v_and_b32 v107, 0xffff0000, v107
    v_pk_mul_f32 v[106:107], v[106:107], v[174:175] op_sel_hi:[1,0]
    v_cvt_pk_bf16_f32 v57, v106, v107
    v_pk_add_f32 v[108:109], v[108:109], v[170:171] op_sel_hi:[1,0]
    v_cvt_pk_bf16_f32 v109, v108, v109
    v_lshlrev_b32 v108, 16, v109
    v_and_b32 v109, 0xffff0000, v109
    v_pk_mul_f32 v[108:109], v[108:109], v[174:175] op_sel_hi:[1,0]
    v_cvt_pk_bf16_f32 v58, v108, v109
    v_pk_add_f32 v[110:111], v[110:111], v[170:171] op_sel_hi:[1,0]
    v_cvt_pk_bf16_f32 v111, v110, v111
    v_lshlrev_b32 v110, 16, v111
    v_and_b32 v111, 0xffff0000, v111
    v_pk_mul_f32 v[110:111], v[110:111], v[174:175] op_sel_hi:[1,0]
    v_cvt_pk_bf16_f32 v59, v110, v111
    s_add_u32 s59, s58, 8192
    buffer_store_dwordx4 v[56:59], v176, s[20:23], s59 offen sc1
    v_pk_add_f32 v[112:113], v[112:113], v[170:171] op_sel_hi:[1,0]
    v_cvt_pk_bf16_f32 v113, v112, v113
    v_lshlrev_b32 v112, 16, v113
    v_and_b32 v113, 0xffff0000, v113
    v_pk_mul_f32 v[112:113], v[112:113], v[174:175] op_sel_hi:[1,0]
    v_cvt_pk_bf16_f32 v60, v112, v113
    v_pk_add_f32 v[114:115], v[114:115], v[170:171] op_sel_hi:[1,0]
    v_cvt_pk_bf16_f32 v115, v114, v115
    v_lshlrev_b32 v114, 16, v115
    v_and_b32 v115, 0xffff0000, v115
    v_pk_mul_f32 v[114:115], v[114:115], v[174:175] op_sel_hi:[1,0]
    v_cvt_pk_bf16_f32 v61, v114, v115
    v_pk_add_f32 v[116:117], v[116:117], v[170:171] op_sel_hi:[1,0]
    v_cvt_pk_bf16_f32 v117, v116, v117
    v_lshlrev_b32 v116, 16, v117
    v_and_b32 v117, 0xffff0000, v117
    v_pk_mul_f32 v[116:117], v[116:117], v[174:175] op_sel_hi:[1,0]
    v_cvt_pk_bf16_f32 v62, v116, v117
    v_pk_add_f32 v[118:119], v[118:119], v[170:171] op_sel_hi:[1,0]
    v_cvt_pk_bf16_f32 v119, v118, v119
    v_lshlrev_b32 v118, 16, v119
    v_and_b32 v119, 0xffff0000, v119
    v_pk_mul_f32 v[118:119], v[118:119], v[174:175] op_sel_hi:[1,0]
    v_cvt_pk_bf16_f32 v63, v118, v119
    s_add_u32 s59, s58, 12288
    buffer_store_dwordx4 v[60:63], v176, s[20:23], s59 offen sc1
    v_pk_add_f32 v[120:121], v[120:121], v[170:171] op_sel_hi:[1,0]
    v_cvt_pk_bf16_f32 v121, v120, v121
    v_lshlrev_b32 v120, 16, v121
    v_and_b32 v121, 0xffff0000, v121
    v_pk_mul_f32 v[120:121], v[120:121], v[174:175] op_sel_hi:[1,0]
    v_cvt_pk_bf16_f32 v64, v120, v121
    v_pk_add_f32 v[122:123], v[122:123], v[170:171] op_sel_hi:[1,0]
    v_cvt_pk_bf16_f32 v123, v122, v123
    v_lshlrev_b32 v122, 16, v123
    v_and_b32 v123, 0xffff0000, v123
    v_pk_mul_f32 v[122:123], v[122:123], v[174:175] op_sel_hi:[1,0]
    v_cvt_pk_bf16_f32 v65, v122, v123
    v_pk_add_f32 v[124:125], v[124:125], v[170:171] op_sel_hi:[1,0]
    v_cvt_pk_bf16_f32 v125, v124, v125
    v_lshlrev_b32 v124, 16, v125
    v_and_b32 v125, 0xffff0000, v125
    v_pk_mul_f32 v[124:125], v[124:125], v[174:175] op_sel_hi:[1,0]
    v_cvt_pk_bf16_f32 v66, v124, v125
    v_pk_add_f32 v[126:127], v[126:127], v[170:171] op_sel_hi:[1,0]
    v_cvt_pk_bf16_f32 v127, v126, v127
    v_lshlrev_b32 v126, 16, v127
    v_and_b32 v127, 0xffff0000, v127
    v_pk_mul_f32 v[126:127], v[126:127], v[174:175] op_sel_hi:[1,0]
    v_cvt_pk_bf16_f32 v67, v126, v127
    s_add_u32 s59, s58, 16384
    buffer_store_dwordx4 v[64:67], v176, s[20:23], s59 offen sc1
    v_pk_add_f32 v[128:129], v[128:129], v[170:171] op_sel_hi:[1,0]
    v_cvt_pk_bf16_f32 v129, v128, v129
    v_lshlrev_b32 v128, 16, v129
    v_and_b32 v129, 0xffff0000, v129
    v_pk_mul_f32 v[128:129], v[128:129], v[174:175] op_sel_hi:[1,0]
    v_cvt_pk_bf16_f32 v68, v128, v129
    v_pk_add_f32 v[130:131], v[130:131], v[170:171] op_sel_hi:[1,0]
    v_cvt_pk_bf16_f32 v131, v130, v131
    v_lshlrev_b32 v130, 16, v131
    v_and_b32 v131, 0xffff0000, v131
    v_pk_mul_f32 v[130:131], v[130:131], v[174:175] op_sel_hi:[1,0]
    v_cvt_pk_bf16_f32 v69, v130, v131
    v_pk_add_f32 v[132:133], v[132:133], v[170:171] op_sel_hi:[1,0]
    v_cvt_pk_bf16_f32 v133, v132, v133
    v_lshlrev_b32 v132, 16, v133
    v_and_b32 v133, 0xffff0000, v133
    v_pk_mul_f32 v[132:133], v[132:133], v[174:175] op_sel_hi:[1,0]
    v_cvt_pk_bf16_f32 v70, v132, v133
    v_pk_add_f32 v[134:135], v[134:135], v[170:171] op_sel_hi:[1,0]
    v_cvt_pk_bf16_f32 v135, v134, v135
    v_lshlrev_b32 v134, 16, v135
    v_and_b32 v135, 0xffff0000, v135
    v_pk_mul_f32 v[134:135], v[134:135], v[174:175] op_sel_hi:[1,0]
    v_cvt_pk_bf16_f32 v71, v134, v135
    s_add_u32 s59, s58, 20480
    buffer_store_dwordx4 v[68:71], v176, s[20:23], s59 offen sc1
    v_pk_add_f32 v[136:137], v[136:137], v[170:171] op_sel_hi:[1,0]
    v_cvt_pk_bf16_f32 v137, v136, v137
    v_lshlrev_b32 v136, 16, v137
    v_and_b32 v137, 0xffff0000, v137
    v_pk_mul_f32 v[136:137], v[136:137], v[174:175] op_sel_hi:[1,0]
    v_cvt_pk_bf16_f32 v72, v136, v137
    v_pk_add_f32 v[138:139], v[138:139], v[170:171] op_sel_hi:[1,0]
    v_cvt_pk_bf16_f32 v139, v138, v139
    v_lshlrev_b32 v138, 16, v139
    v_and_b32 v139, 0xffff0000, v139
    v_pk_mul_f32 v[138:139], v[138:139], v[174:175] op_sel_hi:[1,0]
    v_cvt_pk_bf16_f32 v73, v138, v139
    v_pk_add_f32 v[140:141], v[140:141], v[170:171] op_sel_hi:[1,0]
    v_cvt_pk_bf16_f32 v141, v140, v141
    v_lshlrev_b32 v140, 16, v141
    v_and_b32 v141, 0xffff0000, v141
    v_pk_mul_f32 v[140:141], v[140:141], v[174:175] op_sel_hi:[1,0]
    v_cvt_pk_bf16_f32 v74, v140, v141
    v_pk_add_f32 v[142:143], v[142:143], v[170:171] op_sel_hi:[1,0]
    v_cvt_pk_bf16_f32 v143, v142, v143
    v_lshlrev_b32 v142, 16, v143
    v_and_b32 v143, 0xffff0000, v143
    v_pk_mul_f32 v[142:143], v[142:143], v[174:175] op_sel_hi:[1,0]
    v_cvt_pk_bf16_f32 v75, v142, v143
    s_add_u32 s59, s58, 24576
    buffer_store_dwordx4 v[72:75], v176, s[20:23], s59 offen sc1
    v_pk_add_f32 v[144:145], v[144:145], v[170:171] op_sel_hi:[1,0]
    v_cvt_pk_bf16_f32 v145, v144, v145
    v_lshlrev_b32 v144, 16, v145
    v_and_b32 v145, 0xffff0000, v145
    v_pk_mul_f32 v[144:145], v[144:145], v[174:175] op_sel_hi:[1,0]
    v_cvt_pk_bf16_f32 v76, v144, v145
    v_pk_add_f32 v[146:147], v[146:147], v[170:171] op_sel_hi:[1,0]
    v_cvt_pk_bf16_f32 v147, v146, v147
    v_lshlrev_b32 v146, 16, v147
    v_and_b32 v147, 0xffff0000, v147
    v_pk_mul_f32 v[146:147], v[146:147], v[174:175] op_sel_hi:[1,0]
    v_cvt_pk_bf16_f32 v77, v146, v147
    v_pk_add_f32 v[148:149], v[148:149], v[170:171] op_sel_hi:[1,0]
    v_cvt_pk_bf16_f32 v149, v148, v149
    v_lshlrev_b32 v148, 16, v149
    v_and_b32 v149, 0xffff0000, v149
    v_pk_mul_f32 v[148:149], v[148:149], v[174:175] op_sel_hi:[1,0]
    v_cvt_pk_bf16_f32 v78, v148, v149
    v_pk_add_f32 v[150:151], v[150:151], v[170:171] op_sel_hi:[1,0]
    v_cvt_pk_bf16_f32 v151, v150, v151
    v_lshlrev_b32 v150, 16, v151
    v_and_b32 v151, 0xffff0000, v151
    v_pk_mul_f32 v[150:151], v[150:151], v[174:175] op_sel_hi:[1,0]
    v_cvt_pk_bf16_f32 v79, v150, v151
    s_add_u32 s59, s58, 28672
    buffer_store_dwordx4 v[76:79], v176, s[20:23], s59 offen sc1
    v_pk_add_f32 v[152:153], v[152:153], v[170:171] op_sel_hi:[1,0]
    v_cvt_pk_bf16_f32 v153, v152, v153
    v_lshlrev_b32 v152, 16, v153
    v_and_b32 v153, 0xffff0000, v153
    v_pk_mul_f32 v[152:153], v[152:153], v[174:175] op_sel_hi:[1,0]
    v_cvt_pk_bf16_f32 v80, v152, v153
    v_pk_add_f32 v[154:155], v[154:155], v[170:171] op_sel_hi:[1,0]
    v_cvt_pk_bf16_f32 v155, v154, v155
    v_lshlrev_b32 v154, 16, v155
    v_and_b32 v155, 0xffff0000, v155
    v_pk_mul_f32 v[154:155], v[154:155], v[174:175] op_sel_hi:[1,0]
    v_cvt_pk_bf16_f32 v81, v154, v155
    v_pk_add_f32 v[156:157], v[156:157], v[170:171] op_sel_hi:[1,0]
    v_cvt_pk_bf16_f32 v157, v156, v157
    v_lshlrev_b32 v156, 16, v157
    v_and_b32 v157, 0xffff0000, v157
    v_pk_mul_f32 v[156:157], v[156:157], v[174:175] op_sel_hi:[1,0]
    v_cvt_pk_bf16_f32 v82, v156, v157
    v_pk_add_f32 v[158:159], v[158:159], v[170:171] op_sel_hi:[1,0]
    v_cvt_pk_bf16_f32 v159, v158, v159
    v_lshlrev_b32 v158, 16, v159
    v_and_b32 v159, 0xffff0000, v159
    v_pk_mul_f32 v[158:159], v[158:159], v[174:175] op_sel_hi:[1,0]
    v_cvt_pk_bf16_f32 v83, v158, v159
    s_add_u32 s59, s58, 32768
    buffer_store_dwordx4 v[80:83], v176, s[20:23], s59 offen sc1
    s_waitcnt vmcnt(0)
    s_lshl_b32 s58, s51, 5
    v_mov_b32 v168, 1
    buffer_atomic_add v168, v232, s[36:39], s58 offen sc0 sc1
    s_lshl_b32 s58, s51, 12
    s_add_u32 s58, s58, 50724864
    v_lshlrev_b32 v169, 7, v0
    v_cmp_gt_u32 vcc, 32, v0
    s_nop 1
    v_cndmask_b32 v169, 2.0, v169, vcc
    s_waitcnt vmcnt(0)
    v_readfirstlane_b32 s59, v168
    s_nop 1
    s_and_b32 s59, s59, 31
    s_cmp_eq_u32 s59, 31
    s_cselect_b32 s58, s58, 0x40000000
    buffer_store_dword v233, v169, s[20:23], s58 offen sc0 sc1
    s_add_u32 m0, s61, 0
    s_add_u32 s59, s56, 0
    buffer_load_dwordx4 v2, s[8:11], s59 offen lds
    s_add_u32 m0, s61, 1024
    s_add_u32 s59, s56, 73728
    buffer_load_dwordx4 v2, s[8:11], s59 offen lds
    s_add_u32 m0, s61, 8192
    s_add_u32 s59, s56, 0
    buffer_load_dwordx4 v3, s[12:15], s59 offen lds
    s_add_u32 m0, s61, 9216
    s_add_u32 s59, s56, 73728
    buffer_load_dwordx4 v3, s[12:15], s59 offen lds
    s_add_u32 m0, s61, 16384
    s_cmp_ge_u32 1, s3
    s_cselect_b32 s59, s4, s56
    s_add_u32 s59, s59, 589824
    buffer_load_dwordx4 v2, s[8:11], s59 offen lds
    s_add_u32 m0, s61, 17408
    s_cmp_ge_u32 1, s3
    s_cselect_b32 s59, s4, s56
    s_add_u32 s59, s59, 663552
    buffer_load_dwordx4 v2, s[8:11], s59 offen lds
    s_add_u32 m0, s61, 24576
    s_cmp_ge_u32 1, s3
    s_cselect_b32 s59, s4, s56
    s_add_u32 s59, s59, 589824
    buffer_load_dwordx4 v3, s[12:15], s59 offen lds
    s_add_u32 m0, s61, 25600
    s_cmp_ge_u32 1, s3
    s_cselect_b32 s59, s4, s56
    s_add_u32 s59, s59, 663552
    buffer_load_dwordx4 v3, s[12:15], s59 offen lds
    v_mov_b32 v192, 0
    s_mov_b32 s58, 0
K2_XPOLL:
    buffer_load_dword v193, v192, s[20:23], s42 offen sc0 sc1
    s_waitcnt vmcnt(0)
    v_cmp_ne_u32 vcc, 1, v193
    s_add_u32 s58, s58, 1
    s_nop 4
    s_cbranch_vccz K2_LNJOIN
    s_sleep 2
    s_cmp_lt_u32 s58, 100000
    s_cbranch_scc1 K2_XPOLL
    s_branch K2_LNJOIN
K2_NOLN:
    s_waitcnt vmcnt(0)
    s_add_u32 m0, s61, 0
    s_add_u32 s59, s56, 0
    buffer_load_dwordx4 v2, s[8:11], s59 offen lds
    s_add_u32 m0, s61, 1024
    s_add_u32 s59, s56, 73728
    buffer_load_dwordx4 v2, s[8:11], s59 offen lds
    s_add_u32 m0, s61, 8192
    s_add_u32 s59, s56, 0
    buffer_load_dwordx4 v3, s[12:15], s59 offen lds
    s_add_u32 m0, s61, 9216
    s_add_u32 s59, s56, 73728
    buffer_load_dwordx4 v3, s[12:15], s59 offen lds
    s_add_u32 m0, s61, 16384
    s_cmp_ge_u32 1, s3
    s_cselect_b32 s59, s4, s56
    s_add_u32 s59, s59, 589824
    buffer_load_dwordx4 v2, s[8:11], s59 offen lds
    s_add_u32 m0, s61, 17408
    s_cmp_ge_u32 1, s3
    s_cselect_b32 s59, s4, s56
    s_add_u32 s59, s59, 663552
    buffer_load_dwordx4 v2, s[8:11], s59 offen lds
    s_add_u32 m0, s61, 24576
    s_cmp_ge_u32 1, s3
    s_cselect_b32 s59, s4, s56
    s_add_u32 s59, s59, 589824
    buffer_load_dwordx4 v3, s[12:15], s59 offen lds
    s_add_u32 m0, s61, 25600
    s_cmp_ge_u32 1, s3
    s_cselect_b32 s59, s4, s56
    s_add_u32 s59, s59, 663552
    buffer_load_dwordx4 v3, s[12:15], s59 offen lds
    s_mul_i32 s57, s53, 147456
    v_subrev_u32 v184, s57, v2
    v_subrev_u32 v185, s57, v3
K2_LNJOIN:
    s_barrier
    s_add_u32 s62, s64, 0
    buffer_load_dwordx4 a[0:3], v1, s[20:23], s62 offen offset:0 sc1
    s_add_u32 s62, s65, 0
    buffer_load_dwordx4 a[4:7], v1, s[20:23], s62 offen offset:0 sc1
    s_add_u32 s62, s64, 0
    buffer_load_dwordx4 a[8:11], v1, s[20:23], s62 offen offset:1024 sc1
    s_add_u32 s62, s65, 0
    buffer_load_dwordx4 a[12:15], v1, s[20:23], s62 offen offset:1024 sc1
    s_add_u32 s62, s64, 0
    buffer_load_dwordx4 a[16:19], v1, s[20:23], s62 offen offset:2048 sc1
    s_add_u32 s62, s65, 0
    buffer_load_dwordx4 a[20:23], v1, s[20:23], s62 offen offset:2048 sc1
    s_add_u32 s62, s64, 0
    buffer_load_dwordx4 a[24:27], v1, s[20:23], s62 offen offset:3072 sc1
    s_add_u32 s62, s65, 0
    buffer_load_dwordx4 a[28:31], v1, s[20:23], s62 offen offset:3072 sc1
    s_cmp_ge_u32 1, s3
    s_cselect_b32 s62, s7, s64
    s_add_u32 s62, s62, 4096
    buffer_load_dwordx4 a[32:35], v1, s[20:23], s62 offen offset:0 sc1
    s_cmp_ge_u32 1, s3
    s_cselect_b32 s62, s78, s65
    s_add_u32 s62, s62, 4096
    buffer_load_dwordx4 a[36:39], v1, s[20:23], s62 offen offset:0 sc1
    s_cmp_ge_u32 1, s3
    s_cselect_b32 s62, s7, s64
    s_add_u32 s62, s62, 4096
    buffer_load_dwordx4 a[40:43], v1, s[20:23], s62 offen offset:1024 sc1
    s_cmp_ge_u32 1, s3
    s_cselect_b32 s62, s78, s65
    s_add_u32 s62, s62, 4096
    buffer_load_dwordx4 a[44:47], v1, s[20:23], s62 offen offset:1024 sc1
    s_cmp_ge_u32 1, s3
    s_cselect_b32 s62, s7, s64
    s_add_u32 s62, s62, 4096
    buffer_load_dwordx4 a[48:51], v1, s[20:23], s62 offen offset:2048 sc1
    s_cmp_ge_u32 1, s3
    s_cselect_b32 s62, s78, s65
    s_add_u32 s62, s62, 4096
    buffer_load_dwordx4 a[52:55], v1, s[20:23], s62 offen offset:2048 sc1
    s_cmp_ge_u32 1, s3
    s_cselect_b32 s62, s7, s64
    s_add_u32 s62, s62, 4096
    buffer_load_dwordx4 a[56:59], v1, s[20:23], s62 offen offset:3072 sc1
    s_cmp_ge_u32 1, s3
    s_cselect_b32 s62, s78, s65
    s_add_u32 s62, s62, 4096
    buffer_load_dwordx4 a[60:63], v1, s[20:23], s62 offen offset:3072 sc1
    s_waitcnt vmcnt(16)
    s_barrier
    ds_read_b64_tr_b16 v[208:209], v5 offset:0
    ds_read_b64_tr_b16 v[210:211], v5 offset:512
    ds_read_b64_tr_b16 v[212:213], v6 offset:0
    ds_read_b64_tr_b16 v[214:215], v6 offset:512
    ds_read_b64_tr_b16 v[216:217], v7 offset:0
    ds_read_b64_tr_b16 v[218:219], v7 offset:512
    ds_read_b64_tr_b16 v[220:221], v8 offset:0
    ds_read_b64_tr_b16 v[222:223], v8 offset:512
    s_waitcnt vmcnt(15) lgkmcnt(6)
    v_mfma_f32_32x32x16_bf16 v[48:63], v[208:211], a[0:3], 0
    ds_read_b64_tr_b16 v[224:225], v5 offset:2048
    s_waitcnt vmcnt(14)
    v_mfma_f32_32x32x16_bf16 v[64:79], v[208:211], a[4:7], 0
    ds_read_b64_tr_b16 v[226:227], v5 offset:2560
    s_add_u32 m0, s61, 32768
    s_cmp_ge_u32 2, s3
    s_cselect_b32 s59, s4, s56
    s_add_u32 s59, s59, 1179648
    buffer_load_dwordx4 v2, s[8:11], s59 offen lds
    s_waitcnt lgkmcnt(6)
    v_mfma_f32_32x32x16_bf16 v[80:95], v[212:215], a[0:3], 0
    ds_read_b64_tr_b16 v[208:209], v6 offset:2048
    v_mfma_f32_32x32x16_bf16 v[96:111], v[212:215], a[4:7], 0
    ds_read_b64_tr_b16 v[210:211], v6 offset:2560
    s_add_u32 m0, s61, 33792
    s_cmp_ge_u32 2, s3
    s_cselect_b32 s59, s4, s56
    s_add_u32 s59, s59, 1253376
    buffer_load_dwordx4 v2, s[8:11], s59 offen lds
    s_waitcnt lgkmcnt(6)
    v_mfma_f32_32x32x16_bf16 v[112:127], v[216:219], a[0:3], 0
    ds_read_b64_tr_b16 v[212:213], v7 offset:2048
    v_mfma_f32_32x32x16_bf16 v[128:143], v[216:219], a[4:7], 0
    ds_read_b64_tr_b16 v[214:215], v7 offset:2560
    s_add_u32 m0, s61, 40960
    s_cmp_ge_u32 2, s3
    s_cselect_b32 s59, s4, s56
    s_add_u32 s59, s59, 1179648
    buffer_load_dwordx4 v3, s[12:15], s59 offen lds
    s_waitcnt lgkmcnt(6)
    v_mfma_f32_32x32x16_bf16 v[144:159], v[220:223], a[0:3], 0
    ds_read_b64_tr_b16 v[216:217], v8 offset:2048
    v_mfma_f32_32x32x16_bf16 v[160:175], v[220:223], a[4:7], 0
    ds_read_b64_tr_b16 v[218:219], v8 offset:2560
    s_add_u32 m0, s61, 41984
    s_cmp_ge_u32 2, s3
    s_cselect_b32 s59, s4, s56
    s_add_u32 s59, s59, 1253376
    buffer_load_dwordx4 v3, s[12:15], s59 offen lds
    s_waitcnt vmcnt(17) lgkmcnt(6)
    v_mfma_f32_32x32x16_bf16 v[48:63], v[224:227], a[8:11], v[48:63]
    ds_read_b64_tr_b16 v[220:221], v5 offset:4096
    v_and_b32 v255, 15, v0
    s_waitcnt vmcnt(16)
    v_mfma_f32_32x32x16_bf16 v[64:79], v[224:227], a[12:15], v[64:79]
    ds_read_b64_tr_b16 v[222:223], v5 offset:4608
    s_waitcnt lgkmcnt(6)
    v_mfma_f32_32x32x16_bf16 v[80:95], v[208:211], a[8:11], v[80:95]
    ds_read_b64_tr_b16 v[224:225], v6 offset:4096
    s_lshl_b32 s77, s50, 4
    v_mfma_f32_32x32x16_bf16 v[96:111], v[208:211], a[12:15], v[96:111]
    ds_read_b64_tr_b16 v[226:227], v6 offset:4608
    s_cmp_ge_u32 2, s3
    s_cselect_b32 s62, s7, s64
    s_add_u32 s62, s62, 8192
    buffer_load_dwordx4 a[64:67], v1, s[20:23], s62 offen offset:0 sc1
    s_waitcnt lgkmcnt(6)
    v_mfma_f32_32x32x16_bf16 v[112:127], v[212:215], a[8:11], v[112:127]
    ds_read_b64_tr_b16 v[208:209], v7 offset:4096
    v_add_u32 v255, s77, v255
    v_mfma_f32_32x32x16_bf16 v[128:143], v[212:215], a[12:15], v[128:143]
    ds_read_b64_tr_b16 v[210:211], v7 offset:4608
    s_cmp_ge_u32 2, s3
    s_cselect_b32 s62, s78, s65
    s_add_u32 s62, s62, 8192
    buffer_load_dwordx4 a[68:71], v1, s[20:23], s62 offen offset:0 sc1
    s_waitcnt lgkmcnt(6)
    v_mfma_f32_32x32x16_bf16 v[144:159], v[216:219], a[8:11], v[144:159]
    ds_read_b64_tr_b16 v[212:213], v8 offset:4096
    v_mfma_f32_32x32x16_bf16 v[160:175], v[216:219], a[12:15], v[160:175]
    ds_read_b64_tr_b16 v[214:215], v8 offset:4608
    s_cmp_ge_u32 2, s3
    s_cselect_b32 s62, s7, s64
    s_add_u32 s62, s62, 8192
    buffer_load_dwordx4 a[72:75], v1, s[20:23], s62 offen offset:1024 sc1
    v_lshlrev_b32 v255, 1, v255
    s_waitcnt vmcnt(18) lgkmcnt(6)
    v_mfma_f32_32x32x16_bf16 v[48:63], v[220:223], a[16:19], v[48:63]
    ds_read_b64_tr_b16 v[216:217], v5 offset:6144
    s_waitcnt vmcnt(17)
    v_mfma_f32_32x32x16_bf16 v[64:79], v[220:223], a[20:23], v[64:79]
    ds_read_b64_tr_b16 v[218:219], v5 offset:6656
    s_cmp_ge_u32 2, s3
    s_cselect_b32 s62, s78, s65
    s_add_u32 s62, s62, 8192
    buffer_load_dwordx4 a[76:79], v1, s[20:23], s62 offen offset:1024 sc1
    s_waitcnt lgkmcnt(6)
    v_mfma_f32_32x32x16_bf16 v[80:95], v[224:227], a[16:19], v[80:95]
    ds_read_b64_tr_b16 v[220:221], v6 offset:6144
    buffer_load_ushort v228, v255, s[24:27], 0 offen
    v_mfma_f32_32x32x16_bf16 v[96:111], v[224:227], a[20:23], v[96:111]
    ds_read_b64_tr_b16 v[222:223], v6 offset:6656
    buffer_load_ushort v229, v255, s[28:31], 0 offen
    s_waitcnt lgkmcnt(6)
    v_mfma_f32_32x32x16_bf16 v[112:127], v[208:211], a[16:19], v[112:127]
    ds_read_b64_tr_b16 v[224:225], v7 offset:6144
    v_mfma_f32_32x32x16_bf16 v[128:143], v[208:211], a[20:23], v[128:143]
    ds_read_b64_tr_b16 v[226:227], v7 offset:6656
    s_cmp_ge_u32 2, s3
    s_cselect_b32 s62, s7, s64
    s_add_u32 s62, s62, 8192
    buffer_load_dwordx4 a[80:83], v1, s[20:23], s62 offen offset:2048 sc1
    s_waitcnt lgkmcnt(6)
    v_mfma_f32_32x32x16_bf16 v[144:159], v[212:215], a[16:19], v[144:159]
    ds_read_b64_tr_b16 v[208:209], v8 offset:6144
    buffer_load_ushort v230, v255, s[32:35], 0 offen
    v_mfma_f32_32x32x16_bf16 v[160:175], v[212:215], a[20:23], v[160:175]
    ds_read_b64_tr_b16 v[210:211], v8 offset:6656
    s_cmp_ge_u32 2, s3
    s_cselect_b32 s62, s78, s65
    s_add_u32 s62, s62, 8192
    buffer_load_dwordx4 a[84:87], v1, s[20:23], s62 offen offset:2048 sc1
    s_waitcnt vmcnt(22) lgkmcnt(6)
    v_mfma_f32_32x32x16_bf16 v[48:63], v[216:219], a[24:27], v[48:63]
    s_barrier
    ds_read_b64_tr_b16 v[212:213], v5 offset:16384
    s_waitcnt vmcnt(21)
    v_mfma_f32_32x32x16_bf16 v[64:79], v[216:219], a[28:31], v[64:79]
    ds_read_b64_tr_b16 v[214:215], v5 offset:16896
    s_cmp_ge_u32 2, s3
    s_cselect_b32 s62, s7, s64
    s_add_u32 s62, s62, 8192
    buffer_load_dwordx4 a[88:91], v1, s[20:23], s62 offen offset:3072 sc1
    s_waitcnt lgkmcnt(6)
    v_mfma_f32_32x32x16_bf16 v[80:95], v[220:223], a[24:27], v[80:95]
    ds_read_b64_tr_b16 v[216:217], v6 offset:16384
    v_mfma_f32_32x32x16_bf16 v[96:111], v[220:223], a[28:31], v[96:111]
    ds_read_b64_tr_b16 v[218:219], v6 offset:16896
    s_cmp_ge_u32 2, s3
    s_cselect_b32 s62, s78, s65
    s_add_u32 s62, s62, 8192
    buffer_load_dwordx4 a[92:95], v1, s[20:23], s62 offen offset:3072 sc1
    s_waitcnt lgkmcnt(6)
    v_mfma_f32_32x32x16_bf16 v[112:127], v[224:227], a[24:27], v[112:127]
    ds_read_b64_tr_b16 v[220:221], v7 offset:16384
    v_mfma_f32_32x32x16_bf16 v[128:143], v[224:227], a[28:31], v[128:143]
    ds_read_b64_tr_b16 v[222:223], v7 offset:16896
    s_waitcnt lgkmcnt(6)
    v_mfma_f32_32x32x16_bf16 v[144:159], v[208:211], a[24:27], v[144:159]
    ds_read_b64_tr_b16 v[224:225], v8 offset:16384
    v_mfma_f32_32x32x16_bf16 v[160:175], v[208:211], a[28:31], v[160:175]
    ds_read_b64_tr_b16 v[226:227], v8 offset:16896
    s_add_u32 m0, s61, 49152
    s_cmp_ge_u32 3, s3
    s_cselect_b32 s59, s4, s56
    s_add_u32 s59, s59, 1769472
    buffer_load_dwordx4 v2, s[8:11], s59 offen lds
    s_waitcnt vmcnt(23) lgkmcnt(6)
    v_mfma_f32_32x32x16_bf16 v[48:63], v[212:215], a[32:35], v[48:63]
    ds_read_b64_tr_b16 v[208:209], v5 offset:18432
    s_waitcnt vmcnt(22)
    v_mfma_f32_32x32x16_bf16 v[64:79], v[212:215], a[36:39], v[64:79]
    ds_read_b64_tr_b16 v[210:211], v5 offset:18944
    s_add_u32 m0, s61, 50176
    s_cmp_ge_u32 3, s3
    s_cselect_b32 s59, s4, s56
    s_add_u32 s59, s59, 1843200
    buffer_load_dwordx4 v2, s[8:11], s59 offen lds
    s_waitcnt lgkmcnt(6)
    v_mfma_f32_32x32x16_bf16 v[80:95], v[216:219], a[32:35], v[80:95]
    ds_read_b64_tr_b16 v[212:213], v6 offset:18432
    v_mfma_f32_32x32x16_bf16 v[96:111], v[216:219], a[36:39], v[96:111]
    ds_read_b64_tr_b16 v[214:215], v6 offset:18944
    s_add_u32 m0, s61, 57344
    s_cmp_ge_u32 3, s3
    s_cselect_b32 s59, s4, s56
    s_add_u32 s59, s59, 1769472
    buffer_load_dwordx4 v3, s[12:15], s59 offen lds
    s_waitcnt lgkmcnt(6)
    v_mfma_f32_32x32x16_bf16 v[112:127], v[220:223], a[32:35], v[112:127]
    ds_read_b64_tr_b16 v[216:217], v7 offset:18432
    v_mfma_f32_32x32x16_bf16 v[128:143], v[220:223], a[36:39], v[128:143]
    ds_read_b64_tr_b16 v[218:219], v7 offset:18944
    s_waitcnt lgkmcnt(6)
    v_mfma_f32_32x32x16_bf16 v[144:159], v[224:227], a[32:35], v[144:159]
    ds_read_b64_tr_b16 v[220:221], v8 offset:18432
    v_mfma_f32_32x32x16_bf16 v[160:175], v[224:227], a[36:39], v[160:175]
    ds_read_b64_tr_b16 v[222:223], v8 offset:18944
    s_add_u32 m0, s61, 58368
    s_cmp_ge_u32 3, s3
    s_cselect_b32 s59, s4, s56
    s_add_u32 s59, s59, 1843200
    buffer_load_dwordx4 v3, s[12:15], s59 offen lds
    s_waitcnt vmcnt(24) lgkmcnt(6)
    v_mfma_f32_32x32x16_bf16 v[48:63], v[208:211], a[40:43], v[48:63]
    ds_read_b64_tr_b16 v[224:225], v5 offset:20480
    s_waitcnt vmcnt(23)
    v_mfma_f32_32x32x16_bf16 v[64:79], v[208:211], a[44:47], v[64:79]
    ds_read_b64_tr_b16 v[226:227], v5 offset:20992
    s_cmp_ge_u32 3, s3
    s_cselect_b32 s62, s7, s64
    s_add_u32 s62, s62, 12288
    buffer_load_dwordx4 a[96:99], v1, s[20:23], s62 offen offset:0 sc1
    s_waitcnt lgkmcnt(6)
    v_mfma_f32_32x32x16_bf16 v[80:95], v[212:215], a[40:43], v[80:95]
    ds_read_b64_tr_b16 v[208:209], v6 offset:20480
    v_mfma_f32_32x32x16_bf16 v[96:111], v[212:215], a[44:47], v[96:111]
    ds_read_b64_tr_b16 v[210:211], v6 offset:20992
    s_cmp_ge_u32 3, s3
    s_cselect_b32 s62, s78, s65
    s_add_u32 s62, s62, 12288
    buffer_load_dwordx4 a[100:103], v1, s[20:23], s62 offen offset:0 sc1
    s_waitcnt lgkmcnt(6)
    v_mfma_f32_32x32x16_bf16 v[112:127], v[216:219], a[40:43], v[112:127]
    ds_read_b64_tr_b16 v[212:213], v7 offset:20480
    v_mfma_f32_32x32x16_bf16 v[128:143], v[216:219], a[44:47], v[128:143]
    ds_read_b64_tr_b16 v[214:215], v7 offset:20992
    s_cmp_ge_u32 3, s3
    s_cselect_b32 s62, s7, s64
    s_add_u32 s62, s62, 12288
    buffer_load_dwordx4 a[104:107], v1, s[20:23], s62 offen offset:1024 sc1
    s_waitcnt lgkmcnt(6)
    v_mfma_f32_32x32x16_bf16 v[144:159], v[220:223], a[40:43], v[144:159]
    ds_read_b64_tr_b16 v[216:217], v8 offset:20480
    v_mfma_f32_32x32x16_bf16 v[160:175], v[220:223], a[44:47], v[160:175]
    ds_read_b64_tr_b16 v[218:219], v8 offset:20992
    s_waitcnt vmcnt(25) lgkmcnt(6)
    v_mfma_f32_32x32x16_bf16 v[48:63], v[224:227], a[48:51], v[48:63]
    ds_read_b64_tr_b16 v[220:221], v5 offset:22528
    s_waitcnt vmcnt(24)
    v_mfma_f32_32x32x16_bf16 v[64:79], v[224:227], a[52:55], v[64:79]
    ds_read_b64_tr_b16 v[222:223], v5 offset:23040
    s_cmp_ge_u32 3, s3
    s_cselect_b32 s62, s78, s65
    s_add_u32 s62, s62, 12288
    buffer_load_dwordx4 a[108:111], v1, s[20:23], s62 offen offset:1024 sc1
    s_waitcnt lgkmcnt(6)
    v_mfma_f32_32x32x16_bf16 v[80:95], v[208:211], a[48:51], v[80:95]
    ds_read_b64_tr_b16 v[224:225], v6 offset:22528
    v_mfma_f32_32x32x16_bf16 v[96:111], v[208:211], a[52:55], v[96:111]
    ds_read_b64_tr_b16 v[226:227], v6 offset:23040
    s_cmp_ge_u32 3, s3
    s_cselect_b32 s62, s7, s64
    s_add_u32 s62, s62, 12288
    buffer_load_dwordx4 a[112:115], v1, s[20:23], s62 offen offset:2048 sc1
    s_waitcnt lgkmcnt(6)
    v_mfma_f32_32x32x16_bf16 v[112:127], v[212:215], a[48:51], v[112:127]
    ds_read_b64_tr_b16 v[208:209], v7 offset:22528
    v_mfma_f32_32x32x16_bf16 v[128:143], v[212:215], a[52:55], v[128:143]
    ds_read_b64_tr_b16 v[210:211], v7 offset:23040
    s_cmp_ge_u32 3, s3
    s_cselect_b32 s62, s78, s65
    s_add_u32 s62, s62, 12288
    buffer_load_dwordx4 a[116:119], v1, s[20:23], s62 offen offset:2048 sc1
    s_waitcnt lgkmcnt(6)
    v_mfma_f32_32x32x16_bf16 v[144:159], v[216:219], a[48:51], v[144:159]
    ds_read_b64_tr_b16 v[212:213], v8 offset:22528
    v_mfma_f32_32x32x16_bf16 v[160:175], v[216:219], a[52:55], v[160:175]
    ds_read_b64_tr_b16 v[214:215], v8 offset:23040
    s_cmp_ge_u32 3, s3
    s_cselect_b32 s62, s7, s64
    s_add_u32 s62, s62, 12288
    buffer_load_dwordx4 a[120:123], v1, s[20:23], s62 offen offset:3072 sc1
    s_waitcnt vmcnt(27) lgkmcnt(6)
    v_mfma_f32_32x32x16_bf16 v[48:63], v[220:223], a[56:59], v[48:63]
    s_waitcnt vmcnt(22)
    s_barrier
    ds_read_b64_tr_b16 v[216:217], v5 offset:32768
    v_mfma_f32_32x32x16_bf16 v[64:79], v[220:223], a[60:63], v[64:79]
    ds_read_b64_tr_b16 v[218:219], v5 offset:33280
    s_waitcnt lgkmcnt(6)
    v_mfma_f32_32x32x16_bf16 v[80:95], v[224:227], a[56:59], v[80:95]
    ds_read_b64_tr_b16 v[220:221], v6 offset:32768
    v_mfma_f32_32x32x16_bf16 v[96:111], v[224:227], a[60:63], v[96:111]
    ds_read_b64_tr_b16 v[222:223], v6 offset:33280
    s_cmp_ge_u32 3, s3
    s_cselect_b32 s62, s78, s65
    s_add_u32 s62, s62, 12288
    buffer_load_dwordx4 a[124:127], v1, s[20:23], s62 offen offset:3072 sc1
    s_waitcnt lgkmcnt(6)
    v_mfma_f32_32x32x16_bf16 v[112:127], v[208:211], a[56:59], v[112:127]
    ds_read_b64_tr_b16 v[224:225], v7 offset:32768
    v_mfma_f32_32x32x16_bf16 v[128:143], v[208:211], a[60:63], v[128:143]
    ds_read_b64_tr_b16 v[226:227], v7 offset:33280
    s_add_u32 m0, s61, 65536
    s_cmp_ge_u32 4, s3
    s_cselect_b32 s59, s4, s56
    s_add_u32 s59, s59, 2359296
    buffer_load_dwordx4 v2, s[8:11], s59 offen lds
    s_waitcnt lgkmcnt(6)
    v_mfma_f32_32x32x16_bf16 v[144:159], v[212:215], a[56:59], v[144:159]
    ds_read_b64_tr_b16 v[208:209], v8 offset:32768
    v_mfma_f32_32x32x16_bf16 v[160:175], v[212:215], a[60:63], v[160:175]
    ds_read_b64_tr_b16 v[210:211], v8 offset:33280
    s_add_u32 m0, s61, 66560
    s_cmp_ge_u32 4, s3
    s_cselect_b32 s59, s4, s56
    s_add_u32 s59, s59, 2433024
    buffer_load_dwordx4 v2, s[8:11], s59 offen lds
    s_waitcnt vmcnt(24) lgkmcnt(6)
    v_mfma_f32_32x32x16_bf16 v[48:63], v[216:219], a[64:67], v[48:63]
    ds_read_b64_tr_b16 v[212:213], v5 offset:34816
    s_waitcnt vmcnt(23)
    v_mfma_f32_32x32x16_bf16 v[64:79], v[216:219], a[68:71], v[64:79]
    ds_read_b64_tr_b16 v[214:215], v5 offset:35328
    s_waitcnt lgkmcnt(6)
    v_mfma_f32_32x32x16_bf16 v[80:95], v[220:223], a[64:67], v[80:95]
    ds_read_b64_tr_b16 v[216:217], v6 offset:34816
    v_mfma_f32_32x32x16_bf16 v[96:111], v[220:223], a[68:71], v[96:111]
    ds_read_b64_tr_b16 v[218:219], v6 offset:35328
    s_add_u32 m0, s61, 73728
    s_cmp_ge_u32 4, s3
    s_cselect_b32 s59, s4, s56
    s_add_u32 s59, s59, 2359296
    buffer_load_dwordx4 v3, s[12:15], s59 offen lds
    s_waitcnt lgkmcnt(6)
    v_mfma_f32_32x32x16_bf16 v[112:127], v[224:227], a[64:67], v[112:127]
    ds_read_b64_tr_b16 v[220:221], v7 offset:34816
    v_mfma_f32_32x32x16_bf16 v[128:143], v[224:227], a[68:71], v[128:143]
    ds_read_b64_tr_b16 v[222:223], v7 offset:35328
    s_add_u32 m0, s61, 74752
    s_cmp_ge_u32 4, s3
    s_cselect_b32 s59, s4, s56
    s_add_u32 s59, s59, 2433024
    buffer_load_dwordx4 v3, s[12:15], s59 offen lds
    s_waitcnt lgkmcnt(6)
    v_mfma_f32_32x32x16_bf16 v[144:159], v[208:211], a[64:67], v[144:159]
    ds_read_b64_tr_b16 v[224:225], v8 offset:34816
    v_mfma_f32_32x32x16_bf16 v[160:175], v[208:211], a[68:71], v[160:175]
    ds_read_b64_tr_b16 v[226:227], v8 offset:35328
    s_cmp_ge_u32 4, s3
    s_cselect_b32 s62, s7, s64
    s_add_u32 s62, s62, 16384
    buffer_load_dwordx4 a[128:131], v1, s[20:23], s62 offen offset:0 sc1
    s_waitcnt vmcnt(25) lgkmcnt(6)
    v_mfma_f32_32x32x16_bf16 v[48:63], v[212:215], a[72:75], v[48:63]
    ds_read_b64_tr_b16 v[208:209], v5 offset:36864
    s_waitcnt vmcnt(24)
    v_mfma_f32_32x32x16_bf16 v[64:79], v[212:215], a[76:79], v[64:79]
    ds_read_b64_tr_b16 v[210:211], v5 offset:37376
    s_cmp_ge_u32 4, s3
    s_cselect_b32 s62, s78, s65
    s_add_u32 s62, s62, 16384
    buffer_load_dwordx4 a[132:135], v1, s[20:23], s62 offen offset:0 sc1
    s_waitcnt lgkmcnt(6)
    v_mfma_f32_32x32x16_bf16 v[80:95], v[216:219], a[72:75], v[80:95]
    ds_read_b64_tr_b16 v[212:213], v6 offset:36864
    v_mfma_f32_32x32x16_bf16 v[96:111], v[216:219], a[76:79], v[96:111]
    ds_read_b64_tr_b16 v[214:215], v6 offset:37376
    s_waitcnt lgkmcnt(6)
    v_mfma_f32_32x32x16_bf16 v[112:127], v[220:223], a[72:75], v[112:127]
    ds_read_b64_tr_b16 v[216:217], v7 offset:36864
    v_mfma_f32_32x32x16_bf16 v[128:143], v[220:223], a[76:79], v[128:143]
    ds_read_b64_tr_b16 v[218:219], v7 offset:37376
    s_cmp_ge_u32 4, s3
    s_cselect_b32 s62, s7, s64
    s_add_u32 s62, s62, 16384
    buffer_load_dwordx4 a[136:139], v1, s[20:23], s62 offen offset:1024 sc1
    s_waitcnt lgkmcnt(6)
    v_mfma_f32_32x32x16_bf16 v[144:159], v[224:227], a[72:75], v[144:159]
    ds_read_b64_tr_b16 v[220:221], v8 offset:36864
    v_mfma_f32_32x32x16_bf16 v[160:175], v[224:227], a[76:79], v[160:175]
    ds_read_b64_tr_b16 v[222:223], v8 offset:37376
    s_cmp_ge_u32 4, s3
    s_cselect_b32 s62, s78, s65
    s_add_u32 s62, s62, 16384
    buffer_load_dwordx4 a[140:143], v1, s[20:23], s62 offen offset:1024 sc1
    s_waitcnt vmcnt(24) lgkmcnt(6)
    v_mfma_f32_32x32x16_bf16 v[48:63], v[208:211], a[80:83], v[48:63]
    ds_read_b64_tr_b16 v[224:225], v5 offset:38912
    s_waitcnt vmcnt(22)
    v_mfma_f32_32x32x16_bf16 v[64:79], v[208:211], a[84:87], v[64:79]
    ds_read_b64_tr_b16 v[226:227], v5 offset:39424
    s_cmp_ge_u32 4, s3
    s_cselect_b32 s62, s7, s64
    s_add_u32 s62, s62, 16384
    buffer_load_dwordx4 a[144:147], v1, s[20:23], s62 offen offset:2048 sc1
    s_waitcnt lgkmcnt(6)
    v_mfma_f32_32x32x16_bf16 v[80:95], v[212:215], a[80:83], v[80:95]
    ds_read_b64_tr_b16 v[208:209], v6 offset:38912
    v_mfma_f32_32x32x16_bf16 v[96:111], v[212:215], a[84:87], v[96:111]
    ds_read_b64_tr_b16 v[210:211], v6 offset:39424
    s_cmp_ge_u32 4, s3
    s_cselect_b32 s62, s78, s65
    s_add_u32 s62, s62, 16384
    buffer_load_dwordx4 a[148:151], v1, s[20:23], s62 offen offset:2048 sc1
    s_waitcnt lgkmcnt(6)
    v_mfma_f32_32x32x16_bf16 v[112:127], v[216:219], a[80:83], v[112:127]
    ds_read_b64_tr_b16 v[212:213], v7 offset:38912
    v_mfma_f32_32x32x16_bf16 v[128:143], v[216:219], a[84:87], v[128:143]
    ds_read_b64_tr_b16 v[214:215], v7 offset:39424
    s_waitcnt lgkmcnt(6)
    v_mfma_f32_32x32x16_bf16 v[144:159], v[220:223], a[80:83], v[144:159]
    ds_read_b64_tr_b16 v[216:217], v8 offset:38912
    v_mfma_f32_32x32x16_bf16 v[160:175], v[220:223], a[84:87], v[160:175]
    ds_read_b64_tr_b16 v[218:219], v8 offset:39424
    s_cmp_ge_u32 4, s3
    s_cselect_b32 s62, s7, s64
    s_add_u32 s62, s62, 16384
    buffer_load_dwordx4 a[152:155], v1, s[20:23], s62 offen offset:3072 sc1
    s_waitcnt vmcnt(24) lgkmcnt(6)
    v_mfma_f32_32x32x16_bf16 v[48:63], v[224:227], a[88:91], v[48:63]
    s_waitcnt vmcnt(19)
    s_barrier
    v_add_u32 v5, 49152, v5
    v_add_u32 v6, 49152, v6
    v_add_u32 v7, 49152, v7
    v_add_u32 v8, 49152, v8
    ds_read_b64_tr_b16 v[220:221], v5 offset:0
    v_mfma_f32_32x32x16_bf16 v[64:79], v[224:227], a[92:95], v[64:79]
    ds_read_b64_tr_b16 v[222:223], v5 offset:512
    s_cmp_ge_u32 4, s3
    s_cselect_b32 s62, s78, s65
    s_add_u32 s62, s62, 16384
    buffer_load_dwordx4 a[156:159], v1, s[20:23], s62 offen offset:3072 sc1
    s_waitcnt lgkmcnt(6)
    v_mfma_f32_32x32x16_bf16 v[80:95], v[208:211], a[88:91], v[80:95]
    ds_read_b64_tr_b16 v[224:225], v6 offset:0
    v_mfma_f32_32x32x16_bf16 v[96:111], v[208:211], a[92:95], v[96:111]
    ds_read_b64_tr_b16 v[226:227], v6 offset:512
    s_add_u32 m0, s61, 0
    s_cmp_ge_u32 5, s3
    s_cselect_b32 s59, s4, s56
    s_add_u32 s59, s59, 2949120
    buffer_load_dwordx4 v2, s[8:11], s59 offen lds
    s_waitcnt lgkmcnt(6)
    v_mfma_f32_32x32x16_bf16 v[112:127], v[212:215], a[88:91], v[112:127]
    ds_read_b64_tr_b16 v[208:209], v7 offset:0
    v_mfma_f32_32x32x16_bf16 v[128:143], v[212:215], a[92:95], v[128:143]
    ds_read_b64_tr_b16 v[210:211], v7 offset:512
    s_add_u32 m0, s61, 1024
    s_cmp_ge_u32 5, s3
    s_cselect_b32 s59, s4, s56
    s_add_u32 s59, s59, 3022848
    buffer_load_dwordx4 v2, s[8:11], s59 offen lds
    s_waitcnt lgkmcnt(6)
    v_mfma_f32_32x32x16_bf16 v[144:159], v[216:219], a[88:91], v[144:159]
    ds_read_b64_tr_b16 v[212:213], v8 offset:0
    v_mfma_f32_32x32x16_bf16 v[160:175], v[216:219], a[92:95], v[160:175]
    ds_read_b64_tr_b16 v[214:215], v8 offset:512
    s_waitcnt vmcnt(21) lgkmcnt(6)
    v_mfma_f32_32x32x16_bf16 v[48:63], v[220:223], a[96:99], v[48:63]
    ds_read_b64_tr_b16 v[216:217], v5 offset:2048
    s_waitcnt vmcnt(20)
    v_mfma_f32_32x32x16_bf16 v[64:79], v[220:223], a[100:103], v[64:79]
    ds_read_b64_tr_b16 v[218:219], v5 offset:2560
    s_add_u32 m0, s61, 8192
    s_cmp_ge_u32 5, s3
    s_cselect_b32 s59, s4, s56
    s_add_u32 s59, s59, 2949120
    buffer_load_dwordx4 v3, s[12:15], s59 offen lds
    s_waitcnt lgkmcnt(6)
    v_mfma_f32_32x32x16_bf16 v[80:95], v[224:227], a[96:99], v[80:95]
    ds_read_b64_tr_b16 v[220:221], v6 offset:2048
    v_mfma_f32_32x32x16_bf16 v[96:111], v[224:227], a[100:103], v[96:111]
    ds_read_b64_tr_b16 v[222:223], v6 offset:2560
    s_add_u32 m0, s61, 9216
    s_cmp_ge_u32 5, s3
    s_cselect_b32 s59, s4, s56
    s_add_u32 s59, s59, 3022848
    buffer_load_dwordx4 v3, s[12:15], s59 offen lds
    s_waitcnt lgkmcnt(6)
    v_mfma_f32_32x32x16_bf16 v[112:127], v[208:211], a[96:99], v[112:127]
    ds_read_b64_tr_b16 v[224:225], v7 offset:2048
    v_mfma_f32_32x32x16_bf16 v[128:143], v[208:211], a[100:103], v[128:143]
    ds_read_b64_tr_b16 v[226:227], v7 offset:2560
    s_cmp_ge_u32 5, s3
    s_cselect_b32 s62, s7, s64
    s_add_u32 s62, s62, 20480
    buffer_load_dwordx4 a[160:163], v1, s[20:23], s62 offen offset:0 sc1
    s_waitcnt lgkmcnt(6)
    v_mfma_f32_32x32x16_bf16 v[144:159], v[212:215], a[96:99], v[144:159]
    ds_read_b64_tr_b16 v[208:209], v8 offset:2048
    v_mfma_f32_32x32x16_bf16 v[160:175], v[212:215], a[100:103], v[160:175]
    ds_read_b64_tr_b16 v[210:211], v8 offset:2560
    s_waitcnt vmcnt(22) lgkmcnt(6)
    v_mfma_f32_32x32x16_bf16 v[48:63], v[216:219], a[104:107], v[48:63]
    ds_read_b64_tr_b16 v[212:213], v5 offset:4096
    s_waitcnt vmcnt(21)
    v_mfma_f32_32x32x16_bf16 v[64:79], v[216:219], a[108:111], v[64:79]
    ds_read_b64_tr_b16 v[214:215], v5 offset:4608
    s_cmp_ge_u32 5, s3
    s_cselect_b32 s62, s78, s65
    s_add_u32 s62, s62, 20480
    buffer_load_dwordx4 a[164:167], v1, s[20:23], s62 offen offset:0 sc1
    s_waitcnt lgkmcnt(6)
    v_mfma_f32_32x32x16_bf16 v[80:95], v[220:223], a[104:107], v[80:95]
    ds_read_b64_tr_b16 v[216:217], v6 offset:4096
    v_mfma_f32_32x32x16_bf16 v[96:111], v[220:223], a[108:111], v[96:111]
    ds_read_b64_tr_b16 v[218:219], v6 offset:4608
    s_cmp_ge_u32 5, s3
    s_cselect_b32 s62, s7, s64
    s_add_u32 s62, s62, 20480
    buffer_load_dwordx4 a[168:171], v1, s[20:23], s62 offen offset:1024 sc1
    s_waitcnt lgkmcnt(6)
    v_mfma_f32_32x32x16_bf16 v[112:127], v[224:227], a[104:107], v[112:127]
    ds_read_b64_tr_b16 v[220:221], v7 offset:4096
    v_mfma_f32_32x32x16_bf16 v[128:143], v[224:227], a[108:111], v[128:143]
    ds_read_b64_tr_b16 v[222:223], v7 offset:4608
    s_cmp_ge_u32 5, s3
    s_cselect_b32 s62, s78, s65
    s_add_u32 s62, s62, 20480
    buffer_load_dwordx4 a[172:175], v1, s[20:23], s62 offen offset:1024 sc1
    s_waitcnt lgkmcnt(6)
    v_mfma_f32_32x32x16_bf16 v[144:159], v[208:211], a[104:107], v[144:159]
    ds_read_b64_tr_b16 v[224:225], v8 offset:4096
    v_lshlrev_b32 v228, 16, v228
    v_mfma_f32_32x32x16_bf16 v[160:175], v[208:211], a[108:111], v[160:175]
    ds_read_b64_tr_b16 v[226:227], v8 offset:4608
    s_cmp_ge_u32 5, s3
    s_cselect_b32 s62, s7, s64
    s_add_u32 s62, s62, 20480
    buffer_load_dwordx4 a[176:179], v1, s[20:23], s62 offen offset:2048 sc1
    s_waitcnt vmcnt(24) lgkmcnt(6)
    v_mfma_f32_32x32x16_bf16 v[48:63], v[212:215], a[112:115], v[48:63]
    ds_read_b64_tr_b16 v[208:209], v5 offset:6144
    s_waitcnt vmcnt(23)
    v_mfma_f32_32x32x16_bf16 v[64:79], v[212:215], a[116:119], v[64:79]
    ds_read_b64_tr_b16 v[210:211], v5 offset:6656
    v_lshlrev_b32 v229, 16, v229
    s_waitcnt lgkmcnt(6)
    v_mfma_f32_32x32x16_bf16 v[80:95], v[216:219], a[112:115], v[80:95]
    ds_read_b64_tr_b16 v[212:213], v6 offset:6144
    v_mfma_f32_32x32x16_bf16 v[96:111], v[216:219], a[116:119], v[96:111]
    ds_read_b64_tr_b16 v[214:215], v6 offset:6656
    s_cmp_ge_u32 5, s3
    s_cselect_b32 s62, s78, s65
    s_add_u32 s62, s62, 20480
    buffer_load_dwordx4 a[180:183], v1, s[20:23], s62 offen offset:2048 sc1
    s_waitcnt lgkmcnt(6)
    v_mfma_f32_32x32x16_bf16 v[112:127], v[220:223], a[112:115], v[112:127]
    ds_read_b64_tr_b16 v[216:217], v7 offset:6144
    v_lshlrev_b32 v230, 16, v230
    v_mfma_f32_32x32x16_bf16 v[128:143], v[220:223], a[116:119], v[128:143]
    ds_read_b64_tr_b16 v[218:219], v7 offset:6656
    s_cmp_ge_u32 5, s3
    s_cselect_b32 s62, s7, s64
    s_add_u32 s62, s62, 20480
    buffer_load_dwordx4 a[184:187], v1, s[20:23], s62 offen offset:3072 sc1
    s_waitcnt lgkmcnt(6)
    v_mfma_f32_32x32x16_bf16 v[144:159], v[224:227], a[112:115], v[144:159]
    ds_read_b64_tr_b16 v[220:221], v8 offset:6144
    v_mfma_f32_32x32x16_bf16 v[160:175], v[224:227], a[116:119], v[160:175]
    ds_read_b64_tr_b16 v[222:223], v8 offset:6656
    s_cmp_ge_u32 5, s3
    s_cselect_b32 s62, s78, s65
    s_add_u32 s62, s62, 20480
    buffer_load_dwordx4 a[188:191], v1, s[20:23], s62 offen offset:3072 sc1
    s_waitcnt vmcnt(25) lgkmcnt(6)
    v_mfma_f32_32x32x16_bf16 v[48:63], v[208:211], a[120:123], v[48:63]
    s_waitcnt vmcnt(20)
    s_barrier
    ds_read_b64_tr_b16 v[224:225], v5 offset:16384
    v_mul_f32 v230, 0x3fb8aa3b, v230
    v_mfma_f32_32x32x16_bf16 v[64:79], v[208:211], a[124:127], v[64:79]
    ds_read_b64_tr_b16 v[226:227], v5 offset:16896
    s_add_u32 m0, s61, 16384
    s_cmp_ge_u32 6, s3
    s_cselect_b32 s59, s4, s56
    s_add_u32 s59, s59, 3538944
    buffer_load_dwordx4 v2, s[8:11], s59 offen lds
    s_waitcnt lgkmcnt(6)
    v_mfma_f32_32x32x16_bf16 v[80:95], v[212:215], a[120:123], v[80:95]
    ds_read_b64_tr_b16 v[208:209], v6 offset:16384
    v_mfma_f32_32x32x16_bf16 v[96:111], v[212:215], a[124:127], v[96:111]
    ds_read_b64_tr_b16 v[210:211], v6 offset:16896
    s_waitcnt lgkmcnt(6)
    v_mfma_f32_32x32x16_bf16 v[112:127], v[216:219], a[120:123], v[112:127]
    ds_read_b64_tr_b16 v[212:213], v7 offset:16384
    v_exp_f32 v230, v230
    v_mfma_f32_32x32x16_bf16 v[128:143], v[216:219], a[124:127], v[128:143]
    ds_read_b64_tr_b16 v[214:215], v7 offset:16896
    s_add_u32 m0, s61, 17408
    s_cmp_ge_u32 6, s3
    s_cselect_b32 s59, s4, s56
    s_add_u32 s59, s59, 3612672
    buffer_load_dwordx4 v2, s[8:11], s59 offen lds
    s_waitcnt lgkmcnt(6)
    v_mfma_f32_32x32x16_bf16 v[144:159], v[220:223], a[120:123], v[144:159]
    ds_read_b64_tr_b16 v[216:217], v8 offset:16384
    v_mfma_f32_32x32x16_bf16 v[160:175], v[220:223], a[124:127], v[160:175]
    ds_read_b64_tr_b16 v[218:219], v8 offset:16896
    s_add_u32 m0, s61, 24576
    s_cmp_ge_u32 6, s3
    s_cselect_b32 s59, s4, s56
    s_add_u32 s59, s59, 3538944
    buffer_load_dwordx4 v3, s[12:15], s59 offen lds
    s_waitcnt vmcnt(22) lgkmcnt(6)
    v_mfma_f32_32x32x16_bf16 v[48:63], v[224:227], a[128:131], v[48:63]
    ds_read_b64_tr_b16 v[220:221], v5 offset:18432
    s_waitcnt vmcnt(21)
    v_mfma_f32_32x32x16_bf16 v[64:79], v[224:227], a[132:135], v[64:79]
    ds_read_b64_tr_b16 v[222:223], v5 offset:18944
    s_add_u32 m0, s61, 25600
    s_cmp_ge_u32 6, s3
    s_cselect_b32 s59, s4, s56
    s_add_u32 s59, s59, 3612672
    buffer_load_dwordx4 v3, s[12:15], s59 offen lds
    s_waitcnt lgkmcnt(6)
    v_mfma_f32_32x32x16_bf16 v[80:95], v[208:211], a[128:131], v[80:95]
    ds_read_b64_tr_b16 v[224:225], v6 offset:18432
    v_cvt_pk_bf16_f32 v230, v230, v230
    v_mfma_f32_32x32x16_bf16 v[96:111], v[208:211], a[132:135], v[96:111]
    ds_read_b64_tr_b16 v[226:227], v6 offset:18944
    s_waitcnt lgkmcnt(6)
    v_mfma_f32_32x32x16_bf16 v[112:127], v[212:215], a[128:131], v[112:127]
    ds_read_b64_tr_b16 v[208:209], v7 offset:18432
    v_lshlrev_b32 v230, 16, v230
    v_mfma_f32_32x32x16_bf16 v[128:143], v[212:215], a[132:135], v[128:143]
    ds_read_b64_tr_b16 v[210:211], v7 offset:18944
    s_cmp_ge_u32 6, s3
    s_cselect_b32 s62, s7, s64
    s_add_u32 s62, s62, 24576
    buffer_load_dwordx4 a[192:195], v1, s[20:23], s62 offen offset:0 sc1
    s_waitcnt lgkmcnt(6)
    v_mfma_f32_32x32x16_bf16 v[144:159], v[216:219], a[128:131], v[144:159]
    ds_read_b64_tr_b16 v[212:213], v8 offset:18432
    v_mul_f32 v231, v230, v229
    v_mfma_f32_32x32x16_bf16 v[160:175], v[216:219], a[132:135], v[160:175]
    ds_read_b64_tr_b16 v[214:215], v8 offset:18944
    s_cmp_ge_u32 6, s3
    s_cselect_b32 s62, s78, s65
    s_add_u32 s62, s62, 24576
    buffer_load_dwordx4 a[196:199], v1, s[20:23], s62 offen offset:0 sc1
    s_waitcnt vmcnt(23) lgkmcnt(6)
    v_mfma_f32_32x32x16_bf16 v[48:63], v[220:223], a[136:139], v[48:63]
    ds_read_b64_tr_b16 v[216:217], v5 offset:20480
    s_waitcnt vmcnt(22)
    v_mfma_f32_32x32x16_bf16 v[64:79], v[220:223], a[140:143], v[64:79]
    ds_read_b64_tr_b16 v[218:219], v5 offset:20992
    s_cmp_ge_u32 6, s3
    s_cselect_b32 s62, s7, s64
    s_add_u32 s62, s62, 24576
    buffer_load_dwordx4 a[200:203], v1, s[20:23], s62 offen offset:1024 sc1
    s_waitcnt lgkmcnt(6)
    v_mfma_f32_32x32x16_bf16 v[80:95], v[224:227], a[136:139], v[80:95]
    ds_read_b64_tr_b16 v[220:221], v6 offset:20480
    v_mul_f32 v230, v230, v228
    v_mfma_f32_32x32x16_bf16 v[96:111], v[224:227], a[140:143], v[96:111]
    ds_read_b64_tr_b16 v[222:223], v6 offset:20992
    s_cmp_ge_u32 6, s3
    s_cselect_b32 s62, s78, s65
    s_add_u32 s62, s62, 24576
    buffer_load_dwordx4 a[204:207], v1, s[20:23], s62 offen offset:1024 sc1
    s_waitcnt lgkmcnt(6)
    v_mfma_f32_32x32x16_bf16 v[112:127], v[208:211], a[136:139], v[112:127]
    ds_read_b64_tr_b16 v[224:225], v7 offset:20480
    v_mfma_f32_32x32x16_bf16 v[128:143], v[208:211], a[140:143], v[128:143]
    ds_read_b64_tr_b16 v[226:227], v7 offset:20992
    v_mul_f32 v231, 0x3e22f983, v231
    s_waitcnt lgkmcnt(6)
    v_mfma_f32_32x32x16_bf16 v[144:159], v[212:215], a[136:139], v[144:159]
    ds_read_b64_tr_b16 v[208:209], v8 offset:20480
    v_mfma_f32_32x32x16_bf16 v[160:175], v[212:215], a[140:143], v[160:175]
    ds_read_b64_tr_b16 v[210:211], v8 offset:20992
    s_cmp_ge_u32 6, s3
    s_cselect_b32 s62, s7, s64
    s_add_u32 s62, s62, 24576
    buffer_load_dwordx4 a[208:211], v1, s[20:23], s62 offen offset:2048 sc1
    s_waitcnt vmcnt(24) lgkmcnt(6)
    v_mfma_f32_32x32x16_bf16 v[48:63], v[216:219], a[144:147], v[48:63]
    ds_read_b64_tr_b16 v[212:213], v5 offset:22528
    v_mul_f32 v230, 0x3fb8aa3b, v230
    s_waitcnt vmcnt(23)
    v_mfma_f32_32x32x16_bf16 v[64:79], v[216:219], a[148:151], v[64:79]
    ds_read_b64_tr_b16 v[214:215], v5 offset:23040
    s_cmp_ge_u32 6, s3
    s_cselect_b32 s62, s78, s65
    s_add_u32 s62, s62, 24576
    buffer_load_dwordx4 a[212:215], v1, s[20:23], s62 offen offset:2048 sc1
    s_waitcnt lgkmcnt(6)
    v_mfma_f32_32x32x16_bf16 v[80:95], v[220:223], a[144:147], v[80:95]
    ds_read_b64_tr_b16 v[216:217], v6 offset:22528
    v_mfma_f32_32x32x16_bf16 v[96:111], v[220:223], a[148:151], v[96:111]
    ds_read_b64_tr_b16 v[218:219], v6 offset:23040
    s_cmp_ge_u32 6, s3
    s_cselect_b32 s62, s7, s64
    s_add_u32 s62, s62, 24576
    buffer_load_dwordx4 a[216:219], v1, s[20:23], s62 offen offset:3072 sc1
    s_waitcnt lgkmcnt(6)
    v_mfma_f32_32x32x16_bf16 v[112:127], v[224:227], a[144:147], v[112:127]
    ds_read_b64_tr_b16 v[220:221], v7 offset:22528
    v_exp_f32 v244, v230
    v_mfma_f32_32x32x16_bf16 v[128:143], v[224:227], a[148:151], v[128:143]
    ds_read_b64_tr_b16 v[222:223], v7 offset:23040
    s_cmp_ge_u32 6, s3
    s_cselect_b32 s62, s78, s65
    s_add_u32 s62, s62, 24576
    buffer_load_dwordx4 a[220:223], v1, s[20:23], s62 offen offset:3072 sc1
    s_waitcnt lgkmcnt(6)
    v_mfma_f32_32x32x16_bf16 v[144:159], v[208:211], a[144:147], v[144:159]
    ds_read_b64_tr_b16 v[224:225], v8 offset:22528
    v_mfma_f32_32x32x16_bf16 v[160:175], v[208:211], a[148:151], v[160:175]
    ds_read_b64_tr_b16 v[226:227], v8 offset:23040
    s_waitcnt vmcnt(25) lgkmcnt(6)
    v_mfma_f32_32x32x16_bf16 v[48:63], v[212:215], a[152:155], v[48:63]
    s_waitcnt vmcnt(20)
    s_barrier
    v_add_u32 v5, 4294918144, v5
    v_add_u32 v6, 4294918144, v6
    v_add_u32 v7, 4294918144, v7
    v_add_u32 v8, 4294918144, v8
    ds_read_b64_tr_b16 v[208:209], v5 offset:0
    v_mfma_f32_32x32x16_bf16 v[64:79], v[212:215], a[156:159], v[64:79]
    ds_read_b64_tr_b16 v[210:211], v5 offset:512
    s_add_u32 m0, s61, 32768
    s_cmp_ge_u32 7, s3
    s_cselect_b32 s59, s4, s56
    s_add_u32 s59, s59, 4128768
    buffer_load_dwordx4 v2, s[8:11], s59 offen lds
    s_waitcnt lgkmcnt(6)
    v_mfma_f32_32x32x16_bf16 v[80:95], v[216:219], a[152:155], v[80:95]
    ds_read_b64_tr_b16 v[212:213], v6 offset:0
    v_fract_f32 v235, v231
    v_mfma_f32_32x32x16_bf16 v[96:111], v[216:219], a[156:159], v[96:111]
    ds_read_b64_tr_b16 v[214:215], v6 offset:512
    s_add_u32 m0, s61, 33792
    s_cmp_ge_u32 7, s3
    s_cselect_b32 s59, s4, s56
    s_add_u32 s59, s59, 4202496
    buffer_load_dwordx4 v2, s[8:11], s59 offen lds
    s_waitcnt lgkmcnt(6)
    v_mfma_f32_32x32x16_bf16 v[112:127], v[220:223], a[152:155], v[112:127]
    ds_read_b64_tr_b16 v[216:217], v7 offset:0
    v_mfma_f32_32x32x16_bf16 v[128:143], v[220:223], a[156:159], v[128:143]
    ds_read_b64_tr_b16 v[218:219], v7 offset:512
    s_add_u32 m0, s61, 40960
    s_cmp_ge_u32 7, s3
    s_cselect_b32 s59, s4, s56
    s_add_u32 s59, s59, 4128768
    buffer_load_dwordx4 v3, s[12:15], s59 offen lds
    s_waitcnt lgkmcnt(6)
    v_mfma_f32_32x32x16_bf16 v[144:159], v[224:227], a[152:155], v[144:159]
    ds_read_b64_tr_b16 v[220:221], v8 offset:0
    v_mfma_f32_32x32x16_bf16 v[160:175], v[224:227], a[156:159], v[160:175]
    ds_read_b64_tr_b16 v[222:223], v8 offset:512
    v_cos_f32 v234, v235
    s_waitcnt vmcnt(22) lgkmcnt(6)
    v_mfma_f32_32x32x16_bf16 v[48:63], v[208:211], a[160:163], v[48:63]
    ds_read_b64_tr_b16 v[224:225], v5 offset:2048
    s_waitcnt vmcnt(21)
    v_mfma_f32_32x32x16_bf16 v[64:79], v[208:211], a[164:167], v[64:79]
    ds_read_b64_tr_b16 v[226:227], v5 offset:2560
    s_add_u32 m0, s61, 41984
    s_cmp_ge_u32 7, s3
    s_cselect_b32 s59, s4, s56
    s_add_u32 s59, s59, 4202496
    buffer_load_dwordx4 v3, s[12:15], s59 offen lds
    s_waitcnt lgkmcnt(6)
    v_mfma_f32_32x32x16_bf16 v[80:95], v[212:215], a[160:163], v[80:95]
    ds_read_b64_tr_b16 v[208:209], v6 offset:2048
    v_mfma_f32_32x32x16_bf16 v[96:111], v[212:215], a[164:167], v[96:111]
    ds_read_b64_tr_b16 v[210:211], v6 offset:2560
    s_cmp_ge_u32 7, s3
    s_cselect_b32 s62, s7, s64
    s_add_u32 s62, s62, 28672
    buffer_load_dwordx4 a[224:227], v1, s[20:23], s62 offen offset:0 sc1
    s_waitcnt lgkmcnt(6)
    v_mfma_f32_32x32x16_bf16 v[112:127], v[216:219], a[160:163], v[112:127]
    ds_read_b64_tr_b16 v[212:213], v7 offset:2048
    v_sin_f32 v235, v235
    v_mfma_f32_32x32x16_bf16 v[128:143], v[216:219], a[164:167], v[128:143]
    ds_read_b64_tr_b16 v[214:215], v7 offset:2560
    s_cmp_ge_u32 7, s3
    s_cselect_b32 s62, s78, s65
    s_add_u32 s62, s62, 28672
    buffer_load_dwordx4 a[228:231], v1, s[20:23], s62 offen offset:0 sc1
    s_waitcnt lgkmcnt(6)
    v_mfma_f32_32x32x16_bf16 v[144:159], v[220:223], a[160:163], v[144:159]
    ds_read_b64_tr_b16 v[216:217], v8 offset:2048
    v_mfma_f32_32x32x16_bf16 v[160:175], v[220:223], a[164:167], v[160:175]
    ds_read_b64_tr_b16 v[218:219], v8 offset:2560
    s_cmp_ge_u32 7, s3
    s_cselect_b32 s62, s7, s64
    s_add_u32 s62, s62, 28672
    buffer_load_dwordx4 a[232:235], v1, s[20:23], s62 offen offset:1024 sc1
    s_waitcnt vmcnt(24) lgkmcnt(6)
    v_mfma_f32_32x32x16_bf16 v[48:63], v[224:227], a[168:171], v[48:63]
    ds_read_b64_tr_b16 v[220:221], v5 offset:4096
    s_waitcnt vmcnt(23)
    v_mfma_f32_32x32x16_bf16 v[64:79], v[224:227], a[172:175], v[64:79]
    ds_read_b64_tr_b16 v[222:223], v5 offset:4608
    v_mul_f32 v234, v244, v234
    s_waitcnt lgkmcnt(6)
    v_mfma_f32_32x32x16_bf16 v[80:95], v[208:211], a[168:171], v[80:95]
    ds_read_b64_tr_b16 v[224:225], v6 offset:4096
    v_mfma_f32_32x32x16_bf16 v[96:111], v[208:211], a[172:175], v[96:111]
    ds_read_b64_tr_b16 v[226:227], v6 offset:4608
    s_cmp_ge_u32 7, s3
    s_cselect_b32 s62, s78, s65
    s_add_u32 s62, s62, 28672
    buffer_load_dwordx4 a[236:239], v1, s[20:23], s62 offen offset:1024 sc1
    s_waitcnt lgkmcnt(6)
    v_mfma_f32_32x32x16_bf16 v[112:127], v[212:215], a[168:171], v[112:127]
    ds_read_b64_tr_b16 v[208:209], v7 offset:4096
    v_mul_f32 v235, v244, v235
    v_mfma_f32_32x32x16_bf16 v[128:143], v[212:215], a[172:175], v[128:143]
    ds_read_b64_tr_b16 v[210:211], v7 offset:4608
    s_cmp_ge_u32 7, s3
    s_cselect_b32 s62, s7, s64
    s_add_u32 s62, s62, 28672
    buffer_load_dwordx4 a[240:243], v1, s[20:23], s62 offen offset:2048 sc1
    s_waitcnt lgkmcnt(6)
    v_mfma_f32_32x32x16_bf16 v[144:159], v[216:219], a[168:171], v[144:159]
    ds_read_b64_tr_b16 v[212:213], v8 offset:4096
    v_mfma_f32_32x32x16_bf16 v[160:175], v[216:219], a[172:175], v[160:175]
    ds_read_b64_tr_b16 v[214:215], v8 offset:4608
    s_cmp_ge_u32 7, s3
    s_cselect_b32 s62, s78, s65
    s_add_u32 s62, s62, 28672
    buffer_load_dwordx4 a[244:247], v1, s[20:23], s62 offen offset:2048 sc1
    v_add_f32 v244, -1.0, v234
    s_waitcnt vmcnt(25) lgkmcnt(6)
    v_mfma_f32_32x32x16_bf16 v[48:63], v[220:223], a[176:179], v[48:63]
    ds_read_b64_tr_b16 v[216:217], v5 offset:6144
    s_waitcnt vmcnt(24)
    v_mfma_f32_32x32x16_bf16 v[64:79], v[220:223], a[180:183], v[64:79]
    ds_read_b64_tr_b16 v[218:219], v5 offset:6656
    s_cmp_ge_u32 7, s3
    s_cselect_b32 s62, s7, s64
    s_add_u32 s62, s62, 28672
    buffer_load_dwordx4 a[248:251], v1, s[20:23], s62 offen offset:3072 sc1
    s_waitcnt lgkmcnt(6)
    v_mfma_f32_32x32x16_bf16 v[80:95], v[224:227], a[176:179], v[80:95]
    ds_read_b64_tr_b16 v[220:221], v6 offset:6144
    v_mul_f32 v245, v228, v228
    v_mfma_f32_32x32x16_bf16 v[96:111], v[224:227], a[180:183], v[96:111]
    ds_read_b64_tr_b16 v[222:223], v6 offset:6656
    s_waitcnt lgkmcnt(6)
    v_mfma_f32_32x32x16_bf16 v[112:127], v[208:211], a[176:179], v[112:127]
    ds_read_b64_tr_b16 v[224:225], v7 offset:6144
    v_fmac_f32 v245, v229, v229
    v_mfma_f32_32x32x16_bf16 v[128:143], v[208:211], a[180:183], v[128:143]
    ds_read_b64_tr_b16 v[226:227], v7 offset:6656
    s_cmp_ge_u32 7, s3
    s_cselect_b32 s62, s78, s65
    s_add_u32 s62, s62, 28672
    buffer_load_dwordx4 a[252:255], v1, s[20:23], s62 offen offset:3072 sc1
    s_waitcnt lgkmcnt(6)
    v_mfma_f32_32x32x16_bf16 v[144:159], v[212:215], a[176:179], v[144:159]
    ds_read_b64_tr_b16 v[208:209], v8 offset:6144
    v_mfma_f32_32x32x16_bf16 v[160:175], v[212:215], a[180:183], v[160:175]
    ds_read_b64_tr_b16 v[210:211], v8 offset:6656
    s_add_u32 m0, s61, 49152
    s_cmp_ge_u32 8, s3
    s_cselect_b32 s59, s4, s56
    s_add_u32 s59, s59, 4718592
    buffer_load_dwordx4 v2, s[8:11], s59 offen lds
    s_waitcnt vmcnt(26) lgkmcnt(6)
    v_mfma_f32_32x32x16_bf16 v[48:63], v[216:219], a[184:187], v[48:63]
    s_waitcnt vmcnt(21)
    s_barrier
    ds_read_b64_tr_b16 v[212:213], v5 offset:16384
    v_mfma_f32_32x32x16_bf16 v[64:79], v[216:219], a[188:191], v[64:79]
    ds_read_b64_tr_b16 v[214:215], v5 offset:16896
    s_add_u32 m0, s61, 50176
    s_cmp_ge_u32 8, s3
    s_cselect_b32 s59, s4, s56
    s_add_u32 s59, s59, 4792320
    buffer_load_dwordx4 v2, s[8:11], s59 offen lds
    s_waitcnt lgkmcnt(6)
    v_mfma_f32_32x32x16_bf16 v[80:95], v[220:223], a[184:187], v[80:95]
    ds_read_b64_tr_b16 v[216:217], v6 offset:16384
    v_rcp_f32 v245, v245
    v_mfma_f32_32x32x16_bf16 v[96:111], v[220:223], a[188:191], v[96:111]
    ds_read_b64_tr_b16 v[218:219], v6 offset:16896
    s_add_u32 m0, s61, 57344
    s_cmp_ge_u32 8, s3
    s_cselect_b32 s59, s4, s56
    s_add_u32 s59, s59, 4718592
    buffer_load_dwordx4 v3, s[12:15], s59 offen lds
    s_waitcnt lgkmcnt(6)
    v_mfma_f32_32x32x16_bf16 v[112:127], v[224:227], a[184:187], v[112:127]
    ds_read_b64_tr_b16 v[220:221], v7 offset:16384
    v_mfma_f32_32x32x16_bf16 v[128:143], v[224:227], a[188:191], v[128:143]
    ds_read_b64_tr_b16 v[222:223], v7 offset:16896
    s_waitcnt lgkmcnt(6)
    v_mfma_f32_32x32x16_bf16 v[144:159], v[208:211], a[184:187], v[144:159]
    ds_read_b64_tr_b16 v[224:225], v8 offset:16384
    v_mul_f32 v236, v244, v228
    v_mfma_f32_32x32x16_bf16 v[160:175], v[208:211], a[188:191], v[160:175]
    ds_read_b64_tr_b16 v[226:227], v8 offset:16896
    s_add_u32 m0, s61, 58368
    s_cmp_ge_u32 8, s3
    s_cselect_b32 s59, s4, s56
    s_add_u32 s59, s59, 4792320
    buffer_load_dwordx4 v3, s[12:15], s59 offen lds
    s_waitcnt vmcnt(23) lgkmcnt(6)
    v_mfma_f32_32x32x16_bf16 v[48:63], v[212:215], a[192:195], v[48:63]
    ds_read_b64_tr_b16 v[208:209], v5 offset:18432
    s_waitcnt vmcnt(22)
    v_mfma_f32_32x32x16_bf16 v[64:79], v[212:215], a[196:199], v[64:79]
    ds_read_b64_tr_b16 v[210:211], v5 offset:18944
    s_cmp_ge_u32 8, s3
    s_cselect_b32 s62, s7, s64
    s_add_u32 s62, s62, 32768
    buffer_load_dwordx4 v[16:19], v1, s[20:23], s62 offen offset:0 sc1
    s_waitcnt lgkmcnt(6)
    v_mfma_f32_32x32x16_bf16 v[80:95], v[216:219], a[192:195], v[80:95]
    ds_read_b64_tr_b16 v[212:213], v6 offset:18432
    v_add_f32 v245, v245, v245
    v_mfma_f32_32x32x16_bf16 v[96:111], v[216:219], a[196:199], v[96:111]
    ds_read_b64_tr_b16 v[214:215], v6 offset:18944
    s_cmp_ge_u32 8, s3
    s_cselect_b32 s62, s78, s65
    s_add_u32 s62, s62, 32768
    buffer_load_dwordx4 v[20:23], v1, s[20:23], s62 offen offset:0 sc1
    s_waitcnt lgkmcnt(6)
    v_mfma_f32_32x32x16_bf16 v[112:127], v[220:223], a[192:195], v[112:127]
    ds_read_b64_tr_b16 v[216:217], v7 offset:18432
    v_mfma_f32_32x32x16_bf16 v[128:143], v[220:223], a[196:199], v[128:143]
    ds_read_b64_tr_b16 v[218:219], v7 offset:18944
    v_fmac_f32 v236, v235, v229
    s_waitcnt lgkmcnt(6)
    v_mfma_f32_32x32x16_bf16 v[144:159], v[224:227], a[192:195], v[144:159]
    ds_read_b64_tr_b16 v[220:221], v8 offset:18432
    v_mfma_f32_32x32x16_bf16 v[160:175], v[224:227], a[196:199], v[160:175]
    ds_read_b64_tr_b16 v[222:223], v8 offset:18944
    s_cmp_ge_u32 8, s3
    s_cselect_b32 s62, s7, s64
    s_add_u32 s62, s62, 32768
    buffer_load_dwordx4 v[24:27], v1, s[20:23], s62 offen offset:1024 sc1
    v_mul_f32 v237, v235, v228
    s_waitcnt vmcnt(24) lgkmcnt(6)
    v_mfma_f32_32x32x16_bf16 v[48:63], v[208:211], a[200:203], v[48:63]
    ds_read_b64_tr_b16 v[224:225], v5 offset:20480
    s_waitcnt vmcnt(23)
    v_mfma_f32_32x32x16_bf16 v[64:79], v[208:211], a[204:207], v[64:79]
    ds_read_b64_tr_b16 v[226:227], v5 offset:20992
    s_cmp_ge_u32 8, s3
    s_cselect_b32 s62, s78, s65
    s_add_u32 s62, s62, 32768
    buffer_load_dwordx4 v[28:31], v1, s[20:23], s62 offen offset:1024 sc1
    s_waitcnt lgkmcnt(6)
    v_mfma_f32_32x32x16_bf16 v[80:95], v[212:215], a[200:203], v[80:95]
    ds_read_b64_tr_b16 v[208:209], v6 offset:20480
    v_fma_f32 v237, -v244, v229, v237
    v_mfma_f32_32x32x16_bf16 v[96:111], v[212:215], a[204:207], v[96:111]
    ds_read_b64_tr_b16 v[210:211], v6 offset:20992
    s_cmp_ge_u32 8, s3
    s_cselect_b32 s62, s7, s64
    s_add_u32 s62, s62, 32768
    buffer_load_dwordx4 v[32:35], v1, s[20:23], s62 offen offset:2048 sc1
    s_waitcnt lgkmcnt(6)
    v_mfma_f32_32x32x16_bf16 v[112:127], v[216:219], a[200:203], v[112:127]
    ds_read_b64_tr_b16 v[212:213], v7 offset:20480
    v_mfma_f32_32x32x16_bf16 v[128:143], v[216:219], a[204:207], v[128:143]
    ds_read_b64_tr_b16 v[214:215], v7 offset:20992
    s_cmp_ge_u32 8, s3
    s_cselect_b32 s62, s78, s65
    s_add_u32 s62, s62, 32768
    buffer_load_dwordx4 v[36:39], v1, s[20:23], s62 offen offset:2048 sc1
    s_waitcnt lgkmcnt(6)
    v_mfma_f32_32x32x16_bf16 v[144:159], v[220:223], a[200:203], v[144:159]
    ds_read_b64_tr_b16 v[216:217], v8 offset:20480
    v_mul_f32 v236, v236, v245
    v_mfma_f32_32x32x16_bf16 v[160:175], v[220:223], a[204:207], v[160:175]
    ds_read_b64_tr_b16 v[218:219], v8 offset:20992
    s_waitcnt vmcnt(25) lgkmcnt(6)
    v_mfma_f32_32x32x16_bf16 v[48:63], v[224:227], a[208:211], v[48:63]
    ds_read_b64_tr_b16 v[220:221], v5 offset:22528
    v_mul_f32 v237, v237, v245
    s_waitcnt vmcnt(24)
    v_mfma_f32_32x32x16_bf16 v[64:79], v[224:227], a[212:215], v[64:79]
    ds_read_b64_tr_b16 v[222:223], v5 offset:23040
    s_cmp_ge_u32 8, s3
    s_cselect_b32 s62, s7, s64
    s_add_u32 s62, s62, 32768
    buffer_load_dwordx4 v[40:43], v1, s[20:23], s62 offen offset:3072 sc1
    s_waitcnt lgkmcnt(6)
    v_mfma_f32_32x32x16_bf16 v[80:95], v[208:211], a[208:211], v[80:95]
    ds_read_b64_tr_b16 v[224:225], v6 offset:22528
    v_mfma_f32_32x32x16_bf16 v[96:111], v[208:211], a[212:215], v[96:111]
    ds_read_b64_tr_b16 v[226:227], v6 offset:23040
    s_cmp_ge_u32 8, s3
    s_cselect_b32 s62, s78, s65
    s_add_u32 s62, s62, 32768
    buffer_load_dwordx4 v[44:47], v1, s[20:23], s62 offen offset:3072 sc1
    v_lshrrev_b32 v254, 4, v0
    s_waitcnt lgkmcnt(6)
    v_mfma_f32_32x32x16_bf16 v[112:127], v[212:215], a[208:211], v[112:127]
    ds_read_b64_tr_b16 v[208:209], v7 offset:22528
    v_mfma_f32_32x32x16_bf16 v[128:143], v[212:215], a[212:215], v[128:143]
    ds_read_b64_tr_b16 v[210:211], v7 offset:23040
    s_add_u32 m0, s60, 0
    s_add_u32 s59, s63, 0
    buffer_load_dwordx4 v252, s[44:47], s59 offen lds
    s_waitcnt lgkmcnt(6)
    v_mfma_f32_32x32x16_bf16 v[144:159], v[216:219], a[208:211], v[144:159]
    ds_read_b64_tr_b16 v[212:213], v8 offset:22528
    v_cvt_f32_u32 v254, v254
    v_mfma_f32_32x32x16_bf16 v[160:175], v[216:219], a[212:215], v[160:175]
    ds_read_b64_tr_b16 v[214:215], v8 offset:23040
    s_add_u32 m0, s61, 81920
    s_add_u32 s59, s56, 128
    buffer_load_dwordx4 v2, s[8:11], s59 offen lds
    s_waitcnt vmcnt(27) lgkmcnt(6)
    v_mfma_f32_32x32x16_bf16 v[48:63], v[220:223], a[216:219], v[48:63]
    s_waitcnt vmcnt(22)
    s_barrier
    ds_read_b64_tr_b16 v[216:217], v5 offset:32768
    v_mfma_f32_32x32x16_bf16 v[64:79], v[220:223], a[220:223], v[64:79]
    ds_read_b64_tr_b16 v[218:219], v5 offset:33280
    s_waitcnt lgkmcnt(6)
    v_mfma_f32_32x32x16_bf16 v[80:95], v[224:227], a[216:219], v[80:95]
    ds_read_b64_tr_b16 v[220:221], v6 offset:32768
    v_and_b32 v253, 7, v0
    v_mfma_f32_32x32x16_bf16 v[96:111], v[224:227], a[220:223], v[96:111]
    ds_read_b64_tr_b16 v[222:223], v6 offset:33280
    s_add_u32 m0, s61, 82944
    s_add_u32 s59, s56, 73856
    buffer_load_dwordx4 v2, s[8:11], s59 offen lds
    v_lshlrev_b32 v253, 5, v253
    s_waitcnt lgkmcnt(6)
    v_mfma_f32_32x32x16_bf16 v[112:127], v[208:211], a[216:219], v[112:127]
    ds_read_b64_tr_b16 v[224:225], v7 offset:32768
    buffer_load_dword v240, v253, s[36:39], 0 offen sc0 sc1
    v_mfma_f32_32x32x16_bf16 v[128:143], v[208:211], a[220:223], v[128:143]
    ds_read_b64_tr_b16 v[226:227], v7 offset:33280
    s_add_u32 m0, s61, 90112
    s_add_u32 s59, s56, 128
    buffer_load_dwordx4 v3, s[12:15], s59 offen lds
    s_waitcnt lgkmcnt(6)
    v_mfma_f32_32x32x16_bf16 v[144:159], v[212:215], a[216:219], v[144:159]
    ds_read_b64_tr_b16 v[208:209], v8 offset:32768
    v_mfma_f32_32x32x16_bf16 v[160:175], v[212:215], a[220:223], v[160:175]
    ds_read_b64_tr_b16 v[210:211], v8 offset:33280
    s_add_u32 m0, s61, 91136
    s_add_u32 s59, s56, 73856
    buffer_load_dwordx4 v3, s[12:15], s59 offen lds
    s_waitcnt vmcnt(25) lgkmcnt(6)
    v_mfma_f32_32x32x16_bf16 v[48:63], v[216:219], a[224:227], v[48:63]
    ds_read_b64_tr_b16 v[212:213], v5 offset:34816
    s_waitcnt vmcnt(24)
    v_mfma_f32_32x32x16_bf16 v[64:79], v[216:219], a[228:231], v[64:79]
    ds_read_b64_tr_b16 v[214:215], v5 offset:35328
    s_waitcnt lgkmcnt(6)
    v_mfma_f32_32x32x16_bf16 v[80:95], v[220:223], a[224:227], v[80:95]
    ds_read_b64_tr_b16 v[216:217], v6 offset:34816
    v_mfma_f32_32x32x16_bf16 v[96:111], v[220:223], a[228:231], v[96:111]
    ds_read_b64_tr_b16 v[218:219], v6 offset:35328
    s_add_u32 m0, s60, 4096
    s_cmp_ge_u32 1, s3
    s_cselect_b32 s59, s6, s63
    s_add_u32 s59, s59, 128
    buffer_load_dwordx4 v252, s[44:47], s59 offen lds
    s_waitcnt lgkmcnt(6)
    v_mfma_f32_32x32x16_bf16 v[112:127], v[224:227], a[224:227], v[112:127]
    ds_read_b64_tr_b16 v[220:221], v7 offset:34816
    v_mfma_f32_32x32x16_bf16 v[128:143], v[224:227], a[228:231], v[128:143]
    ds_read_b64_tr_b16 v[222:223], v7 offset:35328
    s_add_u32 m0, s61, 98304
    s_cmp_ge_u32 1, s3
    s_cselect_b32 s59, s4, s56
    s_add_u32 s59, s59, 589952
    buffer_load_dwordx4 v2, s[8:11], s59 offen lds
    s_waitcnt lgkmcnt(6)
    v_mfma_f32_32x32x16_bf16 v[144:159], v[208:211], a[224:227], v[144:159]
    ds_read_b64_tr_b16 v[224:225], v8 offset:34816
    v_mfma_f32_32x32x16_bf16 v[160:175], v[208:211], a[228:231], v[160:175]
    ds_read_b64_tr_b16 v[226:227], v8 offset:35328
    s_add_u32 m0, s61, 99328
    s_cmp_ge_u32 1, s3
    s_cselect_b32 s59, s4, s56
    s_add_u32 s59, s59, 663680
    buffer_load_dwordx4 v2, s[8:11], s59 offen lds
    s_waitcnt vmcnt(26) lgkmcnt(6)
    v_mfma_f32_32x32x16_bf16 v[48:63], v[212:215], a[232:235], v[48:63]
    ds_read_b64_tr_b16 v[208:209], v5 offset:36864
    s_waitcnt vmcnt(25)
    v_mfma_f32_32x32x16_bf16 v[64:79], v[212:215], a[236:239], v[64:79]
    ds_read_b64_tr_b16 v[210:211], v5 offset:37376
    s_add_u32 m0, s61, 106496
    s_cmp_ge_u32 1, s3
    s_cselect_b32 s59, s4, s56
    s_add_u32 s59, s59, 589952
    buffer_load_dwordx4 v3, s[12:15], s59 offen lds
    s_waitcnt lgkmcnt(6)
    v_mfma_f32_32x32x16_bf16 v[80:95], v[216:219], a[232:235], v[80:95]
    ds_read_b64_tr_b16 v[212:213], v6 offset:36864
    v_mfma_f32_32x32x16_bf16 v[96:111], v[216:219], a[236:239], v[96:111]
    ds_read_b64_tr_b16 v[214:215], v6 offset:37376
    s_waitcnt lgkmcnt(6)
    v_mfma_f32_32x32x16_bf16 v[112:127], v[220:223], a[232:235], v[112:127]
    ds_read_b64_tr_b16 v[216:217], v7 offset:36864
    v_mfma_f32_32x32x16_bf16 v[128:143], v[220:223], a[236:239], v[128:143]
    ds_read_b64_tr_b16 v[218:219], v7 offset:37376
    s_add_u32 m0, s61, 107520
    s_cmp_ge_u32 1, s3
    s_cselect_b32 s59, s4, s56
    s_add_u32 s59, s59, 663680
    buffer_load_dwordx4 v3, s[12:15], s59 offen lds
    s_waitcnt lgkmcnt(6)
    v_mfma_f32_32x32x16_bf16 v[144:159], v[224:227], a[232:235], v[144:159]
    ds_read_b64_tr_b16 v[220:221], v8 offset:36864
    v_mfma_f32_32x32x16_bf16 v[160:175], v[224:227], a[236:239], v[160:175]
    ds_read_b64_tr_b16 v[222:223], v8 offset:37376
    s_add_u32 m0, s60, 8192
    s_cmp_ge_u32 2, s3
    s_cselect_b32 s59, s6, s63
    s_add_u32 s59, s59, 256
    buffer_load_dwordx4 v252, s[44:47], s59 offen lds
    s_waitcnt vmcnt(27) lgkmcnt(6)
    v_mfma_f32_32x32x16_bf16 v[48:63], v[208:211], a[240:243], v[48:63]
    ds_read_b64_tr_b16 v[224:225], v5 offset:38912
    s_waitcnt vmcnt(26)
    v_mfma_f32_32x32x16_bf16 v[64:79], v[208:211], a[244:247], v[64:79]
    ds_read_b64_tr_b16 v[226:227], v5 offset:39424
    s_add_u32 m0, s61, 114688
    s_cmp_ge_u32 2, s3
    s_cselect_b32 s59, s4, s56
    s_add_u32 s59, s59, 1179776
    buffer_load_dwordx4 v2, s[8:11], s59 offen lds
    s_waitcnt lgkmcnt(6)
    v_mfma_f32_32x32x16_bf16 v[80:95], v[212:215], a[240:243], v[80:95]
    ds_read_b64_tr_b16 v[208:209], v6 offset:38912
    v_mfma_f32_32x32x16_bf16 v[96:111], v[212:215], a[244:247], v[96:111]
    ds_read_b64_tr_b16 v[210:211], v6 offset:39424
    s_add_u32 m0, s61, 115712
    s_cmp_ge_u32 2, s3
    s_cselect_b32 s59, s4, s56
    s_add_u32 s59, s59, 1253504
    buffer_load_dwordx4 v2, s[8:11], s59 offen lds
    s_waitcnt lgkmcnt(6)
    v_mfma_f32_32x32x16_bf16 v[112:127], v[216:219], a[240:243], v[112:127]
    ds_read_b64_tr_b16 v[212:213], v7 offset:38912
    v_mfma_f32_32x32x16_bf16 v[128:143], v[216:219], a[244:247], v[128:143]
    ds_read_b64_tr_b16 v[214:215], v7 offset:39424
    s_waitcnt lgkmcnt(6)
    v_mfma_f32_32x32x16_bf16 v[144:159], v[220:223], a[240:243], v[144:159]
    ds_read_b64_tr_b16 v[216:217], v8 offset:38912
    v_mfma_f32_32x32x16_bf16 v[160:175], v[220:223], a[244:247], v[160:175]
    ds_read_b64_tr_b16 v[218:219], v8 offset:39424
    s_add_u32 m0, s61, 122880
    s_cmp_ge_u32 2, s3
    s_cselect_b32 s59, s4, s56
    s_add_u32 s59, s59, 1179776
    buffer_load_dwordx4 v3, s[12:15], s59 offen lds
    s_waitcnt vmcnt(28) lgkmcnt(6)
    v_mfma_f32_32x32x16_bf16 v[48:63], v[224:227], a[248:251], v[48:63]
    s_waitcnt vmcnt(23)
    s_barrier
    v_add_u32 v5, 49152, v5
    v_add_u32 v6, 49152, v6
    v_add_u32 v7, 49152, v7
    v_add_u32 v8, 49152, v8
    ds_read_b64_tr_b16 v[220:221], v5 offset:0
    v_mfma_f32_32x32x16_bf16 v[64:79], v[224:227], a[252:255], v[64:79]
    ds_read_b64_tr_b16 v[222:223], v5 offset:512
    s_add_u32 m0, s61, 123904
    s_cmp_ge_u32 2, s3
    s_cselect_b32 s59, s4, s56
    s_add_u32 s59, s59, 1253504
    buffer_load_dwordx4 v3, s[12:15], s59 offen lds
    s_waitcnt lgkmcnt(6)
    v_mfma_f32_32x32x16_bf16 v[80:95], v[208:211], a[248:251], v[80:95]
    ds_read_b64_tr_b16 v[224:225], v5 offset:2048
    v_mfma_f32_32x32x16_bf16 v[96:111], v[208:211], a[252:255], v[96:111]
    ds_read_b64_tr_b16 v[226:227], v5 offset:2560
    s_add_u32 m0, s60, 12288
    s_cmp_ge_u32 3, s3
    s_cselect_b32 s59, s6, s63
    s_add_u32 s59, s59, 384
    buffer_load_dwordx4 v252, s[44:47], s59 offen lds
    s_waitcnt lgkmcnt(6)
    v_mfma_f32_32x32x16_bf16 v[112:127], v[212:215], a[248:251], v[112:127]
    ds_read_b64_tr_b16 v[208:209], v5 offset:4096
    v_mfma_f32_32x32x16_bf16 v[128:143], v[212:215], a[252:255], v[128:143]
    ds_read_b64_tr_b16 v[210:211], v5 offset:4608
    s_add_u32 m0, s61, 131072
    s_cmp_ge_u32 3, s3
    s_cselect_b32 s59, s4, s56
    s_add_u32 s59, s59, 1769600
    buffer_load_dwordx4 v2, s[8:11], s59 offen lds
    s_waitcnt lgkmcnt(6)
    v_mfma_f32_32x32x16_bf16 v[144:159], v[216:219], a[248:251], v[144:159]
    ds_read_b64_tr_b16 v[212:213], v5 offset:6144
    v_mfma_f32_32x32x16_bf16 v[160:175], v[216:219], a[252:255], v[160:175]
    ds_read_b64_tr_b16 v[214:215], v5 offset:6656
    s_waitcnt vmcnt(25) lgkmcnt(6)
    v_mfma_f32_32x32x16_bf16 v[48:63], v[220:223], v[16:19], v[48:63]
    ds_read_b64_tr_b16 v[216:217], v6 offset:0
    s_waitcnt vmcnt(24)
    v_mfma_f32_32x32x16_bf16 v[64:79], v[220:223], v[20:23], v[64:79]
    ds_read_b64_tr_b16 v[218:219], v6 offset:512
    s_add_u32 m0, s61, 132096
    s_cmp_ge_u32 3, s3
    s_cselect_b32 s59, s4, s56
    s_add_u32 s59, s59, 1843328
    buffer_load_dwordx4 v2, s[8:11], s59 offen lds
    s_waitcnt vmcnt(24) lgkmcnt(6)
    v_mfma_f32_32x32x16_bf16 v[48:63], v[224:227], v[24:27], v[48:63]
    ds_read_b64_tr_b16 v[220:221], v7 offset:0
    s_waitcnt vmcnt(23)
    v_mfma_f32_32x32x16_bf16 v[64:79], v[224:227], v[28:31], v[64:79]
    ds_read_b64_tr_b16 v[222:223], v7 offset:512
    s_add_u32 m0, s61, 139264
    s_cmp_ge_u32 3, s3
    s_cselect_b32 s59, s4, s56
    s_add_u32 s59, s59, 1769600
    buffer_load_dwordx4 v3, s[12:15], s59 offen lds
    s_waitcnt vmcnt(23) lgkmcnt(6)
    v_mfma_f32_32x32x16_bf16 v[48:63], v[208:211], v[32:35], v[48:63]
    ds_read_b64_tr_b16 v[224:225], v8 offset:0
    s_waitcnt vmcnt(16)
    v_max_u32 v240, 1, v240
    v_and_b32 v240, 31, v240
    v_cmp_ne_u32 vcc, 0, v240
    s_nop 4
    s_cbranch_vccnz K2A_SLOW
    v_mfma_f32_32x32x16_bf16 v[64:79], v[208:211], v[36:39], v[64:79]
    ds_read_b64_tr_b16 v[226:227], v8 offset:512
    s_add_u32 m0, s61, 140288
    s_cmp_ge_u32 3, s3
    s_cselect_b32 s59, s4, s56
    s_add_u32 s59, s59, 1843328
    buffer_load_dwordx4 v3, s[12:15], s59 offen lds
K2A_BACK:
    s_waitcnt lgkmcnt(6)
    v_mfma_f32_32x32x16_bf16 v[48:63], v[212:215], v[40:43], v[48:63]
    ds_read_b64_tr_b16 v[208:209], v6 offset:2048
    v_mfma_f32_32x32x16_bf16 v[64:79], v[212:215], v[44:47], v[64:79]
    ds_read_b64_tr_b16 v[210:211], v6 offset:2560
    s_waitcnt lgkmcnt(6)
    v_mfma_f32_32x32x16_bf16 v[80:95], v[216:219], v[16:19], v[80:95]
    ds_read_b64_tr_b16 v[212:213], v7 offset:2048
    v_mfma_f32_32x32x16_bf16 v[96:111], v[216:219], v[20:23], v[96:111]
    ds_read_b64_tr_b16 v[214:215], v7 offset:2560
    s_add_u32 m0, s61, 65536
    s_cmp_ge_u32 4, s3
    s_cselect_b32 s59, s4, s56
    s_add_u32 s59, s59, 2359424
    buffer_load_dwordx4 v2, s[8:11], s59 offen lds
    v_mul_f32 v11, v48, v48
    s_waitcnt lgkmcnt(6)
    v_mfma_f32_32x32x16_bf16 v[112:127], v[220:223], v[16:19], v[112:127]
    ds_read_b64_tr_b16 v[216:217], v8 offset:2048
    v_fma_f32 v11, v11, s70, v10
    v_mul_f32 v11, v48, v11
    v_exp_f32 v11, v11
    v_mul_f32 v56, v48, v56
    v_add_f32 v11, 1.0, v11
    v_rcp_f32 v48, v11
    v_mul_f32 v12, v49, v49
    v_mfma_f32_32x32x16_bf16 v[128:143], v[220:223], v[20:23], v[128:143]
    ds_read_b64_tr_b16 v[218:219], v8 offset:2560
    s_add_u32 m0, s61, 66560
    s_cmp_ge_u32 4, s3
    s_cselect_b32 s59, s4, s56
    s_add_u32 s59, s59, 2433152
    buffer_load_dwordx4 v2, s[8:11], s59 offen lds
    v_fma_f32 v12, v12, s70, v10
    s_waitcnt lgkmcnt(6)
    v_mfma_f32_32x32x16_bf16 v[144:159], v[224:227], v[16:19], v[144:159]
    ds_read_b64_tr_b16 v[220:221], v6 offset:4096
    v_mul_f32 v12, v49, v12
    v_exp_f32 v12, v12
    v_mul_f32 v57, v49, v57
    v_add_f32 v12, 1.0, v12
    v_rcp_f32 v49, v12
    v_mul_f32 v56, v56, v48
    v_mul_f32 v11, v50, v50
    v_mfma_f32_32x32x16_bf16 v[160:175], v[224:227], v[20:23], v[160:175]
    ds_read_b64_tr_b16 v[222:223], v6 offset:4608
    s_add_u32 m0, s61, 73728
    s_cmp_ge_u32 4, s3
    s_cselect_b32 s59, s4, s56
    s_add_u32 s59, s59, 2359424
    buffer_load_dwordx4 v3, s[12:15], s59 offen lds
    v_fma_f32 v11, v11, s70, v10
    s_waitcnt lgkmcnt(6)
    v_mfma_f32_32x32x16_bf16 v[80:95], v[208:211], v[24:27], v[80:95]
    ds_read_b64_tr_b16 v[224:225], v7 offset:4096
    v_mul_f32 v11, v50, v11
    v_exp_f32 v11, v11
    v_mul_f32 v58, v50, v58
    v_add_f32 v11, 1.0, v11
    v_rcp_f32 v50, v11
    v_mul_f32 v57, v57, v49
    v_cvt_pk_bf16_f32 v48, v56, v57
    v_mfma_f32_32x32x16_bf16 v[96:111], v[208:211], v[28:31], v[96:111]
    ds_read_b64_tr_b16 v[226:227], v7 offset:4608
    s_add_u32 m0, s61, 74752
    s_cmp_ge_u32 4, s3
    s_cselect_b32 s59, s4, s56
    s_add_u32 s59, s59, 2433152
    buffer_load_dwordx4 v3, s[12:15], s59 offen lds
    v_mul_f32 v12, v51, v51
    s_waitcnt lgkmcnt(6)
    v_mfma_f32_32x32x16_bf16 v[112:127], v[212:215], v[24:27], v[112:127]
    ds_read_b64_tr_b16 v[208:209], v8 offset:4096
    v_fma_f32 v12, v12, s70, v10
    v_mul_f32 v12, v51, v12
    v_exp_f32 v12, v12
    v_mul_f32 v59, v51, v59
    v_add_f32 v12, 1.0, v12
    v_rcp_f32 v51, v12
    v_mul_f32 v58, v58, v50
    v_mfma_f32_32x32x16_bf16 v[128:143], v[212:215], v[28:31], v[128:143]
    ds_read_b64_tr_b16 v[210:211], v8 offset:4608
    v_mul_f32 v11, v52, v52
    v_fma_f32 v11, v11, s70, v10
    v_mul_f32 v11, v52, v11
    v_exp_f32 v11, v11
    v_mul_f32 v60, v52, v60
    v_add_f32 v11, 1.0, v11
    v_rcp_f32 v52, v11
    v_mul_f32 v59, v59, v51
    s_waitcnt lgkmcnt(6)
    v_mfma_f32_32x32x16_bf16 v[144:159], v[216:219], v[24:27], v[144:159]
    ds_read_b64_tr_b16 v[212:213], v6 offset:6144
    v_cvt_pk_bf16_f32 v49, v58, v59
    v_mul_f32 v12, v53, v53
    v_fma_f32 v12, v12, s70, v10
    v_mul_f32 v12, v53, v12
    v_exp_f32 v12, v12
    v_mul_f32 v61, v53, v61
    v_add_f32 v12, 1.0, v12
    v_mfma_f32_32x32x16_bf16 v[160:175], v[216:219], v[28:31], v[160:175]
    ds_read_b64_tr_b16 v[214:215], v6 offset:6656
    s_add_u32 m0, s61, 0
    s_cmp_ge_u32 5, s3
    s_cselect_b32 s59, s4, s56
    s_add_u32 s59, s59, 2949248
    buffer_load_dwordx4 v2, s[8:11], s59 offen lds
    v_rcp_f32 v53, v12
    s_waitcnt lgkmcnt(6)
    v_mfma_f32_32x32x16_bf16 v[80:95], v[220:223], v[32:35], v[80:95]
    ds_read_b64_tr_b16 v[216:217], v7 offset:6144
    v_mul_f32 v60, v60, v52
    v_mul_f32 v11, v54, v54
    v_fma_f32 v11, v11, s70, v10
    v_mul_f32 v11, v54, v11
    v_exp_f32 v11, v11
    v_mul_f32 v62, v54, v62
    v_add_f32 v11, 1.0, v11
    v_mfma_f32_32x32x16_bf16 v[96:111], v[220:223], v[36:39], v[96:111]
    ds_read_b64_tr_b16 v[218:219], v7 offset:6656
    s_add_u32 m0, s61, 1024
    s_cmp_ge_u32 5, s3
    s_cselect_b32 s59, s4, s56
    s_add_u32 s59, s59, 3022976
    buffer_load_dwordx4 v2, s[8:11], s59 offen lds
    v_rcp_f32 v54, v11
    s_waitcnt lgkmcnt(6)
    v_mfma_f32_32x32x16_bf16 v[112:127], v[224:227], v[32:35], v[112:127]
    ds_read_b64_tr_b16 v[220:221], v8 offset:6144
    v_mul_f32 v61, v61, v53
    v_cvt_pk_bf16_f32 v50, v60, v61
    v_mul_f32 v12, v55, v55
    v_fma_f32 v12, v12, s70, v10
    v_mul_f32 v12, v55, v12
    v_exp_f32 v12, v12
    v_mul_f32 v63, v55, v63
    v_add_f32 v12, 1.0, v12
    v_mfma_f32_32x32x16_bf16 v[128:143], v[224:227], v[36:39], v[128:143]
    ds_read_b64_tr_b16 v[222:223], v8 offset:6656
    s_add_u32 m0, s61, 8192
    s_cmp_ge_u32 5, s3
    s_cselect_b32 s59, s4, s56
    s_add_u32 s59, s59, 2949248
    buffer_load_dwordx4 v3, s[12:15], s59 offen lds
    v_rcp_f32 v55, v12
    s_waitcnt lgkmcnt(6)
    v_mfma_f32_32x32x16_bf16 v[144:159], v[208:211], v[32:35], v[144:159]
    s_waitcnt vmcnt(22)
    s_barrier
    ds_read_b128 v[224:227], v14 offset:0
    v_mul_f32 v62, v62, v54
    s_add_u32 s71, s66, 0
    v_mul_f32 v63, v63, v55
    v_cvt_pk_bf16_f32 v51, v62, v63
    buffer_store_dwordx4 v[48:51], v1, s[20:23], s71 offen sc1
    v_mfma_f32_32x32x16_bf16 v[160:175], v[208:211], v[36:39], v[160:175]
    s_add_u32 m0, s61, 9216
    s_cmp_ge_u32 5, s3
    s_cselect_b32 s59, s4, s56
    s_add_u32 s59, s59, 3022976
    buffer_load_dwordx4 v3, s[12:15], s59 offen lds
    v_mul_f32 v11, v64, v64
    s_waitcnt lgkmcnt(5)
    v_mfma_f32_32x32x16_bf16 v[80:95], v[212:215], v[40:43], v[80:95]
    v_xor_b32 v13, 32, v14
    ds_read_b128 v[208:211], v13 offset:0
    v_fma_f32 v11, v11, s70, v10
    v_mul_f32 v11, v64, v11
    v_exp_f32 v11, v11
    v_mul_f32 v72, v64, v72
    v_add_f32 v11, 1.0, v11
    v_rcp_f32 v64, v11
    v_mfma_f32_32x32x16_bf16 v[96:111], v[212:215], v[44:47], v[96:111]
    v_mul_f32 v12, v65, v65
    v_fma_f32 v12, v12, s70, v10
    v_mul_f32 v12, v65, v12
    v_exp_f32 v12, v12
    v_mul_f32 v73, v65, v73
    v_add_f32 v12, 1.0, v12
    v_rcp_f32 v65, v12
    v_mul_f32 v72, v72, v64
    v_mul_f32 v11, v66, v66
    s_waitcnt lgkmcnt(4)
    v_mfma_f32_32x32x16_bf16 v[112:127], v[216:219], v[40:43], v[112:127]
    v_xor_b32 v13, 64, v14
    ds_read_b128 v[212:215], v13 offset:0
    v_fma_f32 v11, v11, s70, v10
    v_mul_f32 v11, v66, v11
    v_exp_f32 v11, v11
    v_mul_f32 v74, v66, v74
    v_add_f32 v11, 1.0, v11
    v_rcp_f32 v66, v11
    v_mfma_f32_32x32x16_bf16 v[128:143], v[216:219], v[44:47], v[128:143]
    s_add_u32 m0, s61, 16384
    s_cmp_ge_u32 6, s3
    s_cselect_b32 s59, s4, s56
    s_add_u32 s59, s59, 3539072
    buffer_load_dwordx4 v2, s[8:11], s59 offen lds
    v_mul_f32 v73, v73, v65
    s_waitcnt lgkmcnt(3)
    v_mfma_f32_32x32x16_bf16 v[144:159], v[220:223], v[40:43], v[144:159]
    v_xor_b32 v13, 96, v14
    ds_read_b128 v[216:219], v13 offset:0
    v_cvt_pk_bf16_f32 v64, v72, v73
    v_mul_f32 v12, v67, v67
    v_fma_f32 v12, v12, s70, v10
    v_mul_f32 v12, v67, v12
    v_exp_f32 v12, v12
    v_mul_f32 v75, v67, v75
    v_mfma_f32_32x32x16_bf16 v[160:175], v[220:223], v[44:47], v[160:175]
    s_add_u32 m0, s61, 17408
    s_cmp_ge_u32 6, s3
    s_cselect_b32 s59, s4, s56
    s_add_u32 s59, s59, 3612800
    buffer_load_dwordx4 v2, s[8:11], s59 offen lds
    v_add_f32 v12, 1.0, v12
    v_rcp_f32 v67, v12
    s_waitcnt lgkmcnt(3)
    v_mfma_f32_32x32x16_bf16 v[176:191], a[0:3], v[224:227], 0
    ds_read_b64_tr_b16 v[220:221], v5 offset:32768
    v_mul_f32 v74, v74, v66
    v_mul_f32 v11, v68, v68
    v_fma_f32 v11, v11, s70, v10
    v_mul_f32 v11, v68, v11
    v_exp_f32 v11, v11
    v_mul_f32 v76, v68, v76
    v_add_f32 v11, 1.0, v11
    v_mfma_f32_32x32x16_bf16 v[192:207], a[4:7], v[224:227], 0
    ds_read_b64_tr_b16 v[222:223], v5 offset:33280
    s_add_u32 m0, s61, 24576
    s_cmp_ge_u32 6, s3
    s_cselect_b32 s59, s4, s56
    s_add_u32 s59, s59, 3539072
    buffer_load_dwordx4 v3, s[12:15], s59 offen lds
    v_rcp_f32 v68, v11
    s_waitcnt lgkmcnt(4)
    v_mfma_f32_32x32x16_bf16 v[176:191], a[8:11], v[208:211], v[176:191]
    ds_read_b64_tr_b16 v[224:225], v5 offset:34816
    v_mul_f32 v75, v75, v67
    v_cvt_pk_bf16_f32 v65, v74, v75
    v_mul_f32 v12, v69, v69
    v_fma_f32 v12, v12, s70, v10
    v_mul_f32 v12, v69, v12
    v_exp_f32 v12, v12
    v_mul_f32 v77, v69, v77
    v_mfma_f32_32x32x16_bf16 v[192:207], a[12:15], v[208:211], v[192:207]
    ds_read_b64_tr_b16 v[226:227], v5 offset:35328
    s_add_u32 m0, s61, 25600
    s_cmp_ge_u32 6, s3
    s_cselect_b32 s59, s4, s56
    s_add_u32 s59, s59, 3612800
    buffer_load_dwordx4 v3, s[12:15], s59 offen lds
    v_add_f32 v12, 1.0, v12
    s_waitcnt lgkmcnt(5)
    v_mfma_f32_32x32x16_bf16 v[176:191], a[16:19], v[212:215], v[176:191]
    ds_read_b64_tr_b16 v[208:209], v5 offset:36864
    v_rcp_f32 v69, v12
    v_mul_f32 v76, v76, v68
    v_mul_f32 v11, v70, v70
    v_fma_f32 v11, v11, s70, v10
    v_mul_f32 v11, v70, v11
    v_exp_f32 v11, v11
    v_mul_f32 v78, v70, v78
    v_add_f32 v11, 1.0, v11
    v_mfma_f32_32x32x16_bf16 v[192:207], a[20:23], v[212:215], v[192:207]
    ds_read_b64_tr_b16 v[210:211], v5 offset:37376
    v_rcp_f32 v70, v11
    v_mul_f32 v77, v77, v69
    v_cvt_pk_bf16_f32 v66, v76, v77
    v_mul_f32 v12, v71, v71
    v_fma_f32 v12, v12, s70, v10
    v_mul_f32 v12, v71, v12
    v_exp_f32 v12, v12
    s_waitcnt lgkmcnt(6)
    v_mfma_f32_32x32x16_bf16 v[176:191], a[24:27], v[216:219], v[176:191]
    ds_read_b64_tr_b16 v[212:213], v5 offset:38912
    v_mul_f32 v79, v71, v79
    v_add_f32 v12, 1.0, v12
    v_rcp_f32 v71, v12
    v_mul_f32 v78, v78, v70
    s_add_u32 s71, s67, 0
    v_mul_f32 v79, v79, v71
    v_cvt_pk_bf16_f32 v67, v78, v79
    buffer_store_dwordx4 v[64:67], v1, s[20:23], s71 offen sc1
    v_mfma_f32_32x32x16_bf16 v[192:207], a[28:31], v[216:219], v[192:207]
    ds_read_b64_tr_b16 v[214:215], v5 offset:39424
    s_add_u32 m0, s61, 32768
    s_cmp_ge_u32 7, s3
    s_cselect_b32 s59, s4, s56
    s_add_u32 s59, s59, 4128896
    buffer_load_dwordx4 v2, s[8:11], s59 offen lds
    s_waitcnt lgkmcnt(6)
    v_mfma_f32_32x32x16_bf16 v[48:63], v[220:223], a[0:3], 0
    s_waitcnt vmcnt(25)
    s_barrier
    ds_read_b128 v[216:219], v14 offset:4096
    v_mul_f32 v11, v80, v80
    v_fma_f32 v11, v11, s70, v10
    v_mul_f32 v11, v80, v11
    v_mfma_f32_32x32x16_bf16 v[64:79], v[220:223], a[4:7], 0
    s_add_u32 m0, s61, 33792
    s_cmp_ge_u32 7, s3
    s_cselect_b32 s59, s4, s56
    s_add_u32 s59, s59, 4202624
    buffer_load_dwordx4 v2, s[8:11], s59 offen lds
    s_waitcnt lgkmcnt(5)
    v_mfma_f32_32x32x16_bf16 v[48:63], v[224:227], a[8:11], v[48:63]
    v_add_u32 v5, 49152, v5
    v_add_u32 v6, 49152, v6
    v_add_u32 v7, 49152, v7
    v_add_u32 v8, 49152, v8
    ds_read_b64_tr_b16 v[220:221], v5 offset:0
    v_exp_f32 v11, v11
    v_mfma_f32_32x32x16_bf16 v[64:79], v[224:227], a[12:15], v[64:79]
    ds_read_b64_tr_b16 v[222:223], v5 offset:512
    s_add_u32 m0, s61, 40960
    s_cmp_ge_u32 7, s3
    s_cselect_b32 s59, s4, s56
    s_add_u32 s59, s59, 4128896
    buffer_load_dwordx4 v3, s[12:15], s59 offen lds
    s_waitcnt lgkmcnt(5)
    v_mfma_f32_32x32x16_bf16 v[48:63], v[208:211], a[16:19], v[48:63]
    v_xor_b32 v13, 32, v14
    ds_read_b128 v[224:227], v13 offset:4096
    v_mul_f32 v88, v80, v88
    v_add_f32 v11, 1.0, v11
    v_rcp_f32 v80, v11
    v_mfma_f32_32x32x16_bf16 v[64:79], v[208:211], a[20:23], v[64:79]
    s_add_u32 m0, s61, 41984
    s_cmp_ge_u32 7, s3
    s_cselect_b32 s59, s4, s56
    s_add_u32 s59, s59, 4202624
    buffer_load_dwordx4 v3, s[12:15], s59 offen lds
    s_waitcnt lgkmcnt(4)
    v_mfma_f32_32x32x16_bf16 v[48:63], v[212:215], a[24:27], v[48:63]
    ds_read_b64_tr_b16 v[208:209], v5 offset:2048
    v_mul_f32 v12, v81, v81
    v_fma_f32 v12, v12, s70, v10
    v_mul_f32 v12, v81, v12
    v_exp_f32 v12, v12
    v_mfma_f32_32x32x16_bf16 v[64:79], v[212:215], a[28:31], v[64:79]
    ds_read_b64_tr_b16 v[210:211], v5 offset:2560
    v_mul_f32 v89, v81, v89
    v_add_f32 v12, 1.0, v12
    v_rcp_f32 v81, v12
    s_waitcnt lgkmcnt(5)
    v_mfma_f32_32x32x16_bf16 v[176:191], a[32:35], v[216:219], v[176:191]
    v_xor_b32 v13, 64, v14
    ds_read_b128 v[212:215], v13 offset:4096
    v_mul_f32 v88, v88, v80
    v_mul_f32 v11, v82, v82
    v_fma_f32 v11, v11, s70, v10
    v_mul_f32 v11, v82, v11
    v_mfma_f32_32x32x16_bf16 v[192:207], a[36:39], v[216:219], v[192:207]
    s_add_u32 m0, s61, 49152
    s_cmp_ge_u32 8, s3
    s_cselect_b32 s59, s4, s56
    s_add_u32 s59, s59, 4718720
    buffer_load_dwordx4 v2, s[8:11], s59 offen lds
    s_waitcnt lgkmcnt(4)
    v_mfma_f32_32x32x16_bf16 v[48:63], v[220:223], a[32:35], v[48:63]
    ds_read_b64_tr_b16 v[216:217], v5 offset:4096
    v_exp_f32 v11, v11
    v_mul_f32 v90, v82, v90
    v_add_f32 v11, 1.0, v11
    v_rcp_f32 v82, v11
    v_mfma_f32_32x32x16_bf16 v[64:79], v[220:223], a[36:39], v[64:79]
    ds_read_b64_tr_b16 v[218:219], v5 offset:4608
    s_add_u32 m0, s61, 50176
    s_cmp_ge_u32 8, s3
    s_cselect_b32 s59, s4, s56
    s_add_u32 s59, s59, 4792448
    buffer_load_dwordx4 v2, s[8:11], s59 offen lds
    s_waitcnt lgkmcnt(5)
    v_mfma_f32_32x32x16_bf16 v[176:191], a[40:43], v[224:227], v[176:191]
    v_xor_b32 v13, 96, v14
    ds_read_b128 v[220:223], v13 offset:4096
    v_mul_f32 v89, v89, v81
    v_cvt_pk_bf16_f32 v80, v88, v89
    v_mul_f32 v12, v83, v83
    v_mfma_f32_32x32x16_bf16 v[192:207], a[44:47], v[224:227], v[192:207]
    s_add_u32 m0, s61, 57344
    s_cmp_ge_u32 8, s3
    s_cselect_b32 s59, s4, s56
    s_add_u32 s59, s59, 4718720
    buffer_load_dwordx4 v3, s[12:15], s59 offen lds
    v_fma_f32 v12, v12, s70, v10
    s_waitcnt lgkmcnt(4)
    v_mfma_f32_32x32x16_bf16 v[48:63], v[208:211], a[40:43], v[48:63]
    ds_read_b64_tr_b16 v[224:225], v5 offset:6144
    v_mul_f32 v12, v83, v12
    v_exp_f32 v12, v12
    v_mul_f32 v91, v83, v91
    v_mfma_f32_32x32x16_bf16 v[64:79], v[208:211], a[44:47], v[64:79]
    ds_read_b64_tr_b16 v[226:227], v5 offset:6656
    s_add_u32 m0, s61, 58368
    s_cmp_ge_u32 8, s3
    s_cselect_b32 s59, s4, s56
    s_add_u32 s59, s59, 4792448
    buffer_load_dwordx4 v3, s[12:15], s59 offen lds
    v_add_f32 v12, 1.0, v12
    s_waitcnt lgkmcnt(5)
    v_mfma_f32_32x32x16_bf16 v[176:191], a[48:51], v[212:215], v[176:191]
    s_waitcnt vmcnt(27)
    s_barrier
    ds_read_b128 v[208:211], v14 offset:8192
    v_rcp_f32 v83, v12
    v_mfma_f32_32x32x16_bf16 v[192:207], a[52:55], v[212:215], v[192:207]
    s_add_u32 m0, s60, 0
    s_cmp_ge_u32 4, s3
    s_cselect_b32 s59, s6, s63
    s_add_u32 s59, s59, 512
    buffer_load_dwordx4 v252, s[44:47], s59 offen lds
    v_mul_f32 v90, v90, v82
    s_waitcnt lgkmcnt(4)
    v_mfma_f32_32x32x16_bf16 v[48:63], v[216:219], a[48:51], v[48:63]
    ds_read_b64_tr_b16 v[212:213], v5 offset:16384
    v_mul_f32 v11, v84, v84
    v_fma_f32 v11, v11, s70, v10
    v_mul_f32 v11, v84, v11
    v_exp_f32 v11, v11
    v_mfma_f32_32x32x16_bf16 v[64:79], v[216:219], a[52:55], v[64:79]
    ds_read_b64_tr_b16 v[214:215], v5 offset:16896
    v_mul_f32 v92, v84, v92
    v_add_f32 v11, 1.0, v11
    v_rcp_f32 v84, v11
    s_waitcnt lgkmcnt(5)
    v_mfma_f32_32x32x16_bf16 v[176:191], a[56:59], v[220:223], v[176:191]
    v_xor_b32 v13, 32, v14
    ds_read_b128 v[216:219], v13 offset:8192
    v_mul_f32 v91, v91, v83
    v_cvt_pk_bf16_f32 v81, v90, v91
    v_mul_f32 v12, v85, v85
    v_fma_f32 v12, v12, s70, v10
    v_mfma_f32_32x32x16_bf16 v[192:207], a[60:63], v[220:223], v[192:207]
    v_mul_f32 v12, v85, v12
    v_exp_f32 v12, v12
    v_mul_f32 v93, v85, v93
    v_add_f32 v12, 1.0, v12
    s_waitcnt lgkmcnt(4)
    v_mfma_f32_32x32x16_bf16 v[48:63], v[224:227], a[56:59], v[48:63]
    ds_read_b64_tr_b16 v[220:221], v5 offset:18432
    v_rcp_f32 v85, v12
    v_mul_f32 v92, v92, v84
    v_mul_f32 v11, v86, v86
    v_mfma_f32_32x32x16_bf16 v[64:79], v[224:227], a[60:63], v[64:79]
    ds_read_b64_tr_b16 v[222:223], v5 offset:18944
    v_fma_f32 v11, v11, s70, v10
    v_mul_f32 v11, v86, v11
    v_exp_f32 v11, v11
    v_mul_f32 v94, v86, v94
    s_waitcnt lgkmcnt(5)
    v_mfma_f32_32x32x16_bf16 v[176:191], a[64:67], v[208:211], v[176:191]
    v_xor_b32 v13, 64, v14
    ds_read_b128 v[224:227], v13 offset:8192
    v_add_f32 v11, 1.0, v11
    v_rcp_f32 v86, v11
    v_mfma_f32_32x32x16_bf16 v[192:207], a[68:71], v[208:211], v[192:207]
    v_mul_f32 v93, v93, v85
    v_cvt_pk_bf16_f32 v82, v92, v93
    v_mul_f32 v12, v87, v87
    v_fma_f32 v12, v12, s70, v10
    v_mul_f32 v12, v87, v12
    s_waitcnt lgkmcnt(4)
    v_mfma_f32_32x32x16_bf16 v[48:63], v[212:215], a[64:67], v[48:63]
    ds_read_b64_tr_b16 v[208:209], v5 offset:20480
    v_exp_f32 v12, v12
    v_mul_f32 v95, v87, v95
    v_add_f32 v12, 1.0, v12
    v_rcp_f32 v87, v12
    v_mfma_f32_32x32x16_bf16 v[64:79], v[212:215], a[68:71], v[64:79]
    ds_read_b64_tr_b16 v[210:211], v5 offset:20992
    v_mul_f32 v94, v94, v86
    v_mul_f32 v95, v95, v87
    v_cvt_pk_bf16_f32 v83, v94, v95
    v_mul_f32 v11, v96, v96
    s_waitcnt lgkmcnt(5)
    v_mfma_f32_32x32x16_bf16 v[176:191], a[72:75], v[216:219], v[176:191]
    v_xor_b32 v13, 96, v14
    ds_read_b128 v[212:215], v13 offset:8192
    v_fma_f32 v11, v11, s70, v10
    v_mul_f32 v11, v96, v11
    v_exp_f32 v11, v11
    v_mfma_f32_32x32x16_bf16 v[192:207], a[76:79], v[216:219], v[192:207]
    v_mul_f32 v104, v96, v104
    v_add_f32 v11, 1.0, v11
    v_rcp_f32 v96, v11
    s_waitcnt lgkmcnt(4)
    v_mfma_f32_32x32x16_bf16 v[48:63], v[220:223], a[72:75], v[48:63]
    ds_read_b64_tr_b16 v[216:217], v5 offset:22528
    v_mul_f32 v12, v97, v97
    v_fma_f32 v12, v12, s70, v10
    v_mul_f32 v12, v97, v12
    v_exp_f32 v12, v12
    v_mfma_f32_32x32x16_bf16 v[64:79], v[220:223], a[76:79], v[64:79]
    ds_read_b64_tr_b16 v[218:219], v5 offset:23040
    v_mul_f32 v105, v97, v105
    v_add_f32 v12, 1.0, v12
    v_rcp_f32 v97, v12
    s_waitcnt lgkmcnt(5)
    v_mfma_f32_32x32x16_bf16 v[176:191], a[80:83], v[224:227], v[176:191]
    s_waitcnt vmcnt(23)
    s_barrier
    ds_read_b128 v[220:223], v14 offset:12288
    v_mul_f32 v104, v104, v96
    v_mul_f32 v11, v98, v98
    v_fma_f32 v11, v11, s70, v10
    v_mfma_f32_32x32x16_bf16 v[192:207], a[84:87], v[224:227], v[192:207]
    s_add_u32 m0, s60, 4096
    s_cmp_ge_u32 5, s3
    s_cselect_b32 s59, s6, s63
    s_add_u32 s59, s59, 640
    buffer_load_dwordx4 v252, s[44:47], s59 offen lds
    v_mul_f32 v11, v98, v11
    s_waitcnt lgkmcnt(4)
    v_mfma_f32_32x32x16_bf16 v[48:63], v[208:211], a[80:83], v[48:63]
    ds_read_b64_tr_b16 v[224:225], v5 offset:32768
    v_exp_f32 v11, v11
    v_mul_f32 v106, v98, v106
    v_add_f32 v11, 1.0, v11
    v_mfma_f32_32x32x16_bf16 v[64:79], v[208:211], a[84:87], v[64:79]
    ds_read_b64_tr_b16 v[226:227], v5 offset:33280
    v_rcp_f32 v98, v11
    v_mul_f32 v105, v105, v97
    v_cvt_pk_bf16_f32 v96, v104, v105
    v_mul_f32 v12, v99, v99
    s_waitcnt lgkmcnt(5)
    v_mfma_f32_32x32x16_bf16 v[176:191], a[88:91], v[212:215], v[176:191]
    v_xor_b32 v13, 32, v14
    ds_read_b128 v[208:211], v13 offset:12288
    v_fma_f32 v12, v12, s70, v10
    v_mul_f32 v12, v99, v12
    v_exp_f32 v12, v12
    v_mfma_f32_32x32x16_bf16 v[192:207], a[92:95], v[212:215], v[192:207]
    v_mul_f32 v107, v99, v107
    v_add_f32 v12, 1.0, v12
    v_rcp_f32 v99, v12
    v_mul_f32 v106, v106, v98
    s_waitcnt lgkmcnt(4)
    v_mfma_f32_32x32x16_bf16 v[48:63], v[216:219], a[88:91], v[48:63]
    ds_read_b64_tr_b16 v[212:213], v5 offset:34816
    v_mul_f32 v11, v100, v100
    v_fma_f32 v11, v11, s70, v10
    v_mul_f32 v11, v100, v11
    v_exp_f32 v11, v11
    v_mfma_f32_32x32x16_bf16 v[64:79], v[216:219], a[92:95], v[64:79]
    ds_read_b64_tr_b16 v[214:215], v5 offset:35328
    v_mul_f32 v108, v100, v108
    v_add_f32 v11, 1.0, v11
    v_rcp_f32 v100, v11
    s_waitcnt lgkmcnt(5)
    v_mfma_f32_32x32x16_bf16 v[176:191], a[96:99], v[220:223], v[176:191]
    v_xor_b32 v13, 64, v14
    ds_read_b128 v[216:219], v13 offset:12288
    v_mul_f32 v107, v107, v99
    v_cvt_pk_bf16_f32 v97, v106, v107
    v_mul_f32 v12, v101, v101
    v_mfma_f32_32x32x16_bf16 v[192:207], a[100:103], v[220:223], v[192:207]
    v_fma_f32 v12, v12, s70, v10
    v_mul_f32 v12, v101, v12
    v_exp_f32 v12, v12
    v_mul_f32 v109, v101, v109
    s_waitcnt lgkmcnt(4)
    v_mfma_f32_32x32x16_bf16 v[48:63], v[224:227], a[96:99], v[48:63]
    ds_read_b64_tr_b16 v[220:221], v5 offset:36864
    v_add_f32 v12, 1.0, v12
    v_rcp_f32 v101, v12
    v_mul_f32 v108, v108, v100
    v_mul_f32 v11, v102, v102
    v_mfma_f32_32x32x16_bf16 v[64:79], v[224:227], a[100:103], v[64:79]
    ds_read_b64_tr_b16 v[222:223], v5 offset:37376
    v_fma_f32 v11, v11, s70, v10
    v_mul_f32 v11, v102, v11
    v_exp_f32 v11, v11
    s_waitcnt lgkmcnt(5)
    v_mfma_f32_32x32x16_bf16 v[176:191], a[104:107], v[208:211], v[176:191]
    v_xor_b32 v13, 96, v14
    ds_read_b128 v[224:227], v13 offset:12288
    v_mul_f32 v110, v102, v110
    v_add_f32 v11, 1.0, v11
    v_rcp_f32 v102, v11
    v_mfma_f32_32x32x16_bf16 v[192:207], a[108:111], v[208:211], v[192:207]
    v_mul_f32 v109, v109, v101
    v_cvt_pk_bf16_f32 v98, v108, v109
    v_mul_f32 v12, v103, v103
    v_fma_f32 v12, v12, s70, v10
    v_mul_f32 v12, v103, v12
    s_waitcnt lgkmcnt(4)
    v_mfma_f32_32x32x16_bf16 v[48:63], v[212:215], a[104:107], v[48:63]
    ds_read_b64_tr_b16 v[208:209], v5 offset:38912
    v_exp_f32 v12, v12
    v_mul_f32 v111, v103, v111
    v_add_f32 v12, 1.0, v12
    v_mfma_f32_32x32x16_bf16 v[64:79], v[212:215], a[108:111], v[64:79]
    ds_read_b64_tr_b16 v[210:211], v5 offset:39424
    v_rcp_f32 v103, v12
    v_mul_f32 v110, v110, v102
    v_mul_f32 v111, v111, v103
    v_cvt_pk_bf16_f32 v99, v110, v111
    s_waitcnt lgkmcnt(5)
    v_mfma_f32_32x32x16_bf16 v[176:191], a[112:115], v[216:219], v[176:191]
    s_waitcnt vmcnt(1)
    s_barrier
    ds_read_b128 v[212:215], v14 offset:0
    v_mul_f32 v11, v112, v112
    v_fma_f32 v11, v11, s70, v10
    v_mul_f32 v11, v112, v11
    v_mfma_f32_32x32x16_bf16 v[192:207], a[116:119], v[216:219], v[192:207]
    s_add_u32 m0, s60, 8192
    s_cmp_ge_u32 6, s3
    s_cselect_b32 s59, s6, s63
    s_add_u32 s59, s59, 768
    buffer_load_dwordx4 v252, s[44:47], s59 offen lds
    s_waitcnt lgkmcnt(4)
    v_mfma_f32_32x32x16_bf16 v[48:63], v[220:223], a[112:115], v[48:63]
    v_add_u32 v5, 4294918144, v5
    v_add_u32 v6, 4294918144, v6
    v_add_u32 v7, 4294918144, v7
    v_add_u32 v8, 4294918144, v8
    ds_read_b64_tr_b16 v[216:217], v5 offset:16384
    v_exp_f32 v11, v11
    v_mfma_f32_32x32x16_bf16 v[64:79], v[220:223], a[116:119], v[64:79]
    ds_read_b64_tr_b16 v[218:219], v5 offset:16896
    v_mul_f32 v120, v112, v120
    v_add_f32 v11, 1.0, v11
    v_rcp_f32 v112, v11
    s_waitcnt lgkmcnt(5)
    v_mfma_f32_32x32x16_bf16 v[176:191], a[120:123], v[224:227], v[176:191]
    v_xor_b32 v13, 32, v14
    ds_read_b128 v[220:223], v13 offset:0
    v_mul_f32 v12, v113, v113
    v_fma_f32 v12, v12, s70, v10
    v_mul_f32 v12, v113, v12
    v_mfma_f32_32x32x16_bf16 v[192:207], a[124:127], v[224:227], v[192:207]
    v_exp_f32 v12, v12
    v_mul_f32 v121, v113, v121
    v_add_f32 v12, 1.0, v12
    v_rcp_f32 v113, v12
    s_waitcnt lgkmcnt(4)
    v_mfma_f32_32x32x16_bf16 v[48:63], v[208:211], a[120:123], v[48:63]
    ds_read_b64_tr_b16 v[224:225], v5 offset:18432
    v_mul_f32 v120, v120, v112
    v_mul_f32 v11, v114, v114
    v_fma_f32 v11, v11, s70, v10
    v_mul_f32 v11, v114, v11
    v_mfma_f32_32x32x16_bf16 v[64:79], v[208:211], a[124:127], v[64:79]
    ds_read_b64_tr_b16 v[226:227], v5 offset:18944
    v_exp_f32 v11, v11
    v_mul_f32 v122, v114, v122
    v_add_f32 v11, 1.0, v11
    s_waitcnt lgkmcnt(5)
    v_mfma_f32_32x32x16_bf16 v[176:191], a[128:131], v[212:215], v[176:191]
    v_xor_b32 v13, 64, v14
    ds_read_b128 v[208:211], v13 offset:0
    v_rcp_f32 v114, v11
    v_mul_f32 v121, v121, v113
    v_cvt_pk_bf16_f32 v112, v120, v121
    v_mfma_f32_32x32x16_bf16 v[192:207], a[132:135], v[212:215], v[192:207]
    v_mul_f32 v12, v115, v115
    v_fma_f32 v12, v12, s70, v10
    v_mul_f32 v12, v115, v12
    v_exp_f32 v12, v12
    s_waitcnt lgkmcnt(4)
    v_mfma_f32_32x32x16_bf16 v[48:63], v[216:219], a[128:131], v[48:63]
    ds_read_b64_tr_b16 v[212:213], v5 offset:20480
    v_mul_f32 v123, v115, v123
    v_add_f32 v12, 1.0, v12
    v_rcp_f32 v115, v12
    v_mul_f32 v122, v122, v114
    v_mfma_f32_32x32x16_bf16 v[64:79], v[216:219], a[132:135], v[64:79]
    ds_read_b64_tr_b16 v[214:215], v5 offset:20992
    v_mul_f32 v11, v116, v116
    v_fma_f32 v11, v11, s70, v10
    v_mul_f32 v11, v116, v11
    v_exp_f32 v11, v11
    s_waitcnt lgkmcnt(5)
    v_mfma_f32_32x32x16_bf16 v[176:191], a[136:139], v[220:223], v[176:191]
    v_xor_b32 v13, 96, v14
    ds_read_b128 v[216:219], v13 offset:0
    v_mul_f32 v124, v116, v124
    v_add_f32 v11, 1.0, v11
    v_mfma_f32_32x32x16_bf16 v[192:207], a[140:143], v[220:223], v[192:207]
    v_rcp_f32 v116, v11
    v_mul_f32 v123, v123, v115
    v_cvt_pk_bf16_f32 v113, v122, v123
    v_mul_f32 v12, v117, v117
    v_fma_f32 v12, v12, s70, v10
    s_waitcnt lgkmcnt(4)
    v_mfma_f32_32x32x16_bf16 v[48:63], v[224:227], a[136:139], v[48:63]
    ds_read_b64_tr_b16 v[220:221], v5 offset:22528
    v_mul_f32 v12, v117, v12
    v_exp_f32 v12, v12
    v_mul_f32 v125, v117, v125
    v_mfma_f32_32x32x16_bf16 v[64:79], v[224:227], a[140:143], v[64:79]
    ds_read_b64_tr_b16 v[222:223], v5 offset:23040
    v_add_f32 v12, 1.0, v12
    v_rcp_f32 v117, v12
    v_mul_f32 v124, v124, v116
    v_mul_f32 v11, v118, v118
    s_waitcnt lgkmcnt(5)
    v_mfma_f32_32x32x16_bf16 v[176:191], a[144:147], v[208:211], v[176:191]
    s_waitcnt vmcnt(1)
    s_barrier
    ds_read_b128 v[224:227], v14 offset:4096
    v_fma_f32 v11, v11, s70, v10
    v_mul_f32 v11, v118, v11
    v_mfma_f32_32x32x16_bf16 v[192:207], a[148:151], v[208:211], v[192:207]
    s_add_u32 m0, s60, 12288
    s_cmp_ge_u32 7, s3
    s_cselect_b32 s59, s6, s63
    s_add_u32 s59, s59, 896
    buffer_load_dwordx4 v252, s[44:47], s59 offen lds
    v_exp_f32 v11, v11
    s_waitcnt lgkmcnt(4)
    v_mfma_f32_32x32x16_bf16 v[48:63], v[212:215], a[144:147], v[48:63]
    v_add_u32 v5, 4294918144, v5
    v_add_u32 v6, 4294918144, v6
    v_add_u32 v7, 4294918144, v7
    v_add_u32 v8, 4294918144, v8
    ds_read_b64_tr_b16 v[208:209], v5 offset:0
    v_mfma_f32_32x32x16_bf16 v[64:79], v[212:215], a[148:151], v[64:79]
    ds_read_b64_tr_b16 v[210:211], v5 offset:512
    v_mul_f32 v126, v118, v126
    v_add_f32 v11, 1.0, v11
    v_rcp_f32 v118, v11
    v_mul_f32 v125, v125, v117
    s_waitcnt lgkmcnt(5)
    v_mfma_f32_32x32x16_bf16 v[176:191], a[152:155], v[216:219], v[176:191]
    v_xor_b32 v13, 32, v14
    ds_read_b128 v[212:215], v13 offset:4096
    v_cvt_pk_bf16_f32 v114, v124, v125
    v_mul_f32 v12, v119, v119
    v_fma_f32 v12, v12, s70, v10
    v_mfma_f32_32x32x16_bf16 v[192:207], a[156:159], v[216:219], v[192:207]
    v_mul_f32 v12, v119, v12
    v_exp_f32 v12, v12
    v_mul_f32 v127, v119, v127
    v_add_f32 v12, 1.0, v12
    s_waitcnt lgkmcnt(4)
    v_mfma_f32_32x32x16_bf16 v[48:63], v[220:223], a[152:155], v[48:63]
    ds_read_b64_tr_b16 v[216:217], v5 offset:2048
    v_rcp_f32 v119, v12
    v_mul_f32 v126, v126, v118
    v_mul_f32 v127, v127, v119
    v_cvt_pk_bf16_f32 v115, v126, v127
    v_mfma_f32_32x32x16_bf16 v[64:79], v[220:223], a[156:159], v[64:79]
    ds_read_b64_tr_b16 v[218:219], v5 offset:2560
    v_mul_f32 v11, v128, v128
    v_fma_f32 v11, v11, s70, v10
    v_mul_f32 v11, v128, v11
    v_exp_f32 v11, v11
    s_waitcnt lgkmcnt(5)
    v_mfma_f32_32x32x16_bf16 v[176:191], a[160:163], v[224:227], v[176:191]
    v_xor_b32 v13, 64, v14
    ds_read_b128 v[220:223], v13 offset:4096
    v_mul_f32 v136, v128, v136
    v_add_f32 v11, 1.0, v11
    v_mfma_f32_32x32x16_bf16 v[192:207], a[164:167], v[224:227], v[192:207]
    v_rcp_f32 v128, v11
    v_mul_f32 v12, v129, v129
    v_fma_f32 v12, v12, s70, v10
    v_mul_f32 v12, v129, v12
    v_exp_f32 v12, v12
    s_waitcnt lgkmcnt(4)
    v_mfma_f32_32x32x16_bf16 v[48:63], v[208:211], a[160:163], v[48:63]
    ds_read_b64_tr_b16 v[224:225], v5 offset:4096
    v_mul_f32 v137, v129, v137
    v_add_f32 v12, 1.0, v12
    v_rcp_f32 v129, v12
    v_mfma_f32_32x32x16_bf16 v[64:79], v[208:211], a[164:167], v[64:79]
    ds_read_b64_tr_b16 v[226:227], v5 offset:4608
    v_mul_f32 v136, v136, v128
    v_mul_f32 v11, v130, v130
    v_fma_f32 v11, v11, s70, v10
    v_mul_f32 v11, v130, v11
    s_waitcnt lgkmcnt(5)
    v_mfma_f32_32x32x16_bf16 v[176:191], a[168:171], v[212:215], v[176:191]
    v_xor_b32 v13, 96, v14
    ds_read_b128 v[208:211], v13 offset:4096
    v_exp_f32 v11, v11
    v_mul_f32 v138, v130, v138
    v_add_f32 v11, 1.0, v11
    v_mfma_f32_32x32x16_bf16 v[192:207], a[172:175], v[212:215], v[192:207]
    v_rcp_f32 v130, v11
    v_mul_f32 v137, v137, v129
    v_cvt_pk_bf16_f32 v128, v136, v137
    v_mul_f32 v12, v131, v131
    s_waitcnt lgkmcnt(4)
    v_mfma_f32_32x32x16_bf16 v[48:63], v[216:219], a[168:171], v[48:63]
    ds_read_b64_tr_b16 v[212:213], v5 offset:6144
    v_fma_f32 v12, v12, s70, v10
    v_mul_f32 v12, v131, v12
    v_exp_f32 v12, v12
    v_mfma_f32_32x32x16_bf16 v[64:79], v[216:219], a[172:175], v[64:79]
    ds_read_b64_tr_b16 v[214:215], v5 offset:6656
    v_mul_f32 v139, v131, v139
    v_add_f32 v12, 1.0, v12
    v_rcp_f32 v131, v12
    v_mul_f32 v138, v138, v130
    s_waitcnt lgkmcnt(5)
    v_mfma_f32_32x32x16_bf16 v[176:191], a[176:179], v[220:223], v[176:191]
    s_waitcnt vmcnt(1)
    s_barrier
    ds_read_b128 v[216:219], v14 offset:8192
    v_mul_f32 v11, v132, v132
    v_fma_f32 v11, v11, s70, v10
    v_mul_f32 v11, v132, v11
    v_mfma_f32_32x32x16_bf16 v[192:207], a[180:183], v[220:223], v[192:207]
    s_add_u32 m0, s60, 0
    s_cmp_ge_u32 8, s3
    s_cselect_b32 s59, s6, s63
    s_add_u32 s59, s59, 1024
    buffer_load_dwordx4 v252, s[44:47], s59 offen lds
    s_waitcnt lgkmcnt(4)
    v_mfma_f32_32x32x16_bf16 v[48:63], v[224:227], a[176:179], v[48:63]
    ds_read_b64_tr_b16 v[220:221], v5 offset:16384
    v_exp_f32 v11, v11
    v_mul_f32 v140, v132, v140
    v_add_f32 v11, 1.0, v11
    v_mfma_f32_32x32x16_bf16 v[64:79], v[224:227], a[180:183], v[64:79]
    ds_read_b64_tr_b16 v[222:223], v5 offset:16896
    v_rcp_f32 v132, v11
    v_mul_f32 v139, v139, v131
    v_cvt_pk_bf16_f32 v129, v138, v139
    v_mul_f32 v12, v133, v133
    s_waitcnt lgkmcnt(5)
    v_mfma_f32_32x32x16_bf16 v[176:191], a[184:187], v[208:211], v[176:191]
    v_xor_b32 v13, 32, v14
    ds_read_b128 v[224:227], v13 offset:8192
    v_fma_f32 v12, v12, s70, v10
    v_mul_f32 v12, v133, v12
    v_exp_f32 v12, v12
    v_mfma_f32_32x32x16_bf16 v[192:207], a[188:191], v[208:211], v[192:207]
    v_mul_f32 v141, v133, v141
    v_add_f32 v12, 1.0, v12
    v_rcp_f32 v133, v12
    v_mul_f32 v140, v140, v132
    s_waitcnt lgkmcnt(4)
    v_mfma_f32_32x32x16_bf16 v[48:63], v[212:215], a[184:187], v[48:63]
    ds_read_b64_tr_b16 v[208:209], v5 offset:18432
    v_mul_f32 v11, v134, v134
    v_fma_f32 v11, v11, s70, v10
    v_mul_f32 v11, v134, v11
    v_exp_f32 v11, v11
    v_mfma_f32_32x32x16_bf16 v[64:79], v[212:215], a[188:191], v[64:79]
    ds_read_b64_tr_b16 v[210:211], v5 offset:18944
    v_mul_f32 v142, v134, v142
    v_add_f32 v11, 1.0, v11
    v_rcp_f32 v134, v11
    s_waitcnt lgkmcnt(5)
    v_mfma_f32_32x32x16_bf16 v[176:191], a[192:195], v[216:219], v[176:191]
    v_xor_b32 v13, 64, v14
    ds_read_b128 v[212:215], v13 offset:8192
    v_mul_f32 v141, v141, v133
    v_cvt_pk_bf16_f32 v130, v140, v141
    v_mul_f32 v12, v135, v135
    v_fma_f32 v12, v12, s70, v10
    v_mfma_f32_32x32x16_bf16 v[192:207], a[196:199], v[216:219], v[192:207]
    v_mul_f32 v12, v135, v12
    v_exp_f32 v12, v12
    v_mul_f32 v143, v135, v143
    v_add_f32 v12, 1.0, v12
    s_waitcnt lgkmcnt(4)
    v_mfma_f32_32x32x16_bf16 v[48:63], v[220:223], a[192:195], v[48:63]
    ds_read_b64_tr_b16 v[216:217], v5 offset:20480
    v_rcp_f32 v135, v12
    v_mul_f32 v142, v142, v134
    v_mul_f32 v143, v143, v135
    v_mfma_f32_32x32x16_bf16 v[64:79], v[220:223], a[196:199], v[64:79]
    ds_read_b64_tr_b16 v[218:219], v5 offset:20992
    v_cvt_pk_bf16_f32 v131, v142, v143
    v_mul_f32 v11, v144, v144
    v_fma_f32 v11, v11, s70, v10
    v_mul_f32 v11, v144, v11
    s_waitcnt lgkmcnt(5)
    v_mfma_f32_32x32x16_bf16 v[176:191], a[200:203], v[224:227], v[176:191]
    v_xor_b32 v13, 96, v14
    ds_read_b128 v[220:223], v13 offset:8192
    v_exp_f32 v11, v11
    v_mul_f32 v152, v144, v152
    v_add_f32 v11, 1.0, v11
    v_mfma_f32_32x32x16_bf16 v[192:207], a[204:207], v[224:227], v[192:207]
    v_rcp_f32 v144, v11
    v_mul_f32 v12, v145, v145
    v_fma_f32 v12, v12, s70, v10
    v_mul_f32 v12, v145, v12
    s_waitcnt lgkmcnt(4)
    v_mfma_f32_32x32x16_bf16 v[48:63], v[208:211], a[200:203], v[48:63]
    ds_read_b64_tr_b16 v[224:225], v5 offset:22528
    v_exp_f32 v12, v12
    v_mul_f32 v153, v145, v153
    v_add_f32 v12, 1.0, v12
    v_mfma_f32_32x32x16_bf16 v[64:79], v[208:211], a[204:207], v[64:79]
    ds_read_b64_tr_b16 v[226:227], v5 offset:23040
    v_rcp_f32 v145, v12
    v_mul_f32 v152, v152, v144
    v_mul_f32 v11, v146, v146
    v_fma_f32 v11, v11, s70, v10
    s_waitcnt lgkmcnt(5)
    v_mfma_f32_32x32x16_bf16 v[176:191], a[208:211], v[212:215], v[176:191]
    s_waitcnt vmcnt(1)
    s_barrier
    ds_read_b128 v[208:211], v14 offset:12288
    v_mul_f32 v11, v146, v11
    v_exp_f32 v11, v11
    v_mfma_f32_32x32x16_bf16 v[192:207], a[212:215], v[212:215], v[192:207]
    s_add_u32 m0, s60, 4096
    s_add_u32 s59, s72, 0
    buffer_load_dwordx4 v4, s[16:19], s59 offen lds
    v_mul_f32 v154, v146, v154
    v_add_f32 v11, 1.0, v11
    s_waitcnt lgkmcnt(4)
    v_mfma_f32_32x32x16_bf16 v[48:63], v[216:219], a[208:211], v[48:63]
    ds_read_b64_tr_b16 v[212:213], v5 offset:32768
    v_rcp_f32 v146, v11
    v_mul_f32 v153, v153, v145
    v_cvt_pk_bf16_f32 v144, v152, v153
    v_mul_f32 v12, v147, v147
    v_mfma_f32_32x32x16_bf16 v[64:79], v[216:219], a[212:215], v[64:79]
    ds_read_b64_tr_b16 v[214:215], v5 offset:33280
    v_fma_f32 v12, v12, s70, v10
    v_mul_f32 v12, v147, v12
    v_exp_f32 v12, v12
    v_mul_f32 v155, v147, v155
    s_waitcnt lgkmcnt(5)
    v_mfma_f32_32x32x16_bf16 v[176:191], a[216:219], v[220:223], v[176:191]
    v_xor_b32 v13, 32, v14
    ds_read_b128 v[216:219], v13 offset:12288
    v_add_f32 v12, 1.0, v12
    v_rcp_f32 v147, v12
    v_mfma_f32_32x32x16_bf16 v[192:207], a[220:223], v[220:223], v[192:207]
    v_mul_f32 v154, v154, v146
    v_mul_f32 v11, v148, v148
    v_fma_f32 v11, v11, s70, v10
    v_mul_f32 v11, v148, v11
    v_exp_f32 v11, v11
    s_waitcnt lgkmcnt(4)
    v_mfma_f32_32x32x16_bf16 v[48:63], v[224:227], a[216:219], v[48:63]
    ds_read_b64_tr_b16 v[220:221], v5 offset:34816
    v_mul_f32 v156, v148, v156
    v_add_f32 v11, 1.0, v11
    v_rcp_f32 v148, v11
    v_mfma_f32_32x32x16_bf16 v[64:79], v[224:227], a[220:223], v[64:79]
    ds_read_b64_tr_b16 v[222:223], v5 offset:35328
    v_mul_f32 v155, v155, v147
    v_cvt_pk_bf16_f32 v145, v154, v155
    v_mul_f32 v12, v149, v149
    v_fma_f32 v12, v12, s70, v10
    s_waitcnt lgkmcnt(5)
    v_mfma_f32_32x32x16_bf16 v[176:191], a[224:227], v[208:211], v[176:191]
    v_xor_b32 v13, 64, v14
    ds_read_b128 v[224:227], v13 offset:12288
    v_mul_f32 v12, v149, v12
    v_exp_f32 v12, v12
    v_mul_f32 v157, v149, v157
    v_mfma_f32_32x32x16_bf16 v[192:207], a[228:231], v[208:211], v[192:207]
    v_add_f32 v12, 1.0, v12
    v_rcp_f32 v149, v12
    v_mul_f32 v156, v156, v148
    v_mul_f32 v11, v150, v150
    s_waitcnt lgkmcnt(4)
    v_mfma_f32_32x32x16_bf16 v[48:63], v[212:215], a[224:227], v[48:63]
    ds_read_b64_tr_b16 v[208:209], v5 offset:36864
    v_fma_f32 v11, v11, s70, v10
    v_mul_f32 v11, v150, v11
    v_exp_f32 v11, v11
    v_mul_f32 v158, v150, v158
    v_mfma_f32_32x32x16_bf16 v[64:79], v[212:215], a[228:231], v[64:79]
    ds_read_b64_tr_b16 v[210:211], v5 offset:37376
    v_add_f32 v11, 1.0, v11
    v_rcp_f32 v150, v11
    v_mul_f32 v157, v157, v149
    s_waitcnt lgkmcnt(5)
    v_mfma_f32_32x32x16_bf16 v[176:191], a[232:235], v[216:219], v[176:191]
    v_xor_b32 v13, 96, v14
    ds_read_b128 v[212:215], v13 offset:12288
    v_cvt_pk_bf16_f32 v146, v156, v157
    v_mul_f32 v12, v151, v151
    v_fma_f32 v12, v12, s70, v10
    v_mul_f32 v12, v151, v12
    v_mfma_f32_32x32x16_bf16 v[192:207], a[236:239], v[216:219], v[192:207]
    v_exp_f32 v12, v12
    v_mul_f32 v159, v151, v159
    v_add_f32 v12, 1.0, v12
    s_waitcnt lgkmcnt(4)
    v_mfma_f32_32x32x16_bf16 v[48:63], v[220:223], a[232:235], v[48:63]
    ds_read_b64_tr_b16 v[216:217], v5 offset:38912
    v_rcp_f32 v151, v12
    v_mul_f32 v158, v158, v150
    v_mul_f32 v159, v159, v151
    v_cvt_pk_bf16_f32 v147, v158, v159
    v_mfma_f32_32x32x16_bf16 v[64:79], v[220:223], a[236:239], v[64:79]
    ds_read_b64_tr_b16 v[218:219], v5 offset:39424
    v_mul_f32 v11, v160, v160
    v_fma_f32 v11, v11, s70, v10
    v_mul_f32 v11, v160, v11
    v_exp_f32 v11, v11
    s_waitcnt lgkmcnt(5)
    v_mfma_f32_32x32x16_bf16 v[176:191], a[240:243], v[224:227], v[176:191]
    s_waitcnt vmcnt(1)
    s_barrier
    ds_read_b128 v[220:223], v14 offset:0
    v_mul_f32 v168, v160, v168
    v_add_f32 v11, 1.0, v11
    v_mfma_f32_32x32x16_bf16 v[192:207], a[244:247], v[224:227], v[192:207]
    s_add_u32 m0, s60, 8192
    s_cmp_ge_u32 1, s3
    s_cselect_b32 s59, s5, s72
    s_add_u32 s59, s59, 589824
    buffer_load_dwordx4 v4, s[16:19], s59 offen lds
    v_rcp_f32 v160, v11
    s_waitcnt lgkmcnt(4)
    v_mfma_f32_32x32x16_bf16 v[48:63], v[208:211], a[240:243], v[48:63]
    v_add_u32 v5, 49152, v5
    v_add_u32 v6, 49152, v6
    v_add_u32 v7, 49152, v7
    v_add_u32 v8, 49152, v8
    ds_read_b64_tr_b16 v[224:225], v5 offset:0
    v_mfma_f32_32x32x16_bf16 v[64:79], v[208:211], a[244:247], v[64:79]
    ds_read_b64_tr_b16 v[226:227], v5 offset:512
    v_mul_f32 v12, v161, v161
    v_fma_f32 v12, v12, s70, v10
    v_mul_f32 v12, v161, v12
    v_exp_f32 v12, v12
    s_waitcnt lgkmcnt(5)
    v_mfma_f32_32x32x16_bf16 v[176:191], a[248:251], v[212:215], v[176:191]
    v_xor_b32 v13, 32, v14
    ds_read_b128 v[208:211], v13 offset:0
    v_mul_f32 v169, v161, v169
    v_add_f32 v12, 1.0, v12
    v_rcp_f32 v161, v12
    v_mfma_f32_32x32x16_bf16 v[192:207], a[252:255], v[212:215], v[192:207]
    v_mul_f32 v168, v168, v160
    v_mul_f32 v11, v162, v162
    v_fma_f32 v11, v11, s70, v10
    v_mul_f32 v11, v162, v11
    s_waitcnt lgkmcnt(4)
    v_mfma_f32_32x32x16_bf16 v[48:63], v[216:219], a[248:251], v[48:63]
    ds_read_b64_tr_b16 v[212:213], v5 offset:2048
    v_exp_f32 v11, v11
    v_mul_f32 v170, v162, v170
    v_add_f32 v11, 1.0, v11
    v_mfma_f32_32x32x16_bf16 v[64:79], v[216:219], a[252:255], v[64:79]
    ds_read_b64_tr_b16 v[214:215], v5 offset:2560
    v_rcp_f32 v162, v11
    v_mul_f32 v169, v169, v161
    v_cvt_pk_bf16_f32 v160, v168, v169
    v_mul_f32 v12, v163, v163
    s_waitcnt lgkmcnt(5)
    v_mfma_f32_32x32x16_bf16 v[176:191], v[16:19], v[220:223], v[176:191]
    v_xor_b32 v13, 64, v14
    ds_read_b128 v[216:219], v13 offset:0
    v_fma_f32 v12, v12, s70, v10
    v_mul_f32 v12, v163, v12
    v_exp_f32 v12, v12
    v_mfma_f32_32x32x16_bf16 v[192:207], v[20:23], v[220:223], v[192:207]
    v_mul_f32 v171, v163, v171
    v_add_f32 v12, 1.0, v12
    v_rcp_f32 v163, v12
    v_mul_f32 v170, v170, v162
    s_waitcnt lgkmcnt(4)
    v_mfma_f32_32x32x16_bf16 v[48:63], v[224:227], v[16:19], v[48:63]
    ds_read_b64_tr_b16 v[220:221], v5 offset:4096
    v_mul_f32 v11, v164, v164
    v_fma_f32 v11, v11, s70, v10
    v_mul_f32 v11, v164, v11
    v_exp_f32 v11, v11
    v_mfma_f32_32x32x16_bf16 v[64:79], v[224:227], v[20:23], v[64:79]
    ds_read_b64_tr_b16 v[222:223], v5 offset:4608
    v_mul_f32 v172, v164, v172
    v_add_f32 v11, 1.0, v11
    v_rcp_f32 v164, v11
    s_waitcnt lgkmcnt(5)
    v_mfma_f32_32x32x16_bf16 v[176:191], v[24:27], v[208:211], v[176:191]
    v_xor_b32 v13, 96, v14
    ds_read_b128 v[224:227], v13 offset:0
    v_mul_f32 v171, v171, v163
    v_cvt_pk_bf16_f32 v161, v170, v171
    v_mul_f32 v12, v165, v165
    v_fma_f32 v12, v12, s70, v10
    v_mfma_f32_32x32x16_bf16 v[192:207], v[28:31], v[208:211], v[192:207]
    v_mul_f32 v12, v165, v12
    v_exp_f32 v12, v12
    v_mul_f32 v173, v165, v173
    v_add_f32 v12, 1.0, v12
    s_waitcnt lgkmcnt(4)
    v_mfma_f32_32x32x16_bf16 v[48:63], v[212:215], v[24:27], v[48:63]
    ds_read_b64_tr_b16 v[208:209], v5 offset:6144
    v_rcp_f32 v165, v12
    v_mul_f32 v172, v172, v164
    v_mul_f32 v11, v166, v166
    v_mfma_f32_32x32x16_bf16 v[64:79], v[212:215], v[28:31], v[64:79]
    ds_read_b64_tr_b16 v[210:211], v5 offset:6656
    v_fma_f32 v11, v11, s70, v10
    v_mul_f32 v11, v166, v11
    v_exp_f32 v11, v11
    v_mul_f32 v174, v166, v174
    s_waitcnt lgkmcnt(5)
    v_mfma_f32_32x32x16_bf16 v[176:191], v[32:35], v[216:219], v[176:191]
    s_waitcnt vmcnt(1)
    s_barrier
    ds_read_b64_tr_b16 v[212:213], v9 offset:4096
    v_add_f32 v11, 1.0, v11
    v_rcp_f32 v166, v11
    v_mfma_f32_32x32x16_bf16 v[192:207], v[36:39], v[216:219], v[192:207]
    ds_read_b64_tr_b16 v[214:215], v15 offset:4096
    s_add_u32 m0, s60, 12288
    s_cmp_ge_u32 2, s3
    s_cselect_b32 s59, s5, s72
    s_add_u32 s59, s59, 1179648
    buffer_load_dwordx4 v4, s[16:19], s59 offen lds
    s_waitcnt lgkmcnt(5)
    v_mfma_f32_32x32x16_bf16 v[48:63], v[220:223], v[32:35], v[48:63]
    ds_read_b64_tr_b16 v[216:217], v6 offset:32768
    v_mul_f32 v173, v173, v165
    v_cvt_pk_bf16_f32 v162, v172, v173
    v_mul_f32 v12, v167, v167
    v_fma_f32 v12, v12, s70, v10
    v_mfma_f32_32x32x16_bf16 v[64:79], v[220:223], v[36:39], v[64:79]
    ds_read_b64_tr_b16 v[218:219], v6 offset:33280
    v_mul_f32 v12, v167, v12
    v_exp_f32 v12, v12
    v_mul_f32 v175, v167, v175
    v_add_f32 v12, 1.0, v12
    s_waitcnt lgkmcnt(6)
    v_mfma_f32_32x32x16_bf16 v[176:191], v[40:43], v[224:227], v[176:191]
    ds_read_b64_tr_b16 v[220:221], v9 offset:4608
    v_rcp_f32 v167, v12
    v_mul_f32 v174, v174, v166
    v_mul_f32 v175, v175, v167
    v_mfma_f32_32x32x16_bf16 v[192:207], v[44:47], v[224:227], v[192:207]
    ds_read_b64_tr_b16 v[222:223], v15 offset:4608
    v_cvt_pk_bf16_f32 v163, v174, v175
    s_add_u32 s71, s66, 1024
    buffer_store_dwordx4 v[80:83], v1, s[20:23], s71 offen sc1
    s_add_u32 s71, s67, 1024
    buffer_store_dwordx4 v[96:99], v1, s[20:23], s71 offen sc1
    s_waitcnt lgkmcnt(6)
    v_mfma_f32_32x32x16_bf16 v[48:63], v[208:211], v[40:43], v[48:63]
    ds_read_b64_tr_b16 v[224:225], v6 offset:34816
    s_add_u32 s71, s66, 2048
    buffer_store_dwordx4 v[112:115], v1, s[20:23], s71 offen sc1
    s_add_u32 s71, s67, 2048
    buffer_store_dwordx4 v[128:131], v1, s[20:23], s71 offen sc1
    v_mfma_f32_32x32x16_bf16 v[64:79], v[208:211], v[44:47], v[64:79]
    ds_read_b64_tr_b16 v[226:227], v6 offset:35328
    s_waitcnt lgkmcnt(6)
    v_mfma_f32_32x32x16_bf16 v[80:95], v[212:215], a[0:3], 0
    ds_read_b64_tr_b16 v[208:209], v9 offset:5120
    v_mfma_f32_32x32x16_bf16 v[96:111], v[212:215], a[4:7], 0
    ds_read_b64_tr_b16 v[210:211], v15 offset:5120
    v_permlane16_swap_b32 v176, v184
    v_permlane16_swap_b32 v177, v185
    s_waitcnt lgkmcnt(6)
    v_mfma_f32_32x32x16_bf16 v[112:127], v[216:219], a[0:3], 0
    ds_read_b64_tr_b16 v[212:213], v6 offset:36864
    v_permlane16_swap_b32 v178, v186
    v_mfma_f32_32x32x16_bf16 v[128:143], v[216:219], a[4:7], 0
    ds_read_b64_tr_b16 v[214:215], v6 offset:37376
    v_permlane16_swap_b32 v179, v187
    v_permlane16_swap_b32 v180, v188
    s_waitcnt lgkmcnt(6)
    v_mfma_f32_32x32x16_bf16 v[80:95], v[220:223], a[8:11], v[80:95]
    ds_read_b64_tr_b16 v[216:217], v9 offset:5632
    v_permlane16_swap_b32 v181, v189
    v_permlane16_swap_b32 v182, v190
    v_mfma_f32_32x32x16_bf16 v[96:111], v[220:223], a[12:15], v[96:111]
    ds_read_b64_tr_b16 v[218:219], v15 offset:5632
    v_permlane16_swap_b32 v183, v191
    v_mul_f32 v228, v236, v176
    s_waitcnt lgkmcnt(6)
    v_mfma_f32_32x32x16_bf16 v[112:127], v[224:227], a[8:11], v[112:127]
    ds_read_b64_tr_b16 v[220:221], v6 offset:38912
    v_mul_f32 v229, v237, v176
    v_fma_f32 v176, -v237, v184, v228
    v_fma_f32 v184, v236, v184, v229
    v_mfma_f32_32x32x16_bf16 v[128:143], v[224:227], a[12:15], v[128:143]
    ds_read_b64_tr_b16 v[222:223], v6 offset:39424
    v_mul_f32 v228, v236, v177
    v_mul_f32 v229, v237, v177
    v_fma_f32 v177, -v237, v185, v228
    v_fma_f32 v185, v236, v185, v229
    s_waitcnt lgkmcnt(6)
    v_mfma_f32_32x32x16_bf16 v[80:95], v[208:211], a[16:19], v[80:95]
    s_waitcnt vmcnt(5)
    s_barrier
    ds_read_b64_tr_b16 v[224:225], v9 offset:8192
    v_fma_f32 v246, v234, v176, v177
    v_fma_f32 v247, v234, v184, v185
    v_mfma_f32_32x32x16_bf16 v[96:111], v[208:211], a[20:23], v[96:111]
    ds_read_b64_tr_b16 v[226:227], v15 offset:8192
    s_add_u32 m0, s60, 0
    s_cmp_ge_u32 3, s3
    s_cselect_b32 s59, s5, s72
    s_add_u32 s59, s59, 1769472
    buffer_load_dwordx4 v4, s[16:19], s59 offen lds
    s_waitcnt lgkmcnt(6)
    v_mfma_f32_32x32x16_bf16 v[112:127], v[212:215], a[16:19], v[112:127]
    v_add_u32 v5, 49152, v5
    v_add_u32 v6, 49152, v6
    v_add_u32 v7, 49152, v7
    v_add_u32 v8, 49152, v8
    ds_read_b64_tr_b16 v[208:209], v6 offset:0
    v_fma_f32 v246, -v235, v184, v246
    v_mfma_f32_32x32x16_bf16 v[128:143], v[212:215], a[20:23], v[128:143]
    ds_read_b64_tr_b16 v[210:211], v6 offset:512
    v_fmac_f32 v247, v235, v176
    v_mul_f32 v228, v236, v178
    v_mul_f32 v229, v237, v178
    s_waitcnt lgkmcnt(6)
    v_mfma_f32_32x32x16_bf16 v[80:95], v[216:219], a[24:27], v[80:95]
    ds_read_b64_tr_b16 v[212:213], v9 offset:8704
    v_fma_f32 v178, -v237, v186, v228
    v_fma_f32 v186, v236, v186, v229
    v_fma_f32 v244, v234, v246, v178
    v_mfma_f32_32x32x16_bf16 v[96:111], v[216:219], a[28:31], v[96:111]
    ds_read_b64_tr_b16 v[214:215], v15 offset:8704
    v_fma_f32 v245, v234, v247, v186
    v_fma_f32 v244, -v235, v247, v244
    v_fmac_f32 v245, v235, v246
    v_mul_f32 v228, v236, v179
    s_waitcnt lgkmcnt(6)
    v_mfma_f32_32x32x16_bf16 v[112:127], v[220:223], a[24:27], v[112:127]
    ds_read_b64_tr_b16 v[216:217], v6 offset:2048
    v_mul_f32 v229, v237, v179
    v_fma_f32 v179, -v237, v187, v228
    v_fma_f32 v187, v236, v187, v229
    v_mfma_f32_32x32x16_bf16 v[128:143], v[220:223], a[28:31], v[128:143]
    ds_read_b64_tr_b16 v[218:219], v6 offset:2560
    v_fma_f32 v246, v234, v244, v179
    v_fma_f32 v247, v234, v245, v187
    v_fma_f32 v246, -v235, v245, v246
    s_waitcnt lgkmcnt(6)
    v_mfma_f32_32x32x16_bf16 v[80:95], v[224:227], a[32:35], v[80:95]
    ds_read_b64_tr_b16 v[220:221], v9 offset:9216
    v_fmac_f32 v247, v235, v244
    v_mul_f32 v228, v236, v180
    v_mul_f32 v229, v237, v180
    v_fma_f32 v180, -v237, v188, v228
    v_mfma_f32_32x32x16_bf16 v[96:111], v[224:227], a[36:39], v[96:111]
    ds_read_b64_tr_b16 v[222:223], v15 offset:9216
    v_fma_f32 v188, v236, v188, v229
    v_fma_f32 v244, v234, v246, v180
    v_fma_f32 v245, v234, v247, v188
    s_waitcnt lgkmcnt(6)
    v_mfma_f32_32x32x16_bf16 v[112:127], v[208:211], a[32:35], v[112:127]
    ds_read_b64_tr_b16 v[224:225], v6 offset:4096
    v_fma_f32 v244, -v235, v247, v244
    v_fmac_f32 v245, v235, v246
    v_mul_f32 v228, v236, v181
    v_mul_f32 v229, v237, v181
    v_mfma_f32_32x32x16_bf16 v[128:143], v[208:211], a[36:39], v[128:143]
    ds_read_b64_tr_b16 v[226:227], v6 offset:4608
    v_fma_f32 v181, -v237, v189, v228
    v_fma_f32 v189, v236, v189, v229
    v_fma_f32 v246, v234, v244, v181
    s_waitcnt lgkmcnt(6)
    v_mfma_f32_32x32x16_bf16 v[80:95], v[212:215], a[40:43], v[80:95]
    ds_read_b64_tr_b16 v[208:209], v9 offset:9728
    v_fma_f32 v247, v234, v245, v189
    v_fma_f32 v246, -v235, v245, v246
    v_fmac_f32 v247, v235, v244
    v_mfma_f32_32x32x16_bf16 v[96:111], v[212:215], a[44:47], v[96:111]
    ds_read_b64_tr_b16 v[210:211], v15 offset:9728
    v_mul_f32 v228, v236, v182
    v_mul_f32 v229, v237, v182
    v_fma_f32 v182, -v237, v190, v228
    v_fma_f32 v190, v236, v190, v229
    s_waitcnt lgkmcnt(6)
    v_mfma_f32_32x32x16_bf16 v[112:127], v[216:219], a[40:43], v[112:127]
    ds_read_b64_tr_b16 v[212:213], v6 offset:6144
    v_fma_f32 v244, v234, v246, v182
    v_fma_f32 v245, v234, v247, v190
    v_fma_f32 v244, -v235, v247, v244
    v_mfma_f32_32x32x16_bf16 v[128:143], v[216:219], a[44:47], v[128:143]
    ds_read_b64_tr_b16 v[214:215], v6 offset:6656
    v_fmac_f32 v245, v235, v246
    v_mul_f32 v228, v236, v183
    v_mul_f32 v229, v237, v183
    s_waitcnt lgkmcnt(6)
    v_mfma_f32_32x32x16_bf16 v[80:95], v[220:223], a[48:51], v[80:95]
    s_waitcnt vmcnt(5)
    s_barrier
    ds_read_b64_tr_b16 v[216:217], v9 offset:12288
    v_fma_f32 v183, -v237, v191, v228
    v_fma_f32 v191, v236, v191, v229
    v_mfma_f32_32x32x16_bf16 v[96:111], v[220:223], a[52:55], v[96:111]
    ds_read_b64_tr_b16 v[218:219], v15 offset:12288
    s_add_u32 m0, s60, 4096
    s_cmp_ge_u32 4, s3
    s_cselect_b32 s59, s5, s72
    s_add_u32 s59, s59, 2359296
    buffer_load_dwordx4 v4, s[16:19], s59 offen lds
    v_fma_f32 v246, v234, v244, v183
    s_waitcnt lgkmcnt(6)
    v_mfma_f32_32x32x16_bf16 v[112:127], v[224:227], a[48:51], v[112:127]
    ds_read_b64_tr_b16 v[220:221], v6 offset:16384
    v_fma_f32 v247, v234, v245, v191
    v_fma_f32 v246, -v235, v245, v246
    v_fmac_f32 v247, v235, v244
    v_mfma_f32_32x32x16_bf16 v[128:143], v[224:227], a[52:55], v[128:143]
    ds_read_b64_tr_b16 v[222:223], v6 offset:16896
    v_permlane16_swap_b32 v192, v200
    v_permlane16_swap_b32 v193, v201
    s_waitcnt lgkmcnt(6)
    v_mfma_f32_32x32x16_bf16 v[80:95], v[208:211], a[56:59], v[80:95]
    ds_read_b64_tr_b16 v[224:225], v9 offset:12800
    v_permlane16_swap_b32 v194, v202
    v_mfma_f32_32x32x16_bf16 v[96:111], v[208:211], a[60:63], v[96:111]
    ds_read_b64_tr_b16 v[226:227], v15 offset:12800
    v_permlane16_swap_b32 v195, v203
    v_permlane16_swap_b32 v196, v204
    s_waitcnt lgkmcnt(6)
    v_mfma_f32_32x32x16_bf16 v[112:127], v[212:215], a[56:59], v[112:127]
    ds_read_b64_tr_b16 v[208:209], v6 offset:18432
    v_permlane16_swap_b32 v197, v205
    v_permlane16_swap_b32 v198, v206
    v_mfma_f32_32x32x16_bf16 v[128:143], v[212:215], a[60:63], v[128:143]
    ds_read_b64_tr_b16 v[210:211], v6 offset:18944
    v_permlane16_swap_b32 v199, v207
    v_mul_f32 v228, v236, v192
    s_waitcnt lgkmcnt(6)
    v_mfma_f32_32x32x16_bf16 v[80:95], v[216:219], a[64:67], v[80:95]
    ds_read_b64_tr_b16 v[212:213], v9 offset:13312
    v_mul_f32 v229, v237, v192
    v_fma_f32 v192, -v237, v200, v228
    v_fma_f32 v200, v236, v200, v229
    v_mfma_f32_32x32x16_bf16 v[96:111], v[216:219], a[68:71], v[96:111]
    ds_read_b64_tr_b16 v[214:215], v15 offset:13312
    v_mul_f32 v228, v236, v193
    v_mul_f32 v229, v237, v193
    v_fma_f32 v193, -v237, v201, v228
    v_fma_f32 v201, v236, v201, v229
    s_waitcnt lgkmcnt(6)
    v_mfma_f32_32x32x16_bf16 v[112:127], v[220:223], a[64:67], v[112:127]
    ds_read_b64_tr_b16 v[216:217], v6 offset:20480
    v_fma_f32 v250, v234, v192, v193
    v_fma_f32 v251, v234, v200, v201
    v_fma_f32 v250, -v235, v200, v250
    v_mfma_f32_32x32x16_bf16 v[128:143], v[220:223], a[68:71], v[128:143]
    ds_read_b64_tr_b16 v[218:219], v6 offset:20992
    v_fmac_f32 v251, v235, v192
    v_mul_f32 v228, v236, v194
    v_mul_f32 v229, v237, v194
    v_fma_f32 v194, -v237, v202, v228
    s_waitcnt lgkmcnt(6)
    v_mfma_f32_32x32x16_bf16 v[80:95], v[224:227], a[72:75], v[80:95]
    ds_read_b64_tr_b16 v[220:221], v9 offset:13824
    v_fma_f32 v202, v236, v202, v229
    v_fma_f32 v248, v234, v250, v194
    v_fma_f32 v249, v234, v251, v202
    v_mfma_f32_32x32x16_bf16 v[96:111], v[224:227], a[76:79], v[96:111]
    ds_read_b64_tr_b16 v[222:223], v15 offset:13824
    v_fma_f32 v248, -v235, v251, v248
    v_fmac_f32 v249, v235, v250
    v_mul_f32 v228, v236, v195
    s_waitcnt lgkmcnt(6)
    v_mfma_f32_32x32x16_bf16 v[112:127], v[208:211], a[72:75], v[112:127]
    ds_read_b64_tr_b16 v[224:225], v6 offset:22528
    v_mul_f32 v229, v237, v195
    v_fma_f32 v195, -v237, v203, v228
    v_fma_f32 v203, v236, v203, v229
    v_fma_f32 v250, v234, v248, v195
    v_mfma_f32_32x32x16_bf16 v[128:143], v[208:211], a[76:79], v[128:143]
    ds_read_b64_tr_b16 v[226:227], v6 offset:23040
    v_fma_f32 v251, v234, v249, v203
    v_fma_f32 v250, -v235, v249, v250
    v_fmac_f32 v251, v235, v248
    s_waitcnt lgkmcnt(6)
    v_mfma_f32_32x32x16_bf16 v[80:95], v[212:215], a[80:83], v[80:95]
    s_waitcnt vmcnt(1)
    s_barrier
    ds_read_b64_tr_b16 v[208:209], v9 offset:0
    v_mul_f32 v228, v236, v196
    v_mul_f32 v229, v237, v196
    v_mfma_f32_32x32x16_bf16 v[96:111], v[212:215], a[84:87], v[96:111]
    ds_read_b64_tr_b16 v[210:211], v15 offset:0
    s_add_u32 m0, s60, 8192
    s_cmp_ge_u32 5, s3
    s_cselect_b32 s59, s5, s72
    s_add_u32 s59, s59, 2949120
    buffer_load_dwordx4 v4, s[16:19], s59 offen lds
    s_waitcnt lgkmcnt(6)
    v_mfma_f32_32x32x16_bf16 v[112:127], v[216:219], a[80:83], v[112:127]
    ds_read_b64_tr_b16 v[212:213], v6 offset:32768
    v_fma_f32 v196, -v237, v204, v228
    v_fma_f32 v204, v236, v204, v229
    v_fma_f32 v248, v234, v250, v196
    v_fma_f32 v249, v234, v251, v204
    v_mfma_f32_32x32x16_bf16 v[128:143], v[216:219], a[84:87], v[128:143]
    ds_read_b64_tr_b16 v[214:215], v6 offset:33280
    v_fma_f32 v248, -v235, v251, v248
    v_fmac_f32 v249, v235, v250
    v_mul_f32 v228, v236, v197
    s_waitcnt lgkmcnt(6)
    v_mfma_f32_32x32x16_bf16 v[80:95], v[220:223], a[88:91], v[80:95]
    ds_read_b64_tr_b16 v[216:217], v9 offset:512
    v_mul_f32 v229, v237, v197
    v_fma_f32 v197, -v237, v205, v228
    v_fma_f32 v205, v236, v205, v229
    v_fma_f32 v250, v234, v248, v197
    v_mfma_f32_32x32x16_bf16 v[96:111], v[220:223], a[92:95], v[96:111]
    ds_read_b64_tr_b16 v[218:219], v15 offset:512
    v_fma_f32 v251, v234, v249, v205
    v_fma_f32 v250, -v235, v249, v250
    v_fmac_f32 v251, v235, v248
    s_waitcnt lgkmcnt(6)
    v_mfma_f32_32x32x16_bf16 v[112:127], v[224:227], a[88:91], v[112:127]
    ds_read_b64_tr_b16 v[220:221], v6 offset:34816
    v_mul_f32 v228, v236, v198
    v_mul_f32 v229, v237, v198
    v_fma_f32 v198, -v237, v206, v228
    v_mfma_f32_32x32x16_bf16 v[128:143], v[224:227], a[92:95], v[128:143]
    ds_read_b64_tr_b16 v[222:223], v6 offset:35328
    v_fma_f32 v206, v236, v206, v229
    v_fma_f32 v248, v234, v250, v198
    v_fma_f32 v249, v234, v251, v206
    v_fma_f32 v248, -v235, v251, v248
    s_waitcnt lgkmcnt(6)
    v_mfma_f32_32x32x16_bf16 v[80:95], v[208:211], a[96:99], v[80:95]
    ds_read_b64_tr_b16 v[224:225], v9 offset:1024
    v_fmac_f32 v249, v235, v250
    v_mul_f32 v228, v236, v199
    v_mul_f32 v229, v237, v199
    v_mfma_f32_32x32x16_bf16 v[96:111], v[208:211], a[100:103], v[96:111]
    ds_read_b64_tr_b16 v[226:227], v15 offset:1024
    v_fma_f32 v199, -v237, v207, v228
    v_fma_f32 v207, v236, v207, v229
    v_fma_f32 v250, v234, v248, v199
    s_waitcnt lgkmcnt(6)
    v_mfma_f32_32x32x16_bf16 v[112:127], v[212:215], a[96:99], v[112:127]
    ds_read_b64_tr_b16 v[208:209], v6 offset:36864
    v_fma_f32 v251, v234, v249, v207
    v_fma_f32 v250, -v235, v249, v250
    v_fmac_f32 v251, v235, v248
    v_mul_f32 v228, 0x41000000, v230
    v_mfma_f32_32x32x16_bf16 v[128:143], v[212:215], a[100:103], v[128:143]
    ds_read_b64_tr_b16 v[210:211], v6 offset:37376
    v_mul_f32 v239, 0x41000000, v231
    v_exp_f32 v228, v228
    s_waitcnt lgkmcnt(6)
    v_mfma_f32_32x32x16_bf16 v[80:95], v[216:219], a[104:107], v[80:95]
    ds_read_b64_tr_b16 v[212:213], v9 offset:1536
    v_fract_f32 v239, v239
    v_cos_f32 v238, v239
    v_mfma_f32_32x32x16_bf16 v[96:111], v[216:219], a[108:111], v[96:111]
    ds_read_b64_tr_b16 v[214:215], v15 offset:1536
    v_sin_f32 v239, v239
    v_mul_f32 v238, v228, v238
    v_mul_f32 v239, v228, v239
    s_waitcnt lgkmcnt(6)
    v_mfma_f32_32x32x16_bf16 v[112:127], v[220:223], a[104:107], v[112:127]
    ds_read_b64_tr_b16 v[216:217], v6 offset:38912
    v_bfe_u32 v255, v0, 4, 1
    v_cvt_f32_u32 v255, v255
    v_mov_b32 v244, v246
    v_mfma_f32_32x32x16_bf16 v[128:143], v[220:223], a[108:111], v[128:143]
    ds_read_b64_tr_b16 v[218:219], v6 offset:39424
    v_mov_b32 v245, v247
    v_permlane16_swap_b32 v246, v244
    s_waitcnt lgkmcnt(6)
    v_mfma_f32_32x32x16_bf16 v[80:95], v[224:227], a[112:115], v[80:95]
    s_waitcnt vmcnt(1)
    s_barrier
    ds_read_b64_tr_b16 v[220:221], v9 offset:4096
    v_permlane16_swap_b32 v247, v245
    v_mul_f32 v240, v255, v246
    v_mfma_f32_32x32x16_bf16 v[96:111], v[224:227], a[116:119], v[96:111]
    ds_read_b64_tr_b16 v[222:223], v15 offset:4096
    s_add_u32 m0, s60, 12288
    s_cmp_ge_u32 6, s3
    s_cselect_b32 s59, s5, s72
    s_add_u32 s59, s59, 3538944
    buffer_load_dwordx4 v4, s[16:19], s59 offen lds
    s_waitcnt lgkmcnt(6)
    v_mfma_f32_32x32x16_bf16 v[112:127], v[208:211], a[112:115], v[112:127]
    v_add_u32 v5, 4294918144, v5
    v_add_u32 v6, 4294918144, v6
    v_add_u32 v7, 4294918144, v7
    v_add_u32 v8, 4294918144, v8
    ds_read_b64_tr_b16 v[224:225], v6 offset:16384
    v_mul_f32 v241, v255, v247
    v_mfma_f32_32x32x16_bf16 v[128:143], v[208:211], a[116:119], v[128:143]
    ds_read_b64_tr_b16 v[226:227], v6 offset:16896
    v_fma_f32 v244, v238, v246, v244
    v_fma_f32 v245, v238, v247, v245
    v_fma_f32 v244, -v239, v247, v244
    s_waitcnt lgkmcnt(6)
    v_mfma_f32_32x32x16_bf16 v[80:95], v[212:215], a[120:123], v[80:95]
    ds_read_b64_tr_b16 v[208:209], v9 offset:4608
    v_fmac_f32 v245, v239, v246
    v_mov_b32 v248, v250
    v_mov_b32 v249, v251
    v_mfma_f32_32x32x16_bf16 v[96:111], v[212:215], a[124:127], v[96:111]
    ds_read_b64_tr_b16 v[210:211], v15 offset:4608
    v_permlane16_swap_b32 v250, v248
    v_permlane16_swap_b32 v251, v249
    s_waitcnt lgkmcnt(6)
    v_mfma_f32_32x32x16_bf16 v[112:127], v[216:219], a[120:123], v[112:127]
    ds_read_b64_tr_b16 v[212:213], v6 offset:18432
    v_mul_f32 v242, v255, v250
    v_mul_f32 v243, v255, v251
    v_fma_f32 v248, v238, v250, v248
    v_mfma_f32_32x32x16_bf16 v[128:143], v[216:219], a[124:127], v[128:143]
    ds_read_b64_tr_b16 v[214:215], v6 offset:18944
    v_fma_f32 v249, v238, v251, v249
    v_fma_f32 v248, -v239, v251, v248
    v_fmac_f32 v249, v239, v250
    s_waitcnt lgkmcnt(6)
    v_mfma_f32_32x32x16_bf16 v[80:95], v[220:223], a[128:131], v[80:95]
    ds_read_b64_tr_b16 v[216:217], v9 offset:5120
    v_mul_f32 v255, 0x41000000, v255
    v_mul_f32 v228, v255, v230
    v_mul_f32 v237, v255, v231
    v_mfma_f32_32x32x16_bf16 v[96:111], v[220:223], a[132:135], v[96:111]
    ds_read_b64_tr_b16 v[218:219], v15 offset:5120
    v_exp_f32 v228, v228
    v_fract_f32 v237, v237
    v_cos_f32 v236, v237
    s_waitcnt lgkmcnt(6)
    v_mfma_f32_32x32x16_bf16 v[112:127], v[224:227], a[128:131], v[112:127]
    ds_read_b64_tr_b16 v[220:221], v6 offset:20480
    v_sin_f32 v237, v237
    v_mul_f32 v236, v228, v236
    v_mfma_f32_32x32x16_bf16 v[128:143], v[224:227], a[132:135], v[128:143]
    ds_read_b64_tr_b16 v[222:223], v6 offset:20992
    v_mul_f32 v237, v228, v237
    v_lshrrev_b32 v255, 5, v0
    v_cvt_f32_u32 v255, v255
    s_waitcnt lgkmcnt(6)
    v_mfma_f32_32x32x16_bf16 v[80:95], v[208:211], a[136:139], v[80:95]
    ds_read_b64_tr_b16 v[224:225], v9 offset:5632
    v_mul_f32 v236, v255, v236
    v_mul_f32 v237, v255, v237
    v_mul_f32 v228, v238, v238
    v_mfma_f32_32x32x16_bf16 v[96:111], v[208:211], a[140:143], v[96:111]
    ds_read_b64_tr_b16 v[226:227], v15 offset:5632
    v_mul_f32 v229, v238, v239
    v_fma_f32 v228, -v239, v239, v228
    v_fmac_f32 v229, v239, v238
    v_mov_b32 v246, v244
    s_waitcnt lgkmcnt(6)
    v_mfma_f32_32x32x16_bf16 v[112:127], v[212:215], a[136:139], v[112:127]
    ds_read_b64_tr_b16 v[208:209], v6 offset:22528
    v_mov_b32 v247, v245
    v_permlane32_swap_b32 v244, v246
    v_mfma_f32_32x32x16_bf16 v[128:143], v[212:215], a[140:143], v[128:143]
    ds_read_b64_tr_b16 v[210:211], v6 offset:23040
    v_permlane32_swap_b32 v245, v247
    v_fma_f32 v240, v236, v244, v240
    s_waitcnt lgkmcnt(6)
    v_mfma_f32_32x32x16_bf16 v[80:95], v[216:219], a[144:147], v[80:95]
    s_waitcnt vmcnt(1)
    s_barrier
    ds_read_b64_tr_b16 v[212:213], v9 offset:8192
    v_fma_f32 v241, v236, v245, v241
    v_fma_f32 v240, -v237, v245, v240
    v_mfma_f32_32x32x16_bf16 v[96:111], v[216:219], a[148:151], v[96:111]
    ds_read_b64_tr_b16 v[214:215], v15 offset:8192
    s_add_u32 m0, s60, 0
    s_cmp_ge_u32 7, s3
    s_cselect_b32 s59, s5, s72
    s_add_u32 s59, s59, 4128768
    buffer_load_dwordx4 v4, s[16:19], s59 offen lds
    v_fmac_f32 v241, v237, v244
    s_waitcnt lgkmcnt(6)
    v_mfma_f32_32x32x16_bf16 v[112:127], v[220:223], a[144:147], v[112:127]
    v_add_u32 v5, 4294918144, v5
    v_add_u32 v6, 4294918144, v6
    v_add_u32 v7, 4294918144, v7
    v_add_u32 v8, 4294918144, v8
    ds_read_b64_tr_b16 v[216:217], v6 offset:0
    v_fma_f32 v246, v228, v244, v246
    v_mfma_f32_32x32x16_bf16 v[128:143], v[220:223], a[148:151], v[128:143]
    ds_read_b64_tr_b16 v[218:219], v6 offset:512
    v_fma_f32 v247, v228, v245, v247
    v_fma_f32 v246, -v229, v245, v246
    v_fmac_f32 v247, v229, v244
    s_waitcnt lgkmcnt(6)
    v_mfma_f32_32x32x16_bf16 v[80:95], v[224:227], a[152:155], v[80:95]
    ds_read_b64_tr_b16 v[220:221], v9 offset:8704
    v_mov_b32 v250, v248
    v_mov_b32 v251, v249
    s_nop 0
    v_permlane32_swap_b32 v248, v250
    v_mfma_f32_32x32x16_bf16 v[96:111], v[224:227], a[156:159], v[96:111]
    ds_read_b64_tr_b16 v[222:223], v15 offset:8704
    v_permlane32_swap_b32 v249, v251
    v_fma_f32 v242, v236, v248, v242
    s_waitcnt lgkmcnt(6)
    v_mfma_f32_32x32x16_bf16 v[112:127], v[208:211], a[152:155], v[112:127]
    ds_read_b64_tr_b16 v[224:225], v6 offset:2048
    v_fma_f32 v243, v236, v249, v243
    v_fma_f32 v242, -v237, v249, v242
    v_fmac_f32 v243, v237, v248
    v_mfma_f32_32x32x16_bf16 v[128:143], v[208:211], a[156:159], v[128:143]
    ds_read_b64_tr_b16 v[226:227], v6 offset:2560
    v_fma_f32 v250, v228, v248, v250
    v_fma_f32 v251, v228, v249, v251
    v_fma_f32 v250, -v229, v249, v250
    s_waitcnt lgkmcnt(6)
    v_mfma_f32_32x32x16_bf16 v[80:95], v[212:215], a[160:163], v[80:95]
    ds_read_b64_tr_b16 v[208:209], v9 offset:9216
    v_fmac_f32 v251, v229, v248
    v_mul_f32 v238, v228, v228
    v_mul_f32 v239, v228, v229
    v_fma_f32 v238, -v229, v229, v238
    v_mfma_f32_32x32x16_bf16 v[96:111], v[212:215], a[164:167], v[96:111]
    ds_read_b64_tr_b16 v[210:211], v15 offset:9216
    v_fmac_f32 v239, v229, v228
    v_fma_f32 v248, v238, v246, v250
    v_fma_f32 v249, v238, v247, v251
    s_waitcnt lgkmcnt(6)
    v_mfma_f32_32x32x16_bf16 v[112:127], v[216:219], a[160:163], v[112:127]
    ds_read_b64_tr_b16 v[212:213], v6 offset:4096
    v_fma_f32 v248, -v239, v247, v248
    v_fmac_f32 v249, v239, v246
    v_mov_b32 v250, 1.0
    v_mfma_f32_32x32x16_bf16 v[128:143], v[216:219], a[164:167], v[128:143]
    ds_read_b64_tr_b16 v[214:215], v6 offset:4608
    v_mov_b32 v251, 1.0
    v_lshlrev_b32 v255, 4, v0
    v_cmp_gt_u32 vcc, 16, v0
    s_nop 1
    v_cndmask_b32 v255, 2.0, v255, vcc
    s_waitcnt lgkmcnt(6)
    v_mfma_f32_32x32x16_bf16 v[80:95], v[220:223], a[168:171], v[80:95]
    ds_read_b64_tr_b16 v[216:217], v9 offset:9728
    buffer_store_dwordx4 v[248:251], v255, s[20:23], s75 offen sc0 sc1
    v_mul_f32 v255, 0x41000000, v254
    v_mul_f32 v228, v255, v230
    v_mfma_f32_32x32x16_bf16 v[96:111], v[220:223], a[172:175], v[96:111]
    ds_read_b64_tr_b16 v[218:219], v15 offset:9728
    v_mul_f32 v237, v255, v231
    v_exp_f32 v228, v228
    v_fract_f32 v237, v237
    s_waitcnt lgkmcnt(6)
    v_mfma_f32_32x32x16_bf16 v[112:127], v[224:227], a[168:171], v[112:127]
    ds_read_b64_tr_b16 v[220:221], v6 offset:6144
    v_cos_f32 v236, v237
    v_mfma_f32_32x32x16_bf16 v[128:143], v[224:227], a[172:175], v[128:143]
    ds_read_b64_tr_b16 v[222:223], v6 offset:6656
    v_sin_f32 v237, v237
    v_mul_f32 v236, v228, v236
    v_mul_f32 v237, v228, v237
    s_waitcnt lgkmcnt(6)
    v_mfma_f32_32x32x16_bf16 v[80:95], v[208:211], a[176:179], v[80:95]
    s_waitcnt vmcnt(2)
    s_barrier
    ds_read_b64_tr_b16 v[224:225], v9 offset:12288
    v_fma_f32 v242, v236, v246, v242
    v_fma_f32 v243, v236, v247, v243
    v_mfma_f32_32x32x16_bf16 v[96:111], v[208:211], a[180:183], v[96:111]
    ds_read_b64_tr_b16 v[226:227], v15 offset:12288
    s_add_u32 m0, s60, 4096
    s_cmp_ge_u32 8, s3
    s_cselect_b32 s59, s5, s72
    s_add_u32 s59, s59, 4718592
    buffer_load_dwordx4 v4, s[16:19], s59 offen lds
    v_fma_f32 v242, -v237, v247, v242
    s_waitcnt lgkmcnt(6)
    v_mfma_f32_32x32x16_bf16 v[112:127], v[212:215], a[176:179], v[112:127]
    ds_read_b64_tr_b16 v[208:209], v6 offset:16384
    v_fmac_f32 v243, v237, v246
    v_mul_f32 v11, v48, v48
    v_fma_f32 v11, v11, s70, v10
    v_mfma_f32_32x32x16_bf16 v[128:143], v[212:215], a[180:183], v[128:143]
    ds_read_b64_tr_b16 v[210:211], v6 offset:16896
    v_mul_f32 v11, v48, v11
    v_exp_f32 v11, v11
    s_waitcnt lgkmcnt(6)
    v_mfma_f32_32x32x16_bf16 v[80:95], v[216:219], a[184:187], v[80:95]
    ds_read_b64_tr_b16 v[212:213], v9 offset:12800
    v_mul_f32 v56, v48, v56
    v_add_f32 v11, 1.0, v11
    v_rcp_f32 v48, v11
    v_mfma_f32_32x32x16_bf16 v[96:111], v[216:219], a[188:191], v[96:111]
    ds_read_b64_tr_b16 v[214:215], v15 offset:12800
    v_mul_f32 v12, v49, v49
    v_fma_f32 v12, v12, s70, v10
    v_mul_f32 v12, v49, v12
    s_waitcnt lgkmcnt(6)
    v_mfma_f32_32x32x16_bf16 v[112:127], v[220:223], a[184:187], v[112:127]
    ds_read_b64_tr_b16 v[216:217], v6 offset:18432
    v_exp_f32 v12, v12
    v_mul_f32 v57, v49, v57
    v_add_f32 v12, 1.0, v12
    v_mfma_f32_32x32x16_bf16 v[128:143], v[220:223], a[188:191], v[128:143]
    ds_read_b64_tr_b16 v[218:219], v6 offset:18944
    v_rcp_f32 v49, v12
    v_mul_f32 v56, v56, v48
    s_waitcnt lgkmcnt(6)
    v_mfma_f32_32x32x16_bf16 v[80:95], v[224:227], a[192:195], v[80:95]
    ds_read_b64_tr_b16 v[220:221], v9 offset:13312
    v_mul_f32 v11, v50, v50
    v_fma_f32 v11, v11, s70, v10
    v_mul_f32 v11, v50, v11
    v_mfma_f32_32x32x16_bf16 v[96:111], v[224:227], a[196:199], v[96:111]
    ds_read_b64_tr_b16 v[222:223], v15 offset:13312
    v_exp_f32 v11, v11
    v_mul_f32 v58, v50, v58
    v_add_f32 v11, 1.0, v11
    s_waitcnt lgkmcnt(6)
    v_mfma_f32_32x32x16_bf16 v[112:127], v[208:211], a[192:195], v[112:127]
    ds_read_b64_tr_b16 v[224:225], v6 offset:20480
    v_rcp_f32 v50, v11
    v_mul_f32 v57, v57, v49
    v_mfma_f32_32x32x16_bf16 v[128:143], v[208:211], a[196:199], v[128:143]
    ds_read_b64_tr_b16 v[226:227], v6 offset:20992
    v_cvt_pk_bf16_f32 v48, v56, v57
    v_mul_f32 v12, v51, v51
    v_fma_f32 v12, v12, s70, v10
    s_waitcnt lgkmcnt(6)
    v_mfma_f32_32x32x16_bf16 v[80:95], v[212:215], a[200:203], v[80:95]
    ds_read_b64_tr_b16 v[208:209], v9 offset:13824
    v_mul_f32 v12, v51, v12
    v_exp_f32 v12, v12
    v_mul_f32 v59, v51, v59
    v_mfma_f32_32x32x16_bf16 v[96:111], v[212:215], a[204:207], v[96:111]
    ds_read_b64_tr_b16 v[210:211], v15 offset:13824
    v_add_f32 v12, 1.0, v12
    v_rcp_f32 v51, v12
    s_waitcnt lgkmcnt(6)
    v_mfma_f32_32x32x16_bf16 v[112:127], v[216:219], a[200:203], v[112:127]
    ds_read_b64_tr_b16 v[212:213], v6 offset:22528
    v_mul_f32 v58, v58, v50
    v_mul_f32 v11, v52, v52
    v_fma_f32 v11, v11, s70, v10
    v_mul_f32 v11, v52, v11
    v_mfma_f32_32x32x16_bf16 v[128:143], v[216:219], a[204:207], v[128:143]
    ds_read_b64_tr_b16 v[214:215], v6 offset:23040
    v_exp_f32 v11, v11
    v_mul_f32 v60, v52, v60
    s_waitcnt lgkmcnt(6)
    v_mfma_f32_32x32x16_bf16 v[80:95], v[220:223], a[208:211], v[80:95]
    s_waitcnt vmcnt(2)
    s_barrier
    ds_read_b64_tr_b16 v[216:217], v9 offset:0
    v_add_f32 v11, 1.0, v11
    v_mfma_f32_32x32x16_bf16 v[96:111], v[220:223], a[212:215], v[96:111]
    ds_read_b64_tr_b16 v[218:219], v15 offset:0
    v_rcp_f32 v52, v11
    v_mul_f32 v59, v59, v51
    v_cvt_pk_bf16_f32 v49, v58, v59
    s_waitcnt lgkmcnt(6)
    v_mfma_f32_32x32x16_bf16 v[112:127], v[224:227], a[208:211], v[112:127]
    ds_read_b64_tr_b16 v[220:221], v6 offset:32768
    v_mul_f32 v12, v53, v53
    v_fma_f32 v12, v12, s70, v10
    v_mul_f32 v12, v53, v12
    v_mfma_f32_32x32x16_bf16 v[128:143], v[224:227], a[212:215], v[128:143]
    ds_read_b64_tr_b16 v[222:223], v6 offset:33280
    v_exp_f32 v12, v12
    v_mul_f32 v61, v53, v61
    v_add_f32 v12, 1.0, v12
    s_waitcnt lgkmcnt(6)
    v_mfma_f32_32x32x16_bf16 v[80:95], v[208:211], a[216:219], v[80:95]
    ds_read_b64_tr_b16 v[224:225], v9 offset:512
    v_rcp_f32 v53, v12
    v_mul_f32 v60, v60, v52
    v_mfma_f32_32x32x16_bf16 v[96:111], v[208:211], a[220:223], v[96:111]
    ds_read_b64_tr_b16 v[226:227], v15 offset:512
    v_mul_f32 v11, v54, v54
    v_fma_f32 v11, v11, s70, v10
    v_mul_f32 v11, v54, v11
    s_waitcnt lgkmcnt(6)
    v_mfma_f32_32x32x16_bf16 v[112:127], v[212:215], a[216:219], v[112:127]
    ds_read_b64_tr_b16 v[208:209], v6 offset:34816
    v_exp_f32 v11, v11
    v_mul_f32 v62, v54, v62
    v_add_f32 v11, 1.0, v11
    v_mfma_f32_32x32x16_bf16 v[128:143], v[212:215], a[220:223], v[128:143]
    ds_read_b64_tr_b16 v[210:211], v6 offset:35328
    v_rcp_f32 v54, v11
    v_mul_f32 v61, v61, v53
    v_cvt_pk_bf16_f32 v50, v60, v61
    s_waitcnt lgkmcnt(6)
    v_mfma_f32_32x32x16_bf16 v[80:95], v[216:219], a[224:227], v[80:95]
    ds_read_b64_tr_b16 v[212:213], v9 offset:1024
    v_mul_f32 v12, v55, v55
    v_fma_f32 v12, v12, s70, v10
    v_mul_f32 v12, v55, v12
    v_mfma_f32_32x32x16_bf16 v[96:111], v[216:219], a[228:231], v[96:111]
    ds_read_b64_tr_b16 v[214:215], v15 offset:1024
    v_exp_f32 v12, v12
    v_mul_f32 v63, v55, v63
    s_waitcnt lgkmcnt(6)
    v_mfma_f32_32x32x16_bf16 v[112:127], v[220:223], a[224:227], v[112:127]
    ds_read_b64_tr_b16 v[216:217], v6 offset:36864
    v_add_f32 v12, 1.0, v12
    v_rcp_f32 v55, v12
    v_mul_f32 v62, v62, v54
    v_mfma_f32_32x32x16_bf16 v[128:143], v[220:223], a[228:231], v[128:143]
    ds_read_b64_tr_b16 v[218:219], v6 offset:37376
    v_mul_f32 v63, v63, v55
    v_cvt_pk_bf16_f32 v51, v62, v63
    v_mul_f32 v11, v64, v64
    s_waitcnt lgkmcnt(6)
    v_mfma_f32_32x32x16_bf16 v[80:95], v[224:227], a[232:235], v[80:95]
    ds_read_b64_tr_b16 v[220:221], v9 offset:1536
    v_fma_f32 v11, v11, s70, v10
    v_mul_f32 v11, v64, v11
    v_exp_f32 v11, v11
    v_mfma_f32_32x32x16_bf16 v[96:111], v[224:227], a[236:239], v[96:111]
    ds_read_b64_tr_b16 v[222:223], v15 offset:1536
    v_mul_f32 v72, v64, v72
    v_add_f32 v11, 1.0, v11
    s_waitcnt lgkmcnt(6)
    v_mfma_f32_32x32x16_bf16 v[112:127], v[208:211], a[232:235], v[112:127]
    ds_read_b64_tr_b16 v[224:225], v6 offset:38912
    v_rcp_f32 v64, v11
    v_mul_f32 v12, v65, v65
    v_fma_f32 v12, v12, s70, v10
    v_mfma_f32_32x32x16_bf16 v[128:143], v[208:211], a[236:239], v[128:143]
    ds_read_b64_tr_b16 v[226:227], v6 offset:39424
    v_mul_f32 v12, v65, v12
    v_exp_f32 v12, v12
    s_waitcnt lgkmcnt(6)
    v_mfma_f32_32x32x16_bf16 v[80:95], v[212:215], a[240:243], v[80:95]
    s_waitcnt vmcnt(0)
    s_barrier
    ds_read_b64_tr_b16 v[208:209], v9 offset:4096
    v_mul_f32 v73, v65, v73
    v_add_f32 v12, 1.0, v12
    v_mfma_f32_32x32x16_bf16 v[96:111], v[212:215], a[244:247], v[96:111]
    ds_read_b64_tr_b16 v[210:211], v15 offset:4096
    v_rcp_f32 v65, v12
    v_mul_f32 v72, v72, v64
    v_mul_f32 v11, v66, v66
    s_waitcnt lgkmcnt(6)
    v_mfma_f32_32x32x16_bf16 v[112:127], v[216:219], a[240:243], v[112:127]
    v_add_u32 v5, 49152, v5
    v_add_u32 v6, 49152, v6
    v_add_u32 v7, 49152, v7
    v_add_u32 v8, 49152, v8
    ds_read_b64_tr_b16 v[212:213], v6 offset:0
    v_fma_f32 v11, v11, s70, v10
    v_mfma_f32_32x32x16_bf16 v[128:143], v[216:219], a[244:247], v[128:143]
    ds_read_b64_tr_b16 v[214:215], v6 offset:512
    v_mul_f32 v11, v66, v11
    v_exp_f32 v11, v11
    s_waitcnt lgkmcnt(6)
    v_mfma_f32_32x32x16_bf16 v[80:95], v[220:223], a[248:251], v[80:95]
    ds_read_b64_tr_b16 v[216:217], v9 offset:4608
    v_mul_f32 v74, v66, v74
    v_add_f32 v11, 1.0, v11
    v_rcp_f32 v66, v11
    v_mfma_f32_32x32x16_bf16 v[96:111], v[220:223], a[252:255], v[96:111]
    ds_read_b64_tr_b16 v[218:219], v15 offset:4608
    v_mul_f32 v73, v73, v65
    v_cvt_pk_bf16_f32 v64, v72, v73
    v_mul_f32 v12, v67, v67
    s_waitcnt lgkmcnt(6)
    v_mfma_f32_32x32x16_bf16 v[112:127], v[224:227], a[248:251], v[112:127]
    ds_read_b64_tr_b16 v[220:221], v6 offset:2048
    v_fma_f32 v12, v12, s70, v10
    v_mul_f32 v12, v67, v12
    v_exp_f32 v12, v12
    v_mfma_f32_32x32x16_bf16 v[128:143], v[224:227], a[252:255], v[128:143]
    ds_read_b64_tr_b16 v[222:223], v6 offset:2560
    v_mul_f32 v75, v67, v75
    v_add_f32 v12, 1.0, v12
    s_waitcnt lgkmcnt(6)
    v_mfma_f32_32x32x16_bf16 v[80:95], v[208:211], v[16:19], v[80:95]
    ds_read_b64_tr_b16 v[224:225], v9 offset:5120
    v_rcp_f32 v67, v12
    v_mul_f32 v74, v74, v66
    v_mul_f32 v11, v68, v68
    v_mfma_f32_32x32x16_bf16 v[96:111], v[208:211], v[20:23], v[96:111]
    ds_read_b64_tr_b16 v[226:227], v15 offset:5120
    v_fma_f32 v11, v11, s70, v10
    v_mul_f32 v11, v68, v11
    v_exp_f32 v11, v11
    s_waitcnt lgkmcnt(6)
    v_mfma_f32_32x32x16_bf16 v[112:127], v[212:215], v[16:19], v[112:127]
    ds_read_b64_tr_b16 v[208:209], v6 offset:4096
    v_mul_f32 v76, v68, v76
    v_add_f32 v11, 1.0, v11
    v_mfma_f32_32x32x16_bf16 v[128:143], v[212:215], v[20:23], v[128:143]
    ds_read_b64_tr_b16 v[210:211], v6 offset:4608
    v_rcp_f32 v68, v11
    v_mul_f32 v75, v75, v67
    v_cvt_pk_bf16_f32 v65, v74, v75
    s_waitcnt lgkmcnt(6)
    v_mfma_f32_32x32x16_bf16 v[80:95], v[216:219], v[24:27], v[80:95]
    ds_read_b64_tr_b16 v[212:213], v9 offset:5632
    v_mul_f32 v12, v69, v69
    v_fma_f32 v12, v12, s70, v10
    v_mul_f32 v12, v69, v12
    v_mfma_f32_32x32x16_bf16 v[96:111], v[216:219], v[28:31], v[96:111]
    ds_read_b64_tr_b16 v[214:215], v15 offset:5632
    v_exp_f32 v12, v12
    v_mul_f32 v77, v69, v77
    v_add_f32 v12, 1.0, v12
    s_waitcnt lgkmcnt(6)
    v_mfma_f32_32x32x16_bf16 v[112:127], v[220:223], v[24:27], v[112:127]
    ds_read_b64_tr_b16 v[216:217], v6 offset:6144
    v_rcp_f32 v69, v12
    v_mul_f32 v76, v76, v68
    v_mfma_f32_32x32x16_bf16 v[128:143], v[220:223], v[28:31], v[128:143]
    ds_read_b64_tr_b16 v[218:219], v6 offset:6656
    v_mul_f32 v11, v70, v70
    v_fma_f32 v11, v11, s70, v10
    v_mul_f32 v11, v70, v11
    s_waitcnt lgkmcnt(6)
    v_mfma_f32_32x32x16_bf16 v[80:95], v[224:227], v[32:35], v[80:95]
    ds_read_b64_tr_b16 v[220:221], v7 offset:32768
    v_exp_f32 v11, v11
    v_mul_f32 v78, v70, v78
    v_add_f32 v11, 1.0, v11
    v_mfma_f32_32x32x16_bf16 v[96:111], v[224:227], v[36:39], v[96:111]
    ds_read_b64_tr_b16 v[222:223], v7 offset:33280
    v_rcp_f32 v70, v11
    v_mul_f32 v77, v77, v69
    s_waitcnt lgkmcnt(6)
    v_mfma_f32_32x32x16_bf16 v[112:127], v[208:211], v[32:35], v[112:127]
    ds_read_b64_tr_b16 v[224:225], v7 offset:34816
    v_cvt_pk_bf16_f32 v66, v76, v77
    v_mul_f32 v12, v71, v71
    v_fma_f32 v12, v12, s70, v10
    v_mul_f32 v12, v71, v12
    v_mfma_f32_32x32x16_bf16 v[128:143], v[208:211], v[36:39], v[128:143]
    ds_read_b64_tr_b16 v[226:227], v7 offset:35328
    v_exp_f32 v12, v12
    v_mul_f32 v79, v71, v79
    s_waitcnt lgkmcnt(6)
    v_mfma_f32_32x32x16_bf16 v[80:95], v[212:215], v[40:43], v[80:95]
    ds_read_b64_tr_b16 v[208:209], v7 offset:36864
    v_add_f32 v12, 1.0, v12
    v_rcp_f32 v71, v12
    v_mfma_f32_32x32x16_bf16 v[96:111], v[212:215], v[44:47], v[96:111]
    ds_read_b64_tr_b16 v[210:211], v7 offset:37376
    v_mul_f32 v78, v78, v70
    v_mul_f32 v79, v79, v71
    v_cvt_pk_bf16_f32 v67, v78, v79
    s_add_u32 s71, s66, 3072
    s_waitcnt lgkmcnt(6)
    v_mfma_f32_32x32x16_bf16 v[112:127], v[216:219], v[40:43], v[112:127]
    ds_read_b64_tr_b16 v[212:213], v7 offset:38912
    buffer_store_dwordx4 v[144:147], v1, s[20:23], s71 offen sc1
    s_add_u32 s71, s67, 3072
    buffer_store_dwordx4 v[160:163], v1, s[20:23], s71 offen sc1
    v_mfma_f32_32x32x16_bf16 v[128:143], v[216:219], v[44:47], v[128:143]
    ds_read_b64_tr_b16 v[214:215], v7 offset:39424
    s_load_dwordx2 s[36:37], s[0:1], 96
    s_load_dwordx4 s[24:27], s[0:1], 40
    s_lshl_b32 s42, s2, 2
    s_add_u32 s42, s42, s53
    s_lshl_b32 s42, s42, 10
    s_waitcnt lgkmcnt(0)
    s_mov_b32 s4, s36
    s_and_b32 s5, s37, 0xffff
    s_mov_b32 s6, 5308416
    s_mov_b32 s7, 0x00020000
    s_mov_b32 s28, s24
    s_and_b32 s29, s25, 0xffff
    s_mov_b32 s30, 663552
    s_mov_b32 s31, 0x00020000
    s_mov_b32 s32, s26
    s_and_b32 s33, s27, 0xffff
    s_mov_b32 s34, 663552
    s_mov_b32 s35, 0x00020000
    s_lshr_b32 s77, s2, 3
    s_lshl_b32 s77, s77, 2
    s_add_u32 s77, s77, s53
    s_getpc_b64 s[24:25]
K2_PC:
    s_add_u32 s24, s24, K3_GOON-K2_PC
    s_addc_u32 s25, s25, 0
    s_and_b32 s25, s25, 0xffff
    s_mov_b32 s26, CODE_END-K3_GOON
    s_mov_b32 s27, 0x00020000
    v_lshlrev_b32 v248, 7, v0
    s_lshl_b32 s77, s77, 13
    v_add_u32 v248, s77, v248
    buffer_load_dword v249, v248, s[24:27], 0 offen
    v_mfma_f32_32x32x16_bf16 v[144:159], v[220:223], a[0:3], 0
    s_barrier
    v_add_u32 v5, 49152, v5
    v_add_u32 v6, 49152, v6
    v_add_u32 v7, 49152, v7
    v_add_u32 v8, 49152, v8
    ds_read_b64_tr_b16 v[216:217], v7 offset:0
    v_mfma_f32_32x32x16_bf16 v[160:175], v[220:223], a[4:7], 0
    ds_read_b64_tr_b16 v[218:219], v7 offset:512
    s_add_u32 s71, s66, 4096
    buffer_store_dwordx4 v[48:51], v1, s[20:23], s71 offen sc1
    s_add_u32 s71, s67, 4096
    v_mfma_f32_32x32x16_bf16 v[144:159], v[224:227], a[8:11], v[144:159]
    ds_read_b64_tr_b16 v[220:221], v7 offset:2048
    buffer_store_dwordx4 v[64:67], v1, s[20:23], s71 offen sc1
    v_mul_f32 v11, v80, v80
    v_fma_f32 v11, v11, s70, v10
    v_mul_f32 v11, v80, v11
    v_mfma_f32_32x32x16_bf16 v[160:175], v[224:227], a[12:15], v[160:175]
    ds_read_b64_tr_b16 v[222:223], v7 offset:2560
    v_exp_f32 v11, v11
    s_add_u32 s43, s42, 0
    v_mfma_f32_32x32x16_bf16 v[144:159], v[208:211], a[16:19], v[144:159]
    ds_read_b64_tr_b16 v[224:225], v7 offset:4096
    buffer_load_dwordx4 v[244:247], v1, s[4:7], s43 offen
    v_mul_f32 v88, v80, v88
    v_add_f32 v11, 1.0, v11
    v_mfma_f32_32x32x16_bf16 v[160:175], v[208:211], a[20:23], v[160:175]
    ds_read_b64_tr_b16 v[226:227], v7 offset:4608
    v_rcp_f32 v80, v11
    v_mul_f32 v12, v81, v81
    v_fma_f32 v12, v12, s70, v10
    v_mfma_f32_32x32x16_bf16 v[144:159], v[212:215], a[24:27], v[144:159]
    ds_read_b64_tr_b16 v[208:209], v7 offset:6144
    v_mul_f32 v12, v81, v12
    v_exp_f32 v12, v12
    v_mul_f32 v89, v81, v89
    v_mfma_f32_32x32x16_bf16 v[160:175], v[212:215], a[28:31], v[160:175]
    ds_read_b64_tr_b16 v[210:211], v7 offset:6656
    v_add_f32 v12, 1.0, v12
    v_rcp_f32 v81, v12
    s_waitcnt lgkmcnt(6)
    v_mfma_f32_32x32x16_bf16 v[144:159], v[216:219], a[32:35], v[144:159]
    ds_read_b64_tr_b16 v[212:213], v7 offset:16384
    v_mul_f32 v88, v88, v80
    v_mul_f32 v11, v82, v82
    v_fma_f32 v11, v11, s70, v10
    v_mfma_f32_32x32x16_bf16 v[160:175], v[216:219], a[36:39], v[160:175]
    ds_read_b64_tr_b16 v[214:215], v7 offset:16896
    v_mul_f32 v11, v82, v11
    v_exp_f32 v11, v11
    v_mul_f32 v90, v82, v90
    s_waitcnt lgkmcnt(6)
    v_mfma_f32_32x32x16_bf16 v[144:159], v[220:223], a[40:43], v[144:159]
    ds_read_b64_tr_b16 v[216:217], v7 offset:18432
    v_add_f32 v11, 1.0, v11
    v_rcp_f32 v82, v11
    v_mfma_f32_32x32x16_bf16 v[160:175], v[220:223], a[44:47], v[160:175]
    ds_read_b64_tr_b16 v[218:219], v7 offset:18944
    s_add_u32 s43, s42, 1048576
    buffer_load_dwordx4 v[244:247], v1, s[4:7], s43 offen
    v_mul_f32 v89, v89, v81
    v_cvt_pk_bf16_f32 v80, v88, v89
    s_waitcnt lgkmcnt(6)
    v_mfma_f32_32x32x16_bf16 v[144:159], v[224:227], a[48:51], v[144:159]
    ds_read_b64_tr_b16 v[220:221], v7 offset:20480
    v_mul_f32 v12, v83, v83
    v_fma_f32 v12, v12, s70, v10
    v_mul_f32 v12, v83, v12
    v_mfma_f32_32x32x16_bf16 v[160:175], v[224:227], a[52:55], v[160:175]
    ds_read_b64_tr_b16 v[222:223], v7 offset:20992
    v_exp_f32 v12, v12
    v_mul_f32 v91, v83, v91
    s_waitcnt lgkmcnt(6)
    v_mfma_f32_32x32x16_bf16 v[144:159], v[208:211], a[56:59], v[144:159]
    ds_read_b64_tr_b16 v[224:225], v7 offset:22528
    v_add_f32 v12, 1.0, v12
    v_rcp_f32 v83, v12
    v_mul_f32 v90, v90, v82
    v_mfma_f32_32x32x16_bf16 v[160:175], v[208:211], a[60:63], v[160:175]
    ds_read_b64_tr_b16 v[226:227], v7 offset:23040
    v_mul_f32 v11, v84, v84
    v_fma_f32 v11, v11, s70, v10
    v_mul_f32 v11, v84, v11
    s_waitcnt lgkmcnt(6)
    v_mfma_f32_32x32x16_bf16 v[144:159], v[212:215], a[64:67], v[144:159]
    ds_read_b64_tr_b16 v[208:209], v7 offset:32768
    v_exp_f32 v11, v11
    v_mul_f32 v92, v84, v92
    v_add_f32 v11, 1.0, v11
    v_mfma_f32_32x32x16_bf16 v[160:175], v[212:215], a[68:71], v[160:175]
    ds_read_b64_tr_b16 v[210:211], v7 offset:33280
    v_rcp_f32 v84, v11
    s_add_u32 s43, s42, 0
    s_waitcnt lgkmcnt(6)
    v_mfma_f32_32x32x16_bf16 v[144:159], v[216:219], a[72:75], v[144:159]
    ds_read_b64_tr_b16 v[212:213], v7 offset:34816
    buffer_load_dwordx4 v[244:247], v1, s[28:31], s43 offen
    v_mul_f32 v91, v91, v83
    v_cvt_pk_bf16_f32 v81, v90, v91
    v_mul_f32 v12, v85, v85
    v_mfma_f32_32x32x16_bf16 v[160:175], v[216:219], a[76:79], v[160:175]
    ds_read_b64_tr_b16 v[214:215], v7 offset:35328
    v_fma_f32 v12, v12, s70, v10
    v_mul_f32 v12, v85, v12
    s_waitcnt lgkmcnt(6)
    v_mfma_f32_32x32x16_bf16 v[144:159], v[220:223], a[80:83], v[144:159]
    ds_read_b64_tr_b16 v[216:217], v7 offset:36864
    v_exp_f32 v12, v12
    v_mul_f32 v93, v85, v93
    v_add_f32 v12, 1.0, v12
    v_mfma_f32_32x32x16_bf16 v[160:175], v[220:223], a[84:87], v[160:175]
    ds_read_b64_tr_b16 v[218:219], v7 offset:37376
    v_rcp_f32 v85, v12
    v_mul_f32 v92, v92, v84
    v_mul_f32 v11, v86, v86
    s_waitcnt lgkmcnt(6)
    v_mfma_f32_32x32x16_bf16 v[144:159], v[224:227], a[88:91], v[144:159]
    ds_read_b64_tr_b16 v[220:221], v7 offset:38912
    v_fma_f32 v11, v11, s70, v10
    v_mul_f32 v11, v86, v11
    v_exp_f32 v11, v11
    v_mfma_f32_32x32x16_bf16 v[160:175], v[224:227], a[92:95], v[160:175]
    ds_read_b64_tr_b16 v[222:223], v7 offset:39424
    v_mul_f32 v94, v86, v94
    v_add_f32 v11, 1.0, v11
    s_waitcnt lgkmcnt(6)
    v_mfma_f32_32x32x16_bf16 v[144:159], v[208:211], a[96:99], v[144:159]
    v_add_u32 v5, 4294918144, v5
    v_add_u32 v6, 4294918144, v6
    v_add_u32 v7, 4294918144, v7
    v_add_u32 v8, 4294918144, v8
    ds_read_b64_tr_b16 v[224:225], v7 offset:16384
    v_rcp_f32 v86, v11
    v_mfma_f32_32x32x16_bf16 v[160:175], v[208:211], a[100:103], v[160:175]
    ds_read_b64_tr_b16 v[226:227], v7 offset:16896
    s_add_u32 s43, s42, 2097152
    buffer_load_dwordx4 v[244:247], v1, s[4:7], s43 offen
    v_mul_f32 v93, v93, v85
    s_waitcnt lgkmcnt(6)
    v_mfma_f32_32x32x16_bf16 v[144:159], v[212:215], a[104:107], v[144:159]
    ds_read_b64_tr_b16 v[208:209], v7 offset:18432
    v_cvt_pk_bf16_f32 v82, v92, v93
    v_mul_f32 v12, v87, v87
    v_fma_f32 v12, v12, s70, v10
    v_mfma_f32_32x32x16_bf16 v[160:175], v[212:215], a[108:111], v[160:175]
    ds_read_b64_tr_b16 v[210:211], v7 offset:18944
    v_mul_f32 v12, v87, v12
    v_exp_f32 v12, v12
    v_mul_f32 v95, v87, v95
    s_waitcnt lgkmcnt(6)
    v_mfma_f32_32x32x16_bf16 v[144:159], v[216:219], a[112:115], v[144:159]
    ds_read_b64_tr_b16 v[212:213], v7 offset:20480
    v_add_f32 v12, 1.0, v12
    v_rcp_f32 v87, v12
    v_mfma_f32_32x32x16_bf16 v[160:175], v[216:219], a[116:119], v[160:175]
    ds_read_b64_tr_b16 v[214:215], v7 offset:20992
    v_mul_f32 v94, v94, v86
    s_add_u32 s71, s68, 0
    v_mul_f32 v95, v95, v87
    s_waitcnt lgkmcnt(6)
    v_mfma_f32_32x32x16_bf16 v[144:159], v[220:223], a[120:123], v[144:159]
    ds_read_b64_tr_b16 v[216:217], v7 offset:22528
    v_cvt_pk_bf16_f32 v83, v94, v95
    buffer_store_dwordx4 v[80:83], v1, s[20:23], s71 offen sc1
    v_mul_f32 v11, v96, v96
    v_fma_f32 v11, v11, s70, v10
    v_mfma_f32_32x32x16_bf16 v[160:175], v[220:223], a[124:127], v[160:175]
    ds_read_b64_tr_b16 v[218:219], v7 offset:23040
    v_mul_f32 v11, v96, v11
    v_exp_f32 v11, v11
    s_waitcnt lgkmcnt(6)
    v_mfma_f32_32x32x16_bf16 v[144:159], v[224:227], a[128:131], v[144:159]
    v_add_u32 v5, 4294918144, v5
    v_add_u32 v6, 4294918144, v6
    v_add_u32 v7, 4294918144, v7
    v_add_u32 v8, 4294918144, v8
    ds_read_b64_tr_b16 v[220:221], v7 offset:0
    s_add_u32 s43, s42, 3145728
    v_mfma_f32_32x32x16_bf16 v[160:175], v[224:227], a[132:135], v[160:175]
    ds_read_b64_tr_b16 v[222:223], v7 offset:512
    buffer_load_dwordx4 v[244:247], v1, s[4:7], s43 offen
    v_mul_f32 v104, v96, v104
    v_add_f32 v11, 1.0, v11
    s_waitcnt lgkmcnt(6)
    v_mfma_f32_32x32x16_bf16 v[144:159], v[208:211], a[136:139], v[144:159]
    ds_read_b64_tr_b16 v[224:225], v7 offset:2048
    v_rcp_f32 v96, v11
    v_mul_f32 v12, v97, v97
    v_fma_f32 v12, v12, s70, v10
    v_mfma_f32_32x32x16_bf16 v[160:175], v[208:211], a[140:143], v[160:175]
    ds_read_b64_tr_b16 v[226:227], v7 offset:2560
    v_mul_f32 v12, v97, v12
    v_exp_f32 v12, v12
    s_waitcnt lgkmcnt(6)
    v_mfma_f32_32x32x16_bf16 v[144:159], v[212:215], a[144:147], v[144:159]
    ds_read_b64_tr_b16 v[208:209], v7 offset:4096
    v_mul_f32 v105, v97, v105
    v_add_f32 v12, 1.0, v12
    v_rcp_f32 v97, v12
    v_mfma_f32_32x32x16_bf16 v[160:175], v[212:215], a[148:151], v[160:175]
    ds_read_b64_tr_b16 v[210:211], v7 offset:4608
    v_mul_f32 v104, v104, v96
    v_mul_f32 v11, v98, v98
    v_fma_f32 v11, v11, s70, v10
    s_waitcnt lgkmcnt(6)
    v_mfma_f32_32x32x16_bf16 v[144:159], v[216:219], a[152:155], v[144:159]
    ds_read_b64_tr_b16 v[212:213], v7 offset:6144
    v_mul_f32 v11, v98, v11
    v_exp_f32 v11, v11
    v_mfma_f32_32x32x16_bf16 v[160:175], v[216:219], a[156:159], v[160:175]
    ds_read_b64_tr_b16 v[214:215], v7 offset:6656
    v_mul_f32 v106, v98, v106
    v_add_f32 v11, 1.0, v11
    s_add_u32 s43, s42, 0
    buffer_load_dwordx4 v[244:247], v1, s[32:35], s43 offen
    s_waitcnt lgkmcnt(6)
    v_mfma_f32_32x32x16_bf16 v[144:159], v[220:223], a[160:163], v[144:159]
    ds_read_b64_tr_b16 v[216:217], v7 offset:16384
    v_rcp_f32 v98, v11
    v_mul_f32 v105, v105, v97
    v_mfma_f32_32x32x16_bf16 v[160:175], v[220:223], a[164:167], v[160:175]
    ds_read_b64_tr_b16 v[218:219], v7 offset:16896
    v_cvt_pk_bf16_f32 v96, v104, v105
    v_mul_f32 v12, v99, v99
    v_fma_f32 v12, v12, s70, v10
    v_mul_f32 v12, v99, v12
    s_waitcnt lgkmcnt(6)
    v_mfma_f32_32x32x16_bf16 v[144:159], v[224:227], a[168:171], v[144:159]
    ds_read_b64_tr_b16 v[220:221], v7 offset:18432
    v_exp_f32 v12, v12
    v_mul_f32 v107, v99, v107
    v_mfma_f32_32x32x16_bf16 v[160:175], v[224:227], a[172:175], v[160:175]
    ds_read_b64_tr_b16 v[222:223], v7 offset:18944
    v_add_f32 v12, 1.0, v12
    v_rcp_f32 v99, v12
    s_waitcnt lgkmcnt(6)
    v_mfma_f32_32x32x16_bf16 v[144:159], v[208:211], a[176:179], v[144:159]
    ds_read_b64_tr_b16 v[224:225], v7 offset:20480
    v_mul_f32 v106, v106, v98
    v_mul_f32 v11, v100, v100
    v_fma_f32 v11, v11, s70, v10
    v_mul_f32 v11, v100, v11
    v_mfma_f32_32x32x16_bf16 v[160:175], v[208:211], a[180:183], v[160:175]
    ds_read_b64_tr_b16 v[226:227], v7 offset:20992
    v_exp_f32 v11, v11
    v_mul_f32 v108, v100, v108
    s_waitcnt lgkmcnt(6)
    v_mfma_f32_32x32x16_bf16 v[144:159], v[212:215], a[184:187], v[144:159]
    ds_read_b64_tr_b16 v[208:209], v7 offset:22528
    v_add_f32 v11, 1.0, v11
    v_rcp_f32 v100, v11
    s_add_u32 s43, s42, 4194304
    v_mfma_f32_32x32x16_bf16 v[160:175], v[212:215], a[188:191], v[160:175]
    ds_read_b64_tr_b16 v[210:211], v7 offset:23040
    buffer_load_dwordx4 v[244:247], v1, s[4:7], s43 offen
    v_mul_f32 v107, v107, v99
    v_cvt_pk_bf16_f32 v97, v106, v107
    s_waitcnt lgkmcnt(6)
    v_mfma_f32_32x32x16_bf16 v[144:159], v[216:219], a[192:195], v[144:159]
    ds_read_b64_tr_b16 v[212:213], v7 offset:32768
    v_mul_f32 v12, v101, v101
    v_fma_f32 v12, v12, s70, v10
    v_mul_f32 v12, v101, v12
    v_mfma_f32_32x32x16_bf16 v[160:175], v[216:219], a[196:199], v[160:175]
    ds_read_b64_tr_b16 v[214:215], v7 offset:33280
    v_exp_f32 v12, v12
    v_mul_f32 v109, v101, v109
    v_add_f32 v12, 1.0, v12
    s_waitcnt lgkmcnt(6)
    v_mfma_f32_32x32x16_bf16 v[144:159], v[220:223], a[200:203], v[144:159]
    ds_read_b64_tr_b16 v[216:217], v7 offset:34816
    v_rcp_f32 v101, v12
    v_mul_f32 v108, v108, v100
    v_mfma_f32_32x32x16_bf16 v[160:175], v[220:223], a[204:207], v[160:175]
    ds_read_b64_tr_b16 v[218:219], v7 offset:35328
    v_mul_f32 v11, v102, v102
    v_fma_f32 v11, v11, s70, v10
    v_mul_f32 v11, v102, v11
    s_waitcnt lgkmcnt(6)
    v_mfma_f32_32x32x16_bf16 v[144:159], v[224:227], a[208:211], v[144:159]
    ds_read_b64_tr_b16 v[220:221], v7 offset:36864
    v_exp_f32 v11, v11
    v_mul_f32 v110, v102, v110
    v_add_f32 v11, 1.0, v11
    v_mfma_f32_32x32x16_bf16 v[160:175], v[224:227], a[212:215], v[160:175]
    ds_read_b64_tr_b16 v[222:223], v7 offset:37376
    v_rcp_f32 v102, v11
    s_add_u32 s43, s42, 5242880
    buffer_load_dwordx4 v[244:247], v1, s[4:7], s43 offen
    s_waitcnt lgkmcnt(6)
    v_mfma_f32_32x32x16_bf16 v[144:159], v[208:211], a[216:219], v[144:159]
    ds_read_b64_tr_b16 v[224:225], v7 offset:38912
    v_mul_f32 v109, v109, v101
    v_cvt_pk_bf16_f32 v98, v108, v109
    v_mul_f32 v12, v103, v103
    v_mfma_f32_32x32x16_bf16 v[160:175], v[208:211], a[220:223], v[160:175]
    ds_read_b64_tr_b16 v[226:227], v7 offset:39424
    v_fma_f32 v12, v12, s70, v10
    v_mul_f32 v12, v103, v12
    v_exp_f32 v12, v12
    s_waitcnt lgkmcnt(6)
    v_mfma_f32_32x32x16_bf16 v[144:159], v[212:215], a[224:227], v[144:159]
    v_add_u32 v5, 49152, v5
    v_add_u32 v6, 49152, v6
    v_add_u32 v7, 49152, v7
    v_add_u32 v8, 49152, v8
    ds_read_b64_tr_b16 v[208:209], v7 offset:0
    v_mfma_f32_32x32x16_bf16 v[160:175], v[212:215], a[228:231], v[160:175]
    ds_read_b64_tr_b16 v[210:211], v7 offset:512
    v_mul_f32 v111, v103, v111
    v_add_f32 v12, 1.0, v12
    v_rcp_f32 v103, v12
    s_waitcnt lgkmcnt(6)
    v_mfma_f32_32x32x16_bf16 v[144:159], v[216:219], a[232:235], v[144:159]
    ds_read_b64_tr_b16 v[212:213], v7 offset:2048
    v_mul_f32 v110, v110, v102
    s_add_u32 s71, s69, 0
    v_mul_f32 v111, v111, v103
    v_mfma_f32_32x32x16_bf16 v[160:175], v[216:219], a[236:239], v[160:175]
    ds_read_b64_tr_b16 v[214:215], v7 offset:2560
    v_cvt_pk_bf16_f32 v99, v110, v111
    buffer_store_dwordx4 v[96:99], v1, s[20:23], s71 offen sc1
    v_mul_f32 v11, v112, v112
    s_waitcnt lgkmcnt(6)
    v_mfma_f32_32x32x16_bf16 v[144:159], v[220:223], a[240:243], v[144:159]
    ds_read_b64_tr_b16 v[216:217], v7 offset:4096
    v_fma_f32 v11, v11, s70, v10
    v_mul_f32 v11, v112, v11
    v_exp_f32 v11, v11
    v_mfma_f32_32x32x16_bf16 v[160:175], v[220:223], a[244:247], v[160:175]
    ds_read_b64_tr_b16 v[218:219], v7 offset:4608
    v_mul_f32 v120, v112, v120
    v_add_f32 v11, 1.0, v11
    v_rcp_f32 v112, v11
    s_waitcnt lgkmcnt(6)
    v_mfma_f32_32x32x16_bf16 v[144:159], v[224:227], a[248:251], v[144:159]
    ds_read_b64_tr_b16 v[220:221], v7 offset:6144
    v_mul_f32 v12, v113, v113
    v_fma_f32 v12, v12, s70, v10
    v_mul_f32 v12, v113, v12
    v_mfma_f32_32x32x16_bf16 v[160:175], v[224:227], a[252:255], v[160:175]
    ds_read_b64_tr_b16 v[222:223], v7 offset:6656
    v_exp_f32 v12, v12
    v_mul_f32 v121, v113, v121
    s_waitcnt lgkmcnt(6)
    v_mfma_f32_32x32x16_bf16 v[144:159], v[208:211], v[16:19], v[144:159]
    ds_read_b64_tr_b16 v[224:225], v8 offset:32768
    v_add_f32 v12, 1.0, v12
    v_rcp_f32 v113, v12
    v_mfma_f32_32x32x16_bf16 v[160:175], v[208:211], v[20:23], v[160:175]
    ds_read_b64_tr_b16 v[226:227], v8 offset:33280
    v_mul_f32 v120, v120, v112
    v_mul_f32 v11, v114, v114
    v_fma_f32 v11, v11, s70, v10
    v_mul_f32 v11, v114, v11
    s_waitcnt lgkmcnt(6)
    v_mfma_f32_32x32x16_bf16 v[144:159], v[212:215], v[24:27], v[144:159]
    ds_read_b64_tr_b16 v[208:209], v8 offset:34816
    v_exp_f32 v11, v11
    v_mul_f32 v122, v114, v122
    v_mfma_f32_32x32x16_bf16 v[160:175], v[212:215], v[28:31], v[160:175]
    ds_read_b64_tr_b16 v[210:211], v8 offset:35328
    v_add_f32 v11, 1.0, v11
    v_rcp_f32 v114, v11
    v_mul_f32 v121, v121, v113
    s_waitcnt lgkmcnt(6)
    v_mfma_f32_32x32x16_bf16 v[144:159], v[216:219], v[32:35], v[144:159]
    ds_read_b64_tr_b16 v[212:213], v8 offset:36864
    v_cvt_pk_bf16_f32 v112, v120, v121
    v_mul_f32 v12, v115, v115
    v_fma_f32 v12, v12, s70, v10
    v_mfma_f32_32x32x16_bf16 v[160:175], v[216:219], v[36:39], v[160:175]
    ds_read_b64_tr_b16 v[214:215], v8 offset:37376
    v_mul_f32 v12, v115, v12
    v_exp_f32 v12, v12
    v_mul_f32 v123, v115, v123
    s_waitcnt lgkmcnt(6)
    v_mfma_f32_32x32x16_bf16 v[144:159], v[220:223], v[40:43], v[144:159]
    ds_read_b64_tr_b16 v[216:217], v8 offset:38912
    v_add_f32 v12, 1.0, v12
    s_waitcnt vmcnt(13)
    buffer_atomic_add v233, v232, s[20:23], s83 offen sc1
    v_mfma_f32_32x32x16_bf16 v[160:175], v[220:223], v[44:47], v[160:175]
    ds_read_b64_tr_b16 v[218:219], v8 offset:39424
    s_waitcnt lgkmcnt(6)
    v_mfma_f32_32x32x16_bf16 v[48:63], v[224:227], a[0:3], 0
    v_add_u32 v5, 49152, v5
    v_add_u32 v6, 49152, v6
    v_add_u32 v7, 49152, v7
    v_add_u32 v8, 49152, v8
    ds_read_b64_tr_b16 v[220:221], v8 offset:0
    v_mfma_f32_32x32x16_bf16 v[64:79], v[224:227], a[4:7], 0
    ds_read_b64_tr_b16 v[222:223], v8 offset:512
    v_rcp_f32 v115, v12
    v_mul_f32 v122, v122, v114
    v_mul_f32 v11, v116, v116
    s_waitcnt lgkmcnt(6)
    v_mfma_f32_32x32x16_bf16 v[48:63], v[208:211], a[8:11], v[48:63]
    ds_read_b64_tr_b16 v[224:225], v8 offset:2048
    v_fma_f32 v11, v11, s70, v10
    v_mul_f32 v11, v116, v11
    v_exp_f32 v11, v11
    v_mul_f32 v124, v116, v124
    v_mfma_f32_32x32x16_bf16 v[64:79], v[208:211], a[12:15], v[64:79]
    ds_read_b64_tr_b16 v[226:227], v8 offset:2560
    v_add_f32 v11, 1.0, v11
    v_rcp_f32 v116, v11
    v_mul_f32 v123, v123, v115
    s_waitcnt lgkmcnt(6)
    v_mfma_f32_32x32x16_bf16 v[48:63], v[212:215], a[16:19], v[48:63]
    ds_read_b64_tr_b16 v[208:209], v8 offset:4096
    v_cvt_pk_bf16_f32 v113, v122, v123
    v_mul_f32 v12, v117, v117
    v_fma_f32 v12, v12, s70, v10
    v_mul_f32 v12, v117, v12
    v_mfma_f32_32x32x16_bf16 v[64:79], v[212:215], a[20:23], v[64:79]
    ds_read_b64_tr_b16 v[210:211], v8 offset:4608
    v_exp_f32 v12, v12
    v_mul_f32 v125, v117, v125
    v_add_f32 v12, 1.0, v12
    v_rcp_f32 v117, v12
    s_waitcnt lgkmcnt(6)
    v_mfma_f32_32x32x16_bf16 v[48:63], v[216:219], a[24:27], v[48:63]
    ds_read_b64_tr_b16 v[212:213], v8 offset:6144
    v_mul_f32 v124, v124, v116
    v_mul_f32 v11, v118, v118
    v_fma_f32 v11, v11, s70, v10
    v_mul_f32 v11, v118, v11
    v_mfma_f32_32x32x16_bf16 v[64:79], v[216:219], a[28:31], v[64:79]
    ds_read_b64_tr_b16 v[214:215], v8 offset:6656
    v_exp_f32 v11, v11
    v_mul_f32 v126, v118, v126
    v_add_f32 v11, 1.0, v11
    s_waitcnt lgkmcnt(6)
    v_mfma_f32_32x32x16_bf16 v[48:63], v[220:223], a[32:35], v[48:63]
    ds_read_b64_tr_b16 v[216:217], v8 offset:16384
    v_rcp_f32 v118, v11
    v_mul_f32 v125, v125, v117
    v_cvt_pk_bf16_f32 v114, v124, v125
    v_mul_f32 v12, v119, v119
    v_mfma_f32_32x32x16_bf16 v[64:79], v[220:223], a[36:39], v[64:79]
    ds_read_b64_tr_b16 v[218:219], v8 offset:16896
    v_fma_f32 v12, v12, s70, v10
    v_mul_f32 v12, v119, v12
    v_exp_f32 v12, v12
    s_waitcnt lgkmcnt(6)
    v_mfma_f32_32x32x16_bf16 v[48:63], v[224:227], a[40:43], v[48:63]
    ds_read_b64_tr_b16 v[220:221], v8 offset:18432
    v_mul_f32 v127, v119, v127
    v_add_f32 v12, 1.0, v12
    v_rcp_f32 v119, v12
    v_mfma_f32_32x32x16_bf16 v[64:79], v[224:227], a[44:47], v[64:79]
    ds_read_b64_tr_b16 v[222:223], v8 offset:18944
    v_mul_f32 v126, v126, v118
    s_add_u32 s71, s66, 5120
    v_mul_f32 v127, v127, v119
    v_cvt_pk_bf16_f32 v115, v126, v127
    buffer_store_dwordx4 v[112:115], v1, s[20:23], s71 offen sc1
    s_waitcnt lgkmcnt(6)
    v_mfma_f32_32x32x16_bf16 v[48:63], v[208:211], a[48:51], v[48:63]
    ds_read_b64_tr_b16 v[224:225], v8 offset:20480
    v_mul_f32 v11, v128, v128
    v_fma_f32 v11, v11, s70, v10
    v_mul_f32 v11, v128, v11
    v_exp_f32 v11, v11
    v_mfma_f32_32x32x16_bf16 v[64:79], v[208:211], a[52:55], v[64:79]
    ds_read_b64_tr_b16 v[226:227], v8 offset:20992
    v_mul_f32 v136, v128, v136
    v_add_f32 v11, 1.0, v11
    v_rcp_f32 v128, v11
    s_waitcnt lgkmcnt(6)
    v_mfma_f32_32x32x16_bf16 v[48:63], v[212:215], a[56:59], v[48:63]
    ds_read_b64_tr_b16 v[208:209], v8 offset:22528
    v_mul_f32 v12, v129, v129
    v_fma_f32 v12, v12, s70, v10
    v_mul_f32 v12, v129, v12
    v_exp_f32 v12, v12
    v_mfma_f32_32x32x16_bf16 v[64:79], v[212:215], a[60:63], v[64:79]
    ds_read_b64_tr_b16 v[210:211], v8 offset:23040
    v_mul_f32 v137, v129, v137
    v_add_f32 v12, 1.0, v12
    v_rcp_f32 v129, v12
    s_waitcnt lgkmcnt(6)
    v_mfma_f32_32x32x16_bf16 v[48:63], v[216:219], a[64:67], v[48:63]
    ds_read_b64_tr_b16 v[212:213], v8 offset:32768
    v_mul_f32 v136, v136, v128
    v_mul_f32 v11, v130, v130
    v_fma_f32 v11, v11, s70, v10
    v_mul_f32 v11, v130, v11
    v_mfma_f32_32x32x16_bf16 v[64:79], v[216:219], a[68:71], v[64:79]
    ds_read_b64_tr_b16 v[214:215], v8 offset:33280
    v_exp_f32 v11, v11
    v_mul_f32 v138, v130, v138
    v_add_f32 v11, 1.0, v11
    s_waitcnt lgkmcnt(6)
    v_mfma_f32_32x32x16_bf16 v[48:63], v[220:223], a[72:75], v[48:63]
    ds_read_b64_tr_b16 v[216:217], v8 offset:34816
    v_rcp_f32 v130, v11
    v_mul_f32 v137, v137, v129
    v_cvt_pk_bf16_f32 v128, v136, v137
    v_mul_f32 v12, v131, v131
    v_mfma_f32_32x32x16_bf16 v[64:79], v[220:223], a[76:79], v[64:79]
    ds_read_b64_tr_b16 v[218:219], v8 offset:35328
    v_fma_f32 v12, v12, s70, v10
    v_mul_f32 v12, v131, v12
    v_exp_f32 v12, v12
    v_mul_f32 v139, v131, v139
    s_waitcnt lgkmcnt(6)
    v_mfma_f32_32x32x16_bf16 v[48:63], v[224:227], a[80:83], v[48:63]
    ds_read_b64_tr_b16 v[220:221], v8 offset:36864
    v_add_f32 v12, 1.0, v12
    v_rcp_f32 v131, v12
    v_mul_f32 v138, v138, v130
    v_mfma_f32_32x32x16_bf16 v[64:79], v[224:227], a[84:87], v[64:79]
    ds_read_b64_tr_b16 v[222:223], v8 offset:37376
    v_mul_f32 v11, v132, v132
    v_fma_f32 v11, v11, s70, v10
    v_mul_f32 v11, v132, v11
    v_exp_f32 v11, v11
    s_waitcnt lgkmcnt(6)
    v_mfma_f32_32x32x16_bf16 v[48:63], v[208:211], a[88:91], v[48:63]
    ds_read_b64_tr_b16 v[224:225], v8 offset:38912
    v_mul_f32 v140, v132, v140
    v_add_f32 v11, 1.0, v11
    v_rcp_f32 v132, v11
    v_mfma_f32_32x32x16_bf16 v[64:79], v[208:211], a[92:95], v[64:79]
    ds_read_b64_tr_b16 v[226:227], v8 offset:39424
    v_mul_f32 v139, v139, v131
    v_cvt_pk_bf16_f32 v129, v138, v139
    v_mul_f32 v12, v133, v133
    v_fma_f32 v12, v12, s70, v10
    s_waitcnt lgkmcnt(6)
    v_mfma_f32_32x32x16_bf16 v[48:63], v[212:215], a[96:99], v[48:63]
    v_add_u32 v5, 4294918144, v5
    v_add_u32 v6, 4294918144, v6
    v_add_u32 v7, 4294918144, v7
    v_add_u32 v8, 4294918144, v8
    ds_read_b64_tr_b16 v[208:209], v8 offset:16384
    v_mul_f32 v12, v133, v12
    v_mfma_f32_32x32x16_bf16 v[64:79], v[212:215], a[100:103], v[64:79]
    ds_read_b64_tr_b16 v[210:211], v8 offset:16896
    v_exp_f32 v12, v12
    v_mul_f32 v141, v133, v141
    v_add_f32 v12, 1.0, v12
    s_waitcnt lgkmcnt(6)
    v_mfma_f32_32x32x16_bf16 v[48:63], v[216:219], a[104:107], v[48:63]
    ds_read_b64_tr_b16 v[212:213], v8 offset:18432
    v_rcp_f32 v133, v12
    v_mul_f32 v140, v140, v132
    v_mul_f32 v11, v134, v134
    v_fma_f32 v11, v11, s70, v10
    v_mfma_f32_32x32x16_bf16 v[64:79], v[216:219], a[108:111], v[64:79]
    ds_read_b64_tr_b16 v[214:215], v8 offset:18944
    v_mul_f32 v11, v134, v11
    v_exp_f32 v11, v11
    v_mul_f32 v142, v134, v142
    v_add_f32 v11, 1.0, v11
    s_waitcnt lgkmcnt(6)
    v_mfma_f32_32x32x16_bf16 v[48:63], v[220:223], a[112:115], v[48:63]
    ds_read_b64_tr_b16 v[216:217], v8 offset:20480
    v_rcp_f32 v134, v11
    v_mul_f32 v141, v141, v133
    v_cvt_pk_bf16_f32 v130, v140, v141
    v_mfma_f32_32x32x16_bf16 v[64:79], v[220:223], a[116:119], v[64:79]
    ds_read_b64_tr_b16 v[218:219], v8 offset:20992
    v_mul_f32 v12, v135, v135
    v_fma_f32 v12, v12, s70, v10
    v_mul_f32 v12, v135, v12
    v_exp_f32 v12, v12
    s_waitcnt lgkmcnt(6)
    v_mfma_f32_32x32x16_bf16 v[48:63], v[224:227], a[120:123], v[48:63]
    ds_read_b64_tr_b16 v[220:221], v8 offset:22528
    v_mul_f32 v143, v135, v143
    v_add_f32 v12, 1.0, v12
    v_rcp_f32 v135, v12
    v_mfma_f32_32x32x16_bf16 v[64:79], v[224:227], a[124:127], v[64:79]
    ds_read_b64_tr_b16 v[222:223], v8 offset:23040
    v_mul_f32 v142, v142, v134
    s_add_u32 s71, s67, 5120
    v_mul_f32 v143, v143, v135
    v_cvt_pk_bf16_f32 v131, v142, v143
    s_waitcnt lgkmcnt(6)
    v_mfma_f32_32x32x16_bf16 v[48:63], v[208:211], a[128:131], v[48:63]
    v_add_u32 v5, 4294918144, v5
    v_add_u32 v6, 4294918144, v6
    v_add_u32 v7, 4294918144, v7
    v_add_u32 v8, 4294918144, v8
    ds_read_b64_tr_b16 v[224:225], v8 offset:0
    buffer_store_dwordx4 v[128:131], v1, s[20:23], s71 offen sc1
    v_mfma_f32_32x32x16_bf16 v[64:79], v[208:211], a[132:135], v[64:79]
    ds_read_b64_tr_b16 v[226:227], v8 offset:512
    v_mul_f32 v11, v144, v144
    v_fma_f32 v11, v11, s70, v10
    v_mul_f32 v11, v144, v11
    v_exp_f32 v11, v11
    s_waitcnt lgkmcnt(6)
    v_mfma_f32_32x32x16_bf16 v[48:63], v[212:215], a[136:139], v[48:63]
    ds_read_b64_tr_b16 v[208:209], v8 offset:2048
    v_mul_f32 v152, v144, v152
    v_add_f32 v11, 1.0, v11
    v_rcp_f32 v144, v11
    v_mfma_f32_32x32x16_bf16 v[64:79], v[212:215], a[140:143], v[64:79]
    ds_read_b64_tr_b16 v[210:211], v8 offset:2560
    v_mul_f32 v12, v145, v145
    v_fma_f32 v12, v12, s70, v10
    v_mul_f32 v12, v145, v12
    v_exp_f32 v12, v12
    s_waitcnt lgkmcnt(6)
    v_mfma_f32_32x32x16_bf16 v[48:63], v[216:219], a[144:147], v[48:63]
    ds_read_b64_tr_b16 v[212:213], v8 offset:4096
    v_mul_f32 v153, v145, v153
    v_add_f32 v12, 1.0, v12
    v_rcp_f32 v145, v12
    v_mfma_f32_32x32x16_bf16 v[64:79], v[216:219], a[148:151], v[64:79]
    ds_read_b64_tr_b16 v[214:215], v8 offset:4608
    v_mul_f32 v152, v152, v144
    v_mul_f32 v11, v146, v146
    v_fma_f32 v11, v11, s70, v10
    v_mul_f32 v11, v146, v11
    s_waitcnt lgkmcnt(6)
    v_mfma_f32_32x32x16_bf16 v[48:63], v[220:223], a[152:155], v[48:63]
    ds_read_b64_tr_b16 v[216:217], v8 offset:6144
    v_exp_f32 v11, v11
    v_mul_f32 v154, v146, v154
    v_add_f32 v11, 1.0, v11
    v_mfma_f32_32x32x16_bf16 v[64:79], v[220:223], a[156:159], v[64:79]
    ds_read_b64_tr_b16 v[218:219], v8 offset:6656
    v_rcp_f32 v146, v11
    v_mul_f32 v153, v153, v145
    v_cvt_pk_bf16_f32 v144, v152, v153
    v_mul_f32 v12, v147, v147
    s_waitcnt lgkmcnt(6)
    v_mfma_f32_32x32x16_bf16 v[48:63], v[224:227], a[160:163], v[48:63]
    ds_read_b64_tr_b16 v[220:221], v8 offset:16384
    v_fma_f32 v12, v12, s70, v10
    v_mul_f32 v12, v147, v12
    v_exp_f32 v12, v12
    v_mul_f32 v155, v147, v155
    v_mfma_f32_32x32x16_bf16 v[64:79], v[224:227], a[164:167], v[64:79]
    ds_read_b64_tr_b16 v[222:223], v8 offset:16896
    v_add_f32 v12, 1.0, v12
    v_rcp_f32 v147, v12
    v_mul_f32 v154, v154, v146
    s_waitcnt lgkmcnt(6)
    v_mfma_f32_32x32x16_bf16 v[48:63], v[208:211], a[168:171], v[48:63]
    ds_read_b64_tr_b16 v[224:225], v8 offset:18432
    v_mul_f32 v11, v148, v148
    v_fma_f32 v11, v11, s70, v10
    v_mul_f32 v11, v148, v11
    v_exp_f32 v11, v11
    v_mfma_f32_32x32x16_bf16 v[64:79], v[208:211], a[172:175], v[64:79]
    ds_read_b64_tr_b16 v[226:227], v8 offset:18944
    v_mul_f32 v156, v148, v156
    v_add_f32 v11, 1.0, v11
    v_rcp_f32 v148, v11
    s_waitcnt lgkmcnt(6)
    v_mfma_f32_32x32x16_bf16 v[48:63], v[212:215], a[176:179], v[48:63]
    ds_read_b64_tr_b16 v[208:209], v8 offset:20480
    v_mul_f32 v155, v155, v147
    v_cvt_pk_bf16_f32 v145, v154, v155
    v_mul_f32 v12, v149, v149
    v_fma_f32 v12, v12, s70, v10
    v_mul_f32 v12, v149, v12
    v_mfma_f32_32x32x16_bf16 v[64:79], v[212:215], a[180:183], v[64:79]
    ds_read_b64_tr_b16 v[210:211], v8 offset:20992
    v_exp_f32 v12, v12
    v_mul_f32 v157, v149, v157
    v_add_f32 v12, 1.0, v12
    s_waitcnt lgkmcnt(6)
    v_mfma_f32_32x32x16_bf16 v[48:63], v[216:219], a[184:187], v[48:63]
    ds_read_b64_tr_b16 v[212:213], v8 offset:22528
    v_rcp_f32 v149, v12
    v_mul_f32 v156, v156, v148
    v_mul_f32 v11, v150, v150
    v_fma_f32 v11, v11, s70, v10
    v_mfma_f32_32x32x16_bf16 v[64:79], v[216:219], a[188:191], v[64:79]
    ds_read_b64_tr_b16 v[214:215], v8 offset:23040
    v_mul_f32 v11, v150, v11
    v_exp_f32 v11, v11
    v_mul_f32 v158, v150, v158
    s_waitcnt lgkmcnt(6)
    v_mfma_f32_32x32x16_bf16 v[48:63], v[220:223], a[192:195], v[48:63]
    ds_read_b64_tr_b16 v[216:217], v8 offset:32768
    v_add_f32 v11, 1.0, v11
    v_rcp_f32 v150, v11
    v_mul_f32 v157, v157, v149
    v_mfma_f32_32x32x16_bf16 v[64:79], v[220:223], a[196:199], v[64:79]
    ds_read_b64_tr_b16 v[218:219], v8 offset:33280
    v_cvt_pk_bf16_f32 v146, v156, v157
    v_mul_f32 v12, v151, v151
    v_fma_f32 v12, v12, s70, v10
    v_mul_f32 v12, v151, v12
    s_waitcnt lgkmcnt(6)
    v_mfma_f32_32x32x16_bf16 v[48:63], v[224:227], a[200:203], v[48:63]
    ds_read_b64_tr_b16 v[220:221], v8 offset:34816
    v_exp_f32 v12, v12
    v_mul_f32 v159, v151, v159
    v_add_f32 v12, 1.0, v12
    v_rcp_f32 v151, v12
    v_mfma_f32_32x32x16_bf16 v[64:79], v[224:227], a[204:207], v[64:79]
    ds_read_b64_tr_b16 v[222:223], v8 offset:35328
    v_mul_f32 v158, v158, v150
    s_add_u32 s71, s66, 6144
    v_mul_f32 v159, v159, v151
    v_cvt_pk_bf16_f32 v147, v158, v159
    s_waitcnt lgkmcnt(6)
    v_mfma_f32_32x32x16_bf16 v[48:63], v[208:211], a[208:211], v[48:63]
    ds_read_b64_tr_b16 v[224:225], v8 offset:36864
    buffer_store_dwordx4 v[144:147], v1, s[20:23], s71 offen sc1
    v_mul_f32 v11, v160, v160
    v_fma_f32 v11, v11, s70, v10
    v_mul_f32 v11, v160, v11
    v_mfma_f32_32x32x16_bf16 v[64:79], v[208:211], a[212:215], v[64:79]
    ds_read_b64_tr_b16 v[226:227], v8 offset:37376
    v_exp_f32 v11, v11
    v_mul_f32 v168, v160, v168
    v_add_f32 v11, 1.0, v11
    s_waitcnt lgkmcnt(6)
    v_mfma_f32_32x32x16_bf16 v[48:63], v[212:215], a[216:219], v[48:63]
    ds_read_b64_tr_b16 v[208:209], v8 offset:38912
    v_rcp_f32 v160, v11
    v_mul_f32 v12, v161, v161
    v_fma_f32 v12, v12, s70, v10
    v_mul_f32 v12, v161, v12
    v_mfma_f32_32x32x16_bf16 v[64:79], v[212:215], a[220:223], v[64:79]
    ds_read_b64_tr_b16 v[210:211], v8 offset:39424
    v_exp_f32 v12, v12
    v_mul_f32 v169, v161, v169
    v_add_f32 v12, 1.0, v12
    s_waitcnt lgkmcnt(6)
    v_mfma_f32_32x32x16_bf16 v[48:63], v[216:219], a[224:227], v[48:63]
    v_add_u32 v5, 49152, v5
    v_add_u32 v6, 49152, v6
    v_add_u32 v7, 49152, v7
    v_add_u32 v8, 49152, v8
    ds_read_b64_tr_b16 v[212:213], v8 offset:0
    v_rcp_f32 v161, v12
    v_mfma_f32_32x32x16_bf16 v[64:79], v[216:219], a[228:231], v[64:79]
    ds_read_b64_tr_b16 v[214:215], v8 offset:512
    v_mul_f32 v168, v168, v160
    v_mul_f32 v11, v162, v162
    v_fma_f32 v11, v11, s70, v10
    v_mul_f32 v11, v162, v11
    s_waitcnt lgkmcnt(6)
    v_mfma_f32_32x32x16_bf16 v[48:63], v[220:223], a[232:235], v[48:63]
    ds_read_b64_tr_b16 v[216:217], v8 offset:2048
    v_exp_f32 v11, v11
    v_mul_f32 v170, v162, v170
    v_add_f32 v11, 1.0, v11
    v_mfma_f32_32x32x16_bf16 v[64:79], v[220:223], a[236:239], v[64:79]
    ds_read_b64_tr_b16 v[218:219], v8 offset:2560
    v_rcp_f32 v162, v11
    v_mul_f32 v169, v169, v161
    v_cvt_pk_bf16_f32 v160, v168, v169
    v_mul_f32 v12, v163, v163
    s_waitcnt lgkmcnt(6)
    v_mfma_f32_32x32x16_bf16 v[48:63], v[224:227], a[240:243], v[48:63]
    ds_read_b64_tr_b16 v[220:221], v8 offset:4096
    v_fma_f32 v12, v12, s70, v10
    v_mul_f32 v12, v163, v12
    v_exp_f32 v12, v12
    v_mfma_f32_32x32x16_bf16 v[64:79], v[224:227], a[244:247], v[64:79]
    ds_read_b64_tr_b16 v[222:223], v8 offset:4608
    v_mul_f32 v171, v163, v171
    v_add_f32 v12, 1.0, v12
    v_rcp_f32 v163, v12
    v_mul_f32 v170, v170, v162
    s_waitcnt lgkmcnt(6)
    v_mfma_f32_32x32x16_bf16 v[48:63], v[208:211], a[248:251], v[48:63]
    ds_read_b64_tr_b16 v[224:225], v8 offset:6144
    v_mul_f32 v11, v164, v164
    v_fma_f32 v11, v11, s70, v10
    v_mul_f32 v11, v164, v11
    v_exp_f32 v11, v11
    v_mfma_f32_32x32x16_bf16 v[64:79], v[208:211], a[252:255], v[64:79]
    ds_read_b64_tr_b16 v[226:227], v8 offset:6656
    v_mul_f32 v172, v164, v172
    v_add_f32 v11, 1.0, v11
    v_rcp_f32 v164, v11
    s_waitcnt lgkmcnt(6)
    v_mfma_f32_32x32x16_bf16 v[48:63], v[212:215], v[16:19], v[48:63]
    v_mul_f32 v171, v171, v163
    v_cvt_pk_bf16_f32 v161, v170, v171
    v_mul_f32 v12, v165, v165
    v_fma_f32 v12, v12, s70, v10
    v_mul_f32 v12, v165, v12
    v_mfma_f32_32x32x16_bf16 v[64:79], v[212:215], v[20:23], v[64:79]
    v_exp_f32 v12, v12
    v_mul_f32 v173, v165, v173
    v_add_f32 v12, 1.0, v12
    v_rcp_f32 v165, v12
    s_waitcnt lgkmcnt(4)
    v_mfma_f32_32x32x16_bf16 v[48:63], v[216:219], v[24:27], v[48:63]
    v_mul_f32 v172, v172, v164
    v_mul_f32 v11, v166, v166
    v_fma_f32 v11, v11, s70, v10
    v_mul_f32 v11, v166, v11
    v_mfma_f32_32x32x16_bf16 v[64:79], v[216:219], v[28:31], v[64:79]
    v_exp_f32 v11, v11
    v_mul_f32 v174, v166, v174
    v_add_f32 v11, 1.0, v11
    v_rcp_f32 v166, v11
    s_waitcnt lgkmcnt(2)
    v_mfma_f32_32x32x16_bf16 v[48:63], v[220:223], v[32:35], v[48:63]
    v_mul_f32 v173, v173, v165
    v_cvt_pk_bf16_f32 v162, v172, v173
    v_mul_f32 v12, v167, v167
    v_fma_f32 v12, v12, s70, v10
    v_mul_f32 v12, v167, v12
    v_mfma_f32_32x32x16_bf16 v[64:79], v[220:223], v[36:39], v[64:79]
    v_exp_f32 v12, v12
    v_mul_f32 v175, v167, v175
    v_add_f32 v12, 1.0, v12
    v_rcp_f32 v167, v12
    s_waitcnt lgkmcnt(0)
    v_mfma_f32_32x32x16_bf16 v[48:63], v[224:227], v[40:43], v[48:63]
    v_mul_f32 v174, v174, v166
    s_add_u32 s71, s67, 6144
    v_mul_f32 v175, v175, v167
    v_cvt_pk_bf16_f32 v163, v174, v175
    buffer_store_dwordx4 v[160:163], v1, s[20:23], s71 offen sc1
    v_mfma_f32_32x32x16_bf16 v[64:79], v[224:227], v[44:47], v[64:79]
    s_nop 5
    v_mul_f32 v11, v48, v48
    v_fma_f32 v11, v11, s70, v10
    v_mul_f32 v11, v48, v11
    v_exp_f32 v11, v11
    v_mul_f32 v56, v48, v56
    v_add_f32 v11, 1.0, v11
    v_rcp_f32 v48, v11
    v_mul_f32 v12, v49, v49
    v_fma_f32 v12, v12, s70, v10
    v_mul_f32 v12, v49, v12
    v_exp_f32 v12, v12
    v_mul_f32 v57, v49, v57
    v_add_f32 v12, 1.0, v12
    v_rcp_f32 v49, v12
    v_mul_f32 v56, v56, v48
    v_mul_f32 v11, v50, v50
    v_fma_f32 v11, v11, s70, v10
    v_mul_f32 v11, v50, v11
    v_exp_f32 v11, v11
    v_mul_f32 v58, v50, v58
    v_add_f32 v11, 1.0, v11
    v_rcp_f32 v50, v11
    v_mul_f32 v57, v57, v49
    v_cvt_pk_bf16_f32 v48, v56, v57
    v_mul_f32 v12, v51, v51
    v_fma_f32 v12, v12, s70, v10
    v_mul_f32 v12, v51, v12
    v_exp_f32 v12, v12
    v_mul_f32 v59, v51, v59
    v_add_f32 v12, 1.0, v12
    v_rcp_f32 v51, v12
    v_mul_f32 v58, v58, v50
    v_mul_f32 v11, v52, v52
    v_fma_f32 v11, v11, s70, v10
    v_mul_f32 v11, v52, v11
    v_exp_f32 v11, v11
    v_mul_f32 v60, v52, v60
    v_add_f32 v11, 1.0, v11
    v_rcp_f32 v52, v11
    v_mul_f32 v59, v59, v51
    v_cvt_pk_bf16_f32 v49, v58, v59
    v_mul_f32 v12, v53, v53
    v_fma_f32 v12, v12, s70, v10
    v_mul_f32 v12, v53, v12
    v_exp_f32 v12, v12
    v_mul_f32 v61, v53, v61
    v_add_f32 v12, 1.0, v12
    v_rcp_f32 v53, v12
    v_mul_f32 v60, v60, v52
    v_mul_f32 v11, v54, v54
    v_fma_f32 v11, v11, s70, v10
    v_mul_f32 v11, v54, v11
    v_exp_f32 v11, v11
    v_mul_f32 v62, v54, v62
    v_add_f32 v11, 1.0, v11
    v_rcp_f32 v54, v11
    v_mul_f32 v61, v61, v53
    v_cvt_pk_bf16_f32 v50, v60, v61
    v_mul_f32 v12, v55, v55
    v_fma_f32 v12, v12, s70, v10
    v_mul_f32 v12, v55, v12
    v_exp_f32 v12, v12
    v_mul_f32 v63, v55, v63
    v_add_f32 v12, 1.0, v12
    v_rcp_f32 v55, v12
    v_mul_f32 v62, v62, v54
    s_add_u32 s71, s66, 7168
    v_mul_f32 v63, v63, v55
    v_cvt_pk_bf16_f32 v51, v62, v63
    buffer_store_dwordx4 v[48:51], v1, s[20:23], s71 offen sc1
    v_mul_f32 v11, v64, v64
    v_fma_f32 v11, v11, s70, v10
    v_mul_f32 v11, v64, v11
    v_exp_f32 v11, v11
    v_mul_f32 v72, v64, v72
    v_add_f32 v11, 1.0, v11
    v_rcp_f32 v64, v11
    v_mul_f32 v12, v65, v65
    v_fma_f32 v12, v12, s70, v10
    v_mul_f32 v12, v65, v12
    v_exp_f32 v12, v12
    v_mul_f32 v73, v65, v73
    v_add_f32 v12, 1.0, v12
    v_rcp_f32 v65, v12
    v_mul_f32 v72, v72, v64
    v_mul_f32 v11, v66, v66
    v_fma_f32 v11, v11, s70, v10
    v_mul_f32 v11, v66, v11
    v_exp_f32 v11, v11
    v_mul_f32 v74, v66, v74
    v_add_f32 v11, 1.0, v11
    v_rcp_f32 v66, v11
    v_mul_f32 v73, v73, v65
    v_cvt_pk_bf16_f32 v64, v72, v73
    v_mul_f32 v12, v67, v67
    v_fma_f32 v12, v12, s70, v10
    v_mul_f32 v12, v67, v12
    v_exp_f32 v12, v12
    v_mul_f32 v75, v67, v75
    v_add_f32 v12, 1.0, v12
    v_rcp_f32 v67, v12
    v_mul_f32 v74, v74, v66
    v_mul_f32 v11, v68, v68
    v_fma_f32 v11, v11, s70, v10
    v_mul_f32 v11, v68, v11
    v_exp_f32 v11, v11
    v_mul_f32 v76, v68, v76
    v_add_f32 v11, 1.0, v11
    v_rcp_f32 v68, v11
    v_mul_f32 v75, v75, v67
    v_cvt_pk_bf16_f32 v65, v74, v75
    v_mul_f32 v12, v69, v69
    v_fma_f32 v12, v12, s70, v10
    v_mul_f32 v12, v69, v12
    v_exp_f32 v12, v12
    v_mul_f32 v77, v69, v77
    v_add_f32 v12, 1.0, v12
    v_rcp_f32 v69, v12
    v_mul_f32 v76, v76, v68
    v_mul_f32 v11, v70, v70
    v_fma_f32 v11, v11, s70, v10
    v_mul_f32 v11, v70, v11
    v_exp_f32 v11, v11
    v_mul_f32 v78, v70, v78
    v_add_f32 v11, 1.0, v11
    v_rcp_f32 v70, v11
    v_mul_f32 v77, v77, v69
    v_cvt_pk_bf16_f32 v66, v76, v77
    v_mul_f32 v12, v71, v71
    v_fma_f32 v12, v12, s70, v10
    v_mul_f32 v12, v71, v12
    v_exp_f32 v12, v12
    v_mul_f32 v79, v71, v79
    v_add_f32 v12, 1.0, v12
    v_rcp_f32 v71, v12
    v_mul_f32 v78, v78, v70
    s_add_u32 s71, s67, 7168
    v_mul_f32 v79, v79, v71
    v_cvt_pk_bf16_f32 v67, v78, v79
    buffer_store_dwordx4 v[64:67], v1, s[20:23], s71 offen sc1
    s_mov_b64 exec, -1
    s_barrier
    s_lshr_b32 s57, s2, 3
    s_and_b32 s58, s57, 27
    s_sub_u32 s58, s58, s52
    s_cmp_lg_u32 s58, 24
    s_cbranch_scc1 K3_GOON
    s_load_dwordx4 s[8:11], s[0:1], 8
    s_load_dwordx2 s[36:37], s[0:1], 56
    s_lshr_b32 s50, s2, 5
    s_lshl_b32 s50, s50, 1
    s_add_u32 s50, s50, 20
    s_add_u32 s54, s50, 1
    s_mul_i32 s63, s50, 18432
    s_lshl_b32 s60, s53, 10
    s_sub_u32 s58, 9, s3
    s_lshl_b32 s58, s58, 7
    s_add_u32 s63, s63, s58
    s_sub_u32 s58, s63, 1152
    s_add_u32 m0, s60, 0
    s_add_u32 s59, s63, 0
    buffer_load_dwordx4 v252, s[44:47], s59 offen lds
    s_add_u32 m0, s60, 4096
    s_cmp_ge_u32 1, s3
    s_cselect_b32 s59, s58, s63
    s_add_u32 s59, s59, 128
    buffer_load_dwordx4 v252, s[44:47], s59 offen lds
    s_add_u32 m0, s60, 8192
    s_cmp_ge_u32 2, s3
    s_cselect_b32 s59, s58, s63
    s_add_u32 s59, s59, 256
    buffer_load_dwordx4 v252, s[44:47], s59 offen lds
    s_add_u32 m0, s60, 12288
    s_cmp_ge_u32 3, s3
    s_cselect_b32 s59, s58, s63
    s_add_u32 s59, s59, 384
    buffer_load_dwordx4 v252, s[44:47], s59 offen lds
    s_add_u32 m0, s60, 16384
    s_cmp_ge_u32 4, s3
    s_cselect_b32 s59, s58, s63
    s_add_u32 s59, s59, 512
    buffer_load_dwordx4 v252, s[44:47], s59 offen lds
    s_add_u32 m0, s60, 20480
    s_cmp_ge_u32 5, s3
    s_cselect_b32 s59, s58, s63
    s_add_u32 s59, s59, 640
    buffer_load_dwordx4 v252, s[44:47], s59 offen lds
    s_add_u32 m0, s60, 24576
    s_cmp_ge_u32 6, s3
    s_cselect_b32 s59, s58, s63
    s_add_u32 s59, s59, 768
    buffer_load_dwordx4 v252, s[44:47], s59 offen lds
    s_add_u32 m0, s60, 28672
    s_cmp_ge_u32 7, s3
    s_cselect_b32 s59, s58, s63
    s_add_u32 s59, s59, 896
    buffer_load_dwordx4 v252, s[44:47], s59 offen lds
    s_add_u32 m0, s60, 32768
    s_cmp_ge_u32 8, s3
    s_cselect_b32 s59, s58, s63
    s_add_u32 s59, s59, 1024
    buffer_load_dwordx4 v252, s[44:47], s59 offen lds
    s_add_u32 m0, s60, 36864
    s_add_u32 s59, s63, 18432
    buffer_load_dwordx4 v252, s[44:47], s59 offen lds
    s_add_u32 m0, s60, 40960
    s_cmp_ge_u32 1, s3
    s_cselect_b32 s59, s58, s63
    s_add_u32 s59, s59, 18560
    buffer_load_dwordx4 v252, s[44:47], s59 offen lds
    s_add_u32 m0, s60, 45056
    s_cmp_ge_u32 2, s3
    s_cselect_b32 s59, s58, s63
    s_add_u32 s59, s59, 18688
    buffer_load_dwordx4 v252, s[44:47], s59 offen lds
    s_add_u32 m0, s60, 49152
    s_cmp_ge_u32 3, s3
    s_cselect_b32 s59, s58, s63
    s_add_u32 s59, s59, 18816
    buffer_load_dwordx4 v252, s[44:47], s59 offen lds
    s_add_u32 m0, s60, 53248
    s_cmp_ge_u32 4, s3
    s_cselect_b32 s59, s58, s63
    s_add_u32 s59, s59, 18944
    buffer_load_dwordx4 v252, s[44:47], s59 offen lds
    s_add_u32 m0, s60, 57344
    s_cmp_ge_u32 5, s3
    s_cselect_b32 s59, s58, s63
    s_add_u32 s59, s59, 19072
    buffer_load_dwordx4 v252, s[44:47], s59 offen lds
    s_add_u32 m0, s60, 61440
    s_cmp_ge_u32 6, s3
    s_cselect_b32 s59, s58, s63
    s_add_u32 s59, s59, 19200
    buffer_load_dwordx4 v252, s[44:47], s59 offen lds
    s_add_u32 m0, s60, 65536
    s_cmp_ge_u32 7, s3
    s_cselect_b32 s59, s58, s63
    s_add_u32 s59, s59, 19328
    buffer_load_dwordx4 v252, s[44:47], s59 offen lds
    s_add_u32 m0, s60, 69632
    s_cmp_ge_u32 8, s3
    s_cselect_b32 s59, s58, s63
    s_add_u32 s59, s59, 19456
    buffer_load_dwordx4 v252, s[44:47], s59 offen lds
    s_waitcnt vmcnt(18)
    buffer_atomic_add v233, v232, s[20:23], s100 offen sc1
    s_waitcnt lgkmcnt(0)
    s_mov_b32 s24, s8
    s_and_b32 s25, s9, 0xffff
    s_mov_b32 s26, 1152
    s_mov_b32 s27, 0x00020000
    s_mov_b32 s28, s10
    s_and_b32 s29, s11, 0xffff
    s_mov_b32 s30, 1152
    s_mov_b32 s31, 0x00020000
    s_mov_b32 s32, s36
    s_and_b32 s33, s37, 0xffff
    s_mov_b32 s34, 1152
    s_mov_b32 s35, 0x00020000
    v_and_b32 v5, 15, v0
    s_lshl_b32 s77, s50, 4
    v_add_u32 v5, s77, v5
    v_lshlrev_b32 v5, 1, v5
    v_add_u32 v6, 32, v5
    buffer_load_ushort v112, v5, s[24:27], 0 offen
    buffer_load_ushort v113, v5, s[28:31], 0 offen
    buffer_load_ushort v114, v5, s[32:35], 0 offen
    buffer_load_ushort v116, v6, s[24:27], 0 offen
    buffer_load_ushort v117, v6, s[28:31], 0 offen
    buffer_load_ushort v118, v6, s[32:35], 0 offen
    v_lshrrev_b32 v228, 4, v0
    v_lshlrev_b32 v228, 3, v228
    v_sub_u32 v228, s76, v228
    v_and_b32 v229, 15, v0
    v_lshlrev_b32 v229, 4, v229
    v_lshrrev_b32 v253, 4, v0
    v_lshlrev_b32 v253, 11, v253
    v_sub_u32 v253, v229, v253
    v_add_u32 v253, s75, v253
    v_mov_b32 v229, 50659328
    v_cmp_lt_i32 vcc, 0, v228
    v_add_u32 v255, 4294967040, v253
    s_nop 0
    v_cndmask_b32 v255, v229, v255, vcc
    buffer_load_dwordx4 v[80:83], v255, s[20:23], 0 offen sc0 sc1
    v_cmp_lt_i32 vcc, 1, v228
    v_add_u32 v255, 4294966784, v253
    s_nop 0
    v_cndmask_b32 v255, v229, v255, vcc
    buffer_load_dwordx4 v[84:87], v255, s[20:23], 0 offen sc0 sc1
    v_cmp_lt_i32 vcc, 2, v228
    v_add_u32 v255, 4294966528, v253
    s_nop 0
    v_cndmask_b32 v255, v229, v255, vcc
    buffer_load_dwordx4 v[88:91], v255, s[20:23], 0 offen sc0 sc1
    v_cmp_lt_i32 vcc, 3, v228
    v_add_u32 v255, 4294966272, v253
    s_nop 0
    v_cndmask_b32 v255, v229, v255, vcc
    buffer_load_dwordx4 v[92:95], v255, s[20:23], 0 offen sc0 sc1
    v_cmp_lt_i32 vcc, 4, v228
    v_add_u32 v255, 4294966016, v253
    s_nop 0
    v_cndmask_b32 v255, v229, v255, vcc
    buffer_load_dwordx4 v[96:99], v255, s[20:23], 0 offen sc0 sc1
    v_cmp_lt_i32 vcc, 5, v228
    v_add_u32 v255, 4294965760, v253
    s_nop 0
    v_cndmask_b32 v255, v229, v255, vcc
    buffer_load_dwordx4 v[100:103], v255, s[20:23], 0 offen sc0 sc1
    v_cmp_lt_i32 vcc, 6, v228
    v_add_u32 v255, 4294965504, v253
    s_nop 0
    v_cndmask_b32 v255, v229, v255, vcc
    buffer_load_dwordx4 v[104:107], v255, s[20:23], 0 offen sc0 sc1
    v_cmp_lt_i32 vcc, 7, v228
    v_add_u32 v255, 4294965248, v253
    s_nop 0
    v_cndmask_b32 v255, v229, v255, vcc
    buffer_load_dwordx4 v[108:111], v255, s[20:23], 0 offen sc0 sc1
    s_waitcnt vmcnt(7)
    v_min_f32 v255, v82, v83
    s_waitcnt vmcnt(6)
    v_min3_f32 v255, v255, v86, v87
    s_waitcnt vmcnt(5)
    v_min3_f32 v255, v255, v90, v91
    s_waitcnt vmcnt(4)
    v_min3_f32 v255, v255, v94, v95
    s_waitcnt vmcnt(3)
    v_min3_f32 v255, v255, v98, v99
    s_waitcnt vmcnt(2)
    v_min3_f32 v255, v255, v102, v103
    s_waitcnt vmcnt(1)
    v_min3_f32 v255, v255, v106, v107
    s_waitcnt vmcnt(0)
    v_min3_f32 v255, v255, v110, v111
    v_cmp_gt_f32 vcc, 0.5, v255
    s_nop 4
    s_cbranch_vccnz K2S_SLOW
K2S_BACK:
    v_mul_f32 v228, 0x42800000, v230
    v_mul_f32 v239, 0x42800000, v231
    v_exp_f32 v228, v228
    v_fract_f32 v239, v239
    v_cos_f32 v238, v239
    v_sin_f32 v239, v239
    v_mul_f32 v238, v228, v238
    v_mul_f32 v239, v228, v239
    v_fma_f32 v104, v238, v108, v104
    v_fma_f32 v105, v238, v109, v105
    v_fma_f32 v104, -v239, v109, v104
    v_fmac_f32 v105, v239, v108
    v_fma_f32 v100, v238, v104, v100
    v_fma_f32 v101, v238, v105, v101
    v_fma_f32 v100, -v239, v105, v100
    v_fmac_f32 v101, v239, v104
    v_fma_f32 v96, v238, v100, v96
    v_fma_f32 v97, v238, v101, v97
    v_fma_f32 v96, -v239, v101, v96
    v_fmac_f32 v97, v239, v100
    v_fma_f32 v92, v238, v96, v92
    v_fma_f32 v93, v238, v97, v93
    v_fma_f32 v92, -v239, v97, v92
    v_fmac_f32 v93, v239, v96
    v_fma_f32 v88, v238, v92, v88
    v_fma_f32 v89, v238, v93, v89
    v_fma_f32 v88, -v239, v93, v88
    v_fmac_f32 v89, v239, v92
    v_fma_f32 v84, v238, v88, v84
    v_fma_f32 v85, v238, v89, v85
    v_fma_f32 v84, -v239, v89, v84
    v_fmac_f32 v85, v239, v88
    v_fma_f32 v80, v238, v84, v80
    v_fma_f32 v81, v238, v85, v81
    v_fma_f32 v80, -v239, v85, v80
    v_fmac_f32 v81, v239, v84
    v_mul_f32 v255, 0x44000000, v254
    v_mul_f32 v228, v255, v230
    v_mul_f32 v239, v255, v231
    v_exp_f32 v228, v228
    v_fract_f32 v239, v239
    v_cos_f32 v238, v239
    v_sin_f32 v239, v239
    v_mul_f32 v238, v228, v238
    v_mul_f32 v239, v228, v239
    v_mul_f32 v236, v238, v80
    v_mul_f32 v237, v238, v81
    v_fma_f32 v236, -v239, v81, v236
    v_fmac_f32 v237, v239, v80
    v_mov_b32 v228, v236
    v_mov_b32 v229, v237
    s_nop 0
    v_permlane16_swap_b32 v236, v228
    v_permlane16_swap_b32 v237, v229
    v_add_f32 v236, v236, v228
    v_add_f32 v237, v237, v229
    v_mov_b32 v228, v236
    v_mov_b32 v229, v237
    s_nop 0
    v_permlane32_swap_b32 v236, v228
    v_permlane32_swap_b32 v237, v229
    v_add_f32 v236, v236, v228
    v_add_f32 v237, v237, v229
    s_lshl_b32 s77, s53, 11
    s_add_u32 s77, s77, 147456
    v_and_b32 v13, 15, v0
    v_lshlrev_b32 v13, 6, v13
    v_bfe_u32 v228, v0, 4, 1
    v_lshl_add_u32 v13, v228, 5, v13
    v_lshrrev_b32 v229, 5, v0
    v_lshl_add_u32 v13, v229, 3, v13
    v_add_u32 v13, s77, v13
    v_lshlrev_b32 v14, 3, v229
    v_bfe_u32 v229, v0, 2, 2
    v_add_u32 v14, v14, v229
    v_lshlrev_b32 v14, 6, v14
    v_lshl_add_u32 v14, v228, 5, v14
    v_and_b32 v229, 3, v0
    v_lshl_add_u32 v14, v229, 3, v14
    v_add_u32 v14, s77, v14
    v_mov_b32 v255, 0x00000000
    v_fmac_f32 v255, 0x41000000, v254
    v_mul_f32 v228, v255, v230
    v_mul_f32 v239, v255, v231
    v_exp_f32 v228, v228
    v_fract_f32 v239, v239
    v_cos_f32 v238, v239
    v_sin_f32 v239, v239
    v_mul_f32 v238, v228, v238
    v_mul_f32 v239, v228, v239
    v_fma_f32 v240, v238, v236, v240
    v_fma_f32 v241, v238, v237, v241
    v_fma_f32 v240, -v239, v237, v240
    v_fmac_f32 v241, v239, v236
    v_fma_f32 v176, v234, v240, v176
    v_fma_f32 v184, v234, v241, v184
    v_fma_f32 v176, -v235, v241, v176
    v_fmac_f32 v184, v235, v240
    v_fma_f32 v177, v234, v176, v177
    v_fma_f32 v185, v234, v184, v185
    v_fma_f32 v177, -v235, v184, v177
    v_fmac_f32 v185, v235, v176
    v_fma_f32 v178, v234, v177, v178
    v_fma_f32 v186, v234, v185, v186
    v_fma_f32 v178, -v235, v185, v178
    v_fmac_f32 v186, v235, v177
    v_fma_f32 v179, v234, v178, v179
    v_fma_f32 v187, v234, v186, v187
    v_fma_f32 v179, -v235, v186, v179
    v_fmac_f32 v187, v235, v178
    v_fma_f32 v180, v234, v179, v180
    v_fma_f32 v188, v234, v187, v188
    v_fma_f32 v180, -v235, v187, v180
    v_fmac_f32 v188, v235, v179
    v_fma_f32 v181, v234, v180, v181
    v_fma_f32 v189, v234, v188, v189
    v_fma_f32 v181, -v235, v188, v181
    v_fmac_f32 v189, v235, v180
    v_fma_f32 v182, v234, v181, v182
    v_fma_f32 v190, v234, v189, v190
    v_fma_f32 v182, -v235, v189, v182
    v_fmac_f32 v190, v235, v181
    v_fma_f32 v183, v234, v182, v183
    v_fma_f32 v191, v234, v190, v191
    v_fma_f32 v183, -v235, v190, v183
    v_fmac_f32 v191, v235, v182
    v_cvt_pk_bf16_f32 v176, v176, v177
    v_cvt_pk_bf16_f32 v177, v178, v179
    v_cvt_pk_bf16_f32 v178, v180, v181
    v_cvt_pk_bf16_f32 v179, v182, v183
    v_cvt_pk_bf16_f32 v184, -v184, -v185
    v_cvt_pk_bf16_f32 v185, -v186, -v187
    v_cvt_pk_bf16_f32 v186, -v188, -v189
    v_cvt_pk_bf16_f32 v187, -v190, -v191
    ds_write_b64 v13, v[176:177]
    ds_write_b64 v13, v[178:179] offset:16
    ds_write_b64 v13, v[184:185] offset:1024
    ds_write_b64 v13, v[186:187] offset:1040
    ds_read_b64_tr_b16 v[180:181], v14
    ds_read_b64_tr_b16 v[182:183], v14 offset:256
    ds_read_b64_tr_b16 v[188:189], v14 offset:1024
    ds_read_b64_tr_b16 v[190:191], v14 offset:1280
    s_add_u32 s77, s40, 36864
    s_waitcnt lgkmcnt(2)
    buffer_store_dwordx4 v[180:183], v1, s[20:23], s40 offen sc1
    s_waitcnt lgkmcnt(0)
    buffer_store_dwordx4 v[188:191], v1, s[20:23], s77 offen sc1
    v_mov_b32 v255, 0x42000000
    v_fmac_f32 v255, 0x41000000, v254
    v_mul_f32 v228, v255, v230
    v_mul_f32 v239, v255, v231
    v_exp_f32 v228, v228
    v_fract_f32 v239, v239
    v_cos_f32 v238, v239
    v_sin_f32 v239, v239
    v_mul_f32 v238, v228, v238
    v_mul_f32 v239, v228, v239
    v_fma_f32 v242, v238, v236, v242
    v_fma_f32 v243, v238, v237, v243
    v_fma_f32 v242, -v239, v237, v242
    v_fmac_f32 v243, v239, v236
    v_fma_f32 v192, v234, v242, v192
    v_fma_f32 v200, v234, v243, v200
    v_fma_f32 v192, -v235, v243, v192
    v_fmac_f32 v200, v235, v242
    v_fma_f32 v193, v234, v192, v193
    v_fma_f32 v201, v234, v200, v201
    v_fma_f32 v193, -v235, v200, v193
    v_fmac_f32 v201, v235, v192
    v_fma_f32 v194, v234, v193, v194
    v_fma_f32 v202, v234, v201, v202
    v_fma_f32 v194, -v235, v201, v194
    v_fmac_f32 v202, v235, v193
    v_fma_f32 v195, v234, v194, v195
    v_fma_f32 v203, v234, v202, v203
    v_fma_f32 v195, -v235, v202, v195
    v_fmac_f32 v203, v235, v194
    v_fma_f32 v196, v234, v195, v196
    v_fma_f32 v204, v234, v203, v204
    v_fma_f32 v196, -v235, v203, v196
    v_fmac_f32 v204, v235, v195
    v_fma_f32 v197, v234, v196, v197
    v_fma_f32 v205, v234, v204, v205
    v_fma_f32 v197, -v235, v204, v197
    v_fmac_f32 v205, v235, v196
    v_fma_f32 v198, v234, v197, v198
    v_fma_f32 v206, v234, v205, v206
    v_fma_f32 v198, -v235, v205, v198
    v_fmac_f32 v206, v235, v197
    v_fma_f32 v199, v234, v198, v199
    v_fma_f32 v207, v234, v206, v207
    v_fma_f32 v199, -v235, v206, v199
    v_fmac_f32 v207, v235, v198
    v_cvt_pk_bf16_f32 v192, v192, v193
    v_cvt_pk_bf16_f32 v193, v194, v195
    v_cvt_pk_bf16_f32 v194, v196, v197
    v_cvt_pk_bf16_f32 v195, v198, v199
    v_cvt_pk_bf16_f32 v200, -v200, -v201
    v_cvt_pk_bf16_f32 v201, -v202, -v203
    v_cvt_pk_bf16_f32 v202, -v204, -v205
    v_cvt_pk_bf16_f32 v203, -v206, -v207
    ds_write_b64 v13, v[192:193]
    ds_write_b64 v13, v[194:195] offset:16
    ds_write_b64 v13, v[200:201] offset:1024
    ds_write_b64 v13, v[202:203] offset:1040
    ds_read_b64_tr_b16 v[196:197], v14
    ds_read_b64_tr_b16 v[198:199], v14 offset:256
    ds_read_b64_tr_b16 v[204:205], v14 offset:1024
    ds_read_b64_tr_b16 v[206:207], v14 offset:1280
    s_add_u32 s77, s41, 36864
    s_waitcnt lgkmcnt(2)
    buffer_store_dwordx4 v[196:199], v1, s[20:23], s41 offen sc1
    s_waitcnt lgkmcnt(0)
    buffer_store_dwordx4 v[204:207], v1, s[20:23], s77 offen sc1
    v_and_b32 v13, 31, v0
    v_bfe_u32 v5, v13, 1, 3
    v_lshrrev_b32 v6, 5, v0
    v_xor_b32 v5, v5, v6
    v_lshlrev_b32 v5, 4, v5
    v_lshl_add_u32 v5, v13, 7, v5
    v_xor_b32 v6, 32, v5
    v_xor_b32 v7, 64, v5
    v_xor_b32 v8, 96, v5
    v_add_u32 v9, 36864, v5
    v_add_u32 v10, 36864, v6
    v_add_u32 v11, 36864, v7
    v_add_u32 v12, 36864, v8
    s_lshl_b32 s56, s50, 5
    s_add_u32 s56, s56, s76
    s_lshl_b32 s56, s56, 8
    s_add_u32 s56, s56, 50331648
    s_add_u32 s74, s56, 8192
    s_lshl_b32 s55, s50, 10
    s_add_u32 s64, s73, s55
    s_add_u32 s65, s64, 368640
    s_add_u32 s66, s64, 1024
    s_add_u32 s67, s65, 1024
    s_add_u32 s68, s101, 1024
    s_barrier
    ds_read_b128 v[144:147], v5 offset:0
    ds_read_b128 v[148:151], v6 offset:0
    ds_read_b128 v[152:155], v7 offset:0
    ds_read_b128 v[156:159], v8 offset:0
    ds_read_b128 v[160:163], v5 offset:4096
    ds_read_b128 v[164:167], v6 offset:4096
    s_waitcnt lgkmcnt(5)
    v_mfma_f32_32x32x16_bf16 v[48:63], a[0:3], v[144:147], 0
    ds_read_b128 v[168:171], v7 offset:4096
    v_mfma_f32_32x32x16_bf16 v[64:79], a[4:7], v[144:147], 0
    s_waitcnt lgkmcnt(5)
    v_mfma_f32_32x32x16_bf16 v[48:63], a[8:11], v[148:151], v[48:63]
    ds_read_b128 v[172:175], v8 offset:4096
    v_mov_b32 v228, v112
    v_mfma_f32_32x32x16_bf16 v[64:79], a[12:15], v[148:151], v[64:79]
    v_mov_b32 v229, v113
    s_waitcnt lgkmcnt(5)
    v_mfma_f32_32x32x16_bf16 v[48:63], a[16:19], v[152:155], v[48:63]
    ds_read_b128 v[144:147], v5 offset:8192
    v_mov_b32 v230, v114
    v_mfma_f32_32x32x16_bf16 v[64:79], a[20:23], v[152:155], v[64:79]
    v_lshlrev_b32 v228, 16, v228
    s_waitcnt lgkmcnt(5)
    v_mfma_f32_32x32x16_bf16 v[48:63], a[24:27], v[156:159], v[48:63]
    ds_read_b128 v[148:151], v6 offset:8192
    v_lshlrev_b32 v229, 16, v229
    v_mfma_f32_32x32x16_bf16 v[64:79], a[28:31], v[156:159], v[64:79]
    v_lshlrev_b32 v230, 16, v230
    s_waitcnt lgkmcnt(5)
    v_mfma_f32_32x32x16_bf16 v[48:63], a[32:35], v[160:163], v[48:63]
    ds_read_b128 v[152:155], v7 offset:8192
    v_mul_f32 v230, 0x3fb8aa3b, v230
    v_mfma_f32_32x32x16_bf16 v[64:79], a[36:39], v[160:163], v[64:79]
    v_exp_f32 v230, v230
    s_waitcnt lgkmcnt(5)
    v_mfma_f32_32x32x16_bf16 v[48:63], a[40:43], v[164:167], v[48:63]
    ds_read_b128 v[156:159], v8 offset:8192
    v_mfma_f32_32x32x16_bf16 v[64:79], a[44:47], v[164:167], v[64:79]
    v_cvt_pk_bf16_f32 v230, v230, v230
    s_waitcnt lgkmcnt(5)
    v_mfma_f32_32x32x16_bf16 v[48:63], a[48:51], v[168:171], v[48:63]
    ds_read_b128 v[160:163], v5 offset:12288
    v_lshlrev_b32 v230, 16, v230
    v_mfma_f32_32x32x16_bf16 v[64:79], a[52:55], v[168:171], v[64:79]
    v_mul_f32 v231, v230, v229
    s_waitcnt lgkmcnt(5)
    v_mfma_f32_32x32x16_bf16 v[48:63], a[56:59], v[172:175], v[48:63]
    ds_read_b128 v[164:167], v6 offset:12288
    v_mul_f32 v230, v230, v228
    v_mfma_f32_32x32x16_bf16 v[64:79], a[60:63], v[172:175], v[64:79]
    v_mul_f32 v231, 0x3e22f983, v231
    s_waitcnt lgkmcnt(5)
    v_mfma_f32_32x32x16_bf16 v[48:63], a[64:67], v[144:147], v[48:63]
    ds_read_b128 v[168:171], v7 offset:12288
    v_mul_f32 v230, 0x3fb8aa3b, v230
    v_mfma_f32_32x32x16_bf16 v[64:79], a[68:71], v[144:147], v[64:79]
    v_exp_f32 v244, v230
    s_waitcnt lgkmcnt(5)
    v_mfma_f32_32x32x16_bf16 v[48:63], a[72:75], v[148:151], v[48:63]
    ds_read_b128 v[172:175], v8 offset:12288
    v_mfma_f32_32x32x16_bf16 v[64:79], a[76:79], v[148:151], v[64:79]
    v_fract_f32 v235, v231
    s_waitcnt lgkmcnt(5)
    v_mfma_f32_32x32x16_bf16 v[48:63], a[80:83], v[152:155], v[48:63]
    ds_read_b128 v[144:147], v5 offset:16384
    v_mfma_f32_32x32x16_bf16 v[64:79], a[84:87], v[152:155], v[64:79]
    v_cos_f32 v234, v235
    s_waitcnt lgkmcnt(5)
    v_mfma_f32_32x32x16_bf16 v[48:63], a[88:91], v[156:159], v[48:63]
    ds_read_b128 v[148:151], v6 offset:16384
    v_mfma_f32_32x32x16_bf16 v[64:79], a[92:95], v[156:159], v[64:79]
    v_sin_f32 v235, v235
    s_waitcnt lgkmcnt(5)
    v_mfma_f32_32x32x16_bf16 v[48:63], a[96:99], v[160:163], v[48:63]
    ds_read_b128 v[152:155], v7 offset:16384
    v_mul_f32 v234, v244, v234
    v_mfma_f32_32x32x16_bf16 v[64:79], a[100:103], v[160:163], v[64:79]
    v_mul_f32 v235, v244, v235
    s_waitcnt lgkmcnt(5)
    v_mfma_f32_32x32x16_bf16 v[48:63], a[104:107], v[164:167], v[48:63]
    ds_read_b128 v[156:159], v8 offset:16384
    v_add_f32 v244, -1.0, v234
    v_mfma_f32_32x32x16_bf16 v[64:79], a[108:111], v[164:167], v[64:79]
    v_mul_f32 v245, v228, v228
    s_waitcnt lgkmcnt(5)
    v_mfma_f32_32x32x16_bf16 v[48:63], a[112:115], v[168:171], v[48:63]
    ds_read_b128 v[160:163], v5 offset:20480
    v_fmac_f32 v245, v229, v229
    v_mfma_f32_32x32x16_bf16 v[64:79], a[116:119], v[168:171], v[64:79]
    v_rcp_f32 v245, v245
    s_waitcnt lgkmcnt(5)
    v_mfma_f32_32x32x16_bf16 v[48:63], a[120:123], v[172:175], v[48:63]
    ds_read_b128 v[164:167], v6 offset:20480
    v_mfma_f32_32x32x16_bf16 v[64:79], a[124:127], v[172:175], v[64:79]
    v_mul_f32 v236, v244, v228
    s_waitcnt lgkmcnt(5)
    v_mfma_f32_32x32x16_bf16 v[48:63], a[128:131], v[144:147], v[48:63]
    ds_read_b128 v[168:171], v7 offset:20480
    v_add_f32 v245, v245, v245
    v_mfma_f32_32x32x16_bf16 v[64:79], a[132:135], v[144:147], v[64:79]
    v_fmac_f32 v236, v235, v229
    s_waitcnt lgkmcnt(5)
    v_mfma_f32_32x32x16_bf16 v[48:63], a[136:139], v[148:151], v[48:63]
    ds_read_b128 v[172:175], v8 offset:20480
    v_mul_f32 v237, v235, v228
    v_mfma_f32_32x32x16_bf16 v[64:79], a[140:143], v[148:151], v[64:79]
    v_fma_f32 v237, -v244, v229, v237
    s_waitcnt lgkmcnt(5)
    v_mfma_f32_32x32x16_bf16 v[48:63], a[144:147], v[152:155], v[48:63]
    ds_read_b128 v[144:147], v5 offset:24576
    v_mul_f32 v236, v236, v245
    v_mfma_f32_32x32x16_bf16 v[64:79], a[148:151], v[152:155], v[64:79]
    v_mul_f32 v237, v237, v245
    s_waitcnt lgkmcnt(5)
    v_mfma_f32_32x32x16_bf16 v[48:63], a[152:155], v[156:159], v[48:63]
    ds_read_b128 v[148:151], v6 offset:24576
    v_lshrrev_b32 v254, 4, v0
    v_mfma_f32_32x32x16_bf16 v[64:79], a[156:159], v[156:159], v[64:79]
    v_cvt_f32_u32 v254, v254
    s_waitcnt lgkmcnt(5)
    v_mfma_f32_32x32x16_bf16 v[48:63], a[160:163], v[160:163], v[48:63]
    ds_read_b128 v[152:155], v7 offset:24576
    v_mfma_f32_32x32x16_bf16 v[64:79], a[164:167], v[160:163], v[64:79]
    s_waitcnt lgkmcnt(5)
    v_mfma_f32_32x32x16_bf16 v[48:63], a[168:171], v[164:167], v[48:63]
    ds_read_b128 v[156:159], v8 offset:24576
    v_mfma_f32_32x32x16_bf16 v[64:79], a[172:175], v[164:167], v[64:79]
    s_waitcnt lgkmcnt(5)
    v_mfma_f32_32x32x16_bf16 v[48:63], a[176:179], v[168:171], v[48:63]
    ds_read_b128 v[160:163], v5 offset:28672
    v_mfma_f32_32x32x16_bf16 v[64:79], a[180:183], v[168:171], v[64:79]
    s_waitcnt lgkmcnt(5)
    v_mfma_f32_32x32x16_bf16 v[48:63], a[184:187], v[172:175], v[48:63]
    ds_read_b128 v[164:167], v6 offset:28672
    v_mfma_f32_32x32x16_bf16 v[64:79], a[188:191], v[172:175], v[64:79]
    s_waitcnt lgkmcnt(5)
    v_mfma_f32_32x32x16_bf16 v[48:63], a[192:195], v[144:147], v[48:63]
    ds_read_b128 v[168:171], v7 offset:28672
    v_mfma_f32_32x32x16_bf16 v[64:79], a[196:199], v[144:147], v[64:79]
    s_waitcnt lgkmcnt(5)
    v_mfma_f32_32x32x16_bf16 v[48:63], a[200:203], v[148:151], v[48:63]
    ds_read_b128 v[172:175], v8 offset:28672
    s_waitcnt vmcnt(0)
    v_mfma_f32_32x32x16_bf16 v[64:79], a[204:207], v[148:151], v[64:79]
    buffer_atomic_add v233, v232, s[20:23], s101 offen sc1
    s_waitcnt lgkmcnt(5)
    v_mfma_f32_32x32x16_bf16 v[48:63], a[208:211], v[152:155], v[48:63]
    ds_read_b128 v[144:147], v5 offset:32768
    v_mfma_f32_32x32x16_bf16 v[64:79], a[212:215], v[152:155], v[64:79]
    s_waitcnt lgkmcnt(5)
    v_mfma_f32_32x32x16_bf16 v[48:63], a[216:219], v[156:159], v[48:63]
    ds_read_b128 v[148:151], v6 offset:32768
    v_mfma_f32_32x32x16_bf16 v[64:79], a[220:223], v[156:159], v[64:79]
    s_waitcnt lgkmcnt(5)
    v_mfma_f32_32x32x16_bf16 v[48:63], a[224:227], v[160:163], v[48:63]
    ds_read_b128 v[152:155], v7 offset:32768
    v_mfma_f32_32x32x16_bf16 v[64:79], a[228:231], v[160:163], v[64:79]
    s_waitcnt lgkmcnt(5)
    v_mfma_f32_32x32x16_bf16 v[48:63], a[232:235], v[164:167], v[48:63]
    ds_read_b128 v[156:159], v8 offset:32768
    v_mfma_f32_32x32x16_bf16 v[64:79], a[236:239], v[164:167], v[64:79]
    s_waitcnt lgkmcnt(5)
    v_mfma_f32_32x32x16_bf16 v[48:63], a[240:243], v[168:171], v[48:63]
    ds_read_b128 v[160:163], v9 offset:0
    v_mfma_f32_32x32x16_bf16 v[64:79], a[244:247], v[168:171], v[64:79]
    s_waitcnt lgkmcnt(5)
    v_mfma_f32_32x32x16_bf16 v[48:63], a[248:251], v[172:175], v[48:63]
    ds_read_b128 v[164:167], v10 offset:0
    v_mfma_f32_32x32x16_bf16 v[64:79], a[252:255], v[172:175], v[64:79]
    s_waitcnt lgkmcnt(5)
    v_mfma_f32_32x32x16_bf16 v[48:63], v[16:19], v[144:147], v[48:63]
    ds_read_b128 v[168:171], v11 offset:0
    v_mfma_f32_32x32x16_bf16 v[64:79], v[20:23], v[144:147], v[64:79]
    s_waitcnt lgkmcnt(5)
    v_mfma_f32_32x32x16_bf16 v[48:63], v[24:27], v[148:151], v[48:63]
    ds_read_b128 v[172:175], v12 offset:0
    v_mfma_f32_32x32x16_bf16 v[64:79], v[28:31], v[148:151], v[64:79]
    s_waitcnt lgkmcnt(5)
    v_mfma_f32_32x32x16_bf16 v[48:63], v[32:35], v[152:155], v[48:63]
    ds_read_b128 v[144:147], v9 offset:4096
    v_mfma_f32_32x32x16_bf16 v[64:79], v[36:39], v[152:155], v[64:79]
    s_waitcnt lgkmcnt(5)
    v_mfma_f32_32x32x16_bf16 v[48:63], v[40:43], v[156:159], v[48:63]
    ds_read_b128 v[148:151], v10 offset:4096
    v_mfma_f32_32x32x16_bf16 v[64:79], v[44:47], v[156:159], v[64:79]
    s_waitcnt lgkmcnt(5)
    v_mfma_f32_32x32x16_bf16 v[80:95], a[0:3], v[160:163], 0
    ds_read_b128 v[152:155], v11 offset:4096
    v_mfma_f32_32x32x16_bf16 v[96:111], a[4:7], v[160:163], 0
    s_waitcnt lgkmcnt(5)
    v_mfma_f32_32x32x16_bf16 v[80:95], a[8:11], v[164:167], v[80:95]
    ds_read_b128 v[156:159], v12 offset:4096
    s_nop 2
    v_permlane16_swap_b32 v48, v56
    v_permlane16_swap_b32 v49, v57
    v_mfma_f32_32x32x16_bf16 v[96:111], a[12:15], v[164:167], v[96:111]
    v_permlane16_swap_b32 v50, v58
    v_permlane16_swap_b32 v51, v59
    s_waitcnt lgkmcnt(5)
    v_mfma_f32_32x32x16_bf16 v[80:95], a[16:19], v[168:171], v[80:95]
    ds_read_b128 v[160:163], v9 offset:8192
    v_permlane16_swap_b32 v52, v60
    v_permlane16_swap_b32 v53, v61
    v_permlane16_swap_b32 v54, v62
    v_mfma_f32_32x32x16_bf16 v[96:111], a[20:23], v[168:171], v[96:111]
    v_permlane16_swap_b32 v55, v63
    v_mul_f32 v228, v236, v48
    v_mul_f32 v229, v237, v48
    s_waitcnt lgkmcnt(5)
    v_mfma_f32_32x32x16_bf16 v[80:95], a[24:27], v[172:175], v[80:95]
    ds_read_b128 v[164:167], v10 offset:8192
    v_fma_f32 v48, -v237, v56, v228
    v_fma_f32 v56, v236, v56, v229
    v_mul_f32 v228, v236, v49
    v_mul_f32 v229, v237, v49
    v_mfma_f32_32x32x16_bf16 v[96:111], a[28:31], v[172:175], v[96:111]
    v_fma_f32 v49, -v237, v57, v228
    v_fma_f32 v57, v236, v57, v229
    v_fma_f32 v246, v234, v48, v49
    v_fma_f32 v247, v234, v56, v57
    v_fma_f32 v246, -v235, v56, v246
    s_waitcnt lgkmcnt(5)
    v_mfma_f32_32x32x16_bf16 v[80:95], a[32:35], v[144:147], v[80:95]
    ds_read_b128 v[168:171], v11 offset:8192
    v_fmac_f32 v247, v235, v48
    v_mul_f32 v228, v236, v50
    v_mul_f32 v229, v237, v50
    v_fma_f32 v50, -v237, v58, v228
    v_mfma_f32_32x32x16_bf16 v[96:111], a[36:39], v[144:147], v[96:111]
    v_fma_f32 v58, v236, v58, v229
    v_fma_f32 v244, v234, v246, v50
    v_fma_f32 v245, v234, v247, v58
    v_fma_f32 v244, -v235, v247, v244
    v_fmac_f32 v245, v235, v246
    s_waitcnt lgkmcnt(5)
    v_mfma_f32_32x32x16_bf16 v[80:95], a[40:43], v[148:151], v[80:95]
    ds_read_b128 v[172:175], v12 offset:8192
    v_mul_f32 v228, v236, v51
    v_mul_f32 v229, v237, v51
    v_fma_f32 v51, -v237, v59, v228
    v_fma_f32 v59, v236, v59, v229
    v_mfma_f32_32x32x16_bf16 v[96:111], a[44:47], v[148:151], v[96:111]
    v_fma_f32 v246, v234, v244, v51
    v_fma_f32 v247, v234, v245, v59
    v_fma_f32 v246, -v235, v245, v246
    v_fmac_f32 v247, v235, v244
    v_mul_f32 v228, v236, v52
    s_waitcnt lgkmcnt(5)
    v_mfma_f32_32x32x16_bf16 v[80:95], a[48:51], v[152:155], v[80:95]
    ds_read_b128 v[144:147], v9 offset:12288
    v_mul_f32 v229, v237, v52
    v_fma_f32 v52, -v237, v60, v228
    v_fma_f32 v60, v236, v60, v229
    v_fma_f32 v244, v234, v246, v52
    v_mfma_f32_32x32x16_bf16 v[96:111], a[52:55], v[152:155], v[96:111]
    v_fma_f32 v245, v234, v247, v60
    v_fma_f32 v244, -v235, v247, v244
    v_fmac_f32 v245, v235, v246
    v_mul_f32 v228, v236, v53
    v_mul_f32 v229, v237, v53
    s_waitcnt lgkmcnt(5)
    v_mfma_f32_32x32x16_bf16 v[80:95], a[56:59], v[156:159], v[80:95]
    ds_read_b128 v[148:151], v10 offset:12288
    v_fma_f32 v53, -v237, v61, v228
    v_fma_f32 v61, v236, v61, v229
    v_fma_f32 v246, v234, v244, v53
    v_fma_f32 v247, v234, v245, v61
    v_mfma_f32_32x32x16_bf16 v[96:111], a[60:63], v[156:159], v[96:111]
    v_fma_f32 v246, -v235, v245, v246
    v_fmac_f32 v247, v235, v244
    v_mul_f32 v228, v236, v54
    v_mul_f32 v229, v237, v54
    v_fma_f32 v54, -v237, v62, v228
    s_waitcnt lgkmcnt(5)
    v_mfma_f32_32x32x16_bf16 v[80:95], a[64:67], v[160:163], v[80:95]
    ds_read_b128 v[152:155], v11 offset:12288
    v_fma_f32 v62, v236, v62, v229
    v_fma_f32 v244, v234, v246, v54
    v_fma_f32 v245, v234, v247, v62
    v_fma_f32 v244, -v235, v247, v244
    v_mfma_f32_32x32x16_bf16 v[96:111], a[68:71], v[160:163], v[96:111]
    v_fmac_f32 v245, v235, v246
    v_mul_f32 v228, v236, v55
    v_mul_f32 v229, v237, v55
    v_fma_f32 v55, -v237, v63, v228
    v_fma_f32 v63, v236, v63, v229
    s_waitcnt lgkmcnt(5)
    v_mfma_f32_32x32x16_bf16 v[80:95], a[72:75], v[164:167], v[80:95]
    ds_read_b128 v[156:159], v12 offset:12288
    v_fma_f32 v246, v234, v244, v55
    v_fma_f32 v247, v234, v245, v63
    v_fma_f32 v246, -v235, v245, v246
    v_fmac_f32 v247, v235, v244
    v_mfma_f32_32x32x16_bf16 v[96:111], a[76:79], v[164:167], v[96:111]
    v_permlane16_swap_b32 v64, v72
    v_permlane16_swap_b32 v65, v73
    s_waitcnt lgkmcnt(5)
    v_mfma_f32_32x32x16_bf16 v[80:95], a[80:83], v[168:171], v[80:95]
    ds_read_b128 v[160:163], v9 offset:16384
    v_permlane16_swap_b32 v66, v74
    v_permlane16_swap_b32 v67, v75
    v_mfma_f32_32x32x16_bf16 v[96:111], a[84:87], v[168:171], v[96:111]
    v_permlane16_swap_b32 v68, v76
    v_permlane16_swap_b32 v69, v77
    v_permlane16_swap_b32 v70, v78
    s_waitcnt lgkmcnt(5)
    v_mfma_f32_32x32x16_bf16 v[80:95], a[88:91], v[172:175], v[80:95]
    ds_read_b128 v[164:167], v10 offset:16384
    v_permlane16_swap_b32 v71, v79
    v_mul_f32 v228, v236, v64
    v_mfma_f32_32x32x16_bf16 v[96:111], a[92:95], v[172:175], v[96:111]
    v_mul_f32 v229, v237, v64
    v_fma_f32 v64, -v237, v72, v228
    v_fma_f32 v72, v236, v72, v229
    v_mul_f32 v228, v236, v65
    v_mul_f32 v229, v237, v65
    s_waitcnt lgkmcnt(5)
    v_mfma_f32_32x32x16_bf16 v[80:95], a[96:99], v[144:147], v[80:95]
    ds_read_b128 v[168:171], v11 offset:16384
    v_fma_f32 v65, -v237, v73, v228
    v_fma_f32 v73, v236, v73, v229
    v_fma_f32 v250, v234, v64, v65
    v_fma_f32 v251, v234, v72, v73
    v_mfma_f32_32x32x16_bf16 v[96:111], a[100:103], v[144:147], v[96:111]
    v_fma_f32 v250, -v235, v72, v250
    v_fmac_f32 v251, v235, v64
    v_mul_f32 v228, v236, v66
    v_mul_f32 v229, v237, v66
    v_fma_f32 v66, -v237, v74, v228
    s_waitcnt lgkmcnt(5)
    v_mfma_f32_32x32x16_bf16 v[80:95], a[104:107], v[148:151], v[80:95]
    ds_read_b128 v[172:175], v12 offset:16384
    v_fma_f32 v74, v236, v74, v229
    v_fma_f32 v248, v234, v250, v66
    v_fma_f32 v249, v234, v251, v74
    v_fma_f32 v248, -v235, v251, v248
    v_mfma_f32_32x32x16_bf16 v[96:111], a[108:111], v[148:151], v[96:111]
    v_fmac_f32 v249, v235, v250
    v_mul_f32 v228, v236, v67
    v_mul_f32 v229, v237, v67
    v_fma_f32 v67, -v237, v75, v228
    v_fma_f32 v75, v236, v75, v229
    s_waitcnt lgkmcnt(5)
    v_mfma_f32_32x32x16_bf16 v[80:95], a[112:115], v[152:155], v[80:95]
    ds_read_b128 v[144:147], v9 offset:20480
    v_fma_f32 v250, v234, v248, v67
    v_fma_f32 v251, v234, v249, v75
    v_fma_f32 v250, -v235, v249, v250
    v_fmac_f32 v251, v235, v248
    v_mfma_f32_32x32x16_bf16 v[96:111], a[116:119], v[152:155], v[96:111]
    v_mul_f32 v228, v236, v68
    v_mul_f32 v229, v237, v68
    v_fma_f32 v68, -v237, v76, v228
    v_fma_f32 v76, v236, v76, v229
    v_fma_f32 v248, v234, v250, v68
    s_waitcnt lgkmcnt(5)
    v_mfma_f32_32x32x16_bf16 v[80:95], a[120:123], v[156:159], v[80:95]
    ds_read_b128 v[148:151], v10 offset:20480
    v_fma_f32 v249, v234, v251, v76
    v_fma_f32 v248, -v235, v251, v248
    v_fmac_f32 v249, v235, v250
    v_mul_f32 v228, v236, v69
    v_mfma_f32_32x32x16_bf16 v[96:111], a[124:127], v[156:159], v[96:111]
    v_mul_f32 v229, v237, v69
    v_fma_f32 v69, -v237, v77, v228
    v_fma_f32 v77, v236, v77, v229
    v_fma_f32 v250, v234, v248, v69
    v_fma_f32 v251, v234, v249, v77
    s_waitcnt lgkmcnt(5)
    v_mfma_f32_32x32x16_bf16 v[80:95], a[128:131], v[160:163], v[80:95]
    ds_read_b128 v[152:155], v11 offset:20480
    v_fma_f32 v250, -v235, v249, v250
    v_fmac_f32 v251, v235, v248
    v_mul_f32 v228, v236, v70
    v_mul_f32 v229, v237, v70
    v_mfma_f32_32x32x16_bf16 v[96:111], a[132:135], v[160:163], v[96:111]
    v_fma_f32 v70, -v237, v78, v228
    v_fma_f32 v78, v236, v78, v229
    v_fma_f32 v248, v234, v250, v70
    v_fma_f32 v249, v234, v251, v78
    v_fma_f32 v248, -v235, v251, v248
    s_waitcnt lgkmcnt(5)
    v_mfma_f32_32x32x16_bf16 v[80:95], a[136:139], v[164:167], v[80:95]
    ds_read_b128 v[156:159], v12 offset:20480
    v_fmac_f32 v249, v235, v250
    v_mul_f32 v228, v236, v71
    v_mul_f32 v229, v237, v71
    v_fma_f32 v71, -v237, v79, v228
    v_mfma_f32_32x32x16_bf16 v[96:111], a[140:143], v[164:167], v[96:111]
    v_fma_f32 v79, v236, v79, v229
    v_fma_f32 v250, v234, v248, v71
    v_fma_f32 v251, v234, v249, v79
    v_fma_f32 v250, -v235, v249, v250
    v_fmac_f32 v251, v235, v248
    s_waitcnt lgkmcnt(5)
    v_mfma_f32_32x32x16_bf16 v[80:95], a[144:147], v[168:171], v[80:95]
    ds_read_b128 v[160:163], v9 offset:24576
    v_mul_f32 v228, 0x41000000, v230
    v_mul_f32 v239, 0x41000000, v231
    v_exp_f32 v228, v228
    v_mfma_f32_32x32x16_bf16 v[96:111], a[148:151], v[168:171], v[96:111]
    v_fract_f32 v239, v239
    v_cos_f32 v238, v239
    v_sin_f32 v239, v239
    s_waitcnt lgkmcnt(5)
    v_mfma_f32_32x32x16_bf16 v[80:95], a[152:155], v[172:175], v[80:95]
    ds_read_b128 v[164:167], v10 offset:24576
    v_mul_f32 v238, v228, v238
    v_mul_f32 v239, v228, v239
    v_bfe_u32 v255, v0, 4, 1
    v_cvt_f32_u32 v255, v255
    v_mfma_f32_32x32x16_bf16 v[96:111], a[156:159], v[172:175], v[96:111]
    v_mov_b32 v244, v246
    v_mov_b32 v245, v247
    s_nop 0
    v_permlane16_swap_b32 v246, v244
    s_waitcnt lgkmcnt(5)
    v_mfma_f32_32x32x16_bf16 v[80:95], a[160:163], v[144:147], v[80:95]
    ds_read_b128 v[168:171], v11 offset:24576
    v_permlane16_swap_b32 v247, v245
    v_mul_f32 v240, v255, v246
    v_mul_f32 v241, v255, v247
    v_fma_f32 v244, v238, v246, v244
    v_mfma_f32_32x32x16_bf16 v[96:111], a[164:167], v[144:147], v[96:111]
    v_fma_f32 v245, v238, v247, v245
    v_fma_f32 v244, -v239, v247, v244
    v_fmac_f32 v245, v239, v246
    v_mov_b32 v248, v250
    v_mov_b32 v249, v251
    s_waitcnt lgkmcnt(5)
    v_mfma_f32_32x32x16_bf16 v[80:95], a[168:171], v[148:151], v[80:95]
    ds_read_b128 v[172:175], v12 offset:24576
    v_permlane16_swap_b32 v250, v248
    v_permlane16_swap_b32 v251, v249
    v_mfma_f32_32x32x16_bf16 v[96:111], a[172:175], v[148:151], v[96:111]
    v_mul_f32 v242, v255, v250
    v_mul_f32 v243, v255, v251
    v_fma_f32 v248, v238, v250, v248
    v_fma_f32 v249, v238, v251, v249
    v_fma_f32 v248, -v239, v251, v248
    s_waitcnt lgkmcnt(5)
    v_mfma_f32_32x32x16_bf16 v[80:95], a[176:179], v[152:155], v[80:95]
    ds_read_b128 v[144:147], v9 offset:28672
    v_fmac_f32 v249, v239, v250
    v_mul_f32 v255, 0x41000000, v255
    v_mul_f32 v228, v255, v230
    v_mul_f32 v237, v255, v231
    v_mfma_f32_32x32x16_bf16 v[96:111], a[180:183], v[152:155], v[96:111]
    v_exp_f32 v228, v228
    v_fract_f32 v237, v237
    v_cos_f32 v236, v237
    s_waitcnt lgkmcnt(5)
    v_mfma_f32_32x32x16_bf16 v[80:95], a[184:187], v[156:159], v[80:95]
    ds_read_b128 v[148:151], v10 offset:28672
    v_sin_f32 v237, v237
    v_mul_f32 v236, v228, v236
    v_mul_f32 v237, v228, v237
    v_mfma_f32_32x32x16_bf16 v[96:111], a[188:191], v[156:159], v[96:111]
    v_lshrrev_b32 v255, 5, v0
    v_cvt_f32_u32 v255, v255
    v_mul_f32 v236, v255, v236
    v_mul_f32 v237, v255, v237
    v_mul_f32 v228, v238, v238
    s_waitcnt lgkmcnt(5)
    v_mfma_f32_32x32x16_bf16 v[80:95], a[192:195], v[160:163], v[80:95]
    ds_read_b128 v[152:155], v11 offset:28672
    v_mul_f32 v229, v238, v239
    v_fma_f32 v228, -v239, v239, v228
    v_fmac_f32 v229, v239, v238
    v_mov_b32 v246, v244
    v_mfma_f32_32x32x16_bf16 v[96:111], a[196:199], v[160:163], v[96:111]
    v_mov_b32 v247, v245
    v_permlane32_swap_b32 v244, v246
    s_nop 0
    v_permlane32_swap_b32 v245, v247
    s_waitcnt lgkmcnt(5)
    v_mfma_f32_32x32x16_bf16 v[80:95], a[200:203], v[164:167], v[80:95]
    ds_read_b128 v[156:159], v12 offset:28672
    v_fma_f32 v240, v236, v244, v240
    v_fma_f32 v241, v236, v245, v241
    v_fma_f32 v240, -v237, v245, v240
    v_fmac_f32 v241, v237, v244
    v_mfma_f32_32x32x16_bf16 v[96:111], a[204:207], v[164:167], v[96:111]
    v_fma_f32 v246, v228, v244, v246
    v_fma_f32 v247, v228, v245, v247
    v_fma_f32 v246, -v229, v245, v246
    v_fmac_f32 v247, v229, v244
    v_mov_b32 v250, v248
    s_waitcnt lgkmcnt(5)
    v_mfma_f32_32x32x16_bf16 v[80:95], a[208:211], v[168:171], v[80:95]
    ds_read_b128 v[160:163], v9 offset:32768
    v_mov_b32 v251, v249
    v_permlane32_swap_b32 v248, v250
    v_mfma_f32_32x32x16_bf16 v[96:111], a[212:215], v[168:171], v[96:111]
    v_permlane32_swap_b32 v249, v251
    v_fma_f32 v242, v236, v248, v242
    v_fma_f32 v243, v236, v249, v243
    v_fma_f32 v242, -v237, v249, v242
    v_fmac_f32 v243, v237, v248
    s_waitcnt lgkmcnt(5)
    v_mfma_f32_32x32x16_bf16 v[80:95], a[216:219], v[172:175], v[80:95]
    ds_read_b128 v[164:167], v10 offset:32768
    v_fma_f32 v250, v228, v248, v250
    v_fma_f32 v251, v228, v249, v251
    v_fma_f32 v250, -v229, v249, v250
    v_fmac_f32 v251, v229, v248
    v_mfma_f32_32x32x16_bf16 v[96:111], a[220:223], v[172:175], v[96:111]
    v_mul_f32 v238, v228, v228
    v_mul_f32 v239, v228, v229
    v_fma_f32 v238, -v229, v229, v238
    v_fmac_f32 v239, v229, v228
    s_waitcnt lgkmcnt(5)
    v_mfma_f32_32x32x16_bf16 v[80:95], a[224:227], v[144:147], v[80:95]
    ds_read_b128 v[168:171], v11 offset:32768
    v_fma_f32 v248, v238, v246, v250
    v_fma_f32 v249, v238, v247, v251
    v_fma_f32 v248, -v239, v247, v248
    v_fmac_f32 v249, v239, v246
    v_mov_b32 v250, 1.0
    v_mfma_f32_32x32x16_bf16 v[96:111], a[228:231], v[144:147], v[96:111]
    v_mov_b32 v251, 1.0
    v_lshlrev_b32 v255, 4, v0
    v_cmp_gt_u32 vcc, 16, v0
    s_nop 1
    v_cndmask_b32 v255, 2.0, v255, vcc
    s_waitcnt lgkmcnt(5)
    v_mfma_f32_32x32x16_bf16 v[80:95], a[232:235], v[148:151], v[80:95]
    ds_read_b128 v[172:175], v12 offset:32768
    buffer_store_dwordx4 v[248:251], v255, s[20:23], s56 offen sc0 sc1
    v_mul_f32 v255, 0x41000000, v254
    v_mul_f32 v228, v255, v230
    v_mul_f32 v237, v255, v231
    v_mfma_f32_32x32x16_bf16 v[96:111], a[236:239], v[148:151], v[96:111]
    v_exp_f32 v228, v228
    v_fract_f32 v237, v237
    v_cos_f32 v236, v237
    s_waitcnt lgkmcnt(5)
    v_mfma_f32_32x32x16_bf16 v[80:95], a[240:243], v[152:155], v[80:95]
    v_sin_f32 v237, v237
    v_mul_f32 v236, v228, v236
    v_mul_f32 v237, v228, v237
    v_fma_f32 v242, v236, v246, v242
    v_mfma_f32_32x32x16_bf16 v[96:111], a[244:247], v[152:155], v[96:111]
    v_fma_f32 v243, v236, v247, v243
    v_fma_f32 v242, -v237, v247, v242
    v_fmac_f32 v243, v237, v246
    v_mov_b32 v176, v230
    v_mov_b32 v177, v231
    s_waitcnt lgkmcnt(4)
    v_mfma_f32_32x32x16_bf16 v[80:95], a[248:251], v[156:159], v[80:95]
    v_mov_b32 v178, v234
    v_mov_b32 v179, v235
    v_mov_b32 v180, v240
    v_mov_b32 v181, v241
    v_mov_b32 v182, v242
    v_mfma_f32_32x32x16_bf16 v[96:111], a[252:255], v[156:159], v[96:111]
    v_mov_b32 v183, v243
    v_mov_b32 v228, v116
    v_mov_b32 v229, v117
    v_mov_b32 v230, v118
    v_lshlrev_b32 v228, 16, v228
    s_waitcnt lgkmcnt(3)
    v_mfma_f32_32x32x16_bf16 v[80:95], v[16:19], v[160:163], v[80:95]
    v_lshlrev_b32 v229, 16, v229
    v_lshlrev_b32 v230, 16, v230
    v_mul_f32 v230, 0x3fb8aa3b, v230
    v_exp_f32 v230, v230
    v_mfma_f32_32x32x16_bf16 v[96:111], v[20:23], v[160:163], v[96:111]
    v_cvt_pk_bf16_f32 v230, v230, v230
    v_lshlrev_b32 v230, 16, v230
    v_mul_f32 v231, v230, v229
    v_mul_f32 v230, v230, v228
    v_mul_f32 v231, 0x3e22f983, v231
    s_waitcnt lgkmcnt(2)
    v_mfma_f32_32x32x16_bf16 v[80:95], v[24:27], v[164:167], v[80:95]
    v_mul_f32 v230, 0x3fb8aa3b, v230
    v_exp_f32 v244, v230
    v_fract_f32 v235, v231
    v_mfma_f32_32x32x16_bf16 v[96:111], v[28:31], v[164:167], v[96:111]
    v_cos_f32 v234, v235
    v_sin_f32 v235, v235
    v_mul_f32 v234, v244, v234
    s_waitcnt lgkmcnt(1)
    v_mfma_f32_32x32x16_bf16 v[80:95], v[32:35], v[168:171], v[80:95]
    v_mul_f32 v235, v244, v235
    v_add_f32 v244, -1.0, v234
    v_mul_f32 v245, v228, v228
    v_fmac_f32 v245, v229, v229
    v_rcp_f32 v245, v245
    v_mfma_f32_32x32x16_bf16 v[96:111], v[36:39], v[168:171], v[96:111]
    v_mul_f32 v236, v244, v228
    v_add_f32 v245, v245, v245
    v_fmac_f32 v236, v235, v229
    v_mul_f32 v237, v235, v228
    s_waitcnt lgkmcnt(0)
    v_mfma_f32_32x32x16_bf16 v[80:95], v[40:43], v[172:175], v[80:95]
    v_fma_f32 v237, -v244, v229, v237
    v_mul_f32 v236, v236, v245
    v_mul_f32 v237, v237, v245
    v_lshrrev_b32 v254, 4, v0
    v_cvt_f32_u32 v254, v254
    v_mfma_f32_32x32x16_bf16 v[96:111], v[44:47], v[172:175], v[96:111]
    s_nop 5
    v_permlane16_swap_b32 v80, v88
    v_permlane16_swap_b32 v81, v89
    v_permlane16_swap_b32 v82, v90
    v_permlane16_swap_b32 v83, v91
    v_permlane16_swap_b32 v84, v92
    v_permlane16_swap_b32 v85, v93
    v_permlane16_swap_b32 v86, v94
    v_permlane16_swap_b32 v87, v95
    v_mul_f32 v228, v236, v80
    v_mul_f32 v229, v237, v80
    v_fma_f32 v80, -v237, v88, v228
    v_fma_f32 v88, v236, v88, v229
    v_mul_f32 v228, v236, v81
    v_mul_f32 v229, v237, v81
    v_fma_f32 v81, -v237, v89, v228
    v_fma_f32 v89, v236, v89, v229
    v_fma_f32 v246, v234, v80, v81
    v_fma_f32 v247, v234, v88, v89
    v_fma_f32 v246, -v235, v88, v246
    v_fmac_f32 v247, v235, v80
    v_mul_f32 v228, v236, v82
    v_mul_f32 v229, v237, v82
    v_fma_f32 v82, -v237, v90, v228
    v_fma_f32 v90, v236, v90, v229
    v_fma_f32 v244, v234, v246, v82
    v_fma_f32 v245, v234, v247, v90
    v_fma_f32 v244, -v235, v247, v244
    v_fmac_f32 v245, v235, v246
    v_mul_f32 v228, v236, v83
    v_mul_f32 v229, v237, v83
    v_fma_f32 v83, -v237, v91, v228
    v_fma_f32 v91, v236, v91, v229
    v_fma_f32 v246, v234, v244, v83
    v_fma_f32 v247, v234, v245, v91
    v_fma_f32 v246, -v235, v245, v246
    v_fmac_f32 v247, v235, v244
    v_mul_f32 v228, v236, v84
    v_mul_f32 v229, v237, v84
    v_fma_f32 v84, -v237, v92, v228
    v_fma_f32 v92, v236, v92, v229
    v_fma_f32 v244, v234, v246, v84
    v_fma_f32 v245, v234, v247, v92
    v_fma_f32 v244, -v235, v247, v244
    v_fmac_f32 v245, v235, v246
    v_mul_f32 v228, v236, v85
    v_mul_f32 v229, v237, v85
    v_fma_f32 v85, -v237, v93, v228
    v_fma_f32 v93, v236, v93, v229
    v_fma_f32 v246, v234, v244, v85
    v_fma_f32 v247, v234, v245, v93
    v_fma_f32 v246, -v235, v245, v246
    v_fmac_f32 v247, v235, v244
    v_mul_f32 v228, v236, v86
    v_mul_f32 v229, v237, v86
    v_fma_f32 v86, -v237, v94, v228
    v_fma_f32 v94, v236, v94, v229
    v_fma_f32 v244, v234, v246, v86
    v_fma_f32 v245, v234, v247, v94
    v_fma_f32 v244, -v235, v247, v244
    v_fmac_f32 v245, v235, v246
    v_mul_f32 v228, v236, v87
    v_mul_f32 v229, v237, v87
    v_fma_f32 v87, -v237, v95, v228
    v_fma_f32 v95, v236, v95, v229
    v_fma_f32 v246, v234, v244, v87
    v_fma_f32 v247, v234, v245, v95
    v_fma_f32 v246, -v235, v245, v246
    v_fmac_f32 v247, v235, v244
    v_permlane16_swap_b32 v96, v104
    v_permlane16_swap_b32 v97, v105
    v_permlane16_swap_b32 v98, v106
    v_permlane16_swap_b32 v99, v107
    v_permlane16_swap_b32 v100, v108
    v_permlane16_swap_b32 v101, v109
    v_permlane16_swap_b32 v102, v110
    v_permlane16_swap_b32 v103, v111
    v_mul_f32 v228, v236, v96
    v_mul_f32 v229, v237, v96
    v_fma_f32 v96, -v237, v104, v228
    v_fma_f32 v104, v236, v104, v229
    v_mul_f32 v228, v236, v97
    v_mul_f32 v229, v237, v97
    v_fma_f32 v97, -v237, v105, v228
    v_fma_f32 v105, v236, v105, v229
    v_fma_f32 v250, v234, v96, v97
    v_fma_f32 v251, v234, v104, v105
    v_fma_f32 v250, -v235, v104, v250
    v_fmac_f32 v251, v235, v96
    v_mul_f32 v228, v236, v98
    v_mul_f32 v229, v237, v98
    v_fma_f32 v98, -v237, v106, v228
    v_fma_f32 v106, v236, v106, v229
    v_fma_f32 v248, v234, v250, v98
    v_fma_f32 v249, v234, v251, v106
    v_fma_f32 v248, -v235, v251, v248
    v_fmac_f32 v249, v235, v250
    v_mul_f32 v228, v236, v99
    v_mul_f32 v229, v237, v99
    v_fma_f32 v99, -v237, v107, v228
    v_fma_f32 v107, v236, v107, v229
    v_fma_f32 v250, v234, v248, v99
    v_fma_f32 v251, v234, v249, v107
    v_fma_f32 v250, -v235, v249, v250
    v_fmac_f32 v251, v235, v248
    v_mul_f32 v228, v236, v100
    v_mul_f32 v229, v237, v100
    v_fma_f32 v100, -v237, v108, v228
    v_fma_f32 v108, v236, v108, v229
    v_fma_f32 v248, v234, v250, v100
    v_fma_f32 v249, v234, v251, v108
    v_fma_f32 v248, -v235, v251, v248
    v_fmac_f32 v249, v235, v250
    v_mul_f32 v228, v236, v101
    v_mul_f32 v229, v237, v101
    v_fma_f32 v101, -v237, v109, v228
    v_fma_f32 v109, v236, v109, v229
    v_fma_f32 v250, v234, v248, v101
    v_fma_f32 v251, v234, v249, v109
    v_fma_f32 v250, -v235, v249, v250
    v_fmac_f32 v251, v235, v248
    v_mul_f32 v228, v236, v102
    v_mul_f32 v229, v237, v102
    v_fma_f32 v102, -v237, v110, v228
    v_fma_f32 v110, v236, v110, v229
    v_fma_f32 v248, v234, v250, v102
    v_fma_f32 v249, v234, v251, v110
    v_fma_f32 v248, -v235, v251, v248
    v_fmac_f32 v249, v235, v250
    v_mul_f32 v228, v236, v103
    v_mul_f32 v229, v237, v103
    v_fma_f32 v103, -v237, v111, v228
    v_fma_f32 v111, v236, v111, v229
    v_fma_f32 v250, v234, v248, v103
    v_fma_f32 v251, v234, v249, v111
    v_fma_f32 v250, -v235, v249, v250
    v_fmac_f32 v251, v235, v248
    v_mul_f32 v228, 0x41000000, v230
    v_mul_f32 v239, 0x41000000, v231
    v_exp_f32 v228, v228
    v_fract_f32 v239, v239
    v_cos_f32 v238, v239
    v_sin_f32 v239, v239
    v_mul_f32 v238, v228, v238
    v_mul_f32 v239, v228, v239
    v_bfe_u32 v255, v0, 4, 1
    v_cvt_f32_u32 v255, v255
    v_mov_b32 v244, v246
    v_mov_b32 v245, v247
    s_nop 0
    v_permlane16_swap_b32 v246, v244
    v_permlane16_swap_b32 v247, v245
    v_mul_f32 v240, v255, v246
    v_mul_f32 v241, v255, v247
    v_fma_f32 v244, v238, v246, v244
    v_fma_f32 v245, v238, v247, v245
    v_fma_f32 v244, -v239, v247, v244
    v_fmac_f32 v245, v239, v246
    v_mov_b32 v248, v250
    v_mov_b32 v249, v251
    s_nop 0
    v_permlane16_swap_b32 v250, v248
    v_permlane16_swap_b32 v251, v249
    v_mul_f32 v242, v255, v250
    v_mul_f32 v243, v255, v251
    v_fma_f32 v248, v238, v250, v248
    v_fma_f32 v249, v238, v251, v249
    v_fma_f32 v248, -v239, v251, v248
    v_fmac_f32 v249, v239, v250
    v_mul_f32 v255, 0x41000000, v255
    v_mul_f32 v228, v255, v230
    v_mul_f32 v237, v255, v231
    v_exp_f32 v228, v228
    v_fract_f32 v237, v237
    v_cos_f32 v236, v237
    v_sin_f32 v237, v237
    v_mul_f32 v236, v228, v236
    v_mul_f32 v237, v228, v237
    v_lshrrev_b32 v255, 5, v0
    v_cvt_f32_u32 v255, v255
    v_mul_f32 v236, v255, v236
    v_mul_f32 v237, v255, v237
    v_mul_f32 v228, v238, v238
    v_mul_f32 v229, v238, v239
    v_fma_f32 v228, -v239, v239, v228
    v_fmac_f32 v229, v239, v238
    v_mov_b32 v246, v244
    v_mov_b32 v247, v245
    s_nop 0
    v_permlane32_swap_b32 v244, v246
    v_permlane32_swap_b32 v245, v247
    v_fma_f32 v240, v236, v244, v240
    v_fma_f32 v241, v236, v245, v241
    v_fma_f32 v240, -v237, v245, v240
    v_fmac_f32 v241, v237, v244
    v_fma_f32 v246, v228, v244, v246
    v_fma_f32 v247, v228, v245, v247
    v_fma_f32 v246, -v229, v245, v246
    v_fmac_f32 v247, v229, v244
    v_mov_b32 v250, v248
    v_mov_b32 v251, v249
    s_nop 0
    v_permlane32_swap_b32 v248, v250
    v_permlane32_swap_b32 v249, v251
    v_fma_f32 v242, v236, v248, v242
    v_fma_f32 v243, v236, v249, v243
    v_fma_f32 v242, -v237, v249, v242
    v_fmac_f32 v243, v237, v248
    v_fma_f32 v250, v228, v248, v250
    v_fma_f32 v251, v228, v249, v251
    v_fma_f32 v250, -v229, v249, v250
    v_fmac_f32 v251, v229, v248
    v_mul_f32 v238, v228, v228
    v_mul_f32 v239, v228, v229
    v_fma_f32 v238, -v229, v229, v238
    v_fmac_f32 v239, v229, v228
    v_fma_f32 v248, v238, v246, v250
    v_fma_f32 v249, v238, v247, v251
    v_fma_f32 v248, -v239, v247, v248
    v_fmac_f32 v249, v239, v246
    v_mov_b32 v250, 1.0
    v_mov_b32 v251, 1.0
    v_lshlrev_b32 v255, 4, v0
    v_cmp_gt_u32 vcc, 16, v0
    s_nop 1
    v_cndmask_b32 v255, 2.0, v255, vcc
    buffer_store_dwordx4 v[248:251], v255, s[20:23], s74 offen sc0 sc1
    v_mul_f32 v255, 0x41000000, v254
    v_mul_f32 v228, v255, v230
    v_mul_f32 v237, v255, v231
    v_exp_f32 v228, v228
    v_fract_f32 v237, v237
    v_cos_f32 v236, v237
    v_sin_f32 v237, v237
    v_mul_f32 v236, v228, v236
    v_mul_f32 v237, v228, v237
    v_fma_f32 v242, v236, v246, v242
    v_fma_f32 v243, v236, v247, v243
    v_fma_f32 v242, -v237, v247, v242
    v_fmac_f32 v243, v237, v246
    v_mov_b32 v184, v230
    v_mov_b32 v230, v176
    v_mov_b32 v185, v231
    v_mov_b32 v231, v177
    v_mov_b32 v186, v234
    v_mov_b32 v234, v178
    v_mov_b32 v187, v235
    v_mov_b32 v235, v179
    v_mov_b32 v188, v240
    v_mov_b32 v240, v180
    v_mov_b32 v189, v241
    v_mov_b32 v241, v181
    v_mov_b32 v190, v242
    v_mov_b32 v242, v182
    v_mov_b32 v191, v243
    v_mov_b32 v243, v183
    v_lshrrev_b32 v228, 4, v0
    v_lshlrev_b32 v228, 3, v228
    v_sub_u32 v228, s76, v228
    v_and_b32 v229, 15, v0
    v_lshlrev_b32 v229, 4, v229
    v_lshrrev_b32 v253, 4, v0
    v_lshlrev_b32 v253, 11, v253
    v_sub_u32 v253, v229, v253
    v_add_u32 v253, s56, v253
    v_mov_b32 v229, 50659328
    v_cmp_lt_i32 vcc, 0, v228
    v_add_u32 v255, 4294967040, v253
    s_nop 0
    v_cndmask_b32 v255, v229, v255, vcc
    buffer_load_dwordx4 v[112:115], v255, s[20:23], 0 offen sc0 sc1
    v_cmp_lt_i32 vcc, 1, v228
    v_add_u32 v255, 4294966784, v253
    s_nop 0
    v_cndmask_b32 v255, v229, v255, vcc
    buffer_load_dwordx4 v[116:119], v255, s[20:23], 0 offen sc0 sc1
    v_cmp_lt_i32 vcc, 2, v228
    v_add_u32 v255, 4294966528, v253
    s_nop 0
    v_cndmask_b32 v255, v229, v255, vcc
    buffer_load_dwordx4 v[120:123], v255, s[20:23], 0 offen sc0 sc1
    v_cmp_lt_i32 vcc, 3, v228
    v_add_u32 v255, 4294966272, v253
    s_nop 0
    v_cndmask_b32 v255, v229, v255, vcc
    buffer_load_dwordx4 v[124:127], v255, s[20:23], 0 offen sc0 sc1
    v_cmp_lt_i32 vcc, 4, v228
    v_add_u32 v255, 4294966016, v253
    s_nop 0
    v_cndmask_b32 v255, v229, v255, vcc
    buffer_load_dwordx4 v[128:131], v255, s[20:23], 0 offen sc0 sc1
    v_cmp_lt_i32 vcc, 5, v228
    v_add_u32 v255, 4294965760, v253
    s_nop 0
    v_cndmask_b32 v255, v229, v255, vcc
    buffer_load_dwordx4 v[132:135], v255, s[20:23], 0 offen sc0 sc1
    v_cmp_lt_i32 vcc, 6, v228
    v_add_u32 v255, 4294965504, v253
    s_nop 0
    v_cndmask_b32 v255, v229, v255, vcc
    buffer_load_dwordx4 v[136:139], v255, s[20:23], 0 offen sc0 sc1
    v_cmp_lt_i32 vcc, 7, v228
    v_add_u32 v255, 4294965248, v253
    s_nop 0
    v_cndmask_b32 v255, v229, v255, vcc
    buffer_load_dwordx4 v[140:143], v255, s[20:23], 0 offen sc0 sc1
    s_waitcnt vmcnt(7)
    v_min_f32 v255, v114, v115
    s_waitcnt vmcnt(6)
    v_min3_f32 v255, v255, v118, v119
    s_waitcnt vmcnt(5)
    v_min3_f32 v255, v255, v122, v123
    s_waitcnt vmcnt(4)
    v_min3_f32 v255, v255, v126, v127
    s_waitcnt vmcnt(3)
    v_min3_f32 v255, v255, v130, v131
    s_waitcnt vmcnt(2)
    v_min3_f32 v255, v255, v134, v135
    s_waitcnt vmcnt(1)
    v_min3_f32 v255, v255, v138, v139
    s_waitcnt vmcnt(0)
    v_min3_f32 v255, v255, v142, v143
    v_cmp_gt_f32 vcc, 0.5, v255
    s_nop 4
    s_cbranch_vccnz K2T0_SLOW
K2T0_BACK:
    v_mul_f32 v228, 0x42800000, v230
    v_mul_f32 v239, 0x42800000, v231
    v_exp_f32 v228, v228
    v_fract_f32 v239, v239
    v_cos_f32 v238, v239
    v_sin_f32 v239, v239
    v_mul_f32 v238, v228, v238
    v_mul_f32 v239, v228, v239
    v_fma_f32 v136, v238, v140, v136
    v_fma_f32 v137, v238, v141, v137
    v_fma_f32 v136, -v239, v141, v136
    v_fmac_f32 v137, v239, v140
    v_fma_f32 v132, v238, v136, v132
    v_fma_f32 v133, v238, v137, v133
    v_fma_f32 v132, -v239, v137, v132
    v_fmac_f32 v133, v239, v136
    v_fma_f32 v128, v238, v132, v128
    v_fma_f32 v129, v238, v133, v129
    v_fma_f32 v128, -v239, v133, v128
    v_fmac_f32 v129, v239, v132
    v_fma_f32 v124, v238, v128, v124
    v_fma_f32 v125, v238, v129, v125
    v_fma_f32 v124, -v239, v129, v124
    v_fmac_f32 v125, v239, v128
    v_fma_f32 v120, v238, v124, v120
    v_fma_f32 v121, v238, v125, v121
    v_fma_f32 v120, -v239, v125, v120
    v_fmac_f32 v121, v239, v124
    v_fma_f32 v116, v238, v120, v116
    v_fma_f32 v117, v238, v121, v117
    v_fma_f32 v116, -v239, v121, v116
    v_fmac_f32 v117, v239, v120
    v_fma_f32 v112, v238, v116, v112
    v_fma_f32 v113, v238, v117, v113
    v_fma_f32 v112, -v239, v117, v112
    v_fmac_f32 v113, v239, v116
    v_mul_f32 v255, 0x44000000, v254
    v_mul_f32 v228, v255, v230
    v_mul_f32 v239, v255, v231
    v_exp_f32 v228, v228
    v_fract_f32 v239, v239
    v_cos_f32 v238, v239
    v_sin_f32 v239, v239
    v_mul_f32 v238, v228, v238
    v_mul_f32 v239, v228, v239
    v_mul_f32 v236, v238, v112
    v_mul_f32 v237, v238, v113
    v_fma_f32 v236, -v239, v113, v236
    v_fmac_f32 v237, v239, v112
    v_mov_b32 v228, v236
    v_mov_b32 v229, v237
    s_nop 0
    v_permlane16_swap_b32 v236, v228
    v_permlane16_swap_b32 v237, v229
    v_add_f32 v236, v236, v228
    v_add_f32 v237, v237, v229
    v_mov_b32 v228, v236
    v_mov_b32 v229, v237
    s_nop 0
    v_permlane32_swap_b32 v236, v228
    v_permlane32_swap_b32 v237, v229
    v_add_f32 v236, v236, v228
    v_add_f32 v237, v237, v229
    s_lshl_b32 s77, s53, 11
    s_add_u32 s77, s77, 147456
    v_and_b32 v13, 15, v0
    v_lshlrev_b32 v13, 6, v13
    v_bfe_u32 v228, v0, 4, 1
    v_lshl_add_u32 v13, v228, 5, v13
    v_lshrrev_b32 v229, 5, v0
    v_lshl_add_u32 v13, v229, 3, v13
    v_add_u32 v13, s77, v13
    v_lshlrev_b32 v14, 3, v229
    v_bfe_u32 v229, v0, 2, 2
    v_add_u32 v14, v14, v229
    v_lshlrev_b32 v14, 6, v14
    v_lshl_add_u32 v14, v228, 5, v14
    v_and_b32 v229, 3, v0
    v_lshl_add_u32 v14, v229, 3, v14
    v_add_u32 v14, s77, v14
    v_mov_b32 v255, 0x00000000
    v_fmac_f32 v255, 0x41000000, v254
    v_mul_f32 v228, v255, v230
    v_mul_f32 v239, v255, v231
    v_exp_f32 v228, v228
    v_fract_f32 v239, v239
    v_cos_f32 v238, v239
    v_sin_f32 v239, v239
    v_mul_f32 v238, v228, v238
    v_mul_f32 v239, v228, v239
    v_fma_f32 v240, v238, v236, v240
    v_fma_f32 v241, v238, v237, v241
    v_fma_f32 v240, -v239, v237, v240
    v_fmac_f32 v241, v239, v236
    v_fma_f32 v48, v234, v240, v48
    v_fma_f32 v56, v234, v241, v56
    v_fma_f32 v48, -v235, v241, v48
    v_fmac_f32 v56, v235, v240
    v_fma_f32 v49, v234, v48, v49
    v_fma_f32 v57, v234, v56, v57
    v_fma_f32 v49, -v235, v56, v49
    v_fmac_f32 v57, v235, v48
    v_fma_f32 v50, v234, v49, v50
    v_fma_f32 v58, v234, v57, v58
    v_fma_f32 v50, -v235, v57, v50
    v_fmac_f32 v58, v235, v49
    v_fma_f32 v51, v234, v50, v51
    v_fma_f32 v59, v234, v58, v59
    v_fma_f32 v51, -v235, v58, v51
    v_fmac_f32 v59, v235, v50
    v_fma_f32 v52, v234, v51, v52
    v_fma_f32 v60, v234, v59, v60
    v_fma_f32 v52, -v235, v59, v52
    v_fmac_f32 v60, v235, v51
    v_fma_f32 v53, v234, v52, v53
    v_fma_f32 v61, v234, v60, v61
    v_fma_f32 v53, -v235, v60, v53
    v_fmac_f32 v61, v235, v52
    v_fma_f32 v54, v234, v53, v54
    v_fma_f32 v62, v234, v61, v62
    v_fma_f32 v54, -v235, v61, v54
    v_fmac_f32 v62, v235, v53
    v_fma_f32 v55, v234, v54, v55
    v_fma_f32 v63, v234, v62, v63
    v_fma_f32 v55, -v235, v62, v55
    v_fmac_f32 v63, v235, v54
    v_cvt_pk_bf16_f32 v48, v48, v49
    v_cvt_pk_bf16_f32 v49, v50, v51
    v_cvt_pk_bf16_f32 v50, v52, v53
    v_cvt_pk_bf16_f32 v51, v54, v55
    v_cvt_pk_bf16_f32 v56, -v56, -v57
    v_cvt_pk_bf16_f32 v57, -v58, -v59
    v_cvt_pk_bf16_f32 v58, -v60, -v61
    v_cvt_pk_bf16_f32 v59, -v62, -v63
    v_lshrrev_b32 v228, 4, v0
    v_lshlrev_b32 v228, 3, v228
    v_sub_u32 v228, s76, v228
    v_and_b32 v229, 15, v0
    v_lshlrev_b32 v229, 4, v229
    v_lshrrev_b32 v253, 4, v0
    v_lshlrev_b32 v253, 11, v253
    v_sub_u32 v253, v229, v253
    v_add_u32 v253, s74, v253
    v_mov_b32 v229, 50659328
    v_cmp_lt_i32 vcc, 0, v228
    v_add_u32 v255, 4294967040, v253
    s_nop 0
    v_cndmask_b32 v255, v229, v255, vcc
    buffer_load_dwordx4 v[144:147], v255, s[20:23], 0 offen sc0 sc1
    v_cmp_lt_i32 vcc, 1, v228
    v_add_u32 v255, 4294966784, v253
    s_nop 0
    v_cndmask_b32 v255, v229, v255, vcc
    buffer_load_dwordx4 v[148:151], v255, s[20:23], 0 offen sc0 sc1
    v_cmp_lt_i32 vcc, 2, v228
    v_add_u32 v255, 4294966528, v253
    s_nop 0
    v_cndmask_b32 v255, v229, v255, vcc
    buffer_load_dwordx4 v[152:155], v255, s[20:23], 0 offen sc0 sc1
    v_cmp_lt_i32 vcc, 3, v228
    v_add_u32 v255, 4294966272, v253
    s_nop 0
    v_cndmask_b32 v255, v229, v255, vcc
    buffer_load_dwordx4 v[156:159], v255, s[20:23], 0 offen sc0 sc1
    v_cmp_lt_i32 vcc, 4, v228
    v_add_u32 v255, 4294966016, v253
    s_nop 0
    v_cndmask_b32 v255, v229, v255, vcc
    buffer_load_dwordx4 v[160:163], v255, s[20:23], 0 offen sc0 sc1
    v_cmp_lt_i32 vcc, 5, v228
    v_add_u32 v255, 4294965760, v253
    s_nop 0
    v_cndmask_b32 v255, v229, v255, vcc
    buffer_load_dwordx4 v[164:167], v255, s[20:23], 0 offen sc0 sc1
    v_cmp_lt_i32 vcc, 6, v228
    v_add_u32 v255, 4294965504, v253
    s_nop 0
    v_cndmask_b32 v255, v229, v255, vcc
    buffer_load_dwordx4 v[168:171], v255, s[20:23], 0 offen sc0 sc1
    v_cmp_lt_i32 vcc, 7, v228
    v_add_u32 v255, 4294965248, v253
    s_nop 0
    v_cndmask_b32 v255, v229, v255, vcc
    buffer_load_dwordx4 v[172:175], v255, s[20:23], 0 offen sc0 sc1
    ds_write_b64 v13, v[48:49]
    ds_write_b64 v13, v[50:51] offset:16
    ds_write_b64 v13, v[56:57] offset:1024
    ds_write_b64 v13, v[58:59] offset:1040
    ds_read_b64_tr_b16 v[52:53], v14
    ds_read_b64_tr_b16 v[54:55], v14 offset:256
    ds_read_b64_tr_b16 v[60:61], v14 offset:1024
    ds_read_b64_tr_b16 v[62:63], v14 offset:1280
    s_add_u32 s77, s64, 36864
    s_waitcnt lgkmcnt(2)
    buffer_store_dwordx4 v[52:55], v1, s[20:23], s64 offen sc1
    s_waitcnt lgkmcnt(0)
    buffer_store_dwordx4 v[60:63], v1, s[20:23], s77 offen sc1
    v_mov_b32 v255, 0x42000000
    v_fmac_f32 v255, 0x41000000, v254
    v_mul_f32 v228, v255, v230
    v_mul_f32 v239, v255, v231
    v_exp_f32 v228, v228
    v_fract_f32 v239, v239
    v_cos_f32 v238, v239
    v_sin_f32 v239, v239
    v_mul_f32 v238, v228, v238
    v_mul_f32 v239, v228, v239
    v_fma_f32 v242, v238, v236, v242
    v_fma_f32 v243, v238, v237, v243
    v_fma_f32 v242, -v239, v237, v242
    v_fmac_f32 v243, v239, v236
    v_fma_f32 v64, v234, v242, v64
    v_fma_f32 v72, v234, v243, v72
    v_fma_f32 v64, -v235, v243, v64
    v_fmac_f32 v72, v235, v242
    v_fma_f32 v65, v234, v64, v65
    v_fma_f32 v73, v234, v72, v73
    v_fma_f32 v65, -v235, v72, v65
    v_fmac_f32 v73, v235, v64
    v_fma_f32 v66, v234, v65, v66
    v_fma_f32 v74, v234, v73, v74
    v_fma_f32 v66, -v235, v73, v66
    v_fmac_f32 v74, v235, v65
    v_fma_f32 v67, v234, v66, v67
    v_fma_f32 v75, v234, v74, v75
    v_fma_f32 v67, -v235, v74, v67
    v_fmac_f32 v75, v235, v66
    v_fma_f32 v68, v234, v67, v68
    v_fma_f32 v76, v234, v75, v76
    v_fma_f32 v68, -v235, v75, v68
    v_fmac_f32 v76, v235, v67
    v_fma_f32 v69, v234, v68, v69
    v_fma_f32 v77, v234, v76, v77
    v_fma_f32 v69, -v235, v76, v69
    v_fmac_f32 v77, v235, v68
    v_fma_f32 v70, v234, v69, v70
    v_fma_f32 v78, v234, v77, v78
    v_fma_f32 v70, -v235, v77, v70
    v_fmac_f32 v78, v235, v69
    v_fma_f32 v71, v234, v70, v71
    v_fma_f32 v79, v234, v78, v79
    v_fma_f32 v71, -v235, v78, v71
    v_fmac_f32 v79, v235, v70
    v_cvt_pk_bf16_f32 v64, v64, v65
    v_cvt_pk_bf16_f32 v65, v66, v67
    v_cvt_pk_bf16_f32 v66, v68, v69
    v_cvt_pk_bf16_f32 v67, v70, v71
    v_cvt_pk_bf16_f32 v72, -v72, -v73
    v_cvt_pk_bf16_f32 v73, -v74, -v75
    v_cvt_pk_bf16_f32 v74, -v76, -v77
    v_cvt_pk_bf16_f32 v75, -v78, -v79
    ds_write_b64 v13, v[64:65]
    ds_write_b64 v13, v[66:67] offset:16
    ds_write_b64 v13, v[72:73] offset:1024
    ds_write_b64 v13, v[74:75] offset:1040
    ds_read_b64_tr_b16 v[68:69], v14
    ds_read_b64_tr_b16 v[70:71], v14 offset:256
    ds_read_b64_tr_b16 v[76:77], v14 offset:1024
    ds_read_b64_tr_b16 v[78:79], v14 offset:1280
    s_add_u32 s77, s65, 36864
    s_waitcnt lgkmcnt(2)
    buffer_store_dwordx4 v[68:71], v1, s[20:23], s65 offen sc1
    s_waitcnt lgkmcnt(0)
    buffer_store_dwordx4 v[76:79], v1, s[20:23], s77 offen sc1
    v_mov_b32 v230, v184
    v_mov_b32 v231, v185
    v_mov_b32 v234, v186
    v_mov_b32 v235, v187
    v_mov_b32 v240, v188
    v_mov_b32 v241, v189
    v_mov_b32 v242, v190
    v_mov_b32 v243, v191
    s_waitcnt vmcnt(11)
    v_min_f32 v255, v146, v147
    s_waitcnt vmcnt(10)
    v_min3_f32 v255, v255, v150, v151
    s_waitcnt vmcnt(9)
    v_min3_f32 v255, v255, v154, v155
    s_waitcnt vmcnt(8)
    v_min3_f32 v255, v255, v158, v159
    s_waitcnt vmcnt(7)
    v_min3_f32 v255, v255, v162, v163
    s_waitcnt vmcnt(6)
    v_min3_f32 v255, v255, v166, v167
    s_waitcnt vmcnt(5)
    v_min3_f32 v255, v255, v170, v171
    s_waitcnt vmcnt(4)
    v_min3_f32 v255, v255, v174, v175
    v_cmp_gt_f32 vcc, 0.5, v255
    s_nop 4
    s_cbranch_vccnz K2T1_SLOW
K2T1_BACK:
    v_mul_f32 v228, 0x42800000, v230
    v_mul_f32 v239, 0x42800000, v231
    v_exp_f32 v228, v228
    v_fract_f32 v239, v239
    v_cos_f32 v238, v239
    v_sin_f32 v239, v239
    v_mul_f32 v238, v228, v238
    v_mul_f32 v239, v228, v239
    v_fma_f32 v168, v238, v172, v168
    v_fma_f32 v169, v238, v173, v169
    v_fma_f32 v168, -v239, v173, v168
    v_fmac_f32 v169, v239, v172
    v_fma_f32 v164, v238, v168, v164
    v_fma_f32 v165, v238, v169, v165
    v_fma_f32 v164, -v239, v169, v164
    v_fmac_f32 v165, v239, v168
    v_fma_f32 v160, v238, v164, v160
    v_fma_f32 v161, v238, v165, v161
    v_fma_f32 v160, -v239, v165, v160
    v_fmac_f32 v161, v239, v164
    v_fma_f32 v156, v238, v160, v156
    v_fma_f32 v157, v238, v161, v157
    v_fma_f32 v156, -v239, v161, v156
    v_fmac_f32 v157, v239, v160
    v_fma_f32 v152, v238, v156, v152
    v_fma_f32 v153, v238, v157, v153
    v_fma_f32 v152, -v239, v157, v152
    v_fmac_f32 v153, v239, v156
    v_fma_f32 v148, v238, v152, v148
    v_fma_f32 v149, v238, v153, v149
    v_fma_f32 v148, -v239, v153, v148
    v_fmac_f32 v149, v239, v152
    v_fma_f32 v144, v238, v148, v144
    v_fma_f32 v145, v238, v149, v145
    v_fma_f32 v144, -v239, v149, v144
    v_fmac_f32 v145, v239, v148
    v_mul_f32 v255, 0x44000000, v254
    v_mul_f32 v228, v255, v230
    v_mul_f32 v239, v255, v231
    v_exp_f32 v228, v228
    v_fract_f32 v239, v239
    v_cos_f32 v238, v239
    v_sin_f32 v239, v239
    v_mul_f32 v238, v228, v238
    v_mul_f32 v239, v228, v239
    v_mul_f32 v236, v238, v144
    v_mul_f32 v237, v238, v145
    v_fma_f32 v236, -v239, v145, v236
    v_fmac_f32 v237, v239, v144
    v_mov_b32 v228, v236
    v_mov_b32 v229, v237
    s_nop 0
    v_permlane16_swap_b32 v236, v228
    v_permlane16_swap_b32 v237, v229
    v_add_f32 v236, v236, v228
    v_add_f32 v237, v237, v229
    v_mov_b32 v228, v236
    v_mov_b32 v229, v237
    s_nop 0
    v_permlane32_swap_b32 v236, v228
    v_permlane32_swap_b32 v237, v229
    v_add_f32 v236, v236, v228
    v_add_f32 v237, v237, v229
    s_lshl_b32 s77, s53, 11
    s_add_u32 s77, s77, 147456
    v_and_b32 v13, 15, v0
    v_lshlrev_b32 v13, 6, v13
    v_bfe_u32 v228, v0, 4, 1
    v_lshl_add_u32 v13, v228, 5, v13
    v_lshrrev_b32 v229, 5, v0
    v_lshl_add_u32 v13, v229, 3, v13
    v_add_u32 v13, s77, v13
    v_lshlrev_b32 v14, 3, v229
    v_bfe_u32 v229, v0, 2, 2
    v_add_u32 v14, v14, v229
    v_lshlrev_b32 v14, 6, v14
    v_lshl_add_u32 v14, v228, 5, v14
    v_and_b32 v229, 3, v0
    v_lshl_add_u32 v14, v229, 3, v14
    v_add_u32 v14, s77, v14
    v_mov_b32 v255, 0x00000000
    v_fmac_f32 v255, 0x41000000, v254
    v_mul_f32 v228, v255, v230
    v_mul_f32 v239, v255, v231
    v_exp_f32 v228, v228
    v_fract_f32 v239, v239
    v_cos_f32 v238, v239
    v_sin_f32 v239, v239
    v_mul_f32 v238, v228, v238
    v_mul_f32 v239, v228, v239
    v_fma_f32 v240, v238, v236, v240
    v_fma_f32 v241, v238, v237, v241
    v_fma_f32 v240, -v239, v237, v240
    v_fmac_f32 v241, v239, v236
    v_fma_f32 v80, v234, v240, v80
    v_fma_f32 v88, v234, v241, v88
    v_fma_f32 v80, -v235, v241, v80
    v_fmac_f32 v88, v235, v240
    v_fma_f32 v81, v234, v80, v81
    v_fma_f32 v89, v234, v88, v89
    v_fma_f32 v81, -v235, v88, v81
    v_fmac_f32 v89, v235, v80
    v_fma_f32 v82, v234, v81, v82
    v_fma_f32 v90, v234, v89, v90
    v_fma_f32 v82, -v235, v89, v82
    v_fmac_f32 v90, v235, v81
    v_fma_f32 v83, v234, v82, v83
    v_fma_f32 v91, v234, v90, v91
    v_fma_f32 v83, -v235, v90, v83
    v_fmac_f32 v91, v235, v82
    v_fma_f32 v84, v234, v83, v84
    v_fma_f32 v92, v234, v91, v92
    v_fma_f32 v84, -v235, v91, v84
    v_fmac_f32 v92, v235, v83
    v_fma_f32 v85, v234, v84, v85
    v_fma_f32 v93, v234, v92, v93
    v_fma_f32 v85, -v235, v92, v85
    v_fmac_f32 v93, v235, v84
    v_fma_f32 v86, v234, v85, v86
    v_fma_f32 v94, v234, v93, v94
    v_fma_f32 v86, -v235, v93, v86
    v_fmac_f32 v94, v235, v85
    v_fma_f32 v87, v234, v86, v87
    v_fma_f32 v95, v234, v94, v95
    v_fma_f32 v87, -v235, v94, v87
    v_fmac_f32 v95, v235, v86
    v_cvt_pk_bf16_f32 v80, v80, v81
    v_cvt_pk_bf16_f32 v81, v82, v83
    v_cvt_pk_bf16_f32 v82, v84, v85
    v_cvt_pk_bf16_f32 v83, v86, v87
    v_cvt_pk_bf16_f32 v88, -v88, -v89
    v_cvt_pk_bf16_f32 v89, -v90, -v91
    v_cvt_pk_bf16_f32 v90, -v92, -v93
    v_cvt_pk_bf16_f32 v91, -v94, -v95
    ds_write_b64 v13, v[80:81]
    ds_write_b64 v13, v[82:83] offset:16
    ds_write_b64 v13, v[88:89] offset:1024
    ds_write_b64 v13, v[90:91] offset:1040
    ds_read_b64_tr_b16 v[84:85], v14
    ds_read_b64_tr_b16 v[86:87], v14 offset:256
    ds_read_b64_tr_b16 v[92:93], v14 offset:1024
    ds_read_b64_tr_b16 v[94:95], v14 offset:1280
    s_add_u32 s77, s66, 36864
    s_waitcnt lgkmcnt(2)
    buffer_store_dwordx4 v[84:87], v1, s[20:23], s66 offen sc1
    s_waitcnt lgkmcnt(0)
    buffer_store_dwordx4 v[92:95], v1, s[20:23], s77 offen sc1
    v_mov_b32 v255, 0x42000000
    v_fmac_f32 v255, 0x41000000, v254
    v_mul_f32 v228, v255, v230
    v_mul_f32 v239, v255, v231
    v_exp_f32 v228, v228
    v_fract_f32 v239, v239
    v_cos_f32 v238, v239
    v_sin_f32 v239, v239
    v_mul_f32 v238, v228, v238
    v_mul_f32 v239, v228, v239
    v_fma_f32 v242, v238, v236, v242
    v_fma_f32 v243, v238, v237, v243
    v_fma_f32 v242, -v239, v237, v242
    v_fmac_f32 v243, v239, v236
    v_fma_f32 v96, v234, v242, v96
    v_fma_f32 v104, v234, v243, v104
    v_fma_f32 v96, -v235, v243, v96
    v_fmac_f32 v104, v235, v242
    v_fma_f32 v97, v234, v96, v97
    v_fma_f32 v105, v234, v104, v105
    v_fma_f32 v97, -v235, v104, v97
    v_fmac_f32 v105, v235, v96
    v_fma_f32 v98, v234, v97, v98
    v_fma_f32 v106, v234, v105, v106
    v_fma_f32 v98, -v235, v105, v98
    v_fmac_f32 v106, v235, v97
    v_fma_f32 v99, v234, v98, v99
    v_fma_f32 v107, v234, v106, v107
    v_fma_f32 v99, -v235, v106, v99
    v_fmac_f32 v107, v235, v98
    v_fma_f32 v100, v234, v99, v100
    v_fma_f32 v108, v234, v107, v108
    v_fma_f32 v100, -v235, v107, v100
    v_fmac_f32 v108, v235, v99
    v_fma_f32 v101, v234, v100, v101
    v_fma_f32 v109, v234, v108, v109
    v_fma_f32 v101, -v235, v108, v101
    v_fmac_f32 v109, v235, v100
    v_fma_f32 v102, v234, v101, v102
    v_fma_f32 v110, v234, v109, v110
    v_fma_f32 v102, -v235, v109, v102
    v_fmac_f32 v110, v235, v101
    v_fma_f32 v103, v234, v102, v103
    v_fma_f32 v111, v234, v110, v111
    v_fma_f32 v103, -v235, v110, v103
    v_fmac_f32 v111, v235, v102
    v_cvt_pk_bf16_f32 v96, v96, v97
    v_cvt_pk_bf16_f32 v97, v98, v99
    v_cvt_pk_bf16_f32 v98, v100, v101
    v_cvt_pk_bf16_f32 v99, v102, v103
    v_cvt_pk_bf16_f32 v104, -v104, -v105
    v_cvt_pk_bf16_f32 v105, -v106, -v107
    v_cvt_pk_bf16_f32 v106, -v108, -v109
    v_cvt_pk_bf16_f32 v107, -v110, -v111
    ds_write_b64 v13, v[96:97]
    ds_write_b64 v13, v[98:99] offset:16
    ds_write_b64 v13, v[104:105] offset:1024
    ds_write_b64 v13, v[106:107] offset:1040
    ds_read_b64_tr_b16 v[100:101], v14
    ds_read_b64_tr_b16 v[102:103], v14 offset:256
    ds_read_b64_tr_b16 v[108:109], v14 offset:1024
    ds_read_b64_tr_b16 v[110:111], v14 offset:1280
    s_add_u32 s77, s67, 36864
    s_waitcnt lgkmcnt(2)
    buffer_store_dwordx4 v[100:103], v1, s[20:23], s67 offen sc1
    s_waitcnt lgkmcnt(0)
    buffer_store_dwordx4 v[108:111], v1, s[20:23], s77 offen sc1
    s_waitcnt vmcnt(0)
    v_mov_b32 v233, 2
    buffer_atomic_add v233, v232, s[20:23], s68 offen sc1
    s_branch K3_END
K2T0_SLOW:
    s_mov_b32 s78, 0
K2T0_SPIN:
    s_sleep 4
    v_lshrrev_b32 v228, 4, v0
    v_lshlrev_b32 v228, 3, v228
    v_sub_u32 v228, s76, v228
    v_and_b32 v229, 15, v0
    v_lshlrev_b32 v229, 4, v229
    v_lshrrev_b32 v253, 4, v0
    v_lshlrev_b32 v253, 11, v253
    v_sub_u32 v253, v229, v253
    v_add_u32 v253, s56, v253
    v_mov_b32 v229, 50659328
    v_cmp_lt_i32 vcc, 0, v228
    v_add_u32 v255, 4294967040, v253
    s_nop 0
    v_cndmask_b32 v255, v229, v255, vcc
    buffer_load_dwordx4 v[112:115], v255, s[20:23], 0 offen sc0 sc1
    v_cmp_lt_i32 vcc, 1, v228
    v_add_u32 v255, 4294966784, v253
    s_nop 0
    v_cndmask_b32 v255, v229, v255, vcc
    buffer_load_dwordx4 v[116:119], v255, s[20:23], 0 offen sc0 sc1
    v_cmp_lt_i32 vcc, 2, v228
    v_add_u32 v255, 4294966528, v253
    s_nop 0
    v_cndmask_b32 v255, v229, v255, vcc
    buffer_load_dwordx4 v[120:123], v255, s[20:23], 0 offen sc0 sc1
    v_cmp_lt_i32 vcc, 3, v228
    v_add_u32 v255, 4294966272, v253
    s_nop 0
    v_cndmask_b32 v255, v229, v255, vcc
    buffer_load_dwordx4 v[124:127], v255, s[20:23], 0 offen sc0 sc1
    v_cmp_lt_i32 vcc, 4, v228
    v_add_u32 v255, 4294966016, v253
    s_nop 0
    v_cndmask_b32 v255, v229, v255, vcc
    buffer_load_dwordx4 v[128:131], v255, s[20:23], 0 offen sc0 sc1
    v_cmp_lt_i32 vcc, 5, v228
    v_add_u32 v255, 4294965760, v253
    s_nop 0
    v_cndmask_b32 v255, v229, v255, vcc
    buffer_load_dwordx4 v[132:135], v255, s[20:23], 0 offen sc0 sc1
    v_cmp_lt_i32 vcc, 6, v228
    v_add_u32 v255, 4294965504, v253
    s_nop 0
    v_cndmask_b32 v255, v229, v255, vcc
    buffer_load_dwordx4 v[136:139], v255, s[20:23], 0 offen sc0 sc1
    v_cmp_lt_i32 vcc, 7, v228
    v_add_u32 v255, 4294965248, v253
    s_nop 0
    v_cndmask_b32 v255, v229, v255, vcc
    buffer_load_dwordx4 v[140:143], v255, s[20:23], 0 offen sc0 sc1
    s_waitcnt vmcnt(7)
    v_min_f32 v255, v114, v115
    s_waitcnt vmcnt(6)
    v_min3_f32 v255, v255, v118, v119
    s_waitcnt vmcnt(5)
    v_min3_f32 v255, v255, v122, v123
    s_waitcnt vmcnt(4)
    v_min3_f32 v255, v255, v126, v127
    s_waitcnt vmcnt(3)
    v_min3_f32 v255, v255, v130, v131
    s_waitcnt vmcnt(2)
    v_min3_f32 v255, v255, v134, v135
    s_waitcnt vmcnt(1)
    v_min3_f32 v255, v255, v138, v139
    s_waitcnt vmcnt(0)
    v_min3_f32 v255, v255, v142, v143
    v_cmp_gt_f32 vcc, 0.5, v255
    s_add_u32 s78, s78, 1
    s_nop 4
    s_cbranch_vccz K2T0_BACK
    s_cmp_lt_u32 s78, 100000
    s_cbranch_scc1 K2T0_SPIN
    s_branch K2T0_BACK
K2T1_SLOW:
    s_mov_b32 s78, 0
K2T1_SPIN:
    s_sleep 4
    v_lshrrev_b32 v228, 4, v0
    v_lshlrev_b32 v228, 3, v228
    v_sub_u32 v228, s76, v228
    v_and_b32 v229, 15, v0
    v_lshlrev_b32 v229, 4, v229
    v_lshrrev_b32 v253, 4, v0
    v_lshlrev_b32 v253, 11, v253
    v_sub_u32 v253, v229, v253
    v_add_u32 v253, s74, v253
    v_mov_b32 v229, 50659328
    v_cmp_lt_i32 vcc, 0, v228
    v_add_u32 v255, 4294967040, v253
    s_nop 0
    v_cndmask_b32 v255, v229, v255, vcc
    buffer_load_dwordx4 v[144:147], v255, s[20:23], 0 offen sc0 sc1
    v_cmp_lt_i32 vcc, 1, v228
    v_add_u32 v255, 4294966784, v253
    s_nop 0
    v_cndmask_b32 v255, v229, v255, vcc
    buffer_load_dwordx4 v[148:151], v255, s[20:23], 0 offen sc0 sc1
    v_cmp_lt_i32 vcc, 2, v228
    v_add_u32 v255, 4294966528, v253
    s_nop 0
    v_cndmask_b32 v255, v229, v255, vcc
    buffer_load_dwordx4 v[152:155], v255, s[20:23], 0 offen sc0 sc1
    v_cmp_lt_i32 vcc, 3, v228
    v_add_u32 v255, 4294966272, v253
    s_nop 0
    v_cndmask_b32 v255, v229, v255, vcc
    buffer_load_dwordx4 v[156:159], v255, s[20:23], 0 offen sc0 sc1
    v_cmp_lt_i32 vcc, 4, v228
    v_add_u32 v255, 4294966016, v253
    s_nop 0
    v_cndmask_b32 v255, v229, v255, vcc
    buffer_load_dwordx4 v[160:163], v255, s[20:23], 0 offen sc0 sc1
    v_cmp_lt_i32 vcc, 5, v228
    v_add_u32 v255, 4294965760, v253
    s_nop 0
    v_cndmask_b32 v255, v229, v255, vcc
    buffer_load_dwordx4 v[164:167], v255, s[20:23], 0 offen sc0 sc1
    v_cmp_lt_i32 vcc, 6, v228
    v_add_u32 v255, 4294965504, v253
    s_nop 0
    v_cndmask_b32 v255, v229, v255, vcc
    buffer_load_dwordx4 v[168:171], v255, s[20:23], 0 offen sc0 sc1
    v_cmp_lt_i32 vcc, 7, v228
    v_add_u32 v255, 4294965248, v253
    s_nop 0
    v_cndmask_b32 v255, v229, v255, vcc
    buffer_load_dwordx4 v[172:175], v255, s[20:23], 0 offen sc0 sc1
    s_waitcnt vmcnt(7)
    v_min_f32 v255, v146, v147
    s_waitcnt vmcnt(6)
    v_min3_f32 v255, v255, v150, v151
    s_waitcnt vmcnt(5)
    v_min3_f32 v255, v255, v154, v155
    s_waitcnt vmcnt(4)
    v_min3_f32 v255, v255, v158, v159
    s_waitcnt vmcnt(3)
    v_min3_f32 v255, v255, v162, v163
    s_waitcnt vmcnt(2)
    v_min3_f32 v255, v255, v166, v167
    s_waitcnt vmcnt(1)
    v_min3_f32 v255, v255, v170, v171
    s_waitcnt vmcnt(0)
    v_min3_f32 v255, v255, v174, v175
    v_cmp_gt_f32 vcc, 0.5, v255
    s_add_u32 s78, s78, 1
    s_nop 4
    s_cbranch_vccz K2T1_BACK
    s_cmp_lt_u32 s78, 100000
    s_cbranch_scc1 K2T1_SPIN
    s_branch K2T1_BACK
K2S_SLOW:
    s_mov_b32 s78, 0
K2S_SPIN:
    s_sleep 4
    v_lshrrev_b32 v228, 4, v0
    v_lshlrev_b32 v228, 3, v228
    v_sub_u32 v228, s76, v228
    v_and_b32 v229, 15, v0
    v_lshlrev_b32 v229, 4, v229
    v_lshrrev_b32 v253, 4, v0
    v_lshlrev_b32 v253, 11, v253
    v_sub_u32 v253, v229, v253
    v_add_u32 v253, s75, v253
    v_mov_b32 v229, 50659328
    v_cmp_lt_i32 vcc, 0, v228
    v_add_u32 v255, 4294967040, v253
    s_nop 0
    v_cndmask_b32 v255, v229, v255, vcc
    buffer_load_dwordx4 v[80:83], v255, s[20:23], 0 offen sc0 sc1
    v_cmp_lt_i32 vcc, 1, v228
    v_add_u32 v255, 4294966784, v253
    s_nop 0
    v_cndmask_b32 v255, v229, v255, vcc
    buffer_load_dwordx4 v[84:87], v255, s[20:23], 0 offen sc0 sc1
    v_cmp_lt_i32 vcc, 2, v228
    v_add_u32 v255, 4294966528, v253
    s_nop 0
    v_cndmask_b32 v255, v229, v255, vcc
    buffer_load_dwordx4 v[88:91], v255, s[20:23], 0 offen sc0 sc1
    v_cmp_lt_i32 vcc, 3, v228
    v_add_u32 v255, 4294966272, v253
    s_nop 0
    v_cndmask_b32 v255, v229, v255, vcc
    buffer_load_dwordx4 v[92:95], v255, s[20:23], 0 offen sc0 sc1
    v_cmp_lt_i32 vcc, 4, v228
    v_add_u32 v255, 4294966016, v253
    s_nop 0
    v_cndmask_b32 v255, v229, v255, vcc
    buffer_load_dwordx4 v[96:99], v255, s[20:23], 0 offen sc0 sc1
    v_cmp_lt_i32 vcc, 5, v228
    v_add_u32 v255, 4294965760, v253
    s_nop 0
    v_cndmask_b32 v255, v229, v255, vcc
    buffer_load_dwordx4 v[100:103], v255, s[20:23], 0 offen sc0 sc1
    v_cmp_lt_i32 vcc, 6, v228
    v_add_u32 v255, 4294965504, v253
    s_nop 0
    v_cndmask_b32 v255, v229, v255, vcc
    buffer_load_dwordx4 v[104:107], v255, s[20:23], 0 offen sc0 sc1
    v_cmp_lt_i32 vcc, 7, v228
    v_add_u32 v255, 4294965248, v253
    s_nop 0
    v_cndmask_b32 v255, v229, v255, vcc
    buffer_load_dwordx4 v[108:111], v255, s[20:23], 0 offen sc0 sc1
    s_waitcnt vmcnt(7)
    v_min_f32 v255, v82, v83
    s_waitcnt vmcnt(6)
    v_min3_f32 v255, v255, v86, v87
    s_waitcnt vmcnt(5)
    v_min3_f32 v255, v255, v90, v91
    s_waitcnt vmcnt(4)
    v_min3_f32 v255, v255, v94, v95
    s_waitcnt vmcnt(3)
    v_min3_f32 v255, v255, v98, v99
    s_waitcnt vmcnt(2)
    v_min3_f32 v255, v255, v102, v103
    s_waitcnt vmcnt(1)
    v_min3_f32 v255, v255, v106, v107
    s_waitcnt vmcnt(0)
    v_min3_f32 v255, v255, v110, v111
    v_cmp_gt_f32 vcc, 0.5, v255
    s_add_u32 s78, s78, 1
    s_nop 4
    s_cbranch_vccz K2S_BACK
    s_cmp_lt_u32 s78, 100000
    s_cbranch_scc1 K2S_SPIN
    s_branch K2S_BACK
K2A_SLOW:
    s_mov_b32 s71, 0
K2A_SPIN:
    s_sleep 8
    buffer_load_dword v240, v253, s[36:39], 0 offen sc0 sc1
    s_waitcnt vmcnt(0)
    v_max_u32 v240, 1, v240
    v_and_b32 v240, 31, v240
    v_cmp_ne_u32 vcc, 0, v240
    s_add_u32 s71, s71, 1
    s_nop 4
    s_cbranch_vccz K2A_BACK
    s_cmp_lt_u32 s71, 100000
    s_cbranch_scc1 K2A_SPIN
    s_branch K2A_BACK
K3_GOON:
    s_mov_b32 s48, s75
    s_mov_b32 s49, s76
    s_mov_b32 s82, s40
    s_mov_b32 s83, s41
    s_load_dwordx4 s[36:39], s[0:1], 96
    s_load_dwordx4 s[40:43], s[0:1], 40
    s_load_dwordx2 s[44:45], s[0:1], 0
    s_load_dwordx2 s[46:47], s[0:1], 64
    s_lshr_b32 s54, s2, 3
    s_and_b32 s55, s2, 7
    s_and_b32 s57, s2, 3
    s_add_u32 s57, s57, 28
    s_cmp_gt_u32 s54, s57
    s_cselect_b32 s58, 1, 0
    s_sub_u32 s57, s57, 4
    s_cmp_gt_u32 s54, s57
    s_subb_u32 s54, s54, s58
    s_and_b32 s50, s55, 4
    s_lshl_b32 s50, s50, 1
    s_and_b32 s57, s54, 7
    s_add_u32 s50, s50, s57
    s_and_b32 s51, s55, 3
    s_lshr_b32 s52, s54, 3
    s_lshl_b32 s57, s55, 1
    s_and_b32 s58, s54, 1
    s_add_u32 s57, s57, s58
    s_bfe_u32 s58, s54, 0x20001
    s_cmp_ge_u32 s54, 24
    s_cselect_b32 s50, s57, s50
    s_cselect_b32 s51, 4, s51
    s_cselect_b32 s52, s58, s52
    s_and_b32 s55, s51, 3
    s_lshl_b32 s63, s50, 2
    s_add_u32 s63, s63, s53
    s_mul_i32 s64, s63, 368640
    s_add_u32 s64, s64, 9437184
    s_lshr_b32 s57, s55, 1
    s_mul_i32 s57, s57, 9
    s_and_b32 s58, s55, 1
    s_mul_i32 s58, s58, 4
    s_add_u32 s57, s57, s58
    s_lshl_b32 s57, s57, 12
    s_add_u32 s72, s64, s57
    s_add_u32 s72, s72, 294912
    s_lshl_b32 s71, s58, 7
    s_mul_i32 s57, s55, 73728
    s_add_u32 s64, s64, s57
    s_lshr_b32 s77, s63, 1
    s_lshl_b32 s77, s77, 2
    s_add_u32 s77, s77, s55
    s_add_u32 s77, s77, 192
    s_mul_i32 s77, s77, 64
    s_add_u32 s77, s77, 53477376
    s_add_u32 s29, s77, 10240
    s_add_u32 s74, s50, 320
    s_mul_i32 s74, s74, 64
    s_add_u32 s74, s74, 53477376
    s_add_u32 s78, s74, 1024
    v_and_b32 v254, 3, v0
    v_mul_u32_u24 v254, 64, v254
    s_cmp_eq_u32 s51, 4
    s_cselect_b32 s57, -1, 0
    v_and_b32 v254, s57, v254
    s_mul_i32 s54, s50, 3
    s_add_u32 s54, s54, s52
    s_mul_i32 s65, s54, 245760
    s_lshl_b32 s57, s53, 11
    s_add_u32 s65, s65, s57
    s_add_u32 s65, s65, 67108864
    s_lshl_b32 s66, s51, 13
    s_add_u32 s66, s66, s65
    s_add_u32 s24, s66, 204800
    s_lshl_b32 s57, s54, 2
    s_add_u32 s57, s57, s53
    s_mul_i32 s69, s57, 64
    s_add_u32 s69, s69, 53477376
    v_lshrrev_b32 v10, 3, v0
    v_bfe_u32 v11, v0, 4, 1
    v_lshlrev_b32 v11, 2, v11
    v_and_b32 v12, 7, v0
    v_xor_b32 v12, v12, v11
    s_lshl_b32 s57, s53, 4
    v_add_u32 v11, s57, v10
    v_mul_u32_u24 v11, 1152, v11
    v_lshl_add_u32 v2, v12, 4, v11
    v_lshrrev_b32 v11, 1, v10
    v_and_b32 v12, 7, v0
    v_xor_b32 v12, v12, v11
    v_mul_u32_u24 v10, 1152, v10
    v_lshl_add_u32 v3, v12, 4, v10
    v_xor_b32 v252, 64, v3
    s_mul_i32 s56, s55, 1327104
    s_mul_i32 s67, s52, 384
    s_add_u32 s56, s56, s67
    s_lshl_b32 s61, s53, 11
    s_mul_i32 s60, s53, 6144
    v_and_b32 v10, 31, v0
    v_bfe_u32 v11, v10, 2, 1
    v_lshlrev_b32 v11, 4, v11
    v_lshrrev_b32 v12, 3, v10
    v_lshl_add_u32 v11, v12, 2, v11
    v_and_b32 v12, 3, v10
    v_add_u32 v11, v11, v12
    v_bfe_u32 v12, v11, 1, 3
    v_lshrrev_b32 v13, 5, v0
    v_xor_b32 v12, v12, v13
    v_lshlrev_b32 v12, 4, v12
    v_lshl_add_u32 v248, v11, 7, v12
    v_xor_b32 v249, 32, v248
    v_xor_b32 v250, 64, v248
    v_xor_b32 v251, 96, v248
    s_lshl_b32 s57, s63, 5
    v_add_u32 v11, s57, v11
    v_lshlrev_b32 v15, 4, v10
    v_lshl_add_u32 v15, v13, 10, v15
    v_lshlrev_b32 v14, 5, v13
    v_mul_u32_u24 v11, 1152, v11
    v_lshl_add_u32 v13, v13, 5, v11
    v_lshlrev_b32 v255, 1, v13
    v_lshrrev_b32 v10, 5, v0
    v_lshlrev_b32 v10, 3, v10
    v_bfe_u32 v11, v0, 2, 2
    v_add_u32 v10, v10, v11
    v_lshlrev_b32 v10, 7, v10
    v_bfe_u32 v11, v0, 3, 1
    v_lshl_add_u32 v10, v11, 6, v10
    v_and_b32 v11, 1, v0
    v_lshl_add_u32 v10, v11, 5, v10
    v_bfe_u32 v11, v0, 4, 1
    v_lshl_add_u32 v10, v11, 4, v10
    v_bfe_u32 v11, v0, 1, 1
    v_lshl_add_u32 v10, v11, 3, v10
    v_xor_b32 v4, 64, v10
    v_add_u32 v4, 16384, v4
    s_add_u32 s57, s51, 1
    s_cmp_ge_u32 s57, 5
    s_cselect_b32 s58, 5, 0
    s_sub_u32 s57, s57, s58
    s_mul_i32 s58, s57, 40960
    s_add_u32 s25, s58, s66
    s_and_b32 s58, s57, 1
    s_lshl_b32 s58, s58, 6
    s_lshr_b32 s57, s57, 1
    s_lshl_b32 s57, s57, 13
    v_xor_b32 v5, s58, v10
    v_add_u32 v5, s57, v5
    s_add_u32 s57, s51, 2
    s_cmp_ge_u32 s57, 5
    s_cselect_b32 s58, 5, 0
    s_sub_u32 s57, s57, s58
    s_mul_i32 s58, s57, 40960
    s_add_u32 s26, s58, s66
    s_and_b32 s58, s57, 1
    s_lshl_b32 s58, s58, 6
    s_lshr_b32 s57, s57, 1
    s_lshl_b32 s57, s57, 13
    v_xor_b32 v6, s58, v10
    v_add_u32 v6, s57, v6
    s_add_u32 s57, s51, 3
    s_cmp_ge_u32 s57, 5
    s_cselect_b32 s58, 5, 0
    s_sub_u32 s57, s57, s58
    s_mul_i32 s58, s57, 40960
    s_add_u32 s27, s58, s66
    s_and_b32 s58, s57, 1
    s_lshl_b32 s58, s58, 6
    s_lshr_b32 s57, s57, 1
    s_lshl_b32 s57, s57, 13
    v_xor_b32 v7, s58, v10
    v_add_u32 v7, s57, v7
    s_add_u32 s57, s51, 4
    s_cmp_ge_u32 s57, 5
    s_cselect_b32 s58, 5, 0
    s_sub_u32 s57, s57, s58
    s_mul_i32 s58, s57, 40960
    s_add_u32 s28, s58, s66
    s_and_b32 s58, s57, 1
    s_lshl_b32 s58, s58, 6
    s_lshr_b32 s57, s57, 1
    s_lshl_b32 s57, s57, 13
    v_xor_b32 v8, s58, v10
    v_add_u32 v8, s57, v8
    s_add_u32 s57, s51, 5
    s_cmp_ge_u32 s57, 5
    s_cselect_b32 s58, 5, 0
    s_sub_u32 s57, s57, s58
    s_and_b32 s58, s57, 1
    s_lshl_b32 s58, s58, 6
    s_lshr_b32 s57, s57, 1
    s_lshl_b32 s57, s57, 13
    v_xor_b32 v9, s58, v10
    v_add_u32 v9, s57, v9
    s_mul_i32 s57, s53, 48
    s_add_u32 s57, s57, 0
    s_lshr_b32 s58, s57, 5
    s_and_b32 s57, s57, 31
    s_add_u32 s59, s58, s51
    s_cmp_ge_u32 s59, 5
    s_cselect_b32 s62, 5, 0
    s_sub_u32 s59, s59, s62
    s_cmp_eq_u32 s58, 0
    s_cselect_b32 s59, 5, s59
    s_lshl_b32 s59, s59, 5
    s_add_u32 s57, s57, s59
    s_mul_i32 s58, s52, 192
    s_add_u32 s57, s57, s58
    s_mul_i32 s57, s57, 1152
    s_add_u32 s92, s57, s71
    s_mul_i32 s57, s53, 48
    s_add_u32 s57, s57, 8
    s_lshr_b32 s58, s57, 5
    s_and_b32 s57, s57, 31
    s_add_u32 s59, s58, s51
    s_cmp_ge_u32 s59, 5
    s_cselect_b32 s62, 5, 0
    s_sub_u32 s59, s59, s62
    s_cmp_eq_u32 s58, 0
    s_cselect_b32 s59, 5, s59
    s_lshl_b32 s59, s59, 5
    s_add_u32 s57, s57, s59
    s_mul_i32 s58, s52, 192
    s_add_u32 s57, s57, s58
    s_mul_i32 s57, s57, 1152
    s_add_u32 s93, s57, s71
    s_mul_i32 s57, s53, 48
    s_add_u32 s57, s57, 16
    s_lshr_b32 s58, s57, 5
    s_and_b32 s57, s57, 31
    s_add_u32 s59, s58, s51
    s_cmp_ge_u32 s59, 5
    s_cselect_b32 s62, 5, 0
    s_sub_u32 s59, s59, s62
    s_cmp_eq_u32 s58, 0
    s_cselect_b32 s59, 5, s59
    s_lshl_b32 s59, s59, 5
    s_add_u32 s57, s57, s59
    s_mul_i32 s58, s52, 192
    s_add_u32 s57, s57, s58
    s_mul_i32 s57, s57, 1152
    s_add_u32 s94, s57, s71
    s_mul_i32 s57, s53, 48
    s_add_u32 s57, s57, 24
    s_lshr_b32 s58, s57, 5
    s_and_b32 s57, s57, 31
    s_add_u32 s59, s58, s51
    s_cmp_ge_u32 s59, 5
    s_cselect_b32 s62, 5, 0
    s_sub_u32 s59, s59, s62
    s_cmp_eq_u32 s58, 0
    s_cselect_b32 s59, 5, s59
    s_lshl_b32 s59, s59, 5
    s_add_u32 s57, s57, s59
    s_mul_i32 s58, s52, 192
    s_add_u32 s57, s57, s58
    s_mul_i32 s57, s57, 1152
    s_add_u32 s95, s57, s71
    s_mul_i32 s57, s53, 48
    s_add_u32 s57, s57, 32
    s_lshr_b32 s58, s57, 5
    s_and_b32 s57, s57, 31
    s_add_u32 s59, s58, s51
    s_cmp_ge_u32 s59, 5
    s_cselect_b32 s62, 5, 0
    s_sub_u32 s59, s59, s62
    s_cmp_eq_u32 s58, 0
    s_cselect_b32 s59, 5, s59
    s_lshl_b32 s59, s59, 5
    s_add_u32 s57, s57, s59
    s_mul_i32 s58, s52, 192
    s_add_u32 s57, s57, s58
    s_mul_i32 s57, s57, 1152
    s_add_u32 s96, s57, s71
    s_mul_i32 s57, s53, 48
    s_add_u32 s57, s57, 40
    s_lshr_b32 s58, s57, 5
    s_and_b32 s57, s57, 31
    s_add_u32 s59, s58, s51
    s_cmp_ge_u32 s59, 5
    s_cselect_b32 s62, 5, 0
    s_sub_u32 s59, s59, s62
    s_cmp_eq_u32 s58, 0
    s_cselect_b32 s59, 5, s59
    s_lshl_b32 s59, s59, 5
    s_add_u32 s57, s57, s59
    s_mul_i32 s58, s52, 192
    s_add_u32 s57, s57, s58
    s_mul_i32 s57, s57, 1152
    s_add_u32 s97, s57, s71
    v_mov_b32 v12, 0
    s_waitcnt lgkmcnt(0)
    s_mov_b32 s8, s36
    s_and_b32 s9, s37, 0xffff
    s_mov_b32 s10, 5308416
    s_mov_b32 s11, 0x00020000
    s_mov_b32 s16, s38
    s_and_b32 s17, s39, 0xffff
    s_mov_b32 s18, 4718592
    s_mov_b32 s19, 0x00020000
    s_mov_b32 s4, s44
    s_and_b32 s5, s45, 0xffff
    s_mov_b32 s6, 2359296
    s_mov_b32 s7, 0x00020000
    s_mov_b32 s32, s46
    s_and_b32 s33, s47, 0xffff
    s_mov_b32 s34, 1152
    s_mov_b32 s35, 0x00020000
    s_cmp_eq_u32 s55, 2
    s_cselect_b32 s57, 1, 0
    s_cmp_eq_u32 s55, 3
    s_cselect_b32 s57, 1, s57
    s_cmp_eq_u32 s57, 1
    s_cselect_b32 s12, s42, s40
    s_cselect_b32 s13, s43, s41
    s_and_b32 s13, s13, 0xffff
    s_mov_b32 s14, 663552
    s_mov_b32 s15, 0x00020000
    s_mov_b32 s40, s42
    s_and_b32 s41, s43, 0xffff
    s_mov_b32 s42, 663552
    s_mov_b32 s43, 0x00020000
    s_mul_i32 s68, s63, 36864
    s_mul_i32 s57, s52, 12288
    s_add_u32 s68, s68, s57
    s_add_u32 s68, s68, 0
    s_cmp_eq_u32 s51, s53
    s_cselect_b32 s73, 0, 0x40000000
    s_lshl_b32 s30, s51, 6
    s_add_u32 s30, s30, s67
    s_lshl_b32 s31, s51, 11
    s_add_u32 s31, s31, s68
    s_add_u32 s75, s67, 320
    s_add_u32 s75, s75, s73
    s_add_u32 s76, s68, 10240
    s_add_u32 s76, s76, s73
    s_cmp_eq_u32 s51, 4
    s_cbranch_scc1 K3_SR
    s_add_u32 m0, s61, 0
    s_add_u32 s59, s56, 294912
    buffer_load_dwordx4 v2, s[8:11], s59 offen lds
    s_add_u32 m0, s61, 1024
    s_add_u32 s59, s56, 304128
    buffer_load_dwordx4 v2, s[8:11], s59 offen lds
    s_add_u32 m0, s61, 8192
    s_add_u32 s59, s56, 295040
    buffer_load_dwordx4 v2, s[8:11], s59 offen lds
    s_add_u32 m0, s61, 9216
    s_add_u32 s59, s56, 304256
    buffer_load_dwordx4 v2, s[8:11], s59 offen lds
    s_add_u32 m0, s61, 16384
    s_add_u32 s59, s56, 295168
    buffer_load_dwordx4 v2, s[8:11], s59 offen lds
    s_add_u32 m0, s61, 17408
    s_add_u32 s59, s56, 304384
    buffer_load_dwordx4 v2, s[8:11], s59 offen lds
    s_add_u32 m0, s61, 24576
    s_add_u32 s59, s56, 442368
    buffer_load_dwordx4 v2, s[8:11], s59 offen lds
    s_add_u32 m0, s61, 25600
    s_add_u32 s59, s56, 451584
    buffer_load_dwordx4 v2, s[8:11], s59 offen lds
    s_add_u32 m0, s61, 32768
    s_add_u32 s59, s56, 442496
    buffer_load_dwordx4 v2, s[8:11], s59 offen lds
    s_add_u32 m0, s61, 33792
    s_add_u32 s59, s56, 451712
    buffer_load_dwordx4 v2, s[8:11], s59 offen lds
    s_add_u32 m0, s61, 40960
    s_add_u32 s59, s56, 442624
    buffer_load_dwordx4 v2, s[8:11], s59 offen lds
    s_add_u32 m0, s61, 41984
    s_add_u32 s59, s56, 451840
    buffer_load_dwordx4 v2, s[8:11], s59 offen lds
    s_add_u32 m0, s61, 49152
    s_add_u32 s59, s56, 663552
    buffer_load_dwordx4 v2, s[8:11], s59 offen lds
    s_add_u32 m0, s61, 50176
    s_add_u32 s59, s56, 672768
    buffer_load_dwordx4 v2, s[8:11], s59 offen lds
    s_add_u32 m0, s61, 57344
    s_add_u32 s59, s56, 663680
    buffer_load_dwordx4 v2, s[8:11], s59 offen lds
    s_add_u32 m0, s61, 58368
    s_add_u32 s59, s56, 672896
    buffer_load_dwordx4 v2, s[8:11], s59 offen lds
    s_add_u32 m0, s61, 65536
    s_add_u32 s59, s56, 663808
    buffer_load_dwordx4 v2, s[8:11], s59 offen lds
    s_add_u32 m0, s61, 66560
    s_add_u32 s59, s56, 673024
    buffer_load_dwordx4 v2, s[8:11], s59 offen lds
    s_add_u32 m0, s61, 73728
    s_add_u32 s59, s56, 811008
    buffer_load_dwordx4 v2, s[8:11], s59 offen lds
    s_add_u32 m0, s61, 74752
    s_add_u32 s59, s56, 820224
    buffer_load_dwordx4 v2, s[8:11], s59 offen lds
    s_add_u32 m0, s61, 81920
    s_add_u32 s59, s56, 811136
    buffer_load_dwordx4 v2, s[8:11], s59 offen lds
    s_add_u32 m0, s61, 82944
    s_add_u32 s59, s56, 820352
    buffer_load_dwordx4 v2, s[8:11], s59 offen lds
    s_add_u32 m0, s61, 90112
    s_add_u32 s59, s56, 811264
    buffer_load_dwordx4 v2, s[8:11], s59 offen lds
    s_add_u32 m0, s61, 91136
    s_add_u32 s59, s56, 820480
    buffer_load_dwordx4 v2, s[8:11], s59 offen lds
    s_waitcnt vmcnt(24)
    buffer_atomic_add v233, v232, s[20:23], s100 offen sc1
    s_mov_b32 s70, 0
K3_HPF:
    buffer_load_dword v253, v254, s[20:23], s29 offen sc0 sc1
    s_waitcnt vmcnt(0)
    v_cmp_gt_u32 vcc, 8, v253
    s_add_u32 s70, s70, 1
    s_nop 4
    s_cbranch_vccz K3_HGF
    s_sleep 2
    s_cmp_lt_u32 s70, 200000
    s_cbranch_scc1 K3_HPF
K3_HGF:
    v_lshrrev_b32 v245, 4, v0
    v_cvt_f32_u32 v245, v245
    s_add_u32 s62, s64, 16384
    buffer_load_dwordx4 v[16:19], v1, s[20:23], s62 offen offset:0 sc1
    s_add_u32 s62, s64, 16384
    buffer_load_dwordx4 v[20:23], v1, s[20:23], s62 offen offset:1024 sc1
    s_add_u32 s62, s64, 16384
    buffer_load_dwordx4 v[24:27], v1, s[20:23], s62 offen offset:2048 sc1
    s_add_u32 s62, s64, 16384
    buffer_load_dwordx4 v[28:31], v1, s[20:23], s62 offen offset:3072 sc1
    s_add_u32 s62, s64, 24576
    buffer_load_dwordx4 v[32:35], v1, s[20:23], s62 offen offset:0 sc1
    s_add_u32 s62, s64, 24576
    buffer_load_dwordx4 v[36:39], v1, s[20:23], s62 offen offset:1024 sc1
    s_add_u32 s62, s64, 24576
    buffer_load_dwordx4 v[40:43], v1, s[20:23], s62 offen offset:2048 sc1
    s_add_u32 s62, s64, 24576
    buffer_load_dwordx4 v[44:47], v1, s[20:23], s62 offen offset:3072 sc1
    s_barrier
    ds_read_b64_tr_b16 v[144:145], v4 offset:0
    ds_read_b64_tr_b16 v[146:147], v4 offset:512
    ds_read_b64_tr_b16 v[148:149], v5 offset:0
    ds_read_b64_tr_b16 v[150:151], v5 offset:512
    ds_read_b64_tr_b16 v[152:153], v6 offset:0
    ds_read_b64_tr_b16 v[154:155], v6 offset:512
    ds_read_b64_tr_b16 v[156:157], v7 offset:0
    ds_read_b64_tr_b16 v[158:159], v7 offset:512
    ds_read_b64_tr_b16 v[160:161], v8 offset:0
    ds_read_b64_tr_b16 v[162:163], v8 offset:512
    ds_read_b64_tr_b16 v[164:165], v9 offset:0
    ds_read_b64_tr_b16 v[166:167], v9 offset:512
    s_waitcnt vmcnt(7) lgkmcnt(10)
    v_mfma_f32_32x32x16_bf16 v[48:63], v[144:147], v[16:19], 0
    ds_read_b64_tr_b16 v[168:169], v4 offset:2048
    ds_read_b64_tr_b16 v[170:171], v4 offset:2560
    s_add_u32 s62, s64, 36864
    buffer_load_dwordx4 a[0:3], v1, s[20:23], s62 offen offset:0 sc1
    s_waitcnt lgkmcnt(10)
    v_mfma_f32_32x32x16_bf16 v[64:79], v[148:151], v[16:19], 0
    ds_read_b64_tr_b16 v[172:173], v5 offset:2048
    ds_read_b64_tr_b16 v[174:175], v5 offset:2560
    s_waitcnt lgkmcnt(10)
    v_mfma_f32_32x32x16_bf16 v[80:95], v[152:155], v[16:19], 0
    ds_read_b64_tr_b16 v[144:145], v6 offset:2048
    ds_read_b64_tr_b16 v[146:147], v6 offset:2560
    s_add_u32 s62, s64, 36864
    buffer_load_dwordx4 a[4:7], v1, s[20:23], s62 offen offset:1024 sc1
    s_waitcnt lgkmcnt(10)
    v_mfma_f32_32x32x16_bf16 v[96:111], v[156:159], v[16:19], 0
    ds_read_b64_tr_b16 v[148:149], v7 offset:2048
    ds_read_b64_tr_b16 v[150:151], v7 offset:2560
    s_waitcnt lgkmcnt(10)
    v_mfma_f32_32x32x16_bf16 v[112:127], v[160:163], v[16:19], 0
    ds_read_b64_tr_b16 v[152:153], v8 offset:2048
    ds_read_b64_tr_b16 v[154:155], v8 offset:2560
    s_add_u32 s62, s64, 36864
    buffer_load_dwordx4 a[8:11], v1, s[20:23], s62 offen offset:2048 sc1
    s_waitcnt lgkmcnt(10)
    v_mfma_f32_32x32x16_bf16 v[128:143], v[164:167], v[16:19], 0
    ds_read_b64_tr_b16 v[156:157], v9 offset:2048
    ds_read_b64_tr_b16 v[158:159], v9 offset:2560
    s_waitcnt vmcnt(9) lgkmcnt(10)
    v_mfma_f32_32x32x16_bf16 v[48:63], v[168:171], v[20:23], v[48:63]
    ds_read_b64_tr_b16 v[160:161], v4 offset:4096
    ds_read_b64_tr_b16 v[162:163], v4 offset:4608
    s_waitcnt lgkmcnt(10)
    v_mfma_f32_32x32x16_bf16 v[64:79], v[172:175], v[20:23], v[64:79]
    ds_read_b64_tr_b16 v[164:165], v5 offset:4096
    ds_read_b64_tr_b16 v[166:167], v5 offset:4608
    s_add_u32 s62, s64, 36864
    buffer_load_dwordx4 a[12:15], v1, s[20:23], s62 offen offset:3072 sc1
    s_waitcnt lgkmcnt(10)
    v_mfma_f32_32x32x16_bf16 v[80:95], v[144:147], v[20:23], v[80:95]
    ds_read_b64_tr_b16 v[168:169], v6 offset:4096
    ds_read_b64_tr_b16 v[170:171], v6 offset:4608
    s_waitcnt lgkmcnt(10)
    v_mfma_f32_32x32x16_bf16 v[96:111], v[148:151], v[20:23], v[96:111]
    ds_read_b64_tr_b16 v[172:173], v7 offset:4096
    ds_read_b64_tr_b16 v[174:175], v7 offset:4608
    s_add_u32 s62, s64, 45056
    buffer_load_dwordx4 a[16:19], v1, s[20:23], s62 offen offset:0 sc1
    s_waitcnt lgkmcnt(10)
    v_mfma_f32_32x32x16_bf16 v[112:127], v[152:155], v[20:23], v[112:127]
    ds_read_b64_tr_b16 v[144:145], v8 offset:4096
    ds_read_b64_tr_b16 v[146:147], v8 offset:4608
    s_waitcnt lgkmcnt(10)
    v_mfma_f32_32x32x16_bf16 v[128:143], v[156:159], v[20:23], v[128:143]
    ds_read_b64_tr_b16 v[148:149], v9 offset:4096
    ds_read_b64_tr_b16 v[150:151], v9 offset:4608
    s_add_u32 s62, s64, 45056
    buffer_load_dwordx4 a[20:23], v1, s[20:23], s62 offen offset:1024 sc1
    s_waitcnt vmcnt(11) lgkmcnt(10)
    v_mfma_f32_32x32x16_bf16 v[48:63], v[160:163], v[24:27], v[48:63]
    ds_read_b64_tr_b16 v[152:153], v4 offset:6144
    ds_read_b64_tr_b16 v[154:155], v4 offset:6656
    s_waitcnt lgkmcnt(10)
    v_mfma_f32_32x32x16_bf16 v[64:79], v[164:167], v[24:27], v[64:79]
    ds_read_b64_tr_b16 v[156:157], v5 offset:6144
    ds_read_b64_tr_b16 v[158:159], v5 offset:6656
    s_waitcnt lgkmcnt(10)
    v_mfma_f32_32x32x16_bf16 v[80:95], v[168:171], v[24:27], v[80:95]
    ds_read_b64_tr_b16 v[160:161], v6 offset:6144
    ds_read_b64_tr_b16 v[162:163], v6 offset:6656
    s_add_u32 s62, s64, 45056
    buffer_load_dwordx4 a[24:27], v1, s[20:23], s62 offen offset:2048 sc1
    s_waitcnt lgkmcnt(10)
    v_mfma_f32_32x32x16_bf16 v[96:111], v[172:175], v[24:27], v[96:111]
    ds_read_b64_tr_b16 v[164:165], v7 offset:6144
    ds_read_b64_tr_b16 v[166:167], v7 offset:6656
    s_waitcnt lgkmcnt(10)
    v_mfma_f32_32x32x16_bf16 v[112:127], v[144:147], v[24:27], v[112:127]
    ds_read_b64_tr_b16 v[168:169], v8 offset:6144
    ds_read_b64_tr_b16 v[170:171], v8 offset:6656
    s_add_u32 s62, s64, 45056
    buffer_load_dwordx4 a[28:31], v1, s[20:23], s62 offen offset:3072 sc1
    s_waitcnt lgkmcnt(10)
    v_mfma_f32_32x32x16_bf16 v[128:143], v[148:151], v[24:27], v[128:143]
    ds_read_b64_tr_b16 v[172:173], v9 offset:6144
    ds_read_b64_tr_b16 v[174:175], v9 offset:6656
    s_waitcnt vmcnt(12) lgkmcnt(10)
    v_mfma_f32_32x32x16_bf16 v[48:63], v[152:155], v[28:31], v[48:63]
    s_barrier
    ds_read_b64_tr_b16 v[144:145], v4 offset:24576
    ds_read_b64_tr_b16 v[146:147], v4 offset:25088
    s_add_u32 m0, s61, 98304
    s_add_u32 s59, s56, 958464
    buffer_load_dwordx4 v2, s[8:11], s59 offen lds
    s_waitcnt lgkmcnt(10)
    v_mfma_f32_32x32x16_bf16 v[64:79], v[156:159], v[28:31], v[64:79]
    ds_read_b64_tr_b16 v[148:149], v5 offset:24576
    ds_read_b64_tr_b16 v[150:151], v5 offset:25088
    s_waitcnt lgkmcnt(10)
    v_mfma_f32_32x32x16_bf16 v[80:95], v[160:163], v[28:31], v[80:95]
    ds_read_b64_tr_b16 v[152:153], v6 offset:24576
    ds_read_b64_tr_b16 v[154:155], v6 offset:25088
    s_waitcnt lgkmcnt(10)
    v_mfma_f32_32x32x16_bf16 v[96:111], v[164:167], v[28:31], v[96:111]
    ds_read_b64_tr_b16 v[156:157], v7 offset:24576
    ds_read_b64_tr_b16 v[158:159], v7 offset:25088
    s_add_u32 m0, s61, 99328
    s_add_u32 s59, s56, 967680
    buffer_load_dwordx4 v2, s[8:11], s59 offen lds
    s_waitcnt lgkmcnt(10)
    v_mfma_f32_32x32x16_bf16 v[112:127], v[168:171], v[28:31], v[112:127]
    ds_read_b64_tr_b16 v[160:161], v8 offset:24576
    ds_read_b64_tr_b16 v[162:163], v8 offset:25088
    s_waitcnt lgkmcnt(10)
    v_mfma_f32_32x32x16_bf16 v[128:143], v[172:175], v[28:31], v[128:143]
    ds_read_b64_tr_b16 v[164:165], v9 offset:24576
    ds_read_b64_tr_b16 v[166:167], v9 offset:25088
    s_add_u32 m0, s61, 106496
    s_add_u32 s59, s56, 958592
    buffer_load_dwordx4 v2, s[8:11], s59 offen lds
    s_waitcnt vmcnt(14) lgkmcnt(10)
    v_mfma_f32_32x32x16_bf16 v[48:63], v[144:147], v[32:35], v[48:63]
    ds_read_b64_tr_b16 v[168:169], v4 offset:26624
    ds_read_b64_tr_b16 v[170:171], v4 offset:27136
    s_waitcnt lgkmcnt(10)
    v_mfma_f32_32x32x16_bf16 v[64:79], v[148:151], v[32:35], v[64:79]
    ds_read_b64_tr_b16 v[172:173], v5 offset:26624
    ds_read_b64_tr_b16 v[174:175], v5 offset:27136
    s_add_u32 m0, s61, 107520
    s_add_u32 s59, s56, 967808
    buffer_load_dwordx4 v2, s[8:11], s59 offen lds
    s_waitcnt lgkmcnt(10)
    v_mfma_f32_32x32x16_bf16 v[80:95], v[152:155], v[32:35], v[80:95]
    ds_read_b64_tr_b16 v[144:145], v6 offset:26624
    ds_read_b64_tr_b16 v[146:147], v6 offset:27136
    s_waitcnt lgkmcnt(10)
    v_mfma_f32_32x32x16_bf16 v[96:111], v[156:159], v[32:35], v[96:111]
    ds_read_b64_tr_b16 v[148:149], v7 offset:26624
    ds_read_b64_tr_b16 v[150:151], v7 offset:27136
    s_waitcnt lgkmcnt(10)
    v_mfma_f32_32x32x16_bf16 v[112:127], v[160:163], v[32:35], v[112:127]
    ds_read_b64_tr_b16 v[152:153], v8 offset:26624
    ds_read_b64_tr_b16 v[154:155], v8 offset:27136
    s_add_u32 m0, s61, 114688
    s_add_u32 s59, s56, 958720
    buffer_load_dwordx4 v2, s[8:11], s59 offen lds
    s_waitcnt lgkmcnt(10)
    v_mfma_f32_32x32x16_bf16 v[128:143], v[164:167], v[32:35], v[128:143]
    ds_read_b64_tr_b16 v[156:157], v9 offset:26624
    ds_read_b64_tr_b16 v[158:159], v9 offset:27136
    s_waitcnt vmcnt(15) lgkmcnt(10)
    v_mfma_f32_32x32x16_bf16 v[48:63], v[168:171], v[36:39], v[48:63]
    ds_read_b64_tr_b16 v[160:161], v4 offset:28672
    ds_read_b64_tr_b16 v[162:163], v4 offset:29184
    s_add_u32 m0, s61, 115712
    s_add_u32 s59, s56, 967936
    buffer_load_dwordx4 v2, s[8:11], s59 offen lds
    s_waitcnt lgkmcnt(10)
    v_mfma_f32_32x32x16_bf16 v[64:79], v[172:175], v[36:39], v[64:79]
    ds_read_b64_tr_b16 v[164:165], v5 offset:28672
    ds_read_b64_tr_b16 v[166:167], v5 offset:29184
    s_waitcnt lgkmcnt(10)
    v_mfma_f32_32x32x16_bf16 v[80:95], v[144:147], v[36:39], v[80:95]
    ds_read_b64_tr_b16 v[168:169], v6 offset:28672
    ds_read_b64_tr_b16 v[170:171], v6 offset:29184
    s_add_u32 s62, s64, 53248
    buffer_load_dwordx4 a[32:35], v1, s[20:23], s62 offen offset:0 sc1
    s_waitcnt lgkmcnt(10)
    v_mfma_f32_32x32x16_bf16 v[96:111], v[148:151], v[36:39], v[96:111]
    ds_read_b64_tr_b16 v[172:173], v7 offset:28672
    ds_read_b64_tr_b16 v[174:175], v7 offset:29184
    s_waitcnt lgkmcnt(10)
    v_mfma_f32_32x32x16_bf16 v[112:127], v[152:155], v[36:39], v[112:127]
    ds_read_b64_tr_b16 v[144:145], v8 offset:28672
    ds_read_b64_tr_b16 v[146:147], v8 offset:29184
    s_waitcnt lgkmcnt(10)
    v_mfma_f32_32x32x16_bf16 v[128:143], v[156:159], v[36:39], v[128:143]
    ds_read_b64_tr_b16 v[148:149], v9 offset:28672
    ds_read_b64_tr_b16 v[150:151], v9 offset:29184
    s_add_u32 s62, s64, 53248
    buffer_load_dwordx4 a[36:39], v1, s[20:23], s62 offen offset:1024 sc1
    s_waitcnt vmcnt(17) lgkmcnt(10)
    v_mfma_f32_32x32x16_bf16 v[48:63], v[160:163], v[40:43], v[48:63]
    ds_read_b64_tr_b16 v[152:153], v4 offset:30720
    ds_read_b64_tr_b16 v[154:155], v4 offset:31232
    s_waitcnt lgkmcnt(10)
    v_mfma_f32_32x32x16_bf16 v[64:79], v[164:167], v[40:43], v[64:79]
    ds_read_b64_tr_b16 v[156:157], v5 offset:30720
    ds_read_b64_tr_b16 v[158:159], v5 offset:31232
    s_add_u32 s62, s64, 53248
    buffer_load_dwordx4 a[40:43], v1, s[20:23], s62 offen offset:2048 sc1
    s_waitcnt lgkmcnt(10)
    v_mfma_f32_32x32x16_bf16 v[80:95], v[168:171], v[40:43], v[80:95]
    ds_read_b64_tr_b16 v[160:161], v6 offset:30720
    ds_read_b64_tr_b16 v[162:163], v6 offset:31232
    s_waitcnt lgkmcnt(10)
    v_mfma_f32_32x32x16_bf16 v[96:111], v[172:175], v[40:43], v[96:111]
    ds_read_b64_tr_b16 v[164:165], v7 offset:30720
    ds_read_b64_tr_b16 v[166:167], v7 offset:31232
    s_waitcnt lgkmcnt(10)
    v_mfma_f32_32x32x16_bf16 v[112:127], v[144:147], v[40:43], v[112:127]
    ds_read_b64_tr_b16 v[168:169], v8 offset:30720
    ds_read_b64_tr_b16 v[170:171], v8 offset:31232
    s_add_u32 s62, s64, 53248
    buffer_load_dwordx4 a[44:47], v1, s[20:23], s62 offen offset:3072 sc1
    s_waitcnt lgkmcnt(10)
    v_mfma_f32_32x32x16_bf16 v[128:143], v[148:151], v[40:43], v[128:143]
    ds_read_b64_tr_b16 v[172:173], v9 offset:30720
    ds_read_b64_tr_b16 v[174:175], v9 offset:31232
    s_waitcnt vmcnt(18) lgkmcnt(10)
    v_mfma_f32_32x32x16_bf16 v[48:63], v[152:155], v[44:47], v[48:63]
    s_barrier
    v_add_u32 v4, 49152, v4
    v_add_u32 v5, 49152, v5
    v_add_u32 v6, 49152, v6
    v_add_u32 v7, 49152, v7
    v_add_u32 v8, 49152, v8
    v_add_u32 v9, 49152, v9
    ds_read_b64_tr_b16 v[144:145], v4 offset:0
    ds_read_b64_tr_b16 v[146:147], v4 offset:512
    s_add_u32 m0, s61, 122880
    s_add_u32 s59, s56, 1105920
    buffer_load_dwordx4 v2, s[8:11], s59 offen lds
    s_waitcnt lgkmcnt(10)
    v_mfma_f32_32x32x16_bf16 v[64:79], v[156:159], v[44:47], v[64:79]
    ds_read_b64_tr_b16 v[148:149], v5 offset:0
    ds_read_b64_tr_b16 v[150:151], v5 offset:512
    s_waitcnt lgkmcnt(10)
    v_mfma_f32_32x32x16_bf16 v[80:95], v[160:163], v[44:47], v[80:95]
    ds_read_b64_tr_b16 v[152:153], v6 offset:0
    ds_read_b64_tr_b16 v[154:155], v6 offset:512
    s_add_u32 m0, s61, 123904
    s_add_u32 s59, s56, 1115136
    buffer_load_dwordx4 v2, s[8:11], s59 offen lds
    s_waitcnt lgkmcnt(10)
    v_mfma_f32_32x32x16_bf16 v[96:111], v[164:167], v[44:47], v[96:111]
    ds_read_b64_tr_b16 v[156:157], v7 offset:0
    ds_read_b64_tr_b16 v[158:159], v7 offset:512
    s_waitcnt lgkmcnt(10)
    v_mfma_f32_32x32x16_bf16 v[112:127], v[168:171], v[44:47], v[112:127]
    ds_read_b64_tr_b16 v[160:161], v8 offset:0
    ds_read_b64_tr_b16 v[162:163], v8 offset:512
    s_waitcnt lgkmcnt(10)
    v_mfma_f32_32x32x16_bf16 v[128:143], v[172:175], v[44:47], v[128:143]
    ds_read_b64_tr_b16 v[164:165], v9 offset:0
    ds_read_b64_tr_b16 v[166:167], v9 offset:512
    s_add_u32 m0, s61, 131072
    s_add_u32 s59, s56, 1106048
    buffer_load_dwordx4 v2, s[8:11], s59 offen lds
    s_waitcnt vmcnt(20) lgkmcnt(10)
    v_mfma_f32_32x32x16_bf16 v[48:63], v[144:147], a[0:3], v[48:63]
    ds_read_b64_tr_b16 v[168:169], v4 offset:2048
    ds_read_b64_tr_b16 v[170:171], v4 offset:2560
    s_waitcnt lgkmcnt(10)
    v_mfma_f32_32x32x16_bf16 v[64:79], v[148:151], a[0:3], v[64:79]
    ds_read_b64_tr_b16 v[172:173], v5 offset:2048
    ds_read_b64_tr_b16 v[174:175], v5 offset:2560
    s_add_u32 m0, s61, 132096
    s_add_u32 s59, s56, 1115264
    buffer_load_dwordx4 v2, s[8:11], s59 offen lds
    s_waitcnt lgkmcnt(10)
    v_mfma_f32_32x32x16_bf16 v[80:95], v[152:155], a[0:3], v[80:95]
    ds_read_b64_tr_b16 v[144:145], v6 offset:2048
    ds_read_b64_tr_b16 v[146:147], v6 offset:2560
    s_waitcnt lgkmcnt(10)
    v_mfma_f32_32x32x16_bf16 v[96:111], v[156:159], a[0:3], v[96:111]
    ds_read_b64_tr_b16 v[148:149], v7 offset:2048
    ds_read_b64_tr_b16 v[150:151], v7 offset:2560
    s_add_u32 m0, s61, 139264
    s_add_u32 s59, s56, 1106176
    buffer_load_dwordx4 v2, s[8:11], s59 offen lds
    s_waitcnt lgkmcnt(10)
    v_mfma_f32_32x32x16_bf16 v[112:127], v[160:163], a[0:3], v[112:127]
    ds_read_b64_tr_b16 v[152:153], v8 offset:2048
    ds_read_b64_tr_b16 v[154:155], v8 offset:2560
    v_lshrrev_b32 v228, 4, v0
    v_lshlrev_b32 v228, 3, v228
    v_sub_u32 v228, s49, v228
    s_waitcnt lgkmcnt(10)
    v_mfma_f32_32x32x16_bf16 v[128:143], v[164:167], a[0:3], v[128:143]
    ds_read_b64_tr_b16 v[156:157], v9 offset:2048
    ds_read_b64_tr_b16 v[158:159], v9 offset:2560
    v_and_b32 v229, 15, v0
    v_lshlrev_b32 v229, 4, v229
    v_lshrrev_b32 v244, 4, v0
    s_waitcnt vmcnt(21) lgkmcnt(10)
    v_mfma_f32_32x32x16_bf16 v[48:63], v[168:171], a[4:7], v[48:63]
    ds_read_b64_tr_b16 v[160:161], v4 offset:4096
    ds_read_b64_tr_b16 v[162:163], v4 offset:4608
    s_add_u32 m0, s61, 140288
    s_add_u32 s59, s56, 1115392
    buffer_load_dwordx4 v2, s[8:11], s59 offen lds
    v_lshlrev_b32 v244, 11, v244
    s_waitcnt lgkmcnt(10)
    v_mfma_f32_32x32x16_bf16 v[64:79], v[172:175], a[4:7], v[64:79]
    ds_read_b64_tr_b16 v[164:165], v5 offset:4096
    ds_read_b64_tr_b16 v[166:167], v5 offset:4608
    v_sub_u32 v244, v229, v244
    v_add_u32 v244, s48, v244
    v_mov_b32 v229, 50659328
    s_waitcnt lgkmcnt(10)
    v_mfma_f32_32x32x16_bf16 v[80:95], v[144:147], a[4:7], v[80:95]
    ds_read_b64_tr_b16 v[168:169], v6 offset:4096
    ds_read_b64_tr_b16 v[170:171], v6 offset:4608
    s_add_u32 s62, s64, 61440
    buffer_load_dwordx4 a[48:51], v1, s[20:23], s62 offen offset:0 sc1
    v_cmp_lt_i32 vcc, 0, v228
    s_waitcnt lgkmcnt(10)
    v_mfma_f32_32x32x16_bf16 v[96:111], v[148:151], a[4:7], v[96:111]
    ds_read_b64_tr_b16 v[172:173], v7 offset:4096
    ds_read_b64_tr_b16 v[174:175], v7 offset:4608
    v_add_u32 v246, 4294967040, v244
    v_cndmask_b32 v246, v229, v246, vcc
    buffer_load_dwordx4 v[16:19], v246, s[20:23], 0 offen sc0 sc1
    s_waitcnt lgkmcnt(10)
    v_mfma_f32_32x32x16_bf16 v[112:127], v[152:155], a[4:7], v[112:127]
    ds_read_b64_tr_b16 v[144:145], v8 offset:4096
    ds_read_b64_tr_b16 v[146:147], v8 offset:4608
    s_add_u32 s62, s64, 61440
    buffer_load_dwordx4 a[52:55], v1, s[20:23], s62 offen offset:1024 sc1
    v_cmp_lt_i32 vcc, 1, v228
    s_waitcnt lgkmcnt(10)
    v_mfma_f32_32x32x16_bf16 v[128:143], v[156:159], a[4:7], v[128:143]
    ds_read_b64_tr_b16 v[148:149], v9 offset:4096
    ds_read_b64_tr_b16 v[150:151], v9 offset:4608
    v_add_u32 v246, 4294966784, v244
    v_cndmask_b32 v246, v229, v246, vcc
    buffer_load_dwordx4 v[20:23], v246, s[20:23], 0 offen sc0 sc1
    s_waitcnt vmcnt(25) lgkmcnt(10)
    v_mfma_f32_32x32x16_bf16 v[48:63], v[160:163], a[8:11], v[48:63]
    ds_read_b64_tr_b16 v[152:153], v4 offset:6144
    ds_read_b64_tr_b16 v[154:155], v4 offset:6656
    v_cmp_lt_i32 vcc, 2, v228
    v_add_u32 v246, 4294966528, v244
    s_nop 0
    v_cndmask_b32 v246, v229, v246, vcc
    s_waitcnt lgkmcnt(10)
    v_mfma_f32_32x32x16_bf16 v[64:79], v[164:167], a[8:11], v[64:79]
    ds_read_b64_tr_b16 v[156:157], v5 offset:6144
    ds_read_b64_tr_b16 v[158:159], v5 offset:6656
    s_add_u32 s62, s64, 61440
    buffer_load_dwordx4 a[56:59], v1, s[20:23], s62 offen offset:2048 sc1
    buffer_load_dwordx4 v[24:27], v246, s[20:23], 0 offen sc0 sc1
    v_cmp_lt_i32 vcc, 3, v228
    s_waitcnt lgkmcnt(10)
    v_mfma_f32_32x32x16_bf16 v[80:95], v[168:171], a[8:11], v[80:95]
    ds_read_b64_tr_b16 v[160:161], v6 offset:6144
    ds_read_b64_tr_b16 v[162:163], v6 offset:6656
    v_add_u32 v246, 4294966272, v244
    v_cndmask_b32 v246, v229, v246, vcc
    buffer_load_dwordx4 v[28:31], v246, s[20:23], 0 offen sc0 sc1
    s_waitcnt lgkmcnt(10)
    v_mfma_f32_32x32x16_bf16 v[96:111], v[172:175], a[8:11], v[96:111]
    ds_read_b64_tr_b16 v[164:165], v7 offset:6144
    ds_read_b64_tr_b16 v[166:167], v7 offset:6656
    s_add_u32 s62, s64, 61440
    buffer_load_dwordx4 a[60:63], v1, s[20:23], s62 offen offset:3072 sc1
    v_cmp_lt_i32 vcc, 4, v228
    s_waitcnt lgkmcnt(10)
    v_mfma_f32_32x32x16_bf16 v[112:127], v[144:147], a[8:11], v[112:127]
    ds_read_b64_tr_b16 v[168:169], v8 offset:6144
    ds_read_b64_tr_b16 v[170:171], v8 offset:6656
    buffer_load_dword v253, v254, s[20:23], s77 offen sc0 sc1
    v_add_u32 v246, 4294966016, v244
    v_cndmask_b32 v246, v229, v246, vcc
    s_waitcnt lgkmcnt(10)
    v_mfma_f32_32x32x16_bf16 v[128:143], v[148:151], a[8:11], v[128:143]
    ds_read_b64_tr_b16 v[172:173], v9 offset:6144
    ds_read_b64_tr_b16 v[174:175], v9 offset:6656
    s_add_u32 m0, s61, 0
    s_add_u32 s59, s56, 589824
    buffer_load_dwordx4 v2, s[8:11], s59 offen lds
    buffer_load_dwordx4 v[32:35], v246, s[20:23], 0 offen sc0 sc1
    s_waitcnt vmcnt(31) lgkmcnt(10)
    v_mfma_f32_32x32x16_bf16 v[48:63], v[152:155], a[12:15], v[48:63]
    s_barrier
    ds_read_b64_tr_b16 v[144:145], v4 offset:24576
    ds_read_b64_tr_b16 v[146:147], v4 offset:25088
    v_cmp_lt_i32 vcc, 5, v228
    v_add_u32 v246, 4294965760, v244
    s_waitcnt lgkmcnt(10)
    v_mfma_f32_32x32x16_bf16 v[64:79], v[156:159], a[12:15], v[64:79]
    ds_read_b64_tr_b16 v[148:149], v5 offset:24576
    ds_read_b64_tr_b16 v[150:151], v5 offset:25088
    v_cndmask_b32 v246, v229, v246, vcc
    buffer_load_dwordx4 v[36:39], v246, s[20:23], 0 offen sc0 sc1
    v_cmp_lt_i32 vcc, 6, v228
    s_waitcnt lgkmcnt(10)
    v_mfma_f32_32x32x16_bf16 v[80:95], v[160:163], a[12:15], v[80:95]
    ds_read_b64_tr_b16 v[152:153], v6 offset:24576
    ds_read_b64_tr_b16 v[154:155], v6 offset:25088
    s_add_u32 m0, s61, 1024
    s_add_u32 s59, s56, 599040
    buffer_load_dwordx4 v2, s[8:11], s59 offen lds
    s_waitcnt lgkmcnt(10)
    v_mfma_f32_32x32x16_bf16 v[96:111], v[164:167], a[12:15], v[96:111]
    ds_read_b64_tr_b16 v[156:157], v7 offset:24576
    ds_read_b64_tr_b16 v[158:159], v7 offset:25088
    v_add_u32 v246, 4294965504, v244
    v_cndmask_b32 v246, v229, v246, vcc
    buffer_load_dwordx4 v[40:43], v246, s[20:23], 0 offen sc0 sc1
    s_waitcnt lgkmcnt(10)
    v_mfma_f32_32x32x16_bf16 v[112:127], v[168:171], a[12:15], v[112:127]
    ds_read_b64_tr_b16 v[160:161], v8 offset:24576
    ds_read_b64_tr_b16 v[162:163], v8 offset:25088
    s_add_u32 m0, s61, 8192
    s_add_u32 s59, s56, 589952
    buffer_load_dwordx4 v2, s[8:11], s59 offen lds
    v_cmp_lt_i32 vcc, 7, v228
    s_waitcnt lgkmcnt(10)
    v_mfma_f32_32x32x16_bf16 v[128:143], v[172:175], a[12:15], v[128:143]
    ds_read_b64_tr_b16 v[164:165], v9 offset:24576
    ds_read_b64_tr_b16 v[166:167], v9 offset:25088
    v_add_u32 v246, 4294965248, v244
    v_cndmask_b32 v246, v229, v246, vcc
    buffer_load_dwordx4 v[44:47], v246, s[20:23], 0 offen sc0 sc1
    s_waitcnt vmcnt(35) lgkmcnt(10)
    v_mfma_f32_32x32x16_bf16 v[48:63], v[144:147], a[16:19], v[48:63]
    ds_read_b64_tr_b16 v[168:169], v4 offset:26624
    ds_read_b64_tr_b16 v[170:171], v4 offset:27136
    s_add_u32 m0, s61, 9216
    s_add_u32 s59, s56, 599168
    buffer_load_dwordx4 v2, s[8:11], s59 offen lds
    s_waitcnt lgkmcnt(10)
    v_mfma_f32_32x32x16_bf16 v[64:79], v[148:151], a[16:19], v[64:79]
    ds_read_b64_tr_b16 v[172:173], v5 offset:26624
    ds_read_b64_tr_b16 v[174:175], v5 offset:27136
    s_waitcnt lgkmcnt(10)
    v_mfma_f32_32x32x16_bf16 v[80:95], v[152:155], a[16:19], v[80:95]
    ds_read_b64_tr_b16 v[144:145], v6 offset:26624
    ds_read_b64_tr_b16 v[146:147], v6 offset:27136
    s_waitcnt lgkmcnt(10)
    v_mfma_f32_32x32x16_bf16 v[96:111], v[156:159], a[16:19], v[96:111]
    ds_read_b64_tr_b16 v[148:149], v7 offset:26624
    ds_read_b64_tr_b16 v[150:151], v7 offset:27136
    s_add_u32 m0, s61, 16384
    s_add_u32 s59, s56, 590080
    buffer_load_dwordx4 v2, s[8:11], s59 offen lds
    s_waitcnt lgkmcnt(10)
    v_mfma_f32_32x32x16_bf16 v[112:127], v[160:163], a[16:19], v[112:127]
    ds_read_b64_tr_b16 v[152:153], v8 offset:26624
    ds_read_b64_tr_b16 v[154:155], v8 offset:27136
    s_waitcnt lgkmcnt(10)
    v_mfma_f32_32x32x16_bf16 v[128:143], v[164:167], a[16:19], v[128:143]
    ds_read_b64_tr_b16 v[156:157], v9 offset:26624
    ds_read_b64_tr_b16 v[158:159], v9 offset:27136
    s_add_u32 m0, s61, 17408
    s_add_u32 s59, s56, 599296
    buffer_load_dwordx4 v2, s[8:11], s59 offen lds
    s_waitcnt vmcnt(37) lgkmcnt(10)
    v_mfma_f32_32x32x16_bf16 v[48:63], v[168:171], a[20:23], v[48:63]
    ds_read_b64_tr_b16 v[160:161], v4 offset:28672
    ds_read_b64_tr_b16 v[162:163], v4 offset:29184
    s_waitcnt lgkmcnt(10)
    v_mfma_f32_32x32x16_bf16 v[64:79], v[172:175], a[20:23], v[64:79]
    ds_read_b64_tr_b16 v[164:165], v5 offset:28672
    ds_read_b64_tr_b16 v[166:167], v5 offset:29184
    s_waitcnt lgkmcnt(10)
    v_mfma_f32_32x32x16_bf16 v[80:95], v[144:147], a[20:23], v[80:95]
    ds_read_b64_tr_b16 v[168:169], v6 offset:28672
    ds_read_b64_tr_b16 v[170:171], v6 offset:29184
    s_add_u32 m0, s61, 24576
    s_add_u32 s59, s56, 1253376
    buffer_load_dwordx4 v2, s[8:11], s59 offen lds
    s_waitcnt lgkmcnt(10)
    v_mfma_f32_32x32x16_bf16 v[96:111], v[148:151], a[20:23], v[96:111]
    ds_read_b64_tr_b16 v[172:173], v7 offset:28672
    ds_read_b64_tr_b16 v[174:175], v7 offset:29184
    s_waitcnt lgkmcnt(10)
    v_mfma_f32_32x32x16_bf16 v[112:127], v[152:155], a[20:23], v[112:127]
    ds_read_b64_tr_b16 v[144:145], v8 offset:28672
    ds_read_b64_tr_b16 v[146:147], v8 offset:29184
    s_add_u32 m0, s61, 25600
    s_add_u32 s59, s56, 1262592
    buffer_load_dwordx4 v2, s[8:11], s59 offen lds
    s_waitcnt lgkmcnt(10)
    v_mfma_f32_32x32x16_bf16 v[128:143], v[156:159], a[20:23], v[128:143]
    ds_read_b64_tr_b16 v[148:149], v9 offset:28672
    ds_read_b64_tr_b16 v[150:151], v9 offset:29184
    s_waitcnt vmcnt(38) lgkmcnt(10)
    v_mfma_f32_32x32x16_bf16 v[48:63], v[160:163], a[24:27], v[48:63]
    ds_read_b64_tr_b16 v[152:153], v4 offset:30720
    ds_read_b64_tr_b16 v[154:155], v4 offset:31232
    s_add_u32 m0, s61, 32768
    s_add_u32 s59, s56, 1253504
    buffer_load_dwordx4 v2, s[8:11], s59 offen lds
    s_waitcnt lgkmcnt(10)
    v_mfma_f32_32x32x16_bf16 v[64:79], v[164:167], a[24:27], v[64:79]
    ds_read_b64_tr_b16 v[156:157], v5 offset:30720
    ds_read_b64_tr_b16 v[158:159], v5 offset:31232
    s_waitcnt lgkmcnt(10)
    v_mfma_f32_32x32x16_bf16 v[80:95], v[168:171], a[24:27], v[80:95]
    ds_read_b64_tr_b16 v[160:161], v6 offset:30720
    ds_read_b64_tr_b16 v[162:163], v6 offset:31232
    s_waitcnt lgkmcnt(10)
    v_mfma_f32_32x32x16_bf16 v[96:111], v[172:175], a[24:27], v[96:111]
    ds_read_b64_tr_b16 v[164:165], v7 offset:30720
    ds_read_b64_tr_b16 v[166:167], v7 offset:31232
    s_add_u32 m0, s61, 33792
    s_add_u32 s59, s56, 1262720
    buffer_load_dwordx4 v2, s[8:11], s59 offen lds
    s_waitcnt lgkmcnt(10)
    v_mfma_f32_32x32x16_bf16 v[112:127], v[144:147], a[24:27], v[112:127]
    ds_read_b64_tr_b16 v[168:169], v8 offset:30720
    ds_read_b64_tr_b16 v[170:171], v8 offset:31232
    s_waitcnt lgkmcnt(10)
    v_mfma_f32_32x32x16_bf16 v[128:143], v[148:151], a[24:27], v[128:143]
    ds_read_b64_tr_b16 v[172:173], v9 offset:30720
    ds_read_b64_tr_b16 v[174:175], v9 offset:31232
    s_add_u32 m0, s61, 40960
    s_add_u32 s59, s56, 1253632
    buffer_load_dwordx4 v2, s[8:11], s59 offen lds
    s_waitcnt vmcnt(40) lgkmcnt(10)
    v_mfma_f32_32x32x16_bf16 v[48:63], v[152:155], a[28:31], v[48:63]
    s_waitcnt vmcnt(34)
    s_barrier
    v_add_u32 v4, 49152, v4
    v_add_u32 v5, 49152, v5
    v_add_u32 v6, 49152, v6
    v_add_u32 v7, 49152, v7
    v_add_u32 v8, 49152, v8
    v_add_u32 v9, 49152, v9
    ds_read_b64_tr_b16 v[144:145], v4 offset:0
    ds_read_b64_tr_b16 v[146:147], v4 offset:512
    s_waitcnt lgkmcnt(10)
    v_mfma_f32_32x32x16_bf16 v[64:79], v[156:159], a[28:31], v[64:79]
    ds_read_b64_tr_b16 v[148:149], v5 offset:0
    ds_read_b64_tr_b16 v[150:151], v5 offset:512
    s_add_u32 m0, s61, 41984
    s_add_u32 s59, s56, 1262848
    buffer_load_dwordx4 v2, s[8:11], s59 offen lds
    s_waitcnt lgkmcnt(10)
    v_mfma_f32_32x32x16_bf16 v[80:95], v[160:163], a[28:31], v[80:95]
    ds_read_b64_tr_b16 v[152:153], v6 offset:0
    ds_read_b64_tr_b16 v[154:155], v6 offset:512
    s_waitcnt lgkmcnt(10)
    v_mfma_f32_32x32x16_bf16 v[96:111], v[164:167], a[28:31], v[96:111]
    ds_read_b64_tr_b16 v[156:157], v7 offset:0
    ds_read_b64_tr_b16 v[158:159], v7 offset:512
    s_waitcnt lgkmcnt(10)
    v_mfma_f32_32x32x16_bf16 v[112:127], v[168:171], a[28:31], v[112:127]
    ds_read_b64_tr_b16 v[160:161], v8 offset:0
    ds_read_b64_tr_b16 v[162:163], v8 offset:512
    s_add_u32 m0, s61, 49152
    s_add_u32 s59, s56, 368640
    buffer_load_dwordx4 v2, s[8:11], s59 offen lds
    s_waitcnt lgkmcnt(10)
    v_mfma_f32_32x32x16_bf16 v[128:143], v[172:175], a[28:31], v[128:143]
    ds_read_b64_tr_b16 v[164:165], v9 offset:0
    ds_read_b64_tr_b16 v[166:167], v9 offset:512
    s_waitcnt vmcnt(35) lgkmcnt(10)
    v_mfma_f32_32x32x16_bf16 v[48:63], v[144:147], a[32:35], v[48:63]
    ds_read_b64_tr_b16 v[168:169], v4 offset:2048
    ds_read_b64_tr_b16 v[170:171], v4 offset:2560
    s_add_u32 m0, s61, 50176
    s_add_u32 s59, s56, 377856
    buffer_load_dwordx4 v2, s[8:11], s59 offen lds
    s_waitcnt lgkmcnt(10)
    v_mfma_f32_32x32x16_bf16 v[64:79], v[148:151], a[32:35], v[64:79]
    ds_read_b64_tr_b16 v[172:173], v5 offset:2048
    ds_read_b64_tr_b16 v[174:175], v5 offset:2560
    s_waitcnt lgkmcnt(10)
    v_mfma_f32_32x32x16_bf16 v[80:95], v[152:155], a[32:35], v[80:95]
    ds_read_b64_tr_b16 v[144:145], v6 offset:2048
    ds_read_b64_tr_b16 v[146:147], v6 offset:2560
    s_add_u32 m0, s61, 57344
    s_add_u32 s59, s56, 368768
    buffer_load_dwordx4 v2, s[8:11], s59 offen lds
    s_waitcnt lgkmcnt(10)
    v_mfma_f32_32x32x16_bf16 v[96:111], v[156:159], a[32:35], v[96:111]
    ds_read_b64_tr_b16 v[148:149], v7 offset:2048
    ds_read_b64_tr_b16 v[150:151], v7 offset:2560
    s_waitcnt lgkmcnt(10)
    v_mfma_f32_32x32x16_bf16 v[112:127], v[160:163], a[32:35], v[112:127]
    ds_read_b64_tr_b16 v[152:153], v8 offset:2048
    ds_read_b64_tr_b16 v[154:155], v8 offset:2560
    s_waitcnt vmcnt(26)
    v_min_f32 v246, v18, v19
    s_waitcnt vmcnt(24)
    v_min3_f32 v246, v246, v22, v23
    s_waitcnt vmcnt(22)
    v_min3_f32 v246, v246, v26, v27
    s_waitcnt vmcnt(21)
    v_min3_f32 v246, v246, v30, v31
    s_waitcnt vmcnt(17)
    v_min3_f32 v246, v246, v34, v35
    s_waitcnt lgkmcnt(10)
    v_mfma_f32_32x32x16_bf16 v[128:143], v[164:167], a[32:35], v[128:143]
    ds_read_b64_tr_b16 v[156:157], v9 offset:2048
    ds_read_b64_tr_b16 v[158:159], v9 offset:2560
    s_add_u32 m0, s61, 58368
    s_add_u32 s59, s56, 377984
    buffer_load_dwordx4 v2, s[8:11], s59 offen lds
    s_waitcnt vmcnt(17)
    v_min3_f32 v246, v246, v38, v39
    s_waitcnt lgkmcnt(10)
    v_mfma_f32_32x32x16_bf16 v[48:63], v[168:171], a[36:39], v[48:63]
    ds_read_b64_tr_b16 v[160:161], v4 offset:4096
    ds_read_b64_tr_b16 v[162:163], v4 offset:4608
    s_waitcnt vmcnt(15)
    v_min3_f32 v246, v246, v42, v43
    s_waitcnt vmcnt(13)
    v_min3_f32 v246, v246, v46, v47
    v_cmp_gt_f32 vcc, 0.5, v246
    s_nop 4
    s_cbranch_vccnz K3SF_SLOW
    s_waitcnt lgkmcnt(10)
    v_mfma_f32_32x32x16_bf16 v[64:79], v[172:175], a[36:39], v[64:79]
    ds_read_b64_tr_b16 v[164:165], v5 offset:4096
    ds_read_b64_tr_b16 v[166:167], v5 offset:4608
    s_add_u32 m0, s61, 65536
    s_add_u32 s59, s56, 368896
    buffer_load_dwordx4 v2, s[8:11], s59 offen lds
K3SF_BACK:
    v_mul_f32 v228, 0x42800000, v230
    s_waitcnt lgkmcnt(10)
    v_mfma_f32_32x32x16_bf16 v[80:95], v[144:147], a[36:39], v[80:95]
    ds_read_b64_tr_b16 v[168:169], v6 offset:4096
    ds_read_b64_tr_b16 v[170:171], v6 offset:4608
    v_cmp_gt_u32 vcc, 8, v253
    s_nop 4
    s_cbranch_vccnz K3_GSF0
K3_GBF0:
    v_mul_f32 v239, 0x42800000, v231
    s_waitcnt lgkmcnt(10)
    v_mfma_f32_32x32x16_bf16 v[96:111], v[148:151], a[36:39], v[96:111]
    ds_read_b64_tr_b16 v[172:173], v7 offset:4096
    ds_read_b64_tr_b16 v[174:175], v7 offset:4608
    s_add_u32 s62, s64, 32768
    buffer_load_dwordx4 a[64:67], v1, s[20:23], s62 offen offset:0 sc1
    v_exp_f32 v228, v228
    s_waitcnt lgkmcnt(10)
    v_mfma_f32_32x32x16_bf16 v[112:127], v[152:155], a[36:39], v[112:127]
    ds_read_b64_tr_b16 v[144:145], v8 offset:4096
    ds_read_b64_tr_b16 v[146:147], v8 offset:4608
    s_add_u32 s62, s64, 32768
    buffer_load_dwordx4 a[68:71], v1, s[20:23], s62 offen offset:1024 sc1
    v_fract_f32 v239, v239
    v_cos_f32 v238, v239
    s_waitcnt lgkmcnt(10)
    v_mfma_f32_32x32x16_bf16 v[128:143], v[156:159], a[36:39], v[128:143]
    ds_read_b64_tr_b16 v[148:149], v9 offset:4096
    ds_read_b64_tr_b16 v[150:151], v9 offset:4608
    s_add_u32 s62, s64, 32768
    buffer_load_dwordx4 a[72:75], v1, s[20:23], s62 offen offset:2048 sc1
    v_sin_f32 v239, v239
    s_waitcnt lgkmcnt(10)
    v_mfma_f32_32x32x16_bf16 v[48:63], v[160:163], a[40:43], v[48:63]
    ds_read_b64_tr_b16 v[152:153], v4 offset:6144
    ds_read_b64_tr_b16 v[154:155], v4 offset:6656
    s_add_u32 s62, s64, 32768
    buffer_load_dwordx4 a[76:79], v1, s[20:23], s62 offen offset:3072 sc1
    v_mul_f32 v238, v228, v238
    v_mul_f32 v239, v228, v239
    s_waitcnt lgkmcnt(10)
    v_mfma_f32_32x32x16_bf16 v[64:79], v[164:167], a[40:43], v[64:79]
    ds_read_b64_tr_b16 v[156:157], v5 offset:6144
    ds_read_b64_tr_b16 v[158:159], v5 offset:6656
    v_fma_f32 v40, v238, v44, v40
    v_fma_f32 v41, v238, v45, v41
    v_fma_f32 v40, -v239, v45, v40
    v_fmac_f32 v41, v239, v44
    v_fma_f32 v36, v238, v40, v36
    s_waitcnt lgkmcnt(10)
    v_mfma_f32_32x32x16_bf16 v[80:95], v[168:171], a[40:43], v[80:95]
    ds_read_b64_tr_b16 v[160:161], v6 offset:6144
    ds_read_b64_tr_b16 v[162:163], v6 offset:6656
    v_fma_f32 v37, v238, v41, v37
    v_fma_f32 v36, -v239, v41, v36
    v_fmac_f32 v37, v239, v40
    v_fma_f32 v32, v238, v36, v32
    v_fma_f32 v33, v238, v37, v33
    s_waitcnt lgkmcnt(10)
    v_mfma_f32_32x32x16_bf16 v[96:111], v[172:175], a[40:43], v[96:111]
    ds_read_b64_tr_b16 v[164:165], v7 offset:6144
    ds_read_b64_tr_b16 v[166:167], v7 offset:6656
    v_fma_f32 v32, -v239, v37, v32
    v_fmac_f32 v33, v239, v36
    v_fma_f32 v28, v238, v32, v28
    v_fma_f32 v29, v238, v33, v29
    s_waitcnt lgkmcnt(10)
    v_mfma_f32_32x32x16_bf16 v[112:127], v[144:147], a[40:43], v[112:127]
    ds_read_b64_tr_b16 v[168:169], v8 offset:6144
    ds_read_b64_tr_b16 v[170:171], v8 offset:6656
    v_fma_f32 v28, -v239, v33, v28
    v_fmac_f32 v29, v239, v32
    v_fma_f32 v24, v238, v28, v24
    v_fma_f32 v25, v238, v29, v25
    v_fma_f32 v24, -v239, v29, v24
    s_waitcnt lgkmcnt(10)
    v_mfma_f32_32x32x16_bf16 v[128:143], v[148:151], a[40:43], v[128:143]
    ds_read_b64_tr_b16 v[172:173], v9 offset:6144
    ds_read_b64_tr_b16 v[174:175], v9 offset:6656
    v_fmac_f32 v25, v239, v28
    v_fma_f32 v20, v238, v24, v20
    v_fma_f32 v21, v238, v25, v21
    v_fma_f32 v20, -v239, v25, v20
    v_fmac_f32 v21, v239, v24
    s_waitcnt lgkmcnt(10)
    v_mfma_f32_32x32x16_bf16 v[48:63], v[152:155], a[44:47], v[48:63]
    s_barrier
    ds_read_b64_tr_b16 v[144:145], v4 offset:24576
    ds_read_b64_tr_b16 v[146:147], v4 offset:25088
    v_fma_f32 v16, v238, v20, v16
    v_fma_f32 v17, v238, v21, v17
    s_waitcnt lgkmcnt(10)
    v_mfma_f32_32x32x16_bf16 v[64:79], v[156:159], a[44:47], v[64:79]
    ds_read_b64_tr_b16 v[148:149], v5 offset:24576
    ds_read_b64_tr_b16 v[150:151], v5 offset:25088
    s_add_u32 s62, s64, 69632
    buffer_load_dwordx4 a[80:83], v1, s[20:23], s62 offen offset:0 sc1
    v_fma_f32 v16, -v239, v21, v16
    v_fmac_f32 v17, v239, v20
    v_mul_f32 v246, 0x44000000, v245
    s_waitcnt lgkmcnt(10)
    v_mfma_f32_32x32x16_bf16 v[80:95], v[160:163], a[44:47], v[80:95]
    ds_read_b64_tr_b16 v[152:153], v6 offset:24576
    ds_read_b64_tr_b16 v[154:155], v6 offset:25088
    v_mul_f32 v228, v246, v230
    v_mul_f32 v239, v246, v231
    v_exp_f32 v228, v228
    s_waitcnt lgkmcnt(10)
    v_mfma_f32_32x32x16_bf16 v[96:111], v[164:167], a[44:47], v[96:111]
    ds_read_b64_tr_b16 v[156:157], v7 offset:24576
    ds_read_b64_tr_b16 v[158:159], v7 offset:25088
    s_add_u32 s62, s64, 69632
    buffer_load_dwordx4 a[84:87], v1, s[20:23], s62 offen offset:1024 sc1
    v_fract_f32 v239, v239
    v_cos_f32 v238, v239
    s_waitcnt lgkmcnt(10)
    v_mfma_f32_32x32x16_bf16 v[112:127], v[168:171], a[44:47], v[112:127]
    ds_read_b64_tr_b16 v[160:161], v8 offset:24576
    ds_read_b64_tr_b16 v[162:163], v8 offset:25088
    v_sin_f32 v239, v239
    v_mul_f32 v238, v228, v238
    v_mul_f32 v239, v228, v239
    s_waitcnt lgkmcnt(10)
    v_mfma_f32_32x32x16_bf16 v[128:143], v[172:175], a[44:47], v[128:143]
    ds_read_b64_tr_b16 v[164:165], v9 offset:24576
    ds_read_b64_tr_b16 v[166:167], v9 offset:25088
    v_mul_f32 v236, v238, v16
    v_mul_f32 v237, v238, v17
    v_fma_f32 v236, -v239, v17, v236
    v_fmac_f32 v237, v239, v16
    v_mov_b32 v228, v236
    s_waitcnt lgkmcnt(10)
    v_mfma_f32_32x32x16_bf16 v[48:63], v[144:147], a[48:51], v[48:63]
    ds_read_b64_tr_b16 v[168:169], v4 offset:26624
    ds_read_b64_tr_b16 v[170:171], v4 offset:27136
    s_add_u32 s62, s64, 69632
    buffer_load_dwordx4 a[88:91], v1, s[20:23], s62 offen offset:2048 sc1
    v_mov_b32 v229, v237
    v_permlane16_swap_b32 v236, v228
    s_waitcnt lgkmcnt(10)
    v_mfma_f32_32x32x16_bf16 v[64:79], v[148:151], a[48:51], v[64:79]
    ds_read_b64_tr_b16 v[172:173], v5 offset:26624
    ds_read_b64_tr_b16 v[174:175], v5 offset:27136
    v_permlane16_swap_b32 v237, v229
    v_add_f32 v236, v236, v228
    v_add_f32 v237, v237, v229
    s_waitcnt lgkmcnt(10)
    v_mfma_f32_32x32x16_bf16 v[80:95], v[152:155], a[48:51], v[80:95]
    ds_read_b64_tr_b16 v[144:145], v6 offset:26624
    ds_read_b64_tr_b16 v[146:147], v6 offset:27136
    s_add_u32 s62, s64, 69632
    buffer_load_dwordx4 a[92:95], v1, s[20:23], s62 offen offset:3072 sc1
    v_mov_b32 v228, v236
    v_mov_b32 v229, v237
    s_waitcnt lgkmcnt(10)
    v_mfma_f32_32x32x16_bf16 v[96:111], v[156:159], a[48:51], v[96:111]
    ds_read_b64_tr_b16 v[148:149], v7 offset:26624
    ds_read_b64_tr_b16 v[150:151], v7 offset:27136
    v_permlane32_swap_b32 v236, v228
    v_permlane32_swap_b32 v237, v229
    v_add_f32 v236, v236, v228
    s_waitcnt lgkmcnt(10)
    v_mfma_f32_32x32x16_bf16 v[112:127], v[160:163], a[48:51], v[112:127]
    ds_read_b64_tr_b16 v[152:153], v8 offset:26624
    ds_read_b64_tr_b16 v[154:155], v8 offset:27136
    s_add_u32 m0, s61, 66560
    s_add_u32 s59, s56, 378112
    buffer_load_dwordx4 v2, s[8:11], s59 offen lds
    v_add_f32 v237, v237, v229
    s_waitcnt lgkmcnt(10)
    v_mfma_f32_32x32x16_bf16 v[128:143], v[164:167], a[48:51], v[128:143]
    ds_read_b64_tr_b16 v[156:157], v9 offset:26624
    ds_read_b64_tr_b16 v[158:159], v9 offset:27136
    s_lshl_b32 s3, s53, 11
    s_add_u32 s3, s3, 147456
    v_and_b32 v208, 15, v0
    v_lshlrev_b32 v208, 6, v208
    v_bfe_u32 v228, v0, 4, 1
    s_waitcnt lgkmcnt(10)
    v_mfma_f32_32x32x16_bf16 v[48:63], v[168:171], a[52:55], v[48:63]
    ds_read_b64_tr_b16 v[160:161], v4 offset:28672
    ds_read_b64_tr_b16 v[162:163], v4 offset:29184
    v_lshl_add_u32 v208, v228, 5, v208
    v_lshrrev_b32 v229, 5, v0
    v_lshl_add_u32 v208, v229, 3, v208
    v_add_u32 v208, s3, v208
    v_lshlrev_b32 v209, 3, v229
    s_waitcnt lgkmcnt(10)
    v_mfma_f32_32x32x16_bf16 v[64:79], v[172:175], a[52:55], v[64:79]
    ds_read_b64_tr_b16 v[164:165], v5 offset:28672
    ds_read_b64_tr_b16 v[166:167], v5 offset:29184
    s_add_u32 s62, s64, 20480
    buffer_load_dwordx4 a[96:99], v1, s[20:23], s62 offen offset:0 sc1
    v_bfe_u32 v229, v0, 2, 2
    v_add_u32 v209, v209, v229
    s_waitcnt lgkmcnt(10)
    v_mfma_f32_32x32x16_bf16 v[80:95], v[144:147], a[52:55], v[80:95]
    ds_read_b64_tr_b16 v[168:169], v6 offset:28672
    ds_read_b64_tr_b16 v[170:171], v6 offset:29184
    v_lshlrev_b32 v209, 6, v209
    v_lshl_add_u32 v209, v228, 5, v209
    v_and_b32 v229, 3, v0
    v_lshl_add_u32 v209, v229, 3, v209
    v_add_u32 v209, s3, v209
    s_waitcnt lgkmcnt(10)
    v_mfma_f32_32x32x16_bf16 v[96:111], v[148:151], a[52:55], v[96:111]
    ds_read_b64_tr_b16 v[172:173], v7 offset:28672
    ds_read_b64_tr_b16 v[174:175], v7 offset:29184
    s_add_u32 s62, s64, 20480
    buffer_load_dwordx4 a[100:103], v1, s[20:23], s62 offen offset:1024 sc1
    v_mov_b32 v246, 0x00000000
    v_fmac_f32 v246, 0x41000000, v245
    s_waitcnt lgkmcnt(10)
    v_mfma_f32_32x32x16_bf16 v[112:127], v[152:155], a[52:55], v[112:127]
    ds_read_b64_tr_b16 v[144:145], v8 offset:28672
    ds_read_b64_tr_b16 v[146:147], v8 offset:29184
    v_mul_f32 v228, v246, v230
    v_mul_f32 v239, v246, v231
    v_exp_f32 v228, v228
    v_fract_f32 v239, v239
    s_waitcnt lgkmcnt(10)
    v_mfma_f32_32x32x16_bf16 v[128:143], v[156:159], a[52:55], v[128:143]
    ds_read_b64_tr_b16 v[148:149], v9 offset:28672
    ds_read_b64_tr_b16 v[150:151], v9 offset:29184
    s_add_u32 s62, s64, 20480
    buffer_load_dwordx4 a[104:107], v1, s[20:23], s62 offen offset:2048 sc1
    v_cos_f32 v238, v239
    s_waitcnt lgkmcnt(10)
    v_mfma_f32_32x32x16_bf16 v[48:63], v[160:163], a[56:59], v[48:63]
    ds_read_b64_tr_b16 v[152:153], v4 offset:30720
    ds_read_b64_tr_b16 v[154:155], v4 offset:31232
    v_sin_f32 v239, v239
    v_mul_f32 v238, v228, v238
    v_mul_f32 v239, v228, v239
    v_fma_f32 v240, v238, v236, v240
    s_waitcnt lgkmcnt(10)
    v_mfma_f32_32x32x16_bf16 v[64:79], v[164:167], a[56:59], v[64:79]
    ds_read_b64_tr_b16 v[156:157], v5 offset:30720
    ds_read_b64_tr_b16 v[158:159], v5 offset:31232
    v_fma_f32 v241, v238, v237, v241
    v_fma_f32 v240, -v239, v237, v240
    v_fmac_f32 v241, v239, v236
    v_fma_f32 v176, v234, v240, v176
    v_fma_f32 v184, v234, v241, v184
    s_waitcnt lgkmcnt(10)
    v_mfma_f32_32x32x16_bf16 v[80:95], v[168:171], a[56:59], v[80:95]
    ds_read_b64_tr_b16 v[160:161], v6 offset:30720
    ds_read_b64_tr_b16 v[162:163], v6 offset:31232
    s_add_u32 s62, s64, 20480
    buffer_load_dwordx4 a[108:111], v1, s[20:23], s62 offen offset:3072 sc1
    v_fma_f32 v176, -v235, v241, v176
    v_fmac_f32 v184, v235, v240
    s_waitcnt lgkmcnt(10)
    v_mfma_f32_32x32x16_bf16 v[96:111], v[172:175], a[56:59], v[96:111]
    ds_read_b64_tr_b16 v[164:165], v7 offset:30720
    ds_read_b64_tr_b16 v[166:167], v7 offset:31232
    v_fma_f32 v177, v234, v176, v177
    v_fma_f32 v185, v234, v184, v185
    v_fma_f32 v177, -v235, v184, v177
    v_fmac_f32 v185, v235, v176
    v_fma_f32 v178, v234, v177, v178
    s_waitcnt lgkmcnt(10)
    v_mfma_f32_32x32x16_bf16 v[112:127], v[144:147], a[56:59], v[112:127]
    ds_read_b64_tr_b16 v[168:169], v8 offset:30720
    ds_read_b64_tr_b16 v[170:171], v8 offset:31232
    s_add_u32 m0, s61, 73728
    s_add_u32 s59, s56, 516096
    buffer_load_dwordx4 v2, s[8:11], s59 offen lds
    v_fma_f32 v186, v234, v185, v186
    s_waitcnt lgkmcnt(10)
    v_mfma_f32_32x32x16_bf16 v[128:143], v[148:151], a[56:59], v[128:143]
    ds_read_b64_tr_b16 v[172:173], v9 offset:30720
    ds_read_b64_tr_b16 v[174:175], v9 offset:31232
    v_fma_f32 v178, -v235, v185, v178
    v_fmac_f32 v186, v235, v177
    v_fma_f32 v179, v234, v178, v179
    v_fma_f32 v187, v234, v186, v187
    s_waitcnt lgkmcnt(10)
    v_mfma_f32_32x32x16_bf16 v[48:63], v[152:155], a[60:63], v[48:63]
    s_waitcnt vmcnt(25)
    s_barrier
    v_add_u32 v4, 4294868992, v4
    v_add_u32 v5, 4294868992, v5
    v_add_u32 v6, 4294868992, v6
    v_add_u32 v7, 4294868992, v7
    v_add_u32 v8, 4294868992, v8
    v_add_u32 v9, 4294868992, v9
    ds_read_b64_tr_b16 v[144:145], v4 offset:0
    ds_read_b64_tr_b16 v[146:147], v4 offset:512
    s_add_u32 m0, s61, 74752
    s_add_u32 s59, s56, 525312
    buffer_load_dwordx4 v2, s[8:11], s59 offen lds
    v_fma_f32 v179, -v235, v186, v179
    s_waitcnt lgkmcnt(10)
    v_mfma_f32_32x32x16_bf16 v[64:79], v[156:159], a[60:63], v[64:79]
    ds_read_b64_tr_b16 v[148:149], v5 offset:0
    ds_read_b64_tr_b16 v[150:151], v5 offset:512
    v_fmac_f32 v187, v235, v178
    v_fma_f32 v180, v234, v179, v180
    v_fma_f32 v188, v234, v187, v188
    v_fma_f32 v180, -v235, v187, v180
    v_fmac_f32 v188, v235, v179
    s_waitcnt lgkmcnt(10)
    v_mfma_f32_32x32x16_bf16 v[80:95], v[160:163], a[60:63], v[80:95]
    ds_read_b64_tr_b16 v[152:153], v6 offset:0
    ds_read_b64_tr_b16 v[154:155], v6 offset:512
    v_fma_f32 v181, v234, v180, v181
    v_fma_f32 v189, v234, v188, v189
    v_fma_f32 v181, -v235, v188, v181
    v_fmac_f32 v189, v235, v180
    s_waitcnt lgkmcnt(10)
    v_mfma_f32_32x32x16_bf16 v[96:111], v[164:167], a[60:63], v[96:111]
    ds_read_b64_tr_b16 v[156:157], v7 offset:0
    ds_read_b64_tr_b16 v[158:159], v7 offset:512
    s_add_u32 m0, s61, 81920
    s_add_u32 s59, s56, 516224
    buffer_load_dwordx4 v2, s[8:11], s59 offen lds
    v_fma_f32 v182, v234, v181, v182
    v_fma_f32 v190, v234, v189, v190
    s_waitcnt lgkmcnt(10)
    v_mfma_f32_32x32x16_bf16 v[112:127], v[168:171], a[60:63], v[112:127]
    ds_read_b64_tr_b16 v[160:161], v8 offset:0
    ds_read_b64_tr_b16 v[162:163], v8 offset:512
    v_fma_f32 v182, -v235, v189, v182
    v_fmac_f32 v190, v235, v181
    v_fma_f32 v183, v234, v182, v183
    v_fma_f32 v191, v234, v190, v191
    s_waitcnt lgkmcnt(10)
    v_mfma_f32_32x32x16_bf16 v[128:143], v[172:175], a[60:63], v[128:143]
    ds_read_b64_tr_b16 v[164:165], v9 offset:0
    ds_read_b64_tr_b16 v[166:167], v9 offset:512
    s_add_u32 m0, s61, 82944
    s_add_u32 s59, s56, 525440
    buffer_load_dwordx4 v2, s[8:11], s59 offen lds
    v_fma_f32 v183, -v235, v190, v183
    s_waitcnt vmcnt(16) lgkmcnt(10)
    v_mfma_f32_32x32x16_bf16 v[48:63], v[144:147], a[64:67], v[48:63]
    ds_read_b64_tr_b16 v[168:169], v4 offset:2048
    ds_read_b64_tr_b16 v[170:171], v4 offset:2560
    v_fmac_f32 v191, v235, v182
    v_cvt_pk_bf16_f32 v176, v176, v177
    v_cvt_pk_bf16_f32 v177, v178, v179
    v_cvt_pk_bf16_f32 v178, v180, v181
    v_cvt_pk_bf16_f32 v179, v182, v183
    s_waitcnt lgkmcnt(10)
    v_mfma_f32_32x32x16_bf16 v[64:79], v[148:151], a[64:67], v[64:79]
    ds_read_b64_tr_b16 v[172:173], v5 offset:2048
    ds_read_b64_tr_b16 v[174:175], v5 offset:2560
    s_add_u32 m0, s61, 90112
    s_add_u32 s59, s56, 516352
    buffer_load_dwordx4 v2, s[8:11], s59 offen lds
    v_cvt_pk_bf16_f32 v184, -v184, -v185
    s_waitcnt lgkmcnt(10)
    v_mfma_f32_32x32x16_bf16 v[80:95], v[152:155], a[64:67], v[80:95]
    ds_read_b64_tr_b16 v[144:145], v6 offset:2048
    ds_read_b64_tr_b16 v[146:147], v6 offset:2560
    v_cvt_pk_bf16_f32 v185, -v186, -v187
    v_cvt_pk_bf16_f32 v186, -v188, -v189
    v_cvt_pk_bf16_f32 v187, -v190, -v191
    ds_write_b64 v208, v[176:177]
    ds_write_b64 v208, v[178:179] offset:16
    s_waitcnt lgkmcnt(12)
    v_mfma_f32_32x32x16_bf16 v[96:111], v[156:159], a[64:67], v[96:111]
    ds_read_b64_tr_b16 v[148:149], v7 offset:2048
    ds_read_b64_tr_b16 v[150:151], v7 offset:2560
    ds_write_b64 v208, v[184:185] offset:1024
    ds_write_b64 v208, v[186:187] offset:1040
    ds_read_b64_tr_b16 v[180:181], v209
    ds_read_b64_tr_b16 v[182:183], v209 offset:256
    ds_read_b64_tr_b16 v[188:189], v209 offset:1024
    s_waitcnt lgkmcnt(15)
    v_mfma_f32_32x32x16_bf16 v[112:127], v[160:163], a[64:67], v[112:127]
    ds_read_b64_tr_b16 v[152:153], v8 offset:2048
    ds_read_b64_tr_b16 v[154:155], v8 offset:2560
    s_add_u32 m0, s61, 91136
    s_add_u32 s59, s56, 525568
    buffer_load_dwordx4 v2, s[8:11], s59 offen lds
    ds_read_b64_tr_b16 v[190:191], v209 offset:1280
    v_mfma_f32_32x32x16_bf16 v[128:143], v[164:167], a[64:67], v[128:143]
    ds_read_b64_tr_b16 v[156:157], v9 offset:2048
    ds_read_b64_tr_b16 v[158:159], v9 offset:2560
    s_add_u32 s3, s82, 36864
    s_waitcnt lgkmcnt(6)
    buffer_store_dwordx4 v[180:183], v1, s[20:23], s82 offen sc1
    s_waitcnt lgkmcnt(2)
    buffer_store_dwordx4 v[188:191], v1, s[20:23], s3 offen sc1
    v_mov_b32 v246, 0x42000000
    v_fmac_f32 v246, 0x41000000, v245
    s_waitcnt vmcnt(19)
    v_mfma_f32_32x32x16_bf16 v[48:63], v[168:171], a[68:71], v[48:63]
    ds_read_b64_tr_b16 v[160:161], v4 offset:4096
    ds_read_b64_tr_b16 v[162:163], v4 offset:4608
    s_add_u32 s62, s64, 28672
    buffer_load_dwordx4 a[112:115], v1, s[20:23], s62 offen offset:0 sc1
    v_mul_f32 v228, v246, v230
    v_mul_f32 v239, v246, v231
    v_mfma_f32_32x32x16_bf16 v[64:79], v[172:175], a[68:71], v[64:79]
    ds_read_b64_tr_b16 v[164:165], v5 offset:4096
    ds_read_b64_tr_b16 v[166:167], v5 offset:4608
    v_exp_f32 v228, v228
    v_fract_f32 v239, v239
    v_cos_f32 v238, v239
    v_mfma_f32_32x32x16_bf16 v[80:95], v[144:147], a[68:71], v[80:95]
    ds_read_b64_tr_b16 v[168:169], v6 offset:4096
    ds_read_b64_tr_b16 v[170:171], v6 offset:4608
    s_add_u32 s62, s64, 28672
    buffer_load_dwordx4 a[116:119], v1, s[20:23], s62 offen offset:1024 sc1
    v_sin_f32 v239, v239
    v_mfma_f32_32x32x16_bf16 v[96:111], v[148:151], a[68:71], v[96:111]
    ds_read_b64_tr_b16 v[172:173], v7 offset:4096
    ds_read_b64_tr_b16 v[174:175], v7 offset:4608
    v_mul_f32 v238, v228, v238
    v_mul_f32 v239, v228, v239
    v_fma_f32 v242, v238, v236, v242
    v_fma_f32 v243, v238, v237, v243
    v_fma_f32 v242, -v239, v237, v242
    v_mfma_f32_32x32x16_bf16 v[112:127], v[152:155], a[68:71], v[112:127]
    ds_read_b64_tr_b16 v[144:145], v8 offset:4096
    ds_read_b64_tr_b16 v[146:147], v8 offset:4608
    v_fmac_f32 v243, v239, v236
    v_fma_f32 v192, v234, v242, v192
    v_fma_f32 v200, v234, v243, v200
    v_fma_f32 v192, -v235, v243, v192
    s_waitcnt lgkmcnt(10)
    v_mfma_f32_32x32x16_bf16 v[128:143], v[156:159], a[68:71], v[128:143]
    ds_read_b64_tr_b16 v[148:149], v9 offset:4096
    ds_read_b64_tr_b16 v[150:151], v9 offset:4608
    s_add_u32 s62, s64, 28672
    buffer_load_dwordx4 a[120:123], v1, s[20:23], s62 offen offset:2048 sc1
    v_fmac_f32 v200, v235, v242
    v_fma_f32 v193, v234, v192, v193
    v_fma_f32 v201, v234, v200, v201
    s_waitcnt vmcnt(21) lgkmcnt(10)
    v_mfma_f32_32x32x16_bf16 v[48:63], v[160:163], a[72:75], v[48:63]
    ds_read_b64_tr_b16 v[152:153], v4 offset:6144
    ds_read_b64_tr_b16 v[154:155], v4 offset:6656
    v_fma_f32 v193, -v235, v200, v193
    v_fmac_f32 v201, v235, v192
    v_fma_f32 v194, v234, v193, v194
    v_fma_f32 v202, v234, v201, v202
    s_waitcnt lgkmcnt(10)
    v_mfma_f32_32x32x16_bf16 v[64:79], v[164:167], a[72:75], v[64:79]
    ds_read_b64_tr_b16 v[156:157], v5 offset:6144
    ds_read_b64_tr_b16 v[158:159], v5 offset:6656
    s_add_u32 s62, s64, 28672
    buffer_load_dwordx4 a[124:127], v1, s[20:23], s62 offen offset:3072 sc1
    v_fma_f32 v194, -v235, v201, v194
    v_fmac_f32 v202, v235, v193
    v_fma_f32 v195, v234, v194, v195
    s_waitcnt lgkmcnt(10)
    v_mfma_f32_32x32x16_bf16 v[80:95], v[168:171], a[72:75], v[80:95]
    ds_read_b64_tr_b16 v[160:161], v6 offset:6144
    ds_read_b64_tr_b16 v[162:163], v6 offset:6656
    v_fma_f32 v203, v234, v202, v203
    v_fma_f32 v195, -v235, v202, v195
    v_fmac_f32 v203, v235, v194
    v_fma_f32 v196, v234, v195, v196
    v_fma_f32 v204, v234, v203, v204
    s_waitcnt lgkmcnt(10)
    v_mfma_f32_32x32x16_bf16 v[96:111], v[172:175], a[72:75], v[96:111]
    ds_read_b64_tr_b16 v[164:165], v7 offset:6144
    ds_read_b64_tr_b16 v[166:167], v7 offset:6656
    v_fma_f32 v196, -v235, v203, v196
    v_fmac_f32 v204, v235, v195
    v_fma_f32 v197, v234, v196, v197
    v_fma_f32 v205, v234, v204, v205
    s_waitcnt lgkmcnt(10)
    v_mfma_f32_32x32x16_bf16 v[112:127], v[144:147], a[72:75], v[112:127]
    ds_read_b64_tr_b16 v[168:169], v8 offset:6144
    ds_read_b64_tr_b16 v[170:171], v8 offset:6656
    s_add_u32 m0, s61, 98304
    s_add_u32 s59, s56, 737280
    buffer_load_dwordx4 v2, s[8:11], s59 offen lds
    v_fma_f32 v197, -v235, v204, v197
    s_waitcnt lgkmcnt(10)
    v_mfma_f32_32x32x16_bf16 v[128:143], v[148:151], a[72:75], v[128:143]
    ds_read_b64_tr_b16 v[172:173], v9 offset:6144
    ds_read_b64_tr_b16 v[174:175], v9 offset:6656
    v_fmac_f32 v205, v235, v196
    v_fma_f32 v198, v234, v197, v198
    v_fma_f32 v206, v234, v205, v206
    v_fma_f32 v198, -v235, v205, v198
    v_fmac_f32 v206, v235, v197
    s_waitcnt vmcnt(22) lgkmcnt(10)
    v_mfma_f32_32x32x16_bf16 v[48:63], v[152:155], a[76:79], v[48:63]
    s_barrier
    ds_read_b64_tr_b16 v[144:145], v4 offset:24576
    ds_read_b64_tr_b16 v[146:147], v4 offset:25088
    s_add_u32 m0, s61, 99328
    s_add_u32 s59, s56, 746496
    buffer_load_dwordx4 v2, s[8:11], s59 offen lds
    v_fma_f32 v199, v234, v198, v199
    s_waitcnt lgkmcnt(10)
    v_mfma_f32_32x32x16_bf16 v[64:79], v[156:159], a[76:79], v[64:79]
    ds_read_b64_tr_b16 v[148:149], v5 offset:24576
    ds_read_b64_tr_b16 v[150:151], v5 offset:25088
    v_fma_f32 v207, v234, v206, v207
    v_fma_f32 v199, -v235, v206, v199
    v_fmac_f32 v207, v235, v198
    v_cvt_pk_bf16_f32 v192, v192, v193
    s_waitcnt lgkmcnt(10)
    v_mfma_f32_32x32x16_bf16 v[80:95], v[160:163], a[76:79], v[80:95]
    ds_read_b64_tr_b16 v[152:153], v6 offset:24576
    ds_read_b64_tr_b16 v[154:155], v6 offset:25088
    s_add_u32 m0, s61, 106496
    s_add_u32 s59, s56, 737408
    buffer_load_dwordx4 v2, s[8:11], s59 offen lds
    v_cvt_pk_bf16_f32 v193, v194, v195
    v_cvt_pk_bf16_f32 v194, v196, v197
    s_waitcnt lgkmcnt(10)
    v_mfma_f32_32x32x16_bf16 v[96:111], v[164:167], a[76:79], v[96:111]
    ds_read_b64_tr_b16 v[156:157], v7 offset:24576
    ds_read_b64_tr_b16 v[158:159], v7 offset:25088
    v_cvt_pk_bf16_f32 v195, v198, v199
    v_cvt_pk_bf16_f32 v200, -v200, -v201
    v_cvt_pk_bf16_f32 v201, -v202, -v203
    v_cvt_pk_bf16_f32 v202, -v204, -v205
    s_waitcnt lgkmcnt(10)
    v_mfma_f32_32x32x16_bf16 v[112:127], v[168:171], a[76:79], v[112:127]
    ds_read_b64_tr_b16 v[160:161], v8 offset:24576
    ds_read_b64_tr_b16 v[162:163], v8 offset:25088
    v_cvt_pk_bf16_f32 v203, -v206, -v207
    ds_write_b64 v208, v[192:193]
    ds_write_b64 v208, v[194:195] offset:16
    ds_write_b64 v208, v[200:201] offset:1024
    ds_write_b64 v208, v[202:203] offset:1040
    s_waitcnt lgkmcnt(14)
    v_mfma_f32_32x32x16_bf16 v[128:143], v[172:175], a[76:79], v[128:143]
    ds_read_b64_tr_b16 v[164:165], v9 offset:24576
    ds_read_b64_tr_b16 v[166:167], v9 offset:25088
    s_add_u32 m0, s61, 107520
    s_add_u32 s59, s56, 746624
    buffer_load_dwordx4 v2, s[8:11], s59 offen lds
    ds_read_b64_tr_b16 v[196:197], v209
    s_waitcnt vmcnt(24) lgkmcnt(15)
    v_mfma_f32_32x32x16_bf16 v[48:63], v[144:147], a[80:83], v[48:63]
    ds_read_b64_tr_b16 v[168:169], v4 offset:26624
    ds_read_b64_tr_b16 v[170:171], v4 offset:27136
    ds_read_b64_tr_b16 v[198:199], v209 offset:256
    ds_read_b64_tr_b16 v[204:205], v209 offset:1024
    ds_read_b64_tr_b16 v[206:207], v209 offset:1280
    s_add_u32 s3, s83, 36864
    s_waitcnt lgkmcnt(2)
    buffer_store_dwordx4 v[196:199], v1, s[20:23], s83 offen sc1
    v_mfma_f32_32x32x16_bf16 v[64:79], v[148:151], a[80:83], v[64:79]
    ds_read_b64_tr_b16 v[172:173], v5 offset:26624
    ds_read_b64_tr_b16 v[174:175], v5 offset:27136
    s_add_u32 m0, s61, 114688
    s_add_u32 s59, s56, 737536
    buffer_load_dwordx4 v2, s[8:11], s59 offen lds
    s_waitcnt lgkmcnt(2)
    buffer_store_dwordx4 v[204:207], v1, s[20:23], s3 offen sc1
    v_mfma_f32_32x32x16_bf16 v[80:95], v[152:155], a[80:83], v[80:95]
    ds_read_b64_tr_b16 v[144:145], v6 offset:26624
    ds_read_b64_tr_b16 v[146:147], v6 offset:27136
    v_mfma_f32_32x32x16_bf16 v[96:111], v[156:159], a[80:83], v[96:111]
    ds_read_b64_tr_b16 v[148:149], v7 offset:26624
    ds_read_b64_tr_b16 v[150:151], v7 offset:27136
    s_add_u32 m0, s61, 115712
    s_add_u32 s59, s56, 746752
    buffer_load_dwordx4 v2, s[8:11], s59 offen lds
    v_mfma_f32_32x32x16_bf16 v[112:127], v[160:163], a[80:83], v[112:127]
    ds_read_b64_tr_b16 v[152:153], v8 offset:26624
    ds_read_b64_tr_b16 v[154:155], v8 offset:27136
    v_mfma_f32_32x32x16_bf16 v[128:143], v[164:167], a[80:83], v[128:143]
    ds_read_b64_tr_b16 v[156:157], v9 offset:26624
    ds_read_b64_tr_b16 v[158:159], v9 offset:27136
    s_waitcnt vmcnt(27)
    v_mfma_f32_32x32x16_bf16 v[48:63], v[168:171], a[84:87], v[48:63]
    ds_read_b64_tr_b16 v[160:161], v4 offset:28672
    ds_read_b64_tr_b16 v[162:163], v4 offset:29184
    s_add_u32 s62, s64, 40960
    buffer_load_dwordx4 a[128:131], v1, s[20:23], s62 offen offset:0 sc1
    s_waitcnt lgkmcnt(10)
    v_mfma_f32_32x32x16_bf16 v[64:79], v[172:175], a[84:87], v[64:79]
    ds_read_b64_tr_b16 v[164:165], v5 offset:28672
    ds_read_b64_tr_b16 v[166:167], v5 offset:29184
    s_waitcnt lgkmcnt(10)
    v_mfma_f32_32x32x16_bf16 v[80:95], v[144:147], a[84:87], v[80:95]
    ds_read_b64_tr_b16 v[168:169], v6 offset:28672
    ds_read_b64_tr_b16 v[170:171], v6 offset:29184
    s_add_u32 s62, s64, 40960
    buffer_load_dwordx4 a[132:135], v1, s[20:23], s62 offen offset:1024 sc1
    s_waitcnt lgkmcnt(10)
    v_mfma_f32_32x32x16_bf16 v[96:111], v[148:151], a[84:87], v[96:111]
    ds_read_b64_tr_b16 v[172:173], v7 offset:28672
    ds_read_b64_tr_b16 v[174:175], v7 offset:29184
    s_waitcnt lgkmcnt(10)
    v_mfma_f32_32x32x16_bf16 v[112:127], v[152:155], a[84:87], v[112:127]
    ds_read_b64_tr_b16 v[144:145], v8 offset:28672
    ds_read_b64_tr_b16 v[146:147], v8 offset:29184
    s_add_u32 s62, s64, 40960
    buffer_load_dwordx4 a[136:139], v1, s[20:23], s62 offen offset:2048 sc1
    s_waitcnt lgkmcnt(10)
    v_mfma_f32_32x32x16_bf16 v[128:143], v[156:159], a[84:87], v[128:143]
    ds_read_b64_tr_b16 v[148:149], v9 offset:28672
    ds_read_b64_tr_b16 v[150:151], v9 offset:29184
    s_waitcnt vmcnt(29) lgkmcnt(10)
    v_mfma_f32_32x32x16_bf16 v[48:63], v[160:163], a[88:91], v[48:63]
    ds_read_b64_tr_b16 v[152:153], v4 offset:30720
    ds_read_b64_tr_b16 v[154:155], v4 offset:31232
    s_waitcnt lgkmcnt(10)
    v_mfma_f32_32x32x16_bf16 v[64:79], v[164:167], a[88:91], v[64:79]
    ds_read_b64_tr_b16 v[156:157], v5 offset:30720
    ds_read_b64_tr_b16 v[158:159], v5 offset:31232
    s_add_u32 s62, s64, 40960
    buffer_load_dwordx4 a[140:143], v1, s[20:23], s62 offen offset:3072 sc1
    s_waitcnt lgkmcnt(10)
    v_mfma_f32_32x32x16_bf16 v[80:95], v[168:171], a[88:91], v[80:95]
    ds_read_b64_tr_b16 v[160:161], v6 offset:30720
    ds_read_b64_tr_b16 v[162:163], v6 offset:31232
    s_waitcnt lgkmcnt(10)
    v_mfma_f32_32x32x16_bf16 v[96:111], v[172:175], a[88:91], v[96:111]
    ds_read_b64_tr_b16 v[164:165], v7 offset:30720
    ds_read_b64_tr_b16 v[166:167], v7 offset:31232
    s_add_u32 m0, s61, 122880
    s_add_u32 s59, s56, 884736
    buffer_load_dwordx4 v2, s[8:11], s59 offen lds
    s_waitcnt lgkmcnt(10)
    v_mfma_f32_32x32x16_bf16 v[112:127], v[144:147], a[88:91], v[112:127]
    ds_read_b64_tr_b16 v[168:169], v8 offset:30720
    ds_read_b64_tr_b16 v[170:171], v8 offset:31232
    s_waitcnt lgkmcnt(10)
    v_mfma_f32_32x32x16_bf16 v[128:143], v[148:151], a[88:91], v[128:143]
    ds_read_b64_tr_b16 v[172:173], v9 offset:30720
    ds_read_b64_tr_b16 v[174:175], v9 offset:31232
    s_add_u32 m0, s61, 123904
    s_add_u32 s59, s56, 893952
    buffer_load_dwordx4 v2, s[8:11], s59 offen lds
    s_waitcnt vmcnt(31) lgkmcnt(10)
    v_mfma_f32_32x32x16_bf16 v[48:63], v[152:155], a[92:95], v[48:63]
    s_waitcnt vmcnt(30)
    s_barrier
    v_add_u32 v4, 49152, v4
    v_add_u32 v5, 49152, v5
    v_add_u32 v6, 49152, v6
    v_add_u32 v7, 49152, v7
    v_add_u32 v8, 49152, v8
    v_add_u32 v9, 49152, v9
    ds_read_b64_tr_b16 v[144:145], v4 offset:0
    ds_read_b64_tr_b16 v[146:147], v4 offset:512
    s_waitcnt lgkmcnt(10)
    v_mfma_f32_32x32x16_bf16 v[64:79], v[156:159], a[92:95], v[64:79]
    ds_read_b64_tr_b16 v[148:149], v5 offset:0
    ds_read_b64_tr_b16 v[150:151], v5 offset:512
    s_waitcnt lgkmcnt(10)
    v_mfma_f32_32x32x16_bf16 v[80:95], v[160:163], a[92:95], v[80:95]
    ds_read_b64_tr_b16 v[152:153], v6 offset:0
    ds_read_b64_tr_b16 v[154:155], v6 offset:512
    s_add_u32 m0, s61, 131072
    s_add_u32 s59, s56, 884864
    buffer_load_dwordx4 v2, s[8:11], s59 offen lds
    s_waitcnt lgkmcnt(10)
    v_mfma_f32_32x32x16_bf16 v[96:111], v[164:167], a[92:95], v[96:111]
    ds_read_b64_tr_b16 v[156:157], v7 offset:0
    ds_read_b64_tr_b16 v[158:159], v7 offset:512
    s_waitcnt lgkmcnt(10)
    v_mfma_f32_32x32x16_bf16 v[112:127], v[168:171], a[92:95], v[112:127]
    ds_read_b64_tr_b16 v[160:161], v8 offset:0
    ds_read_b64_tr_b16 v[162:163], v8 offset:512
    s_add_u32 m0, s61, 132096
    s_add_u32 s59, s56, 894080
    buffer_load_dwordx4 v2, s[8:11], s59 offen lds
    s_waitcnt lgkmcnt(10)
    v_mfma_f32_32x32x16_bf16 v[128:143], v[172:175], a[92:95], v[128:143]
    ds_read_b64_tr_b16 v[164:165], v9 offset:0
    ds_read_b64_tr_b16 v[166:167], v9 offset:512
    s_waitcnt vmcnt(31) lgkmcnt(10)
    v_mfma_f32_32x32x16_bf16 v[48:63], v[144:147], a[96:99], v[48:63]
    ds_read_b64_tr_b16 v[168:169], v4 offset:2048
    ds_read_b64_tr_b16 v[170:171], v4 offset:2560
    s_add_u32 m0, s61, 139264
    s_add_u32 s59, s56, 884992
    buffer_load_dwordx4 v2, s[8:11], s59 offen lds
    s_waitcnt lgkmcnt(10)
    v_mfma_f32_32x32x16_bf16 v[64:79], v[148:151], a[96:99], v[64:79]
    ds_read_b64_tr_b16 v[172:173], v5 offset:2048
    ds_read_b64_tr_b16 v[174:175], v5 offset:2560
    s_waitcnt lgkmcnt(10)
    v_mfma_f32_32x32x16_bf16 v[80:95], v[152:155], a[96:99], v[80:95]
    ds_read_b64_tr_b16 v[144:145], v6 offset:2048
    ds_read_b64_tr_b16 v[146:147], v6 offset:2560
    s_waitcnt lgkmcnt(10)
    v_mfma_f32_32x32x16_bf16 v[96:111], v[156:159], a[96:99], v[96:111]
    ds_read_b64_tr_b16 v[148:149], v7 offset:2048
    ds_read_b64_tr_b16 v[150:151], v7 offset:2560
    s_add_u32 m0, s61, 140288
    s_add_u32 s59, s56, 894208
    buffer_load_dwordx4 v2, s[8:11], s59 offen lds
    s_waitcnt lgkmcnt(10)
    v_mfma_f32_32x32x16_bf16 v[112:127], v[160:163], a[96:99], v[112:127]
    ds_read_b64_tr_b16 v[152:153], v8 offset:2048
    ds_read_b64_tr_b16 v[154:155], v8 offset:2560
    s_waitcnt lgkmcnt(10)
    v_mfma_f32_32x32x16_bf16 v[128:143], v[164:167], a[96:99], v[128:143]
    ds_read_b64_tr_b16 v[156:157], v9 offset:2048
    ds_read_b64_tr_b16 v[158:159], v9 offset:2560
    s_add_u32 s62, s64, 49152
    buffer_load_dwordx4 a[144:147], v1, s[20:23], s62 offen offset:0 sc1
    s_waitcnt vmcnt(33) lgkmcnt(10)
    v_mfma_f32_32x32x16_bf16 v[48:63], v[168:171], a[100:103], v[48:63]
    ds_read_b64_tr_b16 v[160:161], v4 offset:4096
    ds_read_b64_tr_b16 v[162:163], v4 offset:4608
    s_waitcnt lgkmcnt(10)
    v_mfma_f32_32x32x16_bf16 v[64:79], v[172:175], a[100:103], v[64:79]
    ds_read_b64_tr_b16 v[164:165], v5 offset:4096
    ds_read_b64_tr_b16 v[166:167], v5 offset:4608
    s_waitcnt lgkmcnt(10)
    v_mfma_f32_32x32x16_bf16 v[80:95], v[144:147], a[100:103], v[80:95]
    ds_read_b64_tr_b16 v[168:169], v6 offset:4096
    ds_read_b64_tr_b16 v[170:171], v6 offset:4608
    s_add_u32 s62, s64, 49152
    buffer_load_dwordx4 a[148:151], v1, s[20:23], s62 offen offset:1024 sc1
    s_waitcnt lgkmcnt(10)
    v_mfma_f32_32x32x16_bf16 v[96:111], v[148:151], a[100:103], v[96:111]
    ds_read_b64_tr_b16 v[172:173], v7 offset:4096
    ds_read_b64_tr_b16 v[174:175], v7 offset:4608
    s_waitcnt lgkmcnt(10)
    v_mfma_f32_32x32x16_bf16 v[112:127], v[152:155], a[100:103], v[112:127]
    ds_read_b64_tr_b16 v[144:145], v8 offset:4096
    ds_read_b64_tr_b16 v[146:147], v8 offset:4608
    s_add_u32 s62, s64, 49152
    buffer_load_dwordx4 a[152:155], v1, s[20:23], s62 offen offset:2048 sc1
    s_waitcnt lgkmcnt(10)
    v_mfma_f32_32x32x16_bf16 v[128:143], v[156:159], a[100:103], v[128:143]
    ds_read_b64_tr_b16 v[148:149], v9 offset:4096
    ds_read_b64_tr_b16 v[150:151], v9 offset:4608
    s_waitcnt vmcnt(34) lgkmcnt(10)
    v_mfma_f32_32x32x16_bf16 v[48:63], v[160:163], a[104:107], v[48:63]
    ds_read_b64_tr_b16 v[152:153], v4 offset:6144
    ds_read_b64_tr_b16 v[154:155], v4 offset:6656
    s_add_u32 s62, s64, 49152
    buffer_load_dwordx4 a[156:159], v1, s[20:23], s62 offen offset:3072 sc1
    s_waitcnt lgkmcnt(10)
    v_mfma_f32_32x32x16_bf16 v[64:79], v[164:167], a[104:107], v[64:79]
    ds_read_b64_tr_b16 v[156:157], v5 offset:6144
    ds_read_b64_tr_b16 v[158:159], v5 offset:6656
    s_waitcnt lgkmcnt(10)
    v_mfma_f32_32x32x16_bf16 v[80:95], v[168:171], a[104:107], v[80:95]
    ds_read_b64_tr_b16 v[160:161], v6 offset:6144
    ds_read_b64_tr_b16 v[162:163], v6 offset:6656
    s_waitcnt lgkmcnt(10)
    v_mfma_f32_32x32x16_bf16 v[96:111], v[172:175], a[104:107], v[96:111]
    ds_read_b64_tr_b16 v[164:165], v7 offset:6144
    ds_read_b64_tr_b16 v[166:167], v7 offset:6656
    s_add_u32 m0, s61, 0
    s_add_u32 s59, s56, 1032192
    buffer_load_dwordx4 v2, s[8:11], s59 offen lds
    s_waitcnt lgkmcnt(10)
    v_mfma_f32_32x32x16_bf16 v[112:127], v[144:147], a[104:107], v[112:127]
    ds_read_b64_tr_b16 v[168:169], v8 offset:6144
    ds_read_b64_tr_b16 v[170:171], v8 offset:6656
    s_waitcnt lgkmcnt(10)
    v_mfma_f32_32x32x16_bf16 v[128:143], v[148:151], a[104:107], v[128:143]
    ds_read_b64_tr_b16 v[172:173], v9 offset:6144
    ds_read_b64_tr_b16 v[174:175], v9 offset:6656
    s_add_u32 m0, s61, 1024
    s_add_u32 s59, s56, 1041408
    buffer_load_dwordx4 v2, s[8:11], s59 offen lds
    s_waitcnt vmcnt(36) lgkmcnt(10)
    v_mfma_f32_32x32x16_bf16 v[48:63], v[152:155], a[108:111], v[48:63]
    s_waitcnt vmcnt(30)
    s_barrier
    ds_read_b64_tr_b16 v[144:145], v4 offset:24576
    ds_read_b64_tr_b16 v[146:147], v4 offset:25088
    s_waitcnt lgkmcnt(10)
    v_mfma_f32_32x32x16_bf16 v[64:79], v[156:159], a[108:111], v[64:79]
    ds_read_b64_tr_b16 v[148:149], v5 offset:24576
    ds_read_b64_tr_b16 v[150:151], v5 offset:25088
    s_add_u32 m0, s61, 8192
    s_add_u32 s59, s56, 1032320
    buffer_load_dwordx4 v2, s[8:11], s59 offen lds
    s_waitcnt lgkmcnt(10)
    v_mfma_f32_32x32x16_bf16 v[80:95], v[160:163], a[108:111], v[80:95]
    ds_read_b64_tr_b16 v[152:153], v6 offset:24576
    ds_read_b64_tr_b16 v[154:155], v6 offset:25088
    s_waitcnt lgkmcnt(10)
    v_mfma_f32_32x32x16_bf16 v[96:111], v[164:167], a[108:111], v[96:111]
    ds_read_b64_tr_b16 v[156:157], v7 offset:24576
    ds_read_b64_tr_b16 v[158:159], v7 offset:25088
    s_waitcnt lgkmcnt(10)
    v_mfma_f32_32x32x16_bf16 v[112:127], v[168:171], a[108:111], v[112:127]
    ds_read_b64_tr_b16 v[160:161], v8 offset:24576
    ds_read_b64_tr_b16 v[162:163], v8 offset:25088
    s_add_u32 m0, s61, 9216
    s_add_u32 s59, s56, 1041536
    buffer_load_dwordx4 v2, s[8:11], s59 offen lds
    s_waitcnt lgkmcnt(10)
    v_mfma_f32_32x32x16_bf16 v[128:143], v[172:175], a[108:111], v[128:143]
    ds_read_b64_tr_b16 v[164:165], v9 offset:24576
    ds_read_b64_tr_b16 v[166:167], v9 offset:25088
    s_waitcnt vmcnt(19)
    buffer_atomic_add v233, v232, s[20:23], s101 offen sc1
    s_waitcnt lgkmcnt(10)
    v_mfma_f32_32x32x16_bf16 v[48:63], v[144:147], a[112:115], v[48:63]
    ds_read_b64_tr_b16 v[168:169], v4 offset:26624
    ds_read_b64_tr_b16 v[170:171], v4 offset:27136
    s_add_u32 m0, s61, 16384
    s_add_u32 s59, s56, 1032448
    buffer_load_dwordx4 v2, s[8:11], s59 offen lds
    s_waitcnt lgkmcnt(10)
    v_mfma_f32_32x32x16_bf16 v[64:79], v[148:151], a[112:115], v[64:79]
    ds_read_b64_tr_b16 v[172:173], v5 offset:26624
    ds_read_b64_tr_b16 v[174:175], v5 offset:27136
    s_waitcnt lgkmcnt(10)
    v_mfma_f32_32x32x16_bf16 v[80:95], v[152:155], a[112:115], v[80:95]
    ds_read_b64_tr_b16 v[144:145], v6 offset:26624
    ds_read_b64_tr_b16 v[146:147], v6 offset:27136
    s_add_u32 m0, s61, 17408
    s_add_u32 s59, s56, 1041664
    buffer_load_dwordx4 v2, s[8:11], s59 offen lds
    s_waitcnt lgkmcnt(10)
    v_mfma_f32_32x32x16_bf16 v[96:111], v[156:159], a[112:115], v[96:111]
    ds_read_b64_tr_b16 v[148:149], v7 offset:26624
    ds_read_b64_tr_b16 v[150:151], v7 offset:27136
    s_waitcnt lgkmcnt(10)
    v_mfma_f32_32x32x16_bf16 v[112:127], v[160:163], a[112:115], v[112:127]
    ds_read_b64_tr_b16 v[152:153], v8 offset:26624
    ds_read_b64_tr_b16 v[154:155], v8 offset:27136
    s_waitcnt lgkmcnt(10)
    v_mfma_f32_32x32x16_bf16 v[128:143], v[164:167], a[112:115], v[128:143]
    ds_read_b64_tr_b16 v[156:157], v9 offset:26624
    ds_read_b64_tr_b16 v[158:159], v9 offset:27136
    s_add_u32 s62, s64, 57344
    buffer_load_dwordx4 a[160:163], v1, s[20:23], s62 offen offset:0 sc1
    s_waitcnt lgkmcnt(10)
    v_mfma_f32_32x32x16_bf16 v[48:63], v[168:171], a[116:119], v[48:63]
    ds_read_b64_tr_b16 v[160:161], v4 offset:28672
    ds_read_b64_tr_b16 v[162:163], v4 offset:29184
    s_waitcnt lgkmcnt(10)
    v_mfma_f32_32x32x16_bf16 v[64:79], v[172:175], a[116:119], v[64:79]
    ds_read_b64_tr_b16 v[164:165], v5 offset:28672
    ds_read_b64_tr_b16 v[166:167], v5 offset:29184
    s_add_u32 s62, s64, 57344
    buffer_load_dwordx4 a[164:167], v1, s[20:23], s62 offen offset:1024 sc1
    s_waitcnt lgkmcnt(10)
    v_mfma_f32_32x32x16_bf16 v[80:95], v[144:147], a[116:119], v[80:95]
    ds_read_b64_tr_b16 v[168:169], v6 offset:28672
    ds_read_b64_tr_b16 v[170:171], v6 offset:29184
    s_waitcnt lgkmcnt(10)
    v_mfma_f32_32x32x16_bf16 v[96:111], v[148:151], a[116:119], v[96:111]
    ds_read_b64_tr_b16 v[172:173], v7 offset:28672
    ds_read_b64_tr_b16 v[174:175], v7 offset:29184
    s_add_u32 s62, s64, 57344
    buffer_load_dwordx4 a[168:171], v1, s[20:23], s62 offen offset:2048 sc1
    s_waitcnt lgkmcnt(10)
    v_mfma_f32_32x32x16_bf16 v[112:127], v[152:155], a[116:119], v[112:127]
    ds_read_b64_tr_b16 v[144:145], v8 offset:28672
    ds_read_b64_tr_b16 v[146:147], v8 offset:29184
    s_waitcnt lgkmcnt(10)
    v_mfma_f32_32x32x16_bf16 v[128:143], v[156:159], a[116:119], v[128:143]
    ds_read_b64_tr_b16 v[148:149], v9 offset:28672
    ds_read_b64_tr_b16 v[150:151], v9 offset:29184
    s_waitcnt lgkmcnt(10)
    v_mfma_f32_32x32x16_bf16 v[48:63], v[160:163], a[120:123], v[48:63]
    ds_read_b64_tr_b16 v[152:153], v4 offset:30720
    ds_read_b64_tr_b16 v[154:155], v4 offset:31232
    s_add_u32 s62, s64, 57344
    buffer_load_dwordx4 a[172:175], v1, s[20:23], s62 offen offset:3072 sc1
    s_waitcnt lgkmcnt(10)
    v_mfma_f32_32x32x16_bf16 v[64:79], v[164:167], a[120:123], v[64:79]
    ds_read_b64_tr_b16 v[156:157], v5 offset:30720
    ds_read_b64_tr_b16 v[158:159], v5 offset:31232
    s_waitcnt lgkmcnt(10)
    v_mfma_f32_32x32x16_bf16 v[80:95], v[168:171], a[120:123], v[80:95]
    ds_read_b64_tr_b16 v[160:161], v6 offset:30720
    ds_read_b64_tr_b16 v[162:163], v6 offset:31232
    s_add_u32 m0, s61, 24576
    s_add_u32 s59, s56, 1179648
    buffer_load_dwordx4 v2, s[8:11], s59 offen lds
    s_waitcnt lgkmcnt(10)
    v_mfma_f32_32x32x16_bf16 v[96:111], v[172:175], a[120:123], v[96:111]
    ds_read_b64_tr_b16 v[164:165], v7 offset:30720
    ds_read_b64_tr_b16 v[166:167], v7 offset:31232
    s_waitcnt lgkmcnt(10)
    v_mfma_f32_32x32x16_bf16 v[112:127], v[144:147], a[120:123], v[112:127]
    ds_read_b64_tr_b16 v[168:169], v8 offset:30720
    ds_read_b64_tr_b16 v[170:171], v8 offset:31232
    s_add_u32 m0, s61, 25600
    s_add_u32 s59, s56, 1188864
    buffer_load_dwordx4 v2, s[8:11], s59 offen lds
    s_waitcnt lgkmcnt(10)
    v_mfma_f32_32x32x16_bf16 v[128:143], v[148:151], a[120:123], v[128:143]
    ds_read_b64_tr_b16 v[172:173], v9 offset:30720
    ds_read_b64_tr_b16 v[174:175], v9 offset:31232
    s_waitcnt lgkmcnt(10)
    v_mfma_f32_32x32x16_bf16 v[48:63], v[152:155], a[124:127], v[48:63]
    s_waitcnt vmcnt(27)
    s_barrier
    v_add_u32 v4, 49152, v4
    v_add_u32 v5, 49152, v5
    v_add_u32 v6, 49152, v6
    v_add_u32 v7, 49152, v7
    v_add_u32 v8, 49152, v8
    v_add_u32 v9, 49152, v9
    ds_read_b64_tr_b16 v[144:145], v4 offset:0
    ds_read_b64_tr_b16 v[146:147], v4 offset:512
    s_waitcnt lgkmcnt(10)
    v_mfma_f32_32x32x16_bf16 v[64:79], v[156:159], a[124:127], v[64:79]
    ds_read_b64_tr_b16 v[148:149], v5 offset:0
    ds_read_b64_tr_b16 v[150:151], v5 offset:512
    s_add_u32 m0, s61, 32768
    s_add_u32 s59, s56, 1179776
    buffer_load_dwordx4 v2, s[8:11], s59 offen lds
    s_waitcnt lgkmcnt(10)
    v_mfma_f32_32x32x16_bf16 v[80:95], v[160:163], a[124:127], v[80:95]
    ds_read_b64_tr_b16 v[152:153], v6 offset:0
    ds_read_b64_tr_b16 v[154:155], v6 offset:512
    s_waitcnt lgkmcnt(10)
    v_mfma_f32_32x32x16_bf16 v[96:111], v[164:167], a[124:127], v[96:111]
    ds_read_b64_tr_b16 v[156:157], v7 offset:0
    ds_read_b64_tr_b16 v[158:159], v7 offset:512
    s_add_u32 m0, s61, 33792
    s_add_u32 s59, s56, 1188992
    buffer_load_dwordx4 v2, s[8:11], s59 offen lds
    s_waitcnt lgkmcnt(10)
    v_mfma_f32_32x32x16_bf16 v[112:127], v[168:171], a[124:127], v[112:127]
    ds_read_b64_tr_b16 v[160:161], v8 offset:0
    ds_read_b64_tr_b16 v[162:163], v8 offset:512
    s_waitcnt lgkmcnt(10)
    v_mfma_f32_32x32x16_bf16 v[128:143], v[172:175], a[124:127], v[128:143]
    ds_read_b64_tr_b16 v[164:165], v9 offset:0
    ds_read_b64_tr_b16 v[166:167], v9 offset:512
    s_waitcnt vmcnt(28) lgkmcnt(10)
    v_mfma_f32_32x32x16_bf16 v[48:63], v[144:147], a[128:131], v[48:63]
    ds_read_b64_tr_b16 v[168:169], v4 offset:2048
    ds_read_b64_tr_b16 v[170:171], v4 offset:2560
    s_add_u32 m0, s61, 40960
    s_add_u32 s59, s56, 1179904
    buffer_load_dwordx4 v2, s[8:11], s59 offen lds
    s_waitcnt lgkmcnt(10)
    v_mfma_f32_32x32x16_bf16 v[64:79], v[148:151], a[128:131], v[64:79]
    ds_read_b64_tr_b16 v[172:173], v5 offset:2048
    ds_read_b64_tr_b16 v[174:175], v5 offset:2560
    s_waitcnt lgkmcnt(10)
    v_mfma_f32_32x32x16_bf16 v[80:95], v[152:155], a[128:131], v[80:95]
    ds_read_b64_tr_b16 v[144:145], v6 offset:2048
    ds_read_b64_tr_b16 v[146:147], v6 offset:2560
    s_add_u32 m0, s61, 41984
    s_add_u32 s59, s56, 1189120
    buffer_load_dwordx4 v2, s[8:11], s59 offen lds
    s_waitcnt lgkmcnt(10)
    v_mfma_f32_32x32x16_bf16 v[96:111], v[156:159], a[128:131], v[96:111]
    ds_read_b64_tr_b16 v[148:149], v7 offset:2048
    ds_read_b64_tr_b16 v[150:151], v7 offset:2560
    s_waitcnt lgkmcnt(10)
    v_mfma_f32_32x32x16_bf16 v[112:127], v[160:163], a[128:131], v[112:127]
    ds_read_b64_tr_b16 v[152:153], v8 offset:2048
    ds_read_b64_tr_b16 v[154:155], v8 offset:2560
    s_add_u32 s62, s64, 65536
    buffer_load_dwordx4 a[176:179], v1, s[20:23], s62 offen offset:0 sc1
    s_waitcnt lgkmcnt(10)
    v_mfma_f32_32x32x16_bf16 v[128:143], v[164:167], a[128:131], v[128:143]
    ds_read_b64_tr_b16 v[156:157], v9 offset:2048
    ds_read_b64_tr_b16 v[158:159], v9 offset:2560
    s_waitcnt vmcnt(30) lgkmcnt(10)
    v_mfma_f32_32x32x16_bf16 v[48:63], v[168:171], a[132:135], v[48:63]
    ds_read_b64_tr_b16 v[160:161], v4 offset:4096
    ds_read_b64_tr_b16 v[162:163], v4 offset:4608
    s_waitcnt lgkmcnt(10)
    v_mfma_f32_32x32x16_bf16 v[64:79], v[172:175], a[132:135], v[64:79]
    ds_read_b64_tr_b16 v[164:165], v5 offset:4096
    ds_read_b64_tr_b16 v[166:167], v5 offset:4608
    s_add_u32 s62, s64, 65536
    buffer_load_dwordx4 a[180:183], v1, s[20:23], s62 offen offset:1024 sc1
    s_waitcnt lgkmcnt(10)
    v_mfma_f32_32x32x16_bf16 v[80:95], v[144:147], a[132:135], v[80:95]
    ds_read_b64_tr_b16 v[168:169], v6 offset:4096
    ds_read_b64_tr_b16 v[170:171], v6 offset:4608
    s_waitcnt lgkmcnt(10)
    v_mfma_f32_32x32x16_bf16 v[96:111], v[148:151], a[132:135], v[96:111]
    ds_read_b64_tr_b16 v[172:173], v7 offset:4096
    ds_read_b64_tr_b16 v[174:175], v7 offset:4608
    s_add_u32 s62, s64, 65536
    buffer_load_dwordx4 a[184:187], v1, s[20:23], s62 offen offset:2048 sc1
    s_waitcnt lgkmcnt(10)
    v_mfma_f32_32x32x16_bf16 v[112:127], v[152:155], a[132:135], v[112:127]
    ds_read_b64_tr_b16 v[144:145], v8 offset:4096
    ds_read_b64_tr_b16 v[146:147], v8 offset:4608
    s_waitcnt lgkmcnt(10)
    v_mfma_f32_32x32x16_bf16 v[128:143], v[156:159], a[132:135], v[128:143]
    ds_read_b64_tr_b16 v[148:149], v9 offset:4096
    ds_read_b64_tr_b16 v[150:151], v9 offset:4608
    s_add_u32 s62, s64, 65536
    buffer_load_dwordx4 a[188:191], v1, s[20:23], s62 offen offset:3072 sc1
    s_waitcnt vmcnt(32) lgkmcnt(10)
    v_mfma_f32_32x32x16_bf16 v[48:63], v[160:163], a[136:139], v[48:63]
    ds_read_b64_tr_b16 v[152:153], v4 offset:6144
    ds_read_b64_tr_b16 v[154:155], v4 offset:6656
    s_waitcnt lgkmcnt(10)
    v_mfma_f32_32x32x16_bf16 v[64:79], v[164:167], a[136:139], v[64:79]
    ds_read_b64_tr_b16 v[156:157], v5 offset:6144
    ds_read_b64_tr_b16 v[158:159], v5 offset:6656
    s_waitcnt lgkmcnt(10)
    v_mfma_f32_32x32x16_bf16 v[80:95], v[168:171], a[136:139], v[80:95]
    ds_read_b64_tr_b16 v[160:161], v6 offset:6144
    ds_read_b64_tr_b16 v[162:163], v6 offset:6656
    s_add_u32 m0, s60, 49152
    s_add_u32 s59, s92, 0
    buffer_load_dwordx4 v3, s[12:15], s59 offen lds
    s_waitcnt lgkmcnt(10)
    v_mfma_f32_32x32x16_bf16 v[96:111], v[172:175], a[136:139], v[96:111]
    ds_read_b64_tr_b16 v[164:165], v7 offset:6144
    ds_read_b64_tr_b16 v[166:167], v7 offset:6656
    s_waitcnt lgkmcnt(10)
    v_mfma_f32_32x32x16_bf16 v[112:127], v[144:147], a[136:139], v[112:127]
    ds_read_b64_tr_b16 v[168:169], v8 offset:6144
    ds_read_b64_tr_b16 v[170:171], v8 offset:6656
    buffer_load_dword v253, v12, s[20:23], s74 offen sc0 sc1
    s_add_u32 m0, s60, 50176
    s_add_u32 s59, s93, 0
    buffer_load_dwordx4 v252, s[12:15], s59 offen lds
    s_waitcnt lgkmcnt(10)
    v_mfma_f32_32x32x16_bf16 v[128:143], v[148:151], a[136:139], v[128:143]
    ds_read_b64_tr_b16 v[172:173], v9 offset:6144
    ds_read_b64_tr_b16 v[174:175], v9 offset:6656
    s_waitcnt vmcnt(34) lgkmcnt(10)
    v_mfma_f32_32x32x16_bf16 v[48:63], v[152:155], a[140:143], v[48:63]
    s_waitcnt vmcnt(28)
    s_barrier
    ds_read_b64_tr_b16 v[144:145], v4 offset:24576
    ds_read_b64_tr_b16 v[146:147], v4 offset:25088
    s_add_u32 m0, s60, 51200
    s_add_u32 s59, s94, 0
    buffer_load_dwordx4 v3, s[12:15], s59 offen lds
    s_waitcnt lgkmcnt(10)
    v_mfma_f32_32x32x16_bf16 v[64:79], v[156:159], a[140:143], v[64:79]
    ds_read_b64_tr_b16 v[148:149], v5 offset:24576
    ds_read_b64_tr_b16 v[150:151], v5 offset:25088
    s_waitcnt lgkmcnt(10)
    v_mfma_f32_32x32x16_bf16 v[80:95], v[160:163], a[140:143], v[80:95]
    ds_read_b64_tr_b16 v[152:153], v6 offset:24576
    ds_read_b64_tr_b16 v[154:155], v6 offset:25088
    s_waitcnt lgkmcnt(10)
    v_mfma_f32_32x32x16_bf16 v[96:111], v[164:167], a[140:143], v[96:111]
    ds_read_b64_tr_b16 v[156:157], v7 offset:24576
    ds_read_b64_tr_b16 v[158:159], v7 offset:25088
    s_add_u32 m0, s60, 52224
    s_add_u32 s59, s95, 0
    buffer_load_dwordx4 v252, s[12:15], s59 offen lds
    s_waitcnt lgkmcnt(10)
    v_mfma_f32_32x32x16_bf16 v[112:127], v[168:171], a[140:143], v[112:127]
    ds_read_b64_tr_b16 v[160:161], v8 offset:24576
    ds_read_b64_tr_b16 v[162:163], v8 offset:25088
    s_waitcnt lgkmcnt(10)
    v_mfma_f32_32x32x16_bf16 v[128:143], v[172:175], a[140:143], v[128:143]
    ds_read_b64_tr_b16 v[164:165], v9 offset:24576
    ds_read_b64_tr_b16 v[166:167], v9 offset:25088
    s_add_u32 m0, s60, 53248
    s_add_u32 s59, s96, 0
    buffer_load_dwordx4 v3, s[12:15], s59 offen lds
    s_waitcnt vmcnt(30) lgkmcnt(10)
    v_mfma_f32_32x32x16_bf16 v[48:63], v[144:147], a[144:147], v[48:63]
    ds_read_b64_tr_b16 v[168:169], v4 offset:26624
    ds_read_b64_tr_b16 v[170:171], v4 offset:27136
    s_waitcnt lgkmcnt(10)
    v_mfma_f32_32x32x16_bf16 v[64:79], v[148:151], a[144:147], v[64:79]
    ds_read_b64_tr_b16 v[172:173], v5 offset:26624
    ds_read_b64_tr_b16 v[174:175], v5 offset:27136
    s_add_u32 m0, s60, 54272
    s_add_u32 s59, s97, 0
    buffer_load_dwordx4 v252, s[12:15], s59 offen lds
    s_waitcnt lgkmcnt(10)
    v_mfma_f32_32x32x16_bf16 v[80:95], v[152:155], a[144:147], v[80:95]
    ds_read_b64_tr_b16 v[144:145], v6 offset:26624
    ds_read_b64_tr_b16 v[146:147], v6 offset:27136
    s_waitcnt lgkmcnt(10)
    v_mfma_f32_32x32x16_bf16 v[96:111], v[156:159], a[144:147], v[96:111]
    ds_read_b64_tr_b16 v[148:149], v7 offset:26624
    ds_read_b64_tr_b16 v[150:151], v7 offset:27136
    s_waitcnt lgkmcnt(10)
    v_mfma_f32_32x32x16_bf16 v[112:127], v[160:163], a[144:147], v[112:127]
    ds_read_b64_tr_b16 v[152:153], v8 offset:26624
    ds_read_b64_tr_b16 v[154:155], v8 offset:27136
    s_add_u32 m0, s60, 73728
    s_add_u32 s59, s92, 128
    buffer_load_dwordx4 v3, s[12:15], s59 offen lds
    s_waitcnt lgkmcnt(10)
    v_mfma_f32_32x32x16_bf16 v[128:143], v[164:167], a[144:147], v[128:143]
    ds_read_b64_tr_b16 v[156:157], v9 offset:26624
    ds_read_b64_tr_b16 v[158:159], v9 offset:27136
    s_waitcnt vmcnt(31) lgkmcnt(10)
    v_mfma_f32_32x32x16_bf16 v[48:63], v[168:171], a[148:151], v[48:63]
    ds_read_b64_tr_b16 v[160:161], v4 offset:28672
    ds_read_b64_tr_b16 v[162:163], v4 offset:29184
    s_add_u32 m0, s60, 74752
    s_add_u32 s59, s93, 128
    buffer_load_dwordx4 v252, s[12:15], s59 offen lds
    s_waitcnt lgkmcnt(10)
    v_mfma_f32_32x32x16_bf16 v[64:79], v[172:175], a[148:151], v[64:79]
    ds_read_b64_tr_b16 v[164:165], v5 offset:28672
    ds_read_b64_tr_b16 v[166:167], v5 offset:29184
    s_waitcnt lgkmcnt(10)
    v_mfma_f32_32x32x16_bf16 v[80:95], v[144:147], a[148:151], v[80:95]
    ds_read_b64_tr_b16 v[168:169], v6 offset:28672
    ds_read_b64_tr_b16 v[170:171], v6 offset:29184
    s_add_u32 m0, s60, 75776
    s_add_u32 s59, s94, 128
    buffer_load_dwordx4 v3, s[12:15], s59 offen lds
    s_waitcnt lgkmcnt(10)
    v_mfma_f32_32x32x16_bf16 v[96:111], v[148:151], a[148:151], v[96:111]
    ds_read_b64_tr_b16 v[172:173], v7 offset:28672
    ds_read_b64_tr_b16 v[174:175], v7 offset:29184
    s_waitcnt lgkmcnt(10)
    v_mfma_f32_32x32x16_bf16 v[112:127], v[152:155], a[148:151], v[112:127]
    ds_read_b64_tr_b16 v[144:145], v8 offset:28672
    ds_read_b64_tr_b16 v[146:147], v8 offset:29184
    s_waitcnt lgkmcnt(10)
    v_mfma_f32_32x32x16_bf16 v[128:143], v[156:159], a[148:151], v[128:143]
    ds_read_b64_tr_b16 v[148:149], v9 offset:28672
    ds_read_b64_tr_b16 v[150:151], v9 offset:29184
    s_add_u32 m0, s60, 76800
    s_add_u32 s59, s95, 128
    buffer_load_dwordx4 v252, s[12:15], s59 offen lds
    s_waitcnt vmcnt(33) lgkmcnt(10)
    v_mfma_f32_32x32x16_bf16 v[48:63], v[160:163], a[152:155], v[48:63]
    ds_read_b64_tr_b16 v[152:153], v4 offset:30720
    ds_read_b64_tr_b16 v[154:155], v4 offset:31232
    s_waitcnt lgkmcnt(10)
    v_mfma_f32_32x32x16_bf16 v[64:79], v[164:167], a[152:155], v[64:79]
    ds_read_b64_tr_b16 v[156:157], v5 offset:30720
    ds_read_b64_tr_b16 v[158:159], v5 offset:31232
    s_add_u32 m0, s60, 77824
    s_add_u32 s59, s96, 128
    buffer_load_dwordx4 v3, s[12:15], s59 offen lds
    s_waitcnt lgkmcnt(10)
    v_mfma_f32_32x32x16_bf16 v[80:95], v[168:171], a[152:155], v[80:95]
    ds_read_b64_tr_b16 v[160:161], v6 offset:30720
    ds_read_b64_tr_b16 v[162:163], v6 offset:31232
    s_waitcnt lgkmcnt(10)
    v_mfma_f32_32x32x16_bf16 v[96:111], v[172:175], a[152:155], v[96:111]
    ds_read_b64_tr_b16 v[164:165], v7 offset:30720
    ds_read_b64_tr_b16 v[166:167], v7 offset:31232
    s_waitcnt lgkmcnt(10)
    v_mfma_f32_32x32x16_bf16 v[112:127], v[144:147], a[152:155], v[112:127]
    ds_read_b64_tr_b16 v[168:169], v8 offset:30720
    ds_read_b64_tr_b16 v[170:171], v8 offset:31232
    s_add_u32 m0, s60, 78848
    s_add_u32 s59, s97, 128
    buffer_load_dwordx4 v252, s[12:15], s59 offen lds
    s_waitcnt lgkmcnt(10)
    v_mfma_f32_32x32x16_bf16 v[128:143], v[148:151], a[152:155], v[128:143]
    ds_read_b64_tr_b16 v[172:173], v9 offset:30720
    ds_read_b64_tr_b16 v[174:175], v9 offset:31232
    s_waitcnt vmcnt(34) lgkmcnt(10)
    v_mfma_f32_32x32x16_bf16 v[48:63], v[152:155], a[156:159], v[48:63]
    s_waitcnt vmcnt(27)
    s_barrier
    v_add_u32 v4, 4294868992, v4
    v_add_u32 v5, 4294868992, v5
    v_add_u32 v6, 4294868992, v6
    v_add_u32 v7, 4294868992, v7
    v_add_u32 v8, 4294868992, v8
    v_add_u32 v9, 4294868992, v9
    ds_read_b64_tr_b16 v[144:145], v4 offset:0
    ds_read_b64_tr_b16 v[146:147], v4 offset:512
    s_add_u32 m0, s60, 98304
    s_add_u32 s59, s92, 256
    buffer_load_dwordx4 v3, s[12:15], s59 offen lds
    s_waitcnt lgkmcnt(10)
    v_mfma_f32_32x32x16_bf16 v[64:79], v[156:159], a[156:159], v[64:79]
    ds_read_b64_tr_b16 v[148:149], v5 offset:0
    ds_read_b64_tr_b16 v[150:151], v5 offset:512
    s_waitcnt lgkmcnt(10)
    v_mfma_f32_32x32x16_bf16 v[80:95], v[160:163], a[156:159], v[80:95]
    ds_read_b64_tr_b16 v[152:153], v6 offset:0
    ds_read_b64_tr_b16 v[154:155], v6 offset:512
    s_add_u32 m0, s60, 99328
    s_add_u32 s59, s93, 256
    buffer_load_dwordx4 v252, s[12:15], s59 offen lds
    s_waitcnt lgkmcnt(10)
    v_mfma_f32_32x32x16_bf16 v[96:111], v[164:167], a[156:159], v[96:111]
    ds_read_b64_tr_b16 v[156:157], v7 offset:0
    ds_read_b64_tr_b16 v[158:159], v7 offset:512
    s_waitcnt lgkmcnt(10)
    v_mfma_f32_32x32x16_bf16 v[112:127], v[168:171], a[156:159], v[112:127]
    ds_read_b64_tr_b16 v[160:161], v8 offset:0
    ds_read_b64_tr_b16 v[162:163], v8 offset:512
    s_waitcnt lgkmcnt(10)
    v_mfma_f32_32x32x16_bf16 v[128:143], v[172:175], a[156:159], v[128:143]
    ds_read_b64_tr_b16 v[164:165], v9 offset:0
    ds_read_b64_tr_b16 v[166:167], v9 offset:512
    s_add_u32 m0, s60, 100352
    s_add_u32 s59, s94, 256
    buffer_load_dwordx4 v3, s[12:15], s59 offen lds
    s_waitcnt vmcnt(29) lgkmcnt(10)
    v_mfma_f32_32x32x16_bf16 v[48:63], v[144:147], a[160:163], v[48:63]
    ds_read_b64_tr_b16 v[168:169], v4 offset:2048
    ds_read_b64_tr_b16 v[170:171], v4 offset:2560
    s_waitcnt lgkmcnt(10)
    v_mfma_f32_32x32x16_bf16 v[64:79], v[148:151], a[160:163], v[64:79]
    ds_read_b64_tr_b16 v[172:173], v5 offset:2048
    ds_read_b64_tr_b16 v[174:175], v5 offset:2560
    s_add_u32 m0, s60, 101376
    s_add_u32 s59, s95, 256
    buffer_load_dwordx4 v252, s[12:15], s59 offen lds
    s_waitcnt lgkmcnt(10)
    v_mfma_f32_32x32x16_bf16 v[80:95], v[152:155], a[160:163], v[80:95]
    ds_read_b64_tr_b16 v[144:145], v6 offset:2048
    ds_read_b64_tr_b16 v[146:147], v6 offset:2560
    s_waitcnt lgkmcnt(10)
    v_mfma_f32_32x32x16_bf16 v[96:111], v[156:159], a[160:163], v[96:111]
    ds_read_b64_tr_b16 v[148:149], v7 offset:2048
    ds_read_b64_tr_b16 v[150:151], v7 offset:2560
    s_add_u32 m0, s60, 102400
    s_add_u32 s59, s96, 256
    buffer_load_dwordx4 v3, s[12:15], s59 offen lds
    s_waitcnt lgkmcnt(10)
    v_mfma_f32_32x32x16_bf16 v[112:127], v[160:163], a[160:163], v[112:127]
    ds_read_b64_tr_b16 v[152:153], v8 offset:2048
    ds_read_b64_tr_b16 v[154:155], v8 offset:2560
    s_waitcnt lgkmcnt(10)
    v_mfma_f32_32x32x16_bf16 v[128:143], v[164:167], a[160:163], v[128:143]
    ds_read_b64_tr_b16 v[156:157], v9 offset:2048
    ds_read_b64_tr_b16 v[158:159], v9 offset:2560
    s_waitcnt vmcnt(30) lgkmcnt(10)
    v_mfma_f32_32x32x16_bf16 v[48:63], v[168:171], a[164:167], v[48:63]
    ds_read_b64_tr_b16 v[160:161], v4 offset:4096
    ds_read_b64_tr_b16 v[162:163], v4 offset:4608
    s_add_u32 m0, s60, 103424
    s_add_u32 s59, s97, 256
    buffer_load_dwordx4 v252, s[12:15], s59 offen lds
    s_waitcnt lgkmcnt(10)
    v_mfma_f32_32x32x16_bf16 v[64:79], v[172:175], a[164:167], v[64:79]
    ds_read_b64_tr_b16 v[164:165], v5 offset:4096
    ds_read_b64_tr_b16 v[166:167], v5 offset:4608
    s_waitcnt lgkmcnt(10)
    v_mfma_f32_32x32x16_bf16 v[80:95], v[144:147], a[164:167], v[80:95]
    ds_read_b64_tr_b16 v[168:169], v6 offset:4096
    ds_read_b64_tr_b16 v[170:171], v6 offset:4608
    s_waitcnt vmcnt(17)
    v_cmp_gt_u32 vcc, 64, v253
    s_nop 4
    s_cbranch_vccnz K3_GSF1
K3_GBF1:
    s_add_u32 s62, s72, 0
    buffer_load_dwordx4 a[192:195], v1, s[20:23], s62 offen offset:0 sc1
    s_waitcnt lgkmcnt(10)
    v_mfma_f32_32x32x16_bf16 v[96:111], v[148:151], a[164:167], v[96:111]
    ds_read_b64_tr_b16 v[172:173], v7 offset:4096
    ds_read_b64_tr_b16 v[174:175], v7 offset:4608
    s_add_u32 s62, s72, 0
    buffer_load_dwordx4 a[196:199], v1, s[20:23], s62 offen offset:1024 sc1
    s_waitcnt lgkmcnt(10)
    v_mfma_f32_32x32x16_bf16 v[112:127], v[152:155], a[164:167], v[112:127]
    ds_read_b64_tr_b16 v[144:145], v8 offset:4096
    ds_read_b64_tr_b16 v[146:147], v8 offset:4608
    s_add_u32 s62, s72, 0
    buffer_load_dwordx4 a[200:203], v1, s[20:23], s62 offen offset:2048 sc1
    s_waitcnt lgkmcnt(10)
    v_mfma_f32_32x32x16_bf16 v[128:143], v[156:159], a[164:167], v[128:143]
    ds_read_b64_tr_b16 v[148:149], v9 offset:4096
    ds_read_b64_tr_b16 v[150:151], v9 offset:4608
    s_add_u32 s62, s72, 0
    buffer_load_dwordx4 a[204:207], v1, s[20:23], s62 offen offset:3072 sc1
    s_waitcnt lgkmcnt(10)
    v_mfma_f32_32x32x16_bf16 v[48:63], v[160:163], a[168:171], v[48:63]
    ds_read_b64_tr_b16 v[152:153], v4 offset:6144
    ds_read_b64_tr_b16 v[154:155], v4 offset:6656
    s_waitcnt lgkmcnt(10)
    v_mfma_f32_32x32x16_bf16 v[64:79], v[164:167], a[168:171], v[64:79]
    ds_read_b64_tr_b16 v[156:157], v5 offset:6144
    ds_read_b64_tr_b16 v[158:159], v5 offset:6656
    s_waitcnt lgkmcnt(10)
    v_mfma_f32_32x32x16_bf16 v[80:95], v[168:171], a[168:171], v[80:95]
    ds_read_b64_tr_b16 v[160:161], v6 offset:6144
    ds_read_b64_tr_b16 v[162:163], v6 offset:6656
    s_waitcnt lgkmcnt(10)
    v_mfma_f32_32x32x16_bf16 v[96:111], v[172:175], a[168:171], v[96:111]
    ds_read_b64_tr_b16 v[164:165], v7 offset:6144
    ds_read_b64_tr_b16 v[166:167], v7 offset:6656
    s_waitcnt lgkmcnt(10)
    v_mfma_f32_32x32x16_bf16 v[112:127], v[144:147], a[168:171], v[112:127]
    ds_read_b64_tr_b16 v[168:169], v8 offset:6144
    ds_read_b64_tr_b16 v[170:171], v8 offset:6656
    s_waitcnt lgkmcnt(10)
    v_mfma_f32_32x32x16_bf16 v[128:143], v[148:151], a[168:171], v[128:143]
    ds_read_b64_tr_b16 v[172:173], v9 offset:6144
    ds_read_b64_tr_b16 v[174:175], v9 offset:6656
    s_add_u32 s62, s72, 4096
    buffer_load_dwordx4 a[208:211], v1, s[20:23], s62 offen offset:0 sc1
    s_waitcnt lgkmcnt(10)
    v_mfma_f32_32x32x16_bf16 v[48:63], v[152:155], a[172:175], v[48:63]
    s_barrier
    ds_read_b64_tr_b16 v[144:145], v4 offset:24576
    ds_read_b64_tr_b16 v[146:147], v4 offset:25088
    s_waitcnt lgkmcnt(10)
    v_mfma_f32_32x32x16_bf16 v[64:79], v[156:159], a[172:175], v[64:79]
    ds_read_b64_tr_b16 v[148:149], v5 offset:24576
    ds_read_b64_tr_b16 v[150:151], v5 offset:25088
    s_waitcnt lgkmcnt(10)
    v_mfma_f32_32x32x16_bf16 v[80:95], v[160:163], a[172:175], v[80:95]
    ds_read_b64_tr_b16 v[152:153], v6 offset:24576
    ds_read_b64_tr_b16 v[154:155], v6 offset:25088
    s_add_u32 s62, s72, 4096
    buffer_load_dwordx4 a[212:215], v1, s[20:23], s62 offen offset:1024 sc1
    s_waitcnt lgkmcnt(10)
    v_mfma_f32_32x32x16_bf16 v[96:111], v[164:167], a[172:175], v[96:111]
    ds_read_b64_tr_b16 v[156:157], v7 offset:24576
    ds_read_b64_tr_b16 v[158:159], v7 offset:25088
    s_waitcnt lgkmcnt(10)
    v_mfma_f32_32x32x16_bf16 v[112:127], v[168:171], a[172:175], v[112:127]
    ds_read_b64_tr_b16 v[160:161], v8 offset:24576
    ds_read_b64_tr_b16 v[162:163], v8 offset:25088
    s_add_u32 s62, s72, 4096
    buffer_load_dwordx4 a[216:219], v1, s[20:23], s62 offen offset:2048 sc1
    s_waitcnt lgkmcnt(10)
    v_mfma_f32_32x32x16_bf16 v[128:143], v[172:175], a[172:175], v[128:143]
    ds_read_b64_tr_b16 v[164:165], v9 offset:24576
    ds_read_b64_tr_b16 v[166:167], v9 offset:25088
    s_waitcnt lgkmcnt(10)
    v_mfma_f32_32x32x16_bf16 v[48:63], v[144:147], a[176:179], v[48:63]
    ds_read_b64_tr_b16 v[168:169], v4 offset:26624
    ds_read_b64_tr_b16 v[170:171], v4 offset:27136
    s_add_u32 s62, s72, 4096
    buffer_load_dwordx4 a[220:223], v1, s[20:23], s62 offen offset:3072 sc1
    s_waitcnt lgkmcnt(10)
    v_mfma_f32_32x32x16_bf16 v[64:79], v[148:151], a[176:179], v[64:79]
    ds_read_b64_tr_b16 v[172:173], v5 offset:26624
    ds_read_b64_tr_b16 v[174:175], v5 offset:27136
    s_waitcnt lgkmcnt(10)
    v_mfma_f32_32x32x16_bf16 v[80:95], v[152:155], a[176:179], v[80:95]
    ds_read_b64_tr_b16 v[144:145], v6 offset:26624
    ds_read_b64_tr_b16 v[146:147], v6 offset:27136
    s_waitcnt lgkmcnt(10)
    v_mfma_f32_32x32x16_bf16 v[96:111], v[156:159], a[176:179], v[96:111]
    ds_read_b64_tr_b16 v[148:149], v7 offset:26624
    ds_read_b64_tr_b16 v[150:151], v7 offset:27136
    s_add_u32 s62, s72, 8192
    buffer_load_dwordx4 a[224:227], v1, s[20:23], s62 offen offset:0 sc1
    s_waitcnt lgkmcnt(10)
    v_mfma_f32_32x32x16_bf16 v[112:127], v[160:163], a[176:179], v[112:127]
    ds_read_b64_tr_b16 v[152:153], v8 offset:26624
    ds_read_b64_tr_b16 v[154:155], v8 offset:27136
    s_waitcnt lgkmcnt(10)
    v_mfma_f32_32x32x16_bf16 v[128:143], v[164:167], a[176:179], v[128:143]
    ds_read_b64_tr_b16 v[156:157], v9 offset:26624
    ds_read_b64_tr_b16 v[158:159], v9 offset:27136
    s_add_u32 s62, s72, 8192
    buffer_load_dwordx4 a[228:231], v1, s[20:23], s62 offen offset:1024 sc1
    s_waitcnt lgkmcnt(10)
    v_mfma_f32_32x32x16_bf16 v[48:63], v[168:171], a[180:183], v[48:63]
    ds_read_b64_tr_b16 v[160:161], v4 offset:28672
    ds_read_b64_tr_b16 v[162:163], v4 offset:29184
    s_waitcnt lgkmcnt(10)
    v_mfma_f32_32x32x16_bf16 v[64:79], v[172:175], a[180:183], v[64:79]
    ds_read_b64_tr_b16 v[164:165], v5 offset:28672
    ds_read_b64_tr_b16 v[166:167], v5 offset:29184
    s_waitcnt lgkmcnt(10)
    v_mfma_f32_32x32x16_bf16 v[80:95], v[144:147], a[180:183], v[80:95]
    ds_read_b64_tr_b16 v[168:169], v6 offset:28672
    ds_read_b64_tr_b16 v[170:171], v6 offset:29184
    s_add_u32 s62, s72, 8192
    buffer_load_dwordx4 a[232:235], v1, s[20:23], s62 offen offset:2048 sc1
    s_waitcnt lgkmcnt(10)
    v_mfma_f32_32x32x16_bf16 v[96:111], v[148:151], a[180:183], v[96:111]
    ds_read_b64_tr_b16 v[172:173], v7 offset:28672
    ds_read_b64_tr_b16 v[174:175], v7 offset:29184
    s_waitcnt lgkmcnt(10)
    v_mfma_f32_32x32x16_bf16 v[112:127], v[152:155], a[180:183], v[112:127]
    ds_read_b64_tr_b16 v[144:145], v8 offset:28672
    ds_read_b64_tr_b16 v[146:147], v8 offset:29184
    s_add_u32 s62, s72, 8192
    buffer_load_dwordx4 a[236:239], v1, s[20:23], s62 offen offset:3072 sc1
    s_waitcnt lgkmcnt(10)
    v_mfma_f32_32x32x16_bf16 v[128:143], v[156:159], a[180:183], v[128:143]
    ds_read_b64_tr_b16 v[148:149], v9 offset:28672
    ds_read_b64_tr_b16 v[150:151], v9 offset:29184
    s_waitcnt lgkmcnt(10)
    v_mfma_f32_32x32x16_bf16 v[48:63], v[160:163], a[184:187], v[48:63]
    ds_read_b64_tr_b16 v[152:153], v4 offset:30720
    ds_read_b64_tr_b16 v[154:155], v4 offset:31232
    s_add_u32 m0, s60, 122880
    s_add_u32 s59, s92, 384
    buffer_load_dwordx4 v3, s[12:15], s59 offen lds
    s_waitcnt lgkmcnt(10)
    v_mfma_f32_32x32x16_bf16 v[64:79], v[164:167], a[184:187], v[64:79]
    ds_read_b64_tr_b16 v[156:157], v5 offset:30720
    ds_read_b64_tr_b16 v[158:159], v5 offset:31232
    s_waitcnt lgkmcnt(10)
    v_mfma_f32_32x32x16_bf16 v[80:95], v[168:171], a[184:187], v[80:95]
    ds_read_b64_tr_b16 v[160:161], v6 offset:30720
    ds_read_b64_tr_b16 v[162:163], v6 offset:31232
    s_waitcnt lgkmcnt(10)
    v_mfma_f32_32x32x16_bf16 v[96:111], v[172:175], a[184:187], v[96:111]
    ds_read_b64_tr_b16 v[164:165], v7 offset:30720
    ds_read_b64_tr_b16 v[166:167], v7 offset:31232
    s_add_u32 m0, s60, 123904
    s_add_u32 s59, s93, 384
    buffer_load_dwordx4 v252, s[12:15], s59 offen lds
    s_waitcnt lgkmcnt(10)
    v_mfma_f32_32x32x16_bf16 v[112:127], v[144:147], a[184:187], v[112:127]
    ds_read_b64_tr_b16 v[168:169], v8 offset:30720
    ds_read_b64_tr_b16 v[170:171], v8 offset:31232
    s_waitcnt lgkmcnt(10)
    v_mfma_f32_32x32x16_bf16 v[128:143], v[148:151], a[184:187], v[128:143]
    ds_read_b64_tr_b16 v[172:173], v9 offset:30720
    ds_read_b64_tr_b16 v[174:175], v9 offset:31232
    s_add_u32 m0, s60, 124928
    s_add_u32 s59, s94, 384
    buffer_load_dwordx4 v3, s[12:15], s59 offen lds
    s_waitcnt lgkmcnt(10)
    v_mfma_f32_32x32x16_bf16 v[48:63], v[152:155], a[188:191], v[48:63]
    s_waitcnt vmcnt(27)
    s_barrier
    v_add_u32 v248, 49152, v248
    v_add_u32 v249, 49152, v249
    v_add_u32 v250, 49152, v250
    v_add_u32 v251, 49152, v251
    ds_read_b128 v[144:147], v248 offset:0
    s_waitcnt lgkmcnt(9)
    v_mfma_f32_32x32x16_bf16 v[64:79], v[156:159], a[188:191], v[64:79]
    ds_read_b128 v[148:151], v248 offset:4096
    s_add_u32 m0, s60, 125952
    s_add_u32 s59, s95, 384
    buffer_load_dwordx4 v252, s[12:15], s59 offen lds
    s_waitcnt lgkmcnt(8)
    v_mfma_f32_32x32x16_bf16 v[80:95], v[160:163], a[188:191], v[80:95]
    ds_read_b128 v[152:155], v248 offset:8192
    s_waitcnt lgkmcnt(7)
    v_mfma_f32_32x32x16_bf16 v[96:111], v[164:167], a[188:191], v[96:111]
    ds_read_b128 v[156:159], v248 offset:12288
    s_waitcnt lgkmcnt(6)
    v_mfma_f32_32x32x16_bf16 v[112:127], v[168:171], a[188:191], v[112:127]
    ds_read_b128 v[160:163], v248 offset:16384
    s_add_u32 m0, s60, 126976
    s_add_u32 s59, s96, 384
    buffer_load_dwordx4 v3, s[12:15], s59 offen lds
    s_waitcnt lgkmcnt(5)
    v_mfma_f32_32x32x16_bf16 v[128:143], v[172:175], a[188:191], v[128:143]
    ds_read_b128 v[164:167], v248 offset:20480
    s_waitcnt vmcnt(16) lgkmcnt(5)
    v_mfma_f32_32x32x16_bf16 v[48:63], v[144:147], a[192:195], v[48:63]
    ds_read_b128 v[168:171], v249 offset:0
    s_add_u32 m0, s60, 128000
    s_add_u32 s59, s97, 384
    buffer_load_dwordx4 v252, s[12:15], s59 offen lds
    s_waitcnt lgkmcnt(5)
    v_mfma_f32_32x32x16_bf16 v[64:79], v[148:151], a[192:195], v[64:79]
    ds_read_b128 v[172:175], v249 offset:4096
    s_waitcnt lgkmcnt(5)
    v_mfma_f32_32x32x16_bf16 v[80:95], v[152:155], a[192:195], v[80:95]
    ds_read_b128 v[144:147], v249 offset:8192
    s_add_u32 s62, s72, 12288
    buffer_load_dwordx4 a[240:243], v1, s[20:23], s62 offen offset:0 sc1
    s_waitcnt lgkmcnt(5)
    v_mfma_f32_32x32x16_bf16 v[96:111], v[156:159], a[192:195], v[96:111]
    ds_read_b128 v[148:151], v249 offset:12288
    s_waitcnt lgkmcnt(5)
    v_mfma_f32_32x32x16_bf16 v[112:127], v[160:163], a[192:195], v[112:127]
    ds_read_b128 v[152:155], v249 offset:16384
    s_waitcnt lgkmcnt(5)
    v_mfma_f32_32x32x16_bf16 v[128:143], v[164:167], a[192:195], v[128:143]
    ds_read_b128 v[156:159], v249 offset:20480
    s_add_u32 s62, s72, 12288
    buffer_load_dwordx4 a[244:247], v1, s[20:23], s62 offen offset:1024 sc1
    s_waitcnt vmcnt(18) lgkmcnt(5)
    v_mfma_f32_32x32x16_bf16 v[48:63], v[168:171], a[196:199], v[48:63]
    ds_read_b128 v[160:163], v250 offset:0
    s_waitcnt lgkmcnt(5)
    v_mfma_f32_32x32x16_bf16 v[64:79], v[172:175], a[196:199], v[64:79]
    ds_read_b128 v[164:167], v250 offset:4096
    s_add_u32 s62, s72, 12288
    buffer_load_dwordx4 a[248:251], v1, s[20:23], s62 offen offset:2048 sc1
    s_waitcnt lgkmcnt(5)
    v_mfma_f32_32x32x16_bf16 v[80:95], v[144:147], a[196:199], v[80:95]
    ds_read_b128 v[168:171], v250 offset:8192
    s_waitcnt lgkmcnt(5)
    v_mfma_f32_32x32x16_bf16 v[96:111], v[148:151], a[196:199], v[96:111]
    ds_read_b128 v[172:175], v250 offset:12288
    s_add_u32 s62, s72, 12288
    buffer_load_dwordx4 a[252:255], v1, s[20:23], s62 offen offset:3072 sc1
    s_waitcnt lgkmcnt(5)
    v_mfma_f32_32x32x16_bf16 v[112:127], v[152:155], a[196:199], v[112:127]
    ds_read_b128 v[144:147], v250 offset:16384
    s_waitcnt lgkmcnt(5)
    v_mfma_f32_32x32x16_bf16 v[128:143], v[156:159], a[196:199], v[128:143]
    ds_read_b128 v[148:151], v250 offset:20480
    s_waitcnt vmcnt(19) lgkmcnt(5)
    v_mfma_f32_32x32x16_bf16 v[48:63], v[160:163], a[200:203], v[48:63]
    ds_read_b128 v[152:155], v251 offset:0
    buffer_load_dwordx4 v[216:219], v13, s[4:7], s30 offen
    s_waitcnt lgkmcnt(5)
    v_mfma_f32_32x32x16_bf16 v[64:79], v[164:167], a[200:203], v[64:79]
    ds_read_b128 v[156:159], v251 offset:4096
    s_waitcnt lgkmcnt(5)
    v_mfma_f32_32x32x16_bf16 v[80:95], v[168:171], a[200:203], v[80:95]
    ds_read_b128 v[160:163], v251 offset:8192
    s_waitcnt lgkmcnt(5)
    v_mfma_f32_32x32x16_bf16 v[96:111], v[172:175], a[200:203], v[96:111]
    ds_read_b128 v[164:167], v251 offset:12288
    s_waitcnt lgkmcnt(5)
    v_mfma_f32_32x32x16_bf16 v[112:127], v[144:147], a[200:203], v[112:127]
    ds_read_b128 v[168:171], v251 offset:16384
    s_waitcnt lgkmcnt(5)
    v_mfma_f32_32x32x16_bf16 v[128:143], v[148:151], a[200:203], v[128:143]
    ds_read_b128 v[172:175], v251 offset:20480
    s_waitcnt vmcnt(19) lgkmcnt(5)
    v_mfma_f32_32x32x16_bf16 v[48:63], v[152:155], a[204:207], v[48:63]
    s_barrier
    ds_read_b128 v[144:147], v248 offset:24576
    s_waitcnt lgkmcnt(5)
    v_mfma_f32_32x32x16_bf16 v[64:79], v[156:159], a[204:207], v[64:79]
    ds_read_b128 v[148:151], v248 offset:28672
    s_waitcnt lgkmcnt(5)
    v_mfma_f32_32x32x16_bf16 v[80:95], v[160:163], a[204:207], v[80:95]
    ds_read_b128 v[152:155], v248 offset:32768
    s_waitcnt lgkmcnt(5)
    v_mfma_f32_32x32x16_bf16 v[96:111], v[164:167], a[204:207], v[96:111]
    ds_read_b128 v[156:159], v248 offset:36864
    buffer_load_dwordx4 v[220:223], v13, s[4:7], s30 offen offset:16
    s_waitcnt lgkmcnt(5)
    v_mfma_f32_32x32x16_bf16 v[112:127], v[168:171], a[204:207], v[112:127]
    ds_read_b128 v[160:163], v248 offset:40960
    s_waitcnt lgkmcnt(5)
    v_mfma_f32_32x32x16_bf16 v[128:143], v[172:175], a[204:207], v[128:143]
    ds_read_b128 v[164:167], v248 offset:45056
    s_waitcnt vmcnt(19) lgkmcnt(5)
    v_mfma_f32_32x32x16_bf16 v[48:63], v[144:147], a[208:211], v[48:63]
    ds_read_b128 v[168:171], v249 offset:24576
    buffer_load_dwordx4 v[224:227], v15, s[20:23], s31 offen sc1
    s_waitcnt lgkmcnt(5)
    v_mfma_f32_32x32x16_bf16 v[64:79], v[148:151], a[208:211], v[64:79]
    ds_read_b128 v[172:175], v249 offset:28672
    s_waitcnt lgkmcnt(5)
    v_mfma_f32_32x32x16_bf16 v[80:95], v[152:155], a[208:211], v[80:95]
    ds_read_b128 v[144:147], v249 offset:32768
    buffer_load_dwordx4 v[228:231], v15, s[20:23], s31 offen offset:512 sc1
    s_waitcnt lgkmcnt(5)
    v_mfma_f32_32x32x16_bf16 v[96:111], v[156:159], a[208:211], v[96:111]
    ds_read_b128 v[148:151], v249 offset:36864
    s_waitcnt lgkmcnt(5)
    v_mfma_f32_32x32x16_bf16 v[112:127], v[160:163], a[208:211], v[112:127]
    ds_read_b128 v[152:155], v249 offset:40960
    buffer_load_dwordx4 v[232:235], v14, s[32:35], s30 offen
    s_waitcnt lgkmcnt(5)
    v_mfma_f32_32x32x16_bf16 v[128:143], v[164:167], a[208:211], v[128:143]
    ds_read_b128 v[156:159], v249 offset:45056
    buffer_load_dwordx4 v[236:239], v14, s[32:35], s30 offen offset:16
    s_waitcnt vmcnt(22) lgkmcnt(5)
    v_mfma_f32_32x32x16_bf16 v[48:63], v[168:171], a[212:215], v[48:63]
    ds_read_b128 v[160:163], v250 offset:24576
    buffer_load_dwordx4 v[16:19], v13, s[4:7], s75 offen
    s_waitcnt lgkmcnt(5)
    v_mfma_f32_32x32x16_bf16 v[64:79], v[172:175], a[212:215], v[64:79]
    ds_read_b128 v[164:167], v250 offset:28672
    s_waitcnt lgkmcnt(5)
    v_mfma_f32_32x32x16_bf16 v[80:95], v[144:147], a[212:215], v[80:95]
    ds_read_b128 v[168:171], v250 offset:32768
    s_waitcnt lgkmcnt(5)
    v_mfma_f32_32x32x16_bf16 v[96:111], v[148:151], a[212:215], v[96:111]
    ds_read_b128 v[172:175], v250 offset:36864
    s_waitcnt lgkmcnt(5)
    v_mfma_f32_32x32x16_bf16 v[112:127], v[152:155], a[212:215], v[112:127]
    ds_read_b128 v[144:147], v250 offset:40960
    s_waitcnt lgkmcnt(5)
    v_mfma_f32_32x32x16_bf16 v[128:143], v[156:159], a[212:215], v[128:143]
    ds_read_b128 v[148:151], v250 offset:45056
    s_waitcnt vmcnt(22) lgkmcnt(5)
    v_mfma_f32_32x32x16_bf16 v[48:63], v[160:163], a[216:219], v[48:63]
    ds_read_b128 v[152:155], v251 offset:24576
    s_waitcnt lgkmcnt(5)
    v_mfma_f32_32x32x16_bf16 v[64:79], v[164:167], a[216:219], v[64:79]
    ds_read_b128 v[156:159], v251 offset:28672
    s_waitcnt lgkmcnt(5)
    v_mfma_f32_32x32x16_bf16 v[80:95], v[168:171], a[216:219], v[80:95]
    ds_read_b128 v[160:163], v251 offset:32768
    s_waitcnt lgkmcnt(5)
    v_mfma_f32_32x32x16_bf16 v[96:111], v[172:175], a[216:219], v[96:111]
    ds_read_b128 v[164:167], v251 offset:36864
    buffer_load_dwordx4 v[20:23], v13, s[4:7], s75 offen offset:16
    s_waitcnt lgkmcnt(5)
    v_mfma_f32_32x32x16_bf16 v[112:127], v[144:147], a[216:219], v[112:127]
    ds_read_b128 v[168:171], v251 offset:40960
    s_waitcnt lgkmcnt(5)
    v_mfma_f32_32x32x16_bf16 v[128:143], v[148:151], a[216:219], v[128:143]
    ds_read_b128 v[172:175], v251 offset:45056
    buffer_load_dwordx4 v[24:27], v15, s[20:23], s76 offen sc1
    s_waitcnt vmcnt(23) lgkmcnt(5)
    v_mfma_f32_32x32x16_bf16 v[48:63], v[152:155], a[220:223], v[48:63]
    s_barrier
    v_add_u32 v248, 49152, v248
    v_add_u32 v249, 49152, v249
    v_add_u32 v250, 49152, v250
    v_add_u32 v251, 49152, v251
    ds_read_b128 v[144:147], v248 offset:0
    s_waitcnt lgkmcnt(5)
    v_mfma_f32_32x32x16_bf16 v[64:79], v[156:159], a[220:223], v[64:79]
    ds_read_b128 v[148:151], v248 offset:4096
    s_waitcnt lgkmcnt(5)
    v_mfma_f32_32x32x16_bf16 v[80:95], v[160:163], a[220:223], v[80:95]
    ds_read_b128 v[152:155], v248 offset:8192
    buffer_load_dwordx4 v[28:31], v15, s[20:23], s76 offen offset:512 sc1
    s_waitcnt lgkmcnt(5)
    v_mfma_f32_32x32x16_bf16 v[96:111], v[164:167], a[220:223], v[96:111]
    ds_read_b128 v[156:159], v248 offset:12288
    s_waitcnt lgkmcnt(5)
    v_mfma_f32_32x32x16_bf16 v[112:127], v[168:171], a[220:223], v[112:127]
    ds_read_b128 v[160:163], v248 offset:16384
    buffer_load_dwordx4 v[32:35], v14, s[32:35], s75 offen
    s_waitcnt lgkmcnt(5)
    v_mfma_f32_32x32x16_bf16 v[128:143], v[172:175], a[220:223], v[128:143]
    ds_read_b128 v[164:167], v248 offset:20480
    buffer_load_dwordx4 v[36:39], v14, s[32:35], s75 offen offset:16
    s_waitcnt vmcnt(25) lgkmcnt(5)
    v_mfma_f32_32x32x16_bf16 v[48:63], v[144:147], a[224:227], v[48:63]
    ds_read_b128 v[168:171], v249 offset:0
    s_waitcnt lgkmcnt(5)
    v_mfma_f32_32x32x16_bf16 v[64:79], v[148:151], a[224:227], v[64:79]
    ds_read_b128 v[172:175], v249 offset:4096
    s_waitcnt lgkmcnt(5)
    v_mfma_f32_32x32x16_bf16 v[80:95], v[152:155], a[224:227], v[80:95]
    ds_read_b128 v[144:147], v249 offset:8192
    s_waitcnt lgkmcnt(5)
    v_mfma_f32_32x32x16_bf16 v[96:111], v[156:159], a[224:227], v[96:111]
    ds_read_b128 v[148:151], v249 offset:12288
    s_waitcnt lgkmcnt(5)
    v_mfma_f32_32x32x16_bf16 v[112:127], v[160:163], a[224:227], v[112:127]
    ds_read_b128 v[152:155], v249 offset:16384
    s_waitcnt lgkmcnt(5)
    v_mfma_f32_32x32x16_bf16 v[128:143], v[164:167], a[224:227], v[128:143]
    ds_read_b128 v[156:159], v249 offset:20480
    s_waitcnt vmcnt(24) lgkmcnt(5)
    v_mfma_f32_32x32x16_bf16 v[48:63], v[168:171], a[228:231], v[48:63]
    ds_read_b128 v[160:163], v250 offset:0
    s_waitcnt lgkmcnt(5)
    v_mfma_f32_32x32x16_bf16 v[64:79], v[172:175], a[228:231], v[64:79]
    ds_read_b128 v[164:167], v250 offset:4096
    s_waitcnt lgkmcnt(5)
    v_mfma_f32_32x32x16_bf16 v[80:95], v[144:147], a[228:231], v[80:95]
    ds_read_b128 v[168:171], v250 offset:8192
    s_waitcnt lgkmcnt(5)
    v_mfma_f32_32x32x16_bf16 v[96:111], v[148:151], a[228:231], v[96:111]
    ds_read_b128 v[172:175], v250 offset:12288
    s_waitcnt lgkmcnt(5)
    v_mfma_f32_32x32x16_bf16 v[112:127], v[152:155], a[228:231], v[112:127]
    ds_read_b128 v[144:147], v250 offset:16384
    s_waitcnt lgkmcnt(5)
    v_mfma_f32_32x32x16_bf16 v[128:143], v[156:159], a[228:231], v[128:143]
    ds_read_b128 v[148:151], v250 offset:20480
    s_waitcnt vmcnt(23) lgkmcnt(5)
    v_mfma_f32_32x32x16_bf16 v[48:63], v[160:163], a[232:235], v[48:63]
    ds_read_b128 v[152:155], v251 offset:0
    s_waitcnt lgkmcnt(5)
    v_mfma_f32_32x32x16_bf16 v[64:79], v[164:167], a[232:235], v[64:79]
    ds_read_b128 v[156:159], v251 offset:4096
    s_waitcnt lgkmcnt(5)
    v_mfma_f32_32x32x16_bf16 v[80:95], v[168:171], a[232:235], v[80:95]
    ds_read_b128 v[160:163], v251 offset:8192
    s_waitcnt lgkmcnt(5)
    v_mfma_f32_32x32x16_bf16 v[96:111], v[172:175], a[232:235], v[96:111]
    ds_read_b128 v[164:167], v251 offset:12288
    s_waitcnt lgkmcnt(5)
    v_mfma_f32_32x32x16_bf16 v[112:127], v[144:147], a[232:235], v[112:127]
    ds_read_b128 v[168:171], v251 offset:16384
    s_waitcnt lgkmcnt(5)
    v_mfma_f32_32x32x16_bf16 v[128:143], v[148:151], a[232:235], v[128:143]
    ds_read_b128 v[172:175], v251 offset:20480
    s_waitcnt vmcnt(22) lgkmcnt(5)
    v_mfma_f32_32x32x16_bf16 v[48:63], v[152:155], a[236:239], v[48:63]
    s_waitcnt vmcnt(16)
    s_barrier
    ds_read_b128 v[144:147], v248 offset:24576
    s_waitcnt lgkmcnt(5)
    v_mfma_f32_32x32x16_bf16 v[64:79], v[156:159], a[236:239], v[64:79]
    ds_read_b128 v[148:151], v249 offset:24576
    s_waitcnt lgkmcnt(5)
    v_mfma_f32_32x32x16_bf16 v[80:95], v[160:163], a[236:239], v[80:95]
    ds_read_b128 v[152:155], v250 offset:24576
    s_waitcnt lgkmcnt(5)
    v_mfma_f32_32x32x16_bf16 v[96:111], v[164:167], a[236:239], v[96:111]
    ds_read_b128 v[156:159], v251 offset:24576
    s_waitcnt lgkmcnt(5)
    v_mfma_f32_32x32x16_bf16 v[112:127], v[168:171], a[236:239], v[112:127]
    ds_read_b128 v[160:163], v248 offset:28672
    s_waitcnt lgkmcnt(5)
    v_mfma_f32_32x32x16_bf16 v[128:143], v[172:175], a[236:239], v[128:143]
    ds_read_b128 v[164:167], v249 offset:28672
    s_waitcnt vmcnt(15) lgkmcnt(5)
    v_mfma_f32_32x32x16_bf16 v[48:63], v[144:147], a[240:243], v[48:63]
    ds_read_b128 v[168:171], v250 offset:28672
    s_waitcnt vmcnt(14) lgkmcnt(5)
    v_mfma_f32_32x32x16_bf16 v[48:63], v[148:151], a[244:247], v[48:63]
    ds_read_b128 v[172:175], v251 offset:28672
    s_waitcnt vmcnt(13) lgkmcnt(5)
    v_mfma_f32_32x32x16_bf16 v[48:63], v[152:155], a[248:251], v[48:63]
    ds_read_b128 v[144:147], v248 offset:32768
    s_waitcnt vmcnt(12) lgkmcnt(5)
    v_mfma_f32_32x32x16_bf16 v[48:63], v[156:159], a[252:255], v[48:63]
    ds_read_b128 v[148:151], v249 offset:32768
    s_waitcnt lgkmcnt(5)
    v_mfma_f32_32x32x16_bf16 v[64:79], v[160:163], a[240:243], v[64:79]
    ds_read_b128 v[152:155], v250 offset:32768
    s_waitcnt lgkmcnt(5)
    v_mfma_f32_32x32x16_bf16 v[64:79], v[164:167], a[244:247], v[64:79]
    ds_read_b128 v[156:159], v251 offset:32768
    s_nop 4
    v_cvt_pk_bf16_f32 v176, v48, v49
    v_cvt_pk_bf16_f32 v177, v50, v51
    v_cvt_pk_bf16_f32 v178, v52, v53
    v_cvt_pk_bf16_f32 v179, v54, v55
    buffer_store_dwordx4 v[176:179], v1, s[20:23], s24 offen offset:0 sc0 sc1
    s_waitcnt lgkmcnt(5)
    v_mfma_f32_32x32x16_bf16 v[64:79], v[168:171], a[248:251], v[64:79]
    ds_read_b128 v[160:163], v248 offset:36864
    v_cvt_pk_bf16_f32 v180, v56, v57
    v_cvt_pk_bf16_f32 v181, v58, v59
    v_cvt_pk_bf16_f32 v182, v60, v61
    v_cvt_pk_bf16_f32 v183, v62, v63
    buffer_store_dwordx4 v[180:183], v1, s[20:23], s24 offen offset:1024 sc0 sc1
    s_waitcnt lgkmcnt(5)
    v_mfma_f32_32x32x16_bf16 v[64:79], v[172:175], a[252:255], v[64:79]
    ds_read_b128 v[164:167], v249 offset:36864
    s_waitcnt lgkmcnt(5)
    v_mfma_f32_32x32x16_bf16 v[80:95], v[144:147], a[240:243], v[80:95]
    ds_read_b128 v[168:171], v250 offset:36864
    s_waitcnt lgkmcnt(5)
    v_mfma_f32_32x32x16_bf16 v[80:95], v[148:151], a[244:247], v[80:95]
    ds_read_b128 v[172:175], v251 offset:36864
    s_nop 4
    v_cvt_pk_bf16_f32 v184, v64, v65
    v_cvt_pk_bf16_f32 v185, v66, v67
    v_cvt_pk_bf16_f32 v186, v68, v69
    v_cvt_pk_bf16_f32 v187, v70, v71
    buffer_store_dwordx4 v[184:187], v1, s[20:23], s25 offen offset:0 sc0 sc1
    s_waitcnt lgkmcnt(5)
    v_mfma_f32_32x32x16_bf16 v[80:95], v[152:155], a[248:251], v[80:95]
    ds_read_b128 v[144:147], v248 offset:40960
    v_cvt_pk_bf16_f32 v188, v72, v73
    v_cvt_pk_bf16_f32 v189, v74, v75
    v_cvt_pk_bf16_f32 v190, v76, v77
    v_cvt_pk_bf16_f32 v191, v78, v79
    buffer_store_dwordx4 v[188:191], v1, s[20:23], s25 offen offset:1024 sc0 sc1
    s_waitcnt lgkmcnt(5)
    v_mfma_f32_32x32x16_bf16 v[80:95], v[156:159], a[252:255], v[80:95]
    ds_read_b128 v[148:151], v249 offset:40960
    s_waitcnt lgkmcnt(5)
    v_mfma_f32_32x32x16_bf16 v[96:111], v[160:163], a[240:243], v[96:111]
    ds_read_b128 v[152:155], v250 offset:40960
    s_waitcnt lgkmcnt(5)
    v_mfma_f32_32x32x16_bf16 v[96:111], v[164:167], a[244:247], v[96:111]
    ds_read_b128 v[156:159], v251 offset:40960
    s_nop 4
    v_cvt_pk_bf16_f32 v192, v80, v81
    v_cvt_pk_bf16_f32 v193, v82, v83
    v_cvt_pk_bf16_f32 v194, v84, v85
    v_cvt_pk_bf16_f32 v195, v86, v87
    buffer_store_dwordx4 v[192:195], v1, s[20:23], s26 offen offset:0 sc0 sc1
    s_waitcnt lgkmcnt(5)
    v_mfma_f32_32x32x16_bf16 v[96:111], v[168:171], a[248:251], v[96:111]
    ds_read_b128 v[160:163], v248 offset:45056
    v_cvt_pk_bf16_f32 v196, v88, v89
    v_cvt_pk_bf16_f32 v197, v90, v91
    v_cvt_pk_bf16_f32 v198, v92, v93
    v_cvt_pk_bf16_f32 v199, v94, v95
    buffer_store_dwordx4 v[196:199], v1, s[20:23], s26 offen offset:1024 sc0 sc1
    s_waitcnt lgkmcnt(5)
    v_mfma_f32_32x32x16_bf16 v[96:111], v[172:175], a[252:255], v[96:111]
    ds_read_b128 v[164:167], v249 offset:45056
    s_waitcnt lgkmcnt(5)
    v_mfma_f32_32x32x16_bf16 v[112:127], v[144:147], a[240:243], v[112:127]
    ds_read_b128 v[168:171], v250 offset:45056
    s_waitcnt lgkmcnt(5)
    v_mfma_f32_32x32x16_bf16 v[112:127], v[148:151], a[244:247], v[112:127]
    ds_read_b128 v[172:175], v251 offset:45056
    s_nop 4
    v_cvt_pk_bf16_f32 v200, v96, v97
    v_cvt_pk_bf16_f32 v201, v98, v99
    v_cvt_pk_bf16_f32 v202, v100, v101
    v_cvt_pk_bf16_f32 v203, v102, v103
    buffer_store_dwordx4 v[200:203], v1, s[20:23], s27 offen offset:0 sc0 sc1
    s_waitcnt lgkmcnt(5)
    v_mfma_f32_32x32x16_bf16 v[112:127], v[152:155], a[248:251], v[112:127]
    v_cvt_pk_bf16_f32 v204, v104, v105
    v_cvt_pk_bf16_f32 v205, v106, v107
    v_cvt_pk_bf16_f32 v206, v108, v109
    v_cvt_pk_bf16_f32 v207, v110, v111
    buffer_store_dwordx4 v[204:207], v1, s[20:23], s27 offen offset:1024 sc0 sc1
    s_waitcnt lgkmcnt(4)
    v_mfma_f32_32x32x16_bf16 v[112:127], v[156:159], a[252:255], v[112:127]
    s_waitcnt lgkmcnt(3)
    v_mfma_f32_32x32x16_bf16 v[128:143], v[160:163], a[240:243], v[128:143]
    s_waitcnt lgkmcnt(2)
    v_mfma_f32_32x32x16_bf16 v[128:143], v[164:167], a[244:247], v[128:143]
    s_nop 7
    v_cvt_pk_bf16_f32 v208, v112, v113
    v_cvt_pk_bf16_f32 v209, v114, v115
    v_cvt_pk_bf16_f32 v210, v116, v117
    v_cvt_pk_bf16_f32 v211, v118, v119
    buffer_store_dwordx4 v[208:211], v1, s[20:23], s28 offen offset:0 sc0 sc1
    s_waitcnt lgkmcnt(1)
    v_mfma_f32_32x32x16_bf16 v[128:143], v[168:171], a[248:251], v[128:143]
    v_cvt_pk_bf16_f32 v212, v120, v121
    v_cvt_pk_bf16_f32 v213, v122, v123
    v_cvt_pk_bf16_f32 v214, v124, v125
    v_cvt_pk_bf16_f32 v215, v126, v127
    buffer_store_dwordx4 v[212:215], v1, s[20:23], s28 offen offset:1024 sc0 sc1
    s_waitcnt lgkmcnt(0)
    v_mfma_f32_32x32x16_bf16 v[128:143], v[172:175], a[252:255], v[128:143]
    s_waitcnt vmcnt(0)
    s_branch K3_RED
K3_GSF0:
    s_mov_b32 s70, 0
K3_GPF0:
    s_sleep 2
    buffer_load_dword v253, v254, s[20:23], s77 offen sc0 sc1
    s_waitcnt vmcnt(0)
    v_cmp_gt_u32 vcc, 8, v253
    s_add_u32 s70, s70, 1
    s_nop 4
    s_cbranch_vccz K3_GBF0
    s_cmp_lt_u32 s70, 200000
    s_cbranch_scc1 K3_GPF0
    s_branch K3_GBF0
K3_GSF1:
    s_mov_b32 s70, 0
K3_GPF1:
    s_sleep 2
    buffer_load_dword v253, v12, s[20:23], s74 offen sc0 sc1
    s_waitcnt vmcnt(0)
    v_cmp_gt_u32 vcc, 64, v253
    s_add_u32 s70, s70, 1
    s_nop 4
    s_cbranch_vccz K3_GBF1
    s_cmp_lt_u32 s70, 200000
    s_cbranch_scc1 K3_GPF1
    s_branch K3_GBF1
K3SF_SLOW:
    s_mov_b32 s70, 0
K3SF_SPIN:
    s_sleep 4
    v_lshrrev_b32 v228, 4, v0
    v_lshlrev_b32 v228, 3, v228
    v_sub_u32 v228, s49, v228
    v_and_b32 v229, 15, v0
    v_lshlrev_b32 v229, 4, v229
    v_lshrrev_b32 v244, 4, v0
    v_lshlrev_b32 v244, 11, v244
    v_sub_u32 v244, v229, v244
    v_add_u32 v244, s48, v244
    v_mov_b32 v229, 50659328
    v_cmp_lt_i32 vcc, 0, v228
    v_add_u32 v246, 4294967040, v244
    s_nop 0
    v_cndmask_b32 v246, v229, v246, vcc
    buffer_load_dwordx4 v[16:19], v246, s[20:23], 0 offen sc0 sc1
    v_cmp_lt_i32 vcc, 1, v228
    v_add_u32 v246, 4294966784, v244
    s_nop 0
    v_cndmask_b32 v246, v229, v246, vcc
    buffer_load_dwordx4 v[20:23], v246, s[20:23], 0 offen sc0 sc1
    v_cmp_lt_i32 vcc, 2, v228
    v_add_u32 v246, 4294966528, v244
    s_nop 0
    v_cndmask_b32 v246, v229, v246, vcc
    buffer_load_dwordx4 v[24:27], v246, s[20:23], 0 offen sc0 sc1
    v_cmp_lt_i32 vcc, 3, v228
    v_add_u32 v246, 4294966272, v244
    s_nop 0
    v_cndmask_b32 v246, v229, v246, vcc
    buffer_load_dwordx4 v[28:31], v246, s[20:23], 0 offen sc0 sc1
    v_cmp_lt_i32 vcc, 4, v228
    v_add_u32 v246, 4294966016, v244
    s_nop 0
    v_cndmask_b32 v246, v229, v246, vcc
    buffer_load_dwordx4 v[32:35], v246, s[20:23], 0 offen sc0 sc1
    v_cmp_lt_i32 vcc, 5, v228
    v_add_u32 v246, 4294965760, v244
    s_nop 0
    v_cndmask_b32 v246, v229, v246, vcc
    buffer_load_dwordx4 v[36:39], v246, s[20:23], 0 offen sc0 sc1
    v_cmp_lt_i32 vcc, 6, v228
    v_add_u32 v246, 4294965504, v244
    s_nop 0
    v_cndmask_b32 v246, v229, v246, vcc
    buffer_load_dwordx4 v[40:43], v246, s[20:23], 0 offen sc0 sc1
    v_cmp_lt_i32 vcc, 7, v228
    v_add_u32 v246, 4294965248, v244
    s_nop 0
    v_cndmask_b32 v246, v229, v246, vcc
    buffer_load_dwordx4 v[44:47], v246, s[20:23], 0 offen sc0 sc1
    s_waitcnt vmcnt(7)
    v_min_f32 v246, v18, v19
    s_waitcnt vmcnt(6)
    v_min3_f32 v246, v246, v22, v23
    s_waitcnt vmcnt(5)
    v_min3_f32 v246, v246, v26, v27
    s_waitcnt vmcnt(4)
    v_min3_f32 v246, v246, v30, v31
    s_waitcnt vmcnt(3)
    v_min3_f32 v246, v246, v34, v35
    s_waitcnt vmcnt(2)
    v_min3_f32 v246, v246, v38, v39
    s_waitcnt vmcnt(1)
    v_min3_f32 v246, v246, v42, v43
    s_waitcnt vmcnt(0)
    v_min3_f32 v246, v246, v46, v47
    v_cmp_gt_f32 vcc, 0.5, v246
    s_add_u32 s70, s70, 1
    s_nop 4
    s_cbranch_vccz K3SF_BACK
    s_cmp_lt_u32 s70, 100000
    s_cbranch_scc1 K3SF_SPIN
    s_branch K3SF_BACK
K3_SR:
    s_add_u32 m0, s61, 0
    s_add_u32 s59, s56, 0
    buffer_load_dwordx4 v2, s[8:11], s59 offen lds
    s_add_u32 m0, s61, 1024
    s_add_u32 s59, s56, 9216
    buffer_load_dwordx4 v2, s[8:11], s59 offen lds
    s_add_u32 m0, s61, 8192
    s_add_u32 s59, s56, 128
    buffer_load_dwordx4 v2, s[8:11], s59 offen lds
    s_add_u32 m0, s61, 9216
    s_add_u32 s59, s56, 9344
    buffer_load_dwordx4 v2, s[8:11], s59 offen lds
    s_add_u32 m0, s61, 16384
    s_add_u32 s59, s56, 256
    buffer_load_dwordx4 v2, s[8:11], s59 offen lds
    s_add_u32 m0, s61, 17408
    s_add_u32 s59, s56, 9472
    buffer_load_dwordx4 v2, s[8:11], s59 offen lds
    s_add_u32 m0, s61, 24576
    s_add_u32 s59, s56, 1327104
    buffer_load_dwordx4 v2, s[8:11], s59 offen lds
    s_add_u32 m0, s61, 25600
    s_add_u32 s59, s56, 1336320
    buffer_load_dwordx4 v2, s[8:11], s59 offen lds
    s_add_u32 m0, s61, 32768
    s_add_u32 s59, s56, 1327232
    buffer_load_dwordx4 v2, s[8:11], s59 offen lds
    s_add_u32 m0, s61, 33792
    s_add_u32 s59, s56, 1336448
    buffer_load_dwordx4 v2, s[8:11], s59 offen lds
    s_add_u32 m0, s61, 40960
    s_add_u32 s59, s56, 1327360
    buffer_load_dwordx4 v2, s[8:11], s59 offen lds
    s_add_u32 m0, s61, 41984
    s_add_u32 s59, s56, 1336576
    buffer_load_dwordx4 v2, s[8:11], s59 offen lds
    s_add_u32 m0, s61, 49152
    s_add_u32 s59, s56, 2654208
    buffer_load_dwordx4 v2, s[8:11], s59 offen lds
    s_add_u32 m0, s61, 50176
    s_add_u32 s59, s56, 2663424
    buffer_load_dwordx4 v2, s[8:11], s59 offen lds
    s_add_u32 m0, s61, 57344
    s_add_u32 s59, s56, 2654336
    buffer_load_dwordx4 v2, s[8:11], s59 offen lds
    s_add_u32 m0, s61, 58368
    s_add_u32 s59, s56, 2663552
    buffer_load_dwordx4 v2, s[8:11], s59 offen lds
    s_add_u32 m0, s61, 65536
    s_add_u32 s59, s56, 2654464
    buffer_load_dwordx4 v2, s[8:11], s59 offen lds
    s_add_u32 m0, s61, 66560
    s_add_u32 s59, s56, 2663680
    buffer_load_dwordx4 v2, s[8:11], s59 offen lds
    s_add_u32 m0, s61, 73728
    s_add_u32 s59, s56, 3981312
    buffer_load_dwordx4 v2, s[8:11], s59 offen lds
    s_add_u32 m0, s61, 74752
    s_add_u32 s59, s56, 3990528
    buffer_load_dwordx4 v2, s[8:11], s59 offen lds
    s_add_u32 m0, s61, 81920
    s_add_u32 s59, s56, 3981440
    buffer_load_dwordx4 v2, s[8:11], s59 offen lds
    s_add_u32 m0, s61, 82944
    s_add_u32 s59, s56, 3990656
    buffer_load_dwordx4 v2, s[8:11], s59 offen lds
    s_add_u32 m0, s61, 90112
    s_add_u32 s59, s56, 3981568
    buffer_load_dwordx4 v2, s[8:11], s59 offen lds
    s_add_u32 m0, s61, 91136
    s_add_u32 s59, s56, 3990784
    buffer_load_dwordx4 v2, s[8:11], s59 offen lds
    s_waitcnt vmcnt(24)
    buffer_atomic_add v233, v232, s[20:23], s100 offen sc1
    s_mov_b32 s70, 0
K3_HPS:
    buffer_load_dword v253, v254, s[20:23], s29 offen sc0 sc1
    s_waitcnt vmcnt(0)
    v_cmp_gt_u32 vcc, 8, v253
    s_add_u32 s70, s70, 1
    s_nop 4
    s_cbranch_vccz K3_HGS
    s_sleep 2
    s_cmp_lt_u32 s70, 200000
    s_cbranch_scc1 K3_HPS
K3_HGS:
    v_lshrrev_b32 v245, 4, v0
    v_cvt_f32_u32 v245, v245
    s_add_u32 s62, s64, 0
    buffer_load_dwordx4 v[16:19], v1, s[20:23], s62 offen offset:0 sc1
    s_add_u32 s62, s64, 0
    buffer_load_dwordx4 v[20:23], v1, s[20:23], s62 offen offset:1024 sc1
    s_add_u32 s62, s64, 0
    buffer_load_dwordx4 v[24:27], v1, s[20:23], s62 offen offset:2048 sc1
    s_add_u32 s62, s64, 0
    buffer_load_dwordx4 v[28:31], v1, s[20:23], s62 offen offset:3072 sc1
    s_add_u32 s62, s64, 73728
    buffer_load_dwordx4 v[32:35], v1, s[20:23], s62 offen offset:0 sc1
    s_add_u32 s62, s64, 73728
    buffer_load_dwordx4 v[36:39], v1, s[20:23], s62 offen offset:1024 sc1
    s_add_u32 s62, s64, 73728
    buffer_load_dwordx4 v[40:43], v1, s[20:23], s62 offen offset:2048 sc1
    s_add_u32 s62, s64, 73728
    buffer_load_dwordx4 v[44:47], v1, s[20:23], s62 offen offset:3072 sc1
    s_barrier
    ds_read_b64_tr_b16 v[144:145], v4 offset:0
    ds_read_b64_tr_b16 v[146:147], v4 offset:512
    ds_read_b64_tr_b16 v[148:149], v5 offset:0
    ds_read_b64_tr_b16 v[150:151], v5 offset:512
    ds_read_b64_tr_b16 v[152:153], v6 offset:0
    ds_read_b64_tr_b16 v[154:155], v6 offset:512
    ds_read_b64_tr_b16 v[156:157], v7 offset:0
    ds_read_b64_tr_b16 v[158:159], v7 offset:512
    ds_read_b64_tr_b16 v[160:161], v8 offset:0
    ds_read_b64_tr_b16 v[162:163], v8 offset:512
    ds_read_b64_tr_b16 v[164:165], v9 offset:0
    ds_read_b64_tr_b16 v[166:167], v9 offset:512
    s_waitcnt vmcnt(7) lgkmcnt(10)
    v_mfma_f32_32x32x16_bf16 v[48:63], v[144:147], v[16:19], 0
    ds_read_b64_tr_b16 v[168:169], v4 offset:2048
    ds_read_b64_tr_b16 v[170:171], v4 offset:2560
    s_add_u32 s62, s64, 147456
    buffer_load_dwordx4 a[0:3], v1, s[20:23], s62 offen offset:0 sc1
    s_waitcnt lgkmcnt(10)
    v_mfma_f32_32x32x16_bf16 v[64:79], v[148:151], v[16:19], 0
    ds_read_b64_tr_b16 v[172:173], v5 offset:2048
    ds_read_b64_tr_b16 v[174:175], v5 offset:2560
    s_waitcnt lgkmcnt(10)
    v_mfma_f32_32x32x16_bf16 v[80:95], v[152:155], v[16:19], 0
    ds_read_b64_tr_b16 v[144:145], v6 offset:2048
    ds_read_b64_tr_b16 v[146:147], v6 offset:2560
    s_add_u32 s62, s64, 147456
    buffer_load_dwordx4 a[4:7], v1, s[20:23], s62 offen offset:1024 sc1
    s_waitcnt lgkmcnt(10)
    v_mfma_f32_32x32x16_bf16 v[96:111], v[156:159], v[16:19], 0
    ds_read_b64_tr_b16 v[148:149], v7 offset:2048
    ds_read_b64_tr_b16 v[150:151], v7 offset:2560
    s_waitcnt lgkmcnt(10)
    v_mfma_f32_32x32x16_bf16 v[112:127], v[160:163], v[16:19], 0
    ds_read_b64_tr_b16 v[152:153], v8 offset:2048
    ds_read_b64_tr_b16 v[154:155], v8 offset:2560
    s_add_u32 s62, s64, 147456
    buffer_load_dwordx4 a[8:11], v1, s[20:23], s62 offen offset:2048 sc1
    s_waitcnt lgkmcnt(10)
    v_mfma_f32_32x32x16_bf16 v[128:143], v[164:167], v[16:19], 0
    ds_read_b64_tr_b16 v[156:157], v9 offset:2048
    ds_read_b64_tr_b16 v[158:159], v9 offset:2560
    s_waitcnt vmcnt(9) lgkmcnt(10)
    v_mfma_f32_32x32x16_bf16 v[48:63], v[168:171], v[20:23], v[48:63]
    ds_read_b64_tr_b16 v[160:161], v4 offset:4096
    ds_read_b64_tr_b16 v[162:163], v4 offset:4608
    s_waitcnt lgkmcnt(10)
    v_mfma_f32_32x32x16_bf16 v[64:79], v[172:175], v[20:23], v[64:79]
    ds_read_b64_tr_b16 v[164:165], v5 offset:4096
    ds_read_b64_tr_b16 v[166:167], v5 offset:4608
    s_add_u32 s62, s64, 147456
    buffer_load_dwordx4 a[12:15], v1, s[20:23], s62 offen offset:3072 sc1
    s_waitcnt lgkmcnt(10)
    v_mfma_f32_32x32x16_bf16 v[80:95], v[144:147], v[20:23], v[80:95]
    ds_read_b64_tr_b16 v[168:169], v6 offset:4096
    ds_read_b64_tr_b16 v[170:171], v6 offset:4608
    s_waitcnt lgkmcnt(10)
    v_mfma_f32_32x32x16_bf16 v[96:111], v[148:151], v[20:23], v[96:111]
    ds_read_b64_tr_b16 v[172:173], v7 offset:4096
    ds_read_b64_tr_b16 v[174:175], v7 offset:4608
    s_add_u32 s62, s64, 221184
    buffer_load_dwordx4 a[16:19], v1, s[20:23], s62 offen offset:0 sc1
    s_waitcnt lgkmcnt(10)
    v_mfma_f32_32x32x16_bf16 v[112:127], v[152:155], v[20:23], v[112:127]
    ds_read_b64_tr_b16 v[144:145], v8 offset:4096
    ds_read_b64_tr_b16 v[146:147], v8 offset:4608
    s_waitcnt lgkmcnt(10)
    v_mfma_f32_32x32x16_bf16 v[128:143], v[156:159], v[20:23], v[128:143]
    ds_read_b64_tr_b16 v[148:149], v9 offset:4096
    ds_read_b64_tr_b16 v[150:151], v9 offset:4608
    s_add_u32 s62, s64, 221184
    buffer_load_dwordx4 a[20:23], v1, s[20:23], s62 offen offset:1024 sc1
    s_waitcnt vmcnt(11) lgkmcnt(10)
    v_mfma_f32_32x32x16_bf16 v[48:63], v[160:163], v[24:27], v[48:63]
    ds_read_b64_tr_b16 v[152:153], v4 offset:6144
    ds_read_b64_tr_b16 v[154:155], v4 offset:6656
    s_waitcnt lgkmcnt(10)
    v_mfma_f32_32x32x16_bf16 v[64:79], v[164:167], v[24:27], v[64:79]
    ds_read_b64_tr_b16 v[156:157], v5 offset:6144
    ds_read_b64_tr_b16 v[158:159], v5 offset:6656
    s_waitcnt lgkmcnt(10)
    v_mfma_f32_32x32x16_bf16 v[80:95], v[168:171], v[24:27], v[80:95]
    ds_read_b64_tr_b16 v[160:161], v6 offset:6144
    ds_read_b64_tr_b16 v[162:163], v6 offset:6656
    s_add_u32 s62, s64, 221184
    buffer_load_dwordx4 a[24:27], v1, s[20:23], s62 offen offset:2048 sc1
    s_waitcnt lgkmcnt(10)
    v_mfma_f32_32x32x16_bf16 v[96:111], v[172:175], v[24:27], v[96:111]
    ds_read_b64_tr_b16 v[164:165], v7 offset:6144
    ds_read_b64_tr_b16 v[166:167], v7 offset:6656
    s_waitcnt lgkmcnt(10)
    v_mfma_f32_32x32x16_bf16 v[112:127], v[144:147], v[24:27], v[112:127]
    ds_read_b64_tr_b16 v[168:169], v8 offset:6144
    ds_read_b64_tr_b16 v[170:171], v8 offset:6656
    s_add_u32 s62, s64, 221184
    buffer_load_dwordx4 a[28:31], v1, s[20:23], s62 offen offset:3072 sc1
    s_waitcnt lgkmcnt(10)
    v_mfma_f32_32x32x16_bf16 v[128:143], v[148:151], v[24:27], v[128:143]
    ds_read_b64_tr_b16 v[172:173], v9 offset:6144
    ds_read_b64_tr_b16 v[174:175], v9 offset:6656
    s_waitcnt vmcnt(12) lgkmcnt(10)
    v_mfma_f32_32x32x16_bf16 v[48:63], v[152:155], v[28:31], v[48:63]
    s_barrier
    ds_read_b64_tr_b16 v[144:145], v4 offset:24576
    ds_read_b64_tr_b16 v[146:147], v4 offset:25088
    s_add_u32 m0, s61, 98304
    s_add_u32 s59, s56, 147456
    buffer_load_dwordx4 v2, s[8:11], s59 offen lds
    s_waitcnt lgkmcnt(10)
    v_mfma_f32_32x32x16_bf16 v[64:79], v[156:159], v[28:31], v[64:79]
    ds_read_b64_tr_b16 v[148:149], v5 offset:24576
    ds_read_b64_tr_b16 v[150:151], v5 offset:25088
    s_waitcnt lgkmcnt(10)
    v_mfma_f32_32x32x16_bf16 v[80:95], v[160:163], v[28:31], v[80:95]
    ds_read_b64_tr_b16 v[152:153], v6 offset:24576
    ds_read_b64_tr_b16 v[154:155], v6 offset:25088
    s_waitcnt lgkmcnt(10)
    v_mfma_f32_32x32x16_bf16 v[96:111], v[164:167], v[28:31], v[96:111]
    ds_read_b64_tr_b16 v[156:157], v7 offset:24576
    ds_read_b64_tr_b16 v[158:159], v7 offset:25088
    s_add_u32 m0, s61, 99328
    s_add_u32 s59, s56, 156672
    buffer_load_dwordx4 v2, s[8:11], s59 offen lds
    s_waitcnt lgkmcnt(10)
    v_mfma_f32_32x32x16_bf16 v[112:127], v[168:171], v[28:31], v[112:127]
    ds_read_b64_tr_b16 v[160:161], v8 offset:24576
    ds_read_b64_tr_b16 v[162:163], v8 offset:25088
    s_waitcnt lgkmcnt(10)
    v_mfma_f32_32x32x16_bf16 v[128:143], v[172:175], v[28:31], v[128:143]
    ds_read_b64_tr_b16 v[164:165], v9 offset:24576
    ds_read_b64_tr_b16 v[166:167], v9 offset:25088
    s_add_u32 m0, s61, 106496
    s_add_u32 s59, s56, 147584
    buffer_load_dwordx4 v2, s[8:11], s59 offen lds
    s_waitcnt vmcnt(14) lgkmcnt(10)
    v_mfma_f32_32x32x16_bf16 v[48:63], v[144:147], v[32:35], v[48:63]
    ds_read_b64_tr_b16 v[168:169], v4 offset:26624
    ds_read_b64_tr_b16 v[170:171], v4 offset:27136
    s_waitcnt lgkmcnt(10)
    v_mfma_f32_32x32x16_bf16 v[64:79], v[148:151], v[32:35], v[64:79]
    ds_read_b64_tr_b16 v[172:173], v5 offset:26624
    ds_read_b64_tr_b16 v[174:175], v5 offset:27136
    s_add_u32 m0, s61, 107520
    s_add_u32 s59, s56, 156800
    buffer_load_dwordx4 v2, s[8:11], s59 offen lds
    s_waitcnt lgkmcnt(10)
    v_mfma_f32_32x32x16_bf16 v[80:95], v[152:155], v[32:35], v[80:95]
    ds_read_b64_tr_b16 v[144:145], v6 offset:26624
    ds_read_b64_tr_b16 v[146:147], v6 offset:27136
    s_waitcnt lgkmcnt(10)
    v_mfma_f32_32x32x16_bf16 v[96:111], v[156:159], v[32:35], v[96:111]
    ds_read_b64_tr_b16 v[148:149], v7 offset:26624
    ds_read_b64_tr_b16 v[150:151], v7 offset:27136
    s_waitcnt lgkmcnt(10)
    v_mfma_f32_32x32x16_bf16 v[112:127], v[160:163], v[32:35], v[112:127]
    ds_read_b64_tr_b16 v[152:153], v8 offset:26624
    ds_read_b64_tr_b16 v[154:155], v8 offset:27136
    s_add_u32 m0, s61, 114688
    s_add_u32 s59, s56, 147712
    buffer_load_dwordx4 v2, s[8:11], s59 offen lds
    s_waitcnt lgkmcnt(10)
    v_mfma_f32_32x32x16_bf16 v[128:143], v[164:167], v[32:35], v[128:143]
    ds_read_b64_tr_b16 v[156:157], v9 offset:26624
    ds_read_b64_tr_b16 v[158:159], v9 offset:27136
    s_waitcnt vmcnt(15) lgkmcnt(10)
    v_mfma_f32_32x32x16_bf16 v[48:63], v[168:171], v[36:39], v[48:63]
    ds_read_b64_tr_b16 v[160:161], v4 offset:28672
    ds_read_b64_tr_b16 v[162:163], v4 offset:29184
    s_add_u32 m0, s61, 115712
    s_add_u32 s59, s56, 156928
    buffer_load_dwordx4 v2, s[8:11], s59 offen lds
    s_waitcnt lgkmcnt(10)
    v_mfma_f32_32x32x16_bf16 v[64:79], v[172:175], v[36:39], v[64:79]
    ds_read_b64_tr_b16 v[164:165], v5 offset:28672
    ds_read_b64_tr_b16 v[166:167], v5 offset:29184
    s_waitcnt lgkmcnt(10)
    v_mfma_f32_32x32x16_bf16 v[80:95], v[144:147], v[36:39], v[80:95]
    ds_read_b64_tr_b16 v[168:169], v6 offset:28672
    ds_read_b64_tr_b16 v[170:171], v6 offset:29184
    s_add_u32 s62, s64, 8192
    buffer_load_dwordx4 a[32:35], v1, s[20:23], s62 offen offset:0 sc1
    s_waitcnt lgkmcnt(10)
    v_mfma_f32_32x32x16_bf16 v[96:111], v[148:151], v[36:39], v[96:111]
    ds_read_b64_tr_b16 v[172:173], v7 offset:28672
    ds_read_b64_tr_b16 v[174:175], v7 offset:29184
    s_waitcnt lgkmcnt(10)
    v_mfma_f32_32x32x16_bf16 v[112:127], v[152:155], v[36:39], v[112:127]
    ds_read_b64_tr_b16 v[144:145], v8 offset:28672
    ds_read_b64_tr_b16 v[146:147], v8 offset:29184
    s_waitcnt lgkmcnt(10)
    v_mfma_f32_32x32x16_bf16 v[128:143], v[156:159], v[36:39], v[128:143]
    ds_read_b64_tr_b16 v[148:149], v9 offset:28672
    ds_read_b64_tr_b16 v[150:151], v9 offset:29184
    s_add_u32 s62, s64, 8192
    buffer_load_dwordx4 a[36:39], v1, s[20:23], s62 offen offset:1024 sc1
    s_waitcnt vmcnt(17) lgkmcnt(10)
    v_mfma_f32_32x32x16_bf16 v[48:63], v[160:163], v[40:43], v[48:63]
    ds_read_b64_tr_b16 v[152:153], v4 offset:30720
    ds_read_b64_tr_b16 v[154:155], v4 offset:31232
    s_waitcnt lgkmcnt(10)
    v_mfma_f32_32x32x16_bf16 v[64:79], v[164:167], v[40:43], v[64:79]
    ds_read_b64_tr_b16 v[156:157], v5 offset:30720
    ds_read_b64_tr_b16 v[158:159], v5 offset:31232
    s_add_u32 s62, s64, 8192
    buffer_load_dwordx4 a[40:43], v1, s[20:23], s62 offen offset:2048 sc1
    s_waitcnt lgkmcnt(10)
    v_mfma_f32_32x32x16_bf16 v[80:95], v[168:171], v[40:43], v[80:95]
    ds_read_b64_tr_b16 v[160:161], v6 offset:30720
    ds_read_b64_tr_b16 v[162:163], v6 offset:31232
    s_waitcnt lgkmcnt(10)
    v_mfma_f32_32x32x16_bf16 v[96:111], v[172:175], v[40:43], v[96:111]
    ds_read_b64_tr_b16 v[164:165], v7 offset:30720
    ds_read_b64_tr_b16 v[166:167], v7 offset:31232
    s_waitcnt lgkmcnt(10)
    v_mfma_f32_32x32x16_bf16 v[112:127], v[144:147], v[40:43], v[112:127]
    ds_read_b64_tr_b16 v[168:169], v8 offset:30720
    ds_read_b64_tr_b16 v[170:171], v8 offset:31232
    s_add_u32 s62, s64, 8192
    buffer_load_dwordx4 a[44:47], v1, s[20:23], s62 offen offset:3072 sc1
    s_waitcnt lgkmcnt(10)
    v_mfma_f32_32x32x16_bf16 v[128:143], v[148:151], v[40:43], v[128:143]
    ds_read_b64_tr_b16 v[172:173], v9 offset:30720
    ds_read_b64_tr_b16 v[174:175], v9 offset:31232
    s_waitcnt vmcnt(18) lgkmcnt(10)
    v_mfma_f32_32x32x16_bf16 v[48:63], v[152:155], v[44:47], v[48:63]
    s_barrier
    v_add_u32 v4, 49152, v4
    v_add_u32 v5, 49152, v5
    v_add_u32 v6, 49152, v6
    v_add_u32 v7, 49152, v7
    v_add_u32 v8, 49152, v8
    v_add_u32 v9, 49152, v9
    ds_read_b64_tr_b16 v[144:145], v4 offset:0
    ds_read_b64_tr_b16 v[146:147], v4 offset:512
    s_add_u32 m0, s61, 122880
    s_add_u32 s59, s56, 1474560
    buffer_load_dwordx4 v2, s[8:11], s59 offen lds
    s_waitcnt lgkmcnt(10)
    v_mfma_f32_32x32x16_bf16 v[64:79], v[156:159], v[44:47], v[64:79]
    ds_read_b64_tr_b16 v[148:149], v5 offset:0
    ds_read_b64_tr_b16 v[150:151], v5 offset:512
    s_waitcnt lgkmcnt(10)
    v_mfma_f32_32x32x16_bf16 v[80:95], v[160:163], v[44:47], v[80:95]
    ds_read_b64_tr_b16 v[152:153], v6 offset:0
    ds_read_b64_tr_b16 v[154:155], v6 offset:512
    s_add_u32 m0, s61, 123904
    s_add_u32 s59, s56, 1483776
    buffer_load_dwordx4 v2, s[8:11], s59 offen lds
    s_waitcnt lgkmcnt(10)
    v_mfma_f32_32x32x16_bf16 v[96:111], v[164:167], v[44:47], v[96:111]
    ds_read_b64_tr_b16 v[156:157], v7 offset:0
    ds_read_b64_tr_b16 v[158:159], v7 offset:512
    s_waitcnt lgkmcnt(10)
    v_mfma_f32_32x32x16_bf16 v[112:127], v[168:171], v[44:47], v[112:127]
    ds_read_b64_tr_b16 v[160:161], v8 offset:0
    ds_read_b64_tr_b16 v[162:163], v8 offset:512
    s_waitcnt lgkmcnt(10)
    v_mfma_f32_32x32x16_bf16 v[128:143], v[172:175], v[44:47], v[128:143]
    ds_read_b64_tr_b16 v[164:165], v9 offset:0
    ds_read_b64_tr_b16 v[166:167], v9 offset:512
    s_add_u32 m0, s61, 131072
    s_add_u32 s59, s56, 1474688
    buffer_load_dwordx4 v2, s[8:11], s59 offen lds
    s_waitcnt vmcnt(20) lgkmcnt(10)
    v_mfma_f32_32x32x16_bf16 v[48:63], v[144:147], a[0:3], v[48:63]
    ds_read_b64_tr_b16 v[168:169], v4 offset:2048
    ds_read_b64_tr_b16 v[170:171], v4 offset:2560
    s_waitcnt lgkmcnt(10)
    v_mfma_f32_32x32x16_bf16 v[64:79], v[148:151], a[0:3], v[64:79]
    ds_read_b64_tr_b16 v[172:173], v5 offset:2048
    ds_read_b64_tr_b16 v[174:175], v5 offset:2560
    s_add_u32 m0, s61, 132096
    s_add_u32 s59, s56, 1483904
    buffer_load_dwordx4 v2, s[8:11], s59 offen lds
    s_waitcnt lgkmcnt(10)
    v_mfma_f32_32x32x16_bf16 v[80:95], v[152:155], a[0:3], v[80:95]
    ds_read_b64_tr_b16 v[144:145], v6 offset:2048
    ds_read_b64_tr_b16 v[146:147], v6 offset:2560
    s_waitcnt lgkmcnt(10)
    v_mfma_f32_32x32x16_bf16 v[96:111], v[156:159], a[0:3], v[96:111]
    ds_read_b64_tr_b16 v[148:149], v7 offset:2048
    ds_read_b64_tr_b16 v[150:151], v7 offset:2560
    s_add_u32 m0, s61, 139264
    s_add_u32 s59, s56, 1474816
    buffer_load_dwordx4 v2, s[8:11], s59 offen lds
    s_waitcnt lgkmcnt(10)
    v_mfma_f32_32x32x16_bf16 v[112:127], v[160:163], a[0:3], v[112:127]
    ds_read_b64_tr_b16 v[152:153], v8 offset:2048
    ds_read_b64_tr_b16 v[154:155], v8 offset:2560
    v_lshrrev_b32 v228, 4, v0
    v_lshlrev_b32 v228, 3, v228
    v_sub_u32 v228, s49, v228
    s_waitcnt lgkmcnt(10)
    v_mfma_f32_32x32x16_bf16 v[128:143], v[164:167], a[0:3], v[128:143]
    ds_read_b64_tr_b16 v[156:157], v9 offset:2048
    ds_read_b64_tr_b16 v[158:159], v9 offset:2560
    v_and_b32 v229, 15, v0
    v_lshlrev_b32 v229, 4, v229
    v_lshrrev_b32 v244, 4, v0
    s_waitcnt vmcnt(21) lgkmcnt(10)
    v_mfma_f32_32x32x16_bf16 v[48:63], v[168:171], a[4:7], v[48:63]
    ds_read_b64_tr_b16 v[160:161], v4 offset:4096
    ds_read_b64_tr_b16 v[162:163], v4 offset:4608
    s_add_u32 m0, s61, 140288
    s_add_u32 s59, s56, 1484032
    buffer_load_dwordx4 v2, s[8:11], s59 offen lds
    v_lshlrev_b32 v244, 11, v244
    s_waitcnt lgkmcnt(10)
    v_mfma_f32_32x32x16_bf16 v[64:79], v[172:175], a[4:7], v[64:79]
    ds_read_b64_tr_b16 v[164:165], v5 offset:4096
    ds_read_b64_tr_b16 v[166:167], v5 offset:4608
    v_sub_u32 v244, v229, v244
    v_add_u32 v244, s48, v244
    s_waitcnt lgkmcnt(10)
    v_mfma_f32_32x32x16_bf16 v[80:95], v[144:147], a[4:7], v[80:95]
    ds_read_b64_tr_b16 v[168:169], v6 offset:4096
    ds_read_b64_tr_b16 v[170:171], v6 offset:4608
    s_add_u32 s62, s64, 81920
    buffer_load_dwordx4 a[48:51], v1, s[20:23], s62 offen offset:0 sc1
    v_mov_b32 v229, 50659328
    v_cmp_lt_i32 vcc, 0, v228
    s_waitcnt lgkmcnt(10)
    v_mfma_f32_32x32x16_bf16 v[96:111], v[148:151], a[4:7], v[96:111]
    ds_read_b64_tr_b16 v[172:173], v7 offset:4096
    ds_read_b64_tr_b16 v[174:175], v7 offset:4608
    v_add_u32 v246, 4294967040, v244
    v_cndmask_b32 v246, v229, v246, vcc
    buffer_load_dwordx4 v[16:19], v246, s[20:23], 0 offen sc0 sc1
    s_waitcnt lgkmcnt(10)
    v_mfma_f32_32x32x16_bf16 v[112:127], v[152:155], a[4:7], v[112:127]
    ds_read_b64_tr_b16 v[144:145], v8 offset:4096
    ds_read_b64_tr_b16 v[146:147], v8 offset:4608
    s_add_u32 s62, s64, 81920
    buffer_load_dwordx4 a[52:55], v1, s[20:23], s62 offen offset:1024 sc1
    v_cmp_lt_i32 vcc, 1, v228
    s_waitcnt lgkmcnt(10)
    v_mfma_f32_32x32x16_bf16 v[128:143], v[156:159], a[4:7], v[128:143]
    ds_read_b64_tr_b16 v[148:149], v9 offset:4096
    ds_read_b64_tr_b16 v[150:151], v9 offset:4608
    v_add_u32 v246, 4294966784, v244
    v_cndmask_b32 v246, v229, v246, vcc
    buffer_load_dwordx4 v[20:23], v246, s[20:23], 0 offen sc0 sc1
    s_waitcnt vmcnt(25) lgkmcnt(10)
    v_mfma_f32_32x32x16_bf16 v[48:63], v[160:163], a[8:11], v[48:63]
    ds_read_b64_tr_b16 v[152:153], v4 offset:6144
    ds_read_b64_tr_b16 v[154:155], v4 offset:6656
    v_cmp_lt_i32 vcc, 2, v228
    v_add_u32 v246, 4294966528, v244
    s_nop 0
    v_cndmask_b32 v246, v229, v246, vcc
    s_waitcnt lgkmcnt(10)
    v_mfma_f32_32x32x16_bf16 v[64:79], v[164:167], a[8:11], v[64:79]
    ds_read_b64_tr_b16 v[156:157], v5 offset:6144
    ds_read_b64_tr_b16 v[158:159], v5 offset:6656
    s_add_u32 s62, s64, 81920
    buffer_load_dwordx4 a[56:59], v1, s[20:23], s62 offen offset:2048 sc1
    buffer_load_dwordx4 v[24:27], v246, s[20:23], 0 offen sc0 sc1
    s_waitcnt lgkmcnt(10)
    v_mfma_f32_32x32x16_bf16 v[80:95], v[168:171], a[8:11], v[80:95]
    ds_read_b64_tr_b16 v[160:161], v6 offset:6144
    ds_read_b64_tr_b16 v[162:163], v6 offset:6656
    v_cmp_lt_i32 vcc, 3, v228
    v_add_u32 v246, 4294966272, v244
    s_nop 0
    v_cndmask_b32 v246, v229, v246, vcc
    s_waitcnt lgkmcnt(10)
    v_mfma_f32_32x32x16_bf16 v[96:111], v[172:175], a[8:11], v[96:111]
    ds_read_b64_tr_b16 v[164:165], v7 offset:6144
    ds_read_b64_tr_b16 v[166:167], v7 offset:6656
    s_add_u32 s62, s64, 81920
    buffer_load_dwordx4 a[60:63], v1, s[20:23], s62 offen offset:3072 sc1
    buffer_load_dwordx4 v[28:31], v246, s[20:23], 0 offen sc0 sc1
    v_cmp_lt_i32 vcc, 4, v228
    s_waitcnt lgkmcnt(10)
    v_mfma_f32_32x32x16_bf16 v[112:127], v[144:147], a[8:11], v[112:127]
    ds_read_b64_tr_b16 v[168:169], v8 offset:6144
    ds_read_b64_tr_b16 v[170:171], v8 offset:6656
    v_add_u32 v246, 4294966016, v244
    v_cndmask_b32 v246, v229, v246, vcc
    buffer_load_dwordx4 v[32:35], v246, s[20:23], 0 offen sc0 sc1
    s_waitcnt lgkmcnt(10)
    v_mfma_f32_32x32x16_bf16 v[128:143], v[148:151], a[8:11], v[128:143]
    ds_read_b64_tr_b16 v[172:173], v9 offset:6144
    ds_read_b64_tr_b16 v[174:175], v9 offset:6656
    s_add_u32 m0, s61, 0
    s_add_u32 s59, s56, 2801664
    buffer_load_dwordx4 v2, s[8:11], s59 offen lds
    s_waitcnt vmcnt(30) lgkmcnt(10)
    v_mfma_f32_32x32x16_bf16 v[48:63], v[152:155], a[12:15], v[48:63]
    s_barrier
    ds_read_b64_tr_b16 v[144:145], v4 offset:24576
    ds_read_b64_tr_b16 v[146:147], v4 offset:25088
    v_cmp_lt_i32 vcc, 5, v228
    v_add_u32 v246, 4294965760, v244
    s_waitcnt lgkmcnt(10)
    v_mfma_f32_32x32x16_bf16 v[64:79], v[156:159], a[12:15], v[64:79]
    ds_read_b64_tr_b16 v[148:149], v5 offset:24576
    ds_read_b64_tr_b16 v[150:151], v5 offset:25088
    v_cndmask_b32 v246, v229, v246, vcc
    buffer_load_dwordx4 v[36:39], v246, s[20:23], 0 offen sc0 sc1
    v_cmp_lt_i32 vcc, 6, v228
    s_waitcnt lgkmcnt(10)
    v_mfma_f32_32x32x16_bf16 v[80:95], v[160:163], a[12:15], v[80:95]
    ds_read_b64_tr_b16 v[152:153], v6 offset:24576
    ds_read_b64_tr_b16 v[154:155], v6 offset:25088
    s_add_u32 m0, s61, 1024
    s_add_u32 s59, s56, 2810880
    buffer_load_dwordx4 v2, s[8:11], s59 offen lds
    s_waitcnt lgkmcnt(10)
    v_mfma_f32_32x32x16_bf16 v[96:111], v[164:167], a[12:15], v[96:111]
    ds_read_b64_tr_b16 v[156:157], v7 offset:24576
    ds_read_b64_tr_b16 v[158:159], v7 offset:25088
    v_add_u32 v246, 4294965504, v244
    v_cndmask_b32 v246, v229, v246, vcc
    buffer_load_dwordx4 v[40:43], v246, s[20:23], 0 offen sc0 sc1
    s_waitcnt lgkmcnt(10)
    v_mfma_f32_32x32x16_bf16 v[112:127], v[168:171], a[12:15], v[112:127]
    ds_read_b64_tr_b16 v[160:161], v8 offset:24576
    ds_read_b64_tr_b16 v[162:163], v8 offset:25088
    s_add_u32 m0, s61, 8192
    s_add_u32 s59, s56, 2801792
    buffer_load_dwordx4 v2, s[8:11], s59 offen lds
    v_cmp_lt_i32 vcc, 7, v228
    s_waitcnt lgkmcnt(10)
    v_mfma_f32_32x32x16_bf16 v[128:143], v[172:175], a[12:15], v[128:143]
    ds_read_b64_tr_b16 v[164:165], v9 offset:24576
    ds_read_b64_tr_b16 v[166:167], v9 offset:25088
    v_add_u32 v246, 4294965248, v244
    v_cndmask_b32 v246, v229, v246, vcc
    buffer_load_dwordx4 v[44:47], v246, s[20:23], 0 offen sc0 sc1
    s_waitcnt vmcnt(34) lgkmcnt(10)
    v_mfma_f32_32x32x16_bf16 v[48:63], v[144:147], a[16:19], v[48:63]
    ds_read_b64_tr_b16 v[168:169], v4 offset:26624
    ds_read_b64_tr_b16 v[170:171], v4 offset:27136
    s_add_u32 m0, s61, 9216
    s_add_u32 s59, s56, 2811008
    buffer_load_dwordx4 v2, s[8:11], s59 offen lds
    s_waitcnt lgkmcnt(10)
    v_mfma_f32_32x32x16_bf16 v[64:79], v[148:151], a[16:19], v[64:79]
    ds_read_b64_tr_b16 v[172:173], v5 offset:26624
    ds_read_b64_tr_b16 v[174:175], v5 offset:27136
    s_waitcnt lgkmcnt(10)
    v_mfma_f32_32x32x16_bf16 v[80:95], v[152:155], a[16:19], v[80:95]
    ds_read_b64_tr_b16 v[144:145], v6 offset:26624
    ds_read_b64_tr_b16 v[146:147], v6 offset:27136
    s_waitcnt lgkmcnt(10)
    v_mfma_f32_32x32x16_bf16 v[96:111], v[156:159], a[16:19], v[96:111]
    ds_read_b64_tr_b16 v[148:149], v7 offset:26624
    ds_read_b64_tr_b16 v[150:151], v7 offset:27136
    s_add_u32 m0, s61, 16384
    s_add_u32 s59, s56, 2801920
    buffer_load_dwordx4 v2, s[8:11], s59 offen lds
    s_waitcnt lgkmcnt(10)
    v_mfma_f32_32x32x16_bf16 v[112:127], v[160:163], a[16:19], v[112:127]
    ds_read_b64_tr_b16 v[152:153], v8 offset:26624
    ds_read_b64_tr_b16 v[154:155], v8 offset:27136
    s_waitcnt lgkmcnt(10)
    v_mfma_f32_32x32x16_bf16 v[128:143], v[164:167], a[16:19], v[128:143]
    ds_read_b64_tr_b16 v[156:157], v9 offset:26624
    ds_read_b64_tr_b16 v[158:159], v9 offset:27136
    s_add_u32 m0, s61, 17408
    s_add_u32 s59, s56, 2811136
    buffer_load_dwordx4 v2, s[8:11], s59 offen lds
    s_waitcnt vmcnt(36) lgkmcnt(10)
    v_mfma_f32_32x32x16_bf16 v[48:63], v[168:171], a[20:23], v[48:63]
    ds_read_b64_tr_b16 v[160:161], v4 offset:28672
    ds_read_b64_tr_b16 v[162:163], v4 offset:29184
    s_waitcnt lgkmcnt(10)
    v_mfma_f32_32x32x16_bf16 v[64:79], v[172:175], a[20:23], v[64:79]
    ds_read_b64_tr_b16 v[164:165], v5 offset:28672
    ds_read_b64_tr_b16 v[166:167], v5 offset:29184
    s_waitcnt lgkmcnt(10)
    v_mfma_f32_32x32x16_bf16 v[80:95], v[144:147], a[20:23], v[80:95]
    ds_read_b64_tr_b16 v[168:169], v6 offset:28672
    ds_read_b64_tr_b16 v[170:171], v6 offset:29184
    s_add_u32 s62, s64, 155648
    buffer_load_dwordx4 a[64:67], v1, s[20:23], s62 offen offset:0 sc1
    s_waitcnt lgkmcnt(10)
    v_mfma_f32_32x32x16_bf16 v[96:111], v[148:151], a[20:23], v[96:111]
    ds_read_b64_tr_b16 v[172:173], v7 offset:28672
    ds_read_b64_tr_b16 v[174:175], v7 offset:29184
    s_waitcnt lgkmcnt(10)
    v_mfma_f32_32x32x16_bf16 v[112:127], v[152:155], a[20:23], v[112:127]
    ds_read_b64_tr_b16 v[144:145], v8 offset:28672
    ds_read_b64_tr_b16 v[146:147], v8 offset:29184
    s_add_u32 s62, s64, 155648
    buffer_load_dwordx4 a[68:71], v1, s[20:23], s62 offen offset:1024 sc1
    s_waitcnt lgkmcnt(10)
    v_mfma_f32_32x32x16_bf16 v[128:143], v[156:159], a[20:23], v[128:143]
    ds_read_b64_tr_b16 v[148:149], v9 offset:28672
    ds_read_b64_tr_b16 v[150:151], v9 offset:29184
    s_waitcnt vmcnt(37) lgkmcnt(10)
    v_mfma_f32_32x32x16_bf16 v[48:63], v[160:163], a[24:27], v[48:63]
    ds_read_b64_tr_b16 v[152:153], v4 offset:30720
    ds_read_b64_tr_b16 v[154:155], v4 offset:31232
    s_add_u32 s62, s64, 155648
    buffer_load_dwordx4 a[72:75], v1, s[20:23], s62 offen offset:2048 sc1
    s_waitcnt lgkmcnt(10)
    v_mfma_f32_32x32x16_bf16 v[64:79], v[164:167], a[24:27], v[64:79]
    ds_read_b64_tr_b16 v[156:157], v5 offset:30720
    ds_read_b64_tr_b16 v[158:159], v5 offset:31232
    s_waitcnt lgkmcnt(10)
    v_mfma_f32_32x32x16_bf16 v[80:95], v[168:171], a[24:27], v[80:95]
    ds_read_b64_tr_b16 v[160:161], v6 offset:30720
    ds_read_b64_tr_b16 v[162:163], v6 offset:31232
    s_waitcnt lgkmcnt(10)
    v_mfma_f32_32x32x16_bf16 v[96:111], v[172:175], a[24:27], v[96:111]
    ds_read_b64_tr_b16 v[164:165], v7 offset:30720
    ds_read_b64_tr_b16 v[166:167], v7 offset:31232
    s_add_u32 s62, s64, 155648
    buffer_load_dwordx4 a[76:79], v1, s[20:23], s62 offen offset:3072 sc1
    s_waitcnt lgkmcnt(10)
    v_mfma_f32_32x32x16_bf16 v[112:127], v[144:147], a[24:27], v[112:127]
    ds_read_b64_tr_b16 v[168:169], v8 offset:30720
    ds_read_b64_tr_b16 v[170:171], v8 offset:31232
    s_waitcnt lgkmcnt(10)
    v_mfma_f32_32x32x16_bf16 v[128:143], v[148:151], a[24:27], v[128:143]
    ds_read_b64_tr_b16 v[172:173], v9 offset:30720
    ds_read_b64_tr_b16 v[174:175], v9 offset:31232
    s_add_u32 m0, s61, 24576
    s_add_u32 s59, s56, 4128768
    buffer_load_dwordx4 v2, s[8:11], s59 offen lds
    s_waitcnt vmcnt(39) lgkmcnt(10)
    v_mfma_f32_32x32x16_bf16 v[48:63], v[152:155], a[28:31], v[48:63]
    s_waitcnt vmcnt(33)
    s_barrier
    v_add_u32 v4, 49152, v4
    v_add_u32 v5, 49152, v5
    v_add_u32 v6, 49152, v6
    v_add_u32 v7, 49152, v7
    v_add_u32 v8, 49152, v8
    v_add_u32 v9, 49152, v9
    ds_read_b64_tr_b16 v[144:145], v4 offset:0
    ds_read_b64_tr_b16 v[146:147], v4 offset:512
    s_waitcnt lgkmcnt(10)
    v_mfma_f32_32x32x16_bf16 v[64:79], v[156:159], a[28:31], v[64:79]
    ds_read_b64_tr_b16 v[148:149], v5 offset:0
    ds_read_b64_tr_b16 v[150:151], v5 offset:512
    s_add_u32 m0, s61, 25600
    s_add_u32 s59, s56, 4137984
    buffer_load_dwordx4 v2, s[8:11], s59 offen lds
    s_waitcnt lgkmcnt(10)
    v_mfma_f32_32x32x16_bf16 v[80:95], v[160:163], a[28:31], v[80:95]
    ds_read_b64_tr_b16 v[152:153], v6 offset:0
    ds_read_b64_tr_b16 v[154:155], v6 offset:512
    s_waitcnt lgkmcnt(10)
    v_mfma_f32_32x32x16_bf16 v[96:111], v[164:167], a[28:31], v[96:111]
    ds_read_b64_tr_b16 v[156:157], v7 offset:0
    ds_read_b64_tr_b16 v[158:159], v7 offset:512
    s_waitcnt lgkmcnt(10)
    v_mfma_f32_32x32x16_bf16 v[112:127], v[168:171], a[28:31], v[112:127]
    ds_read_b64_tr_b16 v[160:161], v8 offset:0
    ds_read_b64_tr_b16 v[162:163], v8 offset:512
    s_add_u32 m0, s61, 32768
    s_add_u32 s59, s56, 4128896
    buffer_load_dwordx4 v2, s[8:11], s59 offen lds
    s_waitcnt lgkmcnt(10)
    v_mfma_f32_32x32x16_bf16 v[128:143], v[172:175], a[28:31], v[128:143]
    ds_read_b64_tr_b16 v[164:165], v9 offset:0
    ds_read_b64_tr_b16 v[166:167], v9 offset:512
    s_waitcnt vmcnt(34) lgkmcnt(10)
    v_mfma_f32_32x32x16_bf16 v[48:63], v[144:147], a[32:35], v[48:63]
    ds_read_b64_tr_b16 v[168:169], v4 offset:2048
    ds_read_b64_tr_b16 v[170:171], v4 offset:2560
    s_add_u32 m0, s61, 33792
    s_add_u32 s59, s56, 4138112
    buffer_load_dwordx4 v2, s[8:11], s59 offen lds
    s_waitcnt lgkmcnt(10)
    v_mfma_f32_32x32x16_bf16 v[64:79], v[148:151], a[32:35], v[64:79]
    ds_read_b64_tr_b16 v[172:173], v5 offset:2048
    ds_read_b64_tr_b16 v[174:175], v5 offset:2560
    s_waitcnt lgkmcnt(10)
    v_mfma_f32_32x32x16_bf16 v[80:95], v[152:155], a[32:35], v[80:95]
    ds_read_b64_tr_b16 v[144:145], v6 offset:2048
    ds_read_b64_tr_b16 v[146:147], v6 offset:2560
    s_add_u32 m0, s61, 40960
    s_add_u32 s59, s56, 4129024
    buffer_load_dwordx4 v2, s[8:11], s59 offen lds
    s_waitcnt lgkmcnt(10)
    v_mfma_f32_32x32x16_bf16 v[96:111], v[156:159], a[32:35], v[96:111]
    ds_read_b64_tr_b16 v[148:149], v7 offset:2048
    ds_read_b64_tr_b16 v[150:151], v7 offset:2560
    s_waitcnt lgkmcnt(10)
    v_mfma_f32_32x32x16_bf16 v[112:127], v[160:163], a[32:35], v[112:127]
    ds_read_b64_tr_b16 v[152:153], v8 offset:2048
    ds_read_b64_tr_b16 v[154:155], v8 offset:2560
    s_waitcnt vmcnt(25)
    v_min_f32 v246, v18, v19
    s_waitcnt vmcnt(23)
    v_min3_f32 v246, v246, v22, v23
    s_waitcnt vmcnt(21)
    v_min3_f32 v246, v246, v26, v27
    s_waitcnt vmcnt(19)
    v_min3_f32 v246, v246, v30, v31
    s_waitcnt vmcnt(18)
    v_min3_f32 v246, v246, v34, v35
    s_waitcnt lgkmcnt(10)
    v_mfma_f32_32x32x16_bf16 v[128:143], v[164:167], a[32:35], v[128:143]
    ds_read_b64_tr_b16 v[156:157], v9 offset:2048
    ds_read_b64_tr_b16 v[158:159], v9 offset:2560
    s_add_u32 m0, s61, 41984
    s_add_u32 s59, s56, 4138240
    buffer_load_dwordx4 v2, s[8:11], s59 offen lds
    s_waitcnt vmcnt(17)
    v_min3_f32 v246, v246, v38, v39
    s_waitcnt lgkmcnt(10)
    v_mfma_f32_32x32x16_bf16 v[48:63], v[168:171], a[36:39], v[48:63]
    ds_read_b64_tr_b16 v[160:161], v4 offset:4096
    ds_read_b64_tr_b16 v[162:163], v4 offset:4608
    s_waitcnt vmcnt(15)
    v_min3_f32 v246, v246, v42, v43
    s_waitcnt vmcnt(13)
    v_min3_f32 v246, v246, v46, v47
    v_cmp_gt_f32 vcc, 0.5, v246
    s_nop 4
    s_cbranch_vccnz K3SS_SLOW
    s_waitcnt lgkmcnt(10)
    v_mfma_f32_32x32x16_bf16 v[64:79], v[172:175], a[36:39], v[64:79]
    ds_read_b64_tr_b16 v[164:165], v5 offset:4096
    ds_read_b64_tr_b16 v[166:167], v5 offset:4608
    s_add_u32 s62, s64, 229376
    buffer_load_dwordx4 a[80:83], v1, s[20:23], s62 offen offset:0 sc1
K3SS_BACK:
    v_mul_f32 v228, 0x42800000, v230
    v_mul_f32 v239, 0x42800000, v231
    s_waitcnt lgkmcnt(10)
    v_mfma_f32_32x32x16_bf16 v[80:95], v[144:147], a[36:39], v[80:95]
    ds_read_b64_tr_b16 v[168:169], v6 offset:4096
    ds_read_b64_tr_b16 v[170:171], v6 offset:4608
    v_exp_f32 v228, v228
    v_fract_f32 v239, v239
    v_cos_f32 v238, v239
    s_waitcnt lgkmcnt(10)
    v_mfma_f32_32x32x16_bf16 v[96:111], v[148:151], a[36:39], v[96:111]
    ds_read_b64_tr_b16 v[172:173], v7 offset:4096
    ds_read_b64_tr_b16 v[174:175], v7 offset:4608
    s_add_u32 s62, s64, 229376
    buffer_load_dwordx4 a[84:87], v1, s[20:23], s62 offen offset:1024 sc1
    v_sin_f32 v239, v239
    s_waitcnt lgkmcnt(10)
    v_mfma_f32_32x32x16_bf16 v[112:127], v[152:155], a[36:39], v[112:127]
    ds_read_b64_tr_b16 v[144:145], v8 offset:4096
    ds_read_b64_tr_b16 v[146:147], v8 offset:4608
    v_mul_f32 v238, v228, v238
    v_mul_f32 v239, v228, v239
    v_fma_f32 v40, v238, v44, v40
    v_fma_f32 v41, v238, v45, v41
    v_fma_f32 v40, -v239, v45, v40
    s_waitcnt lgkmcnt(10)
    v_mfma_f32_32x32x16_bf16 v[128:143], v[156:159], a[36:39], v[128:143]
    ds_read_b64_tr_b16 v[148:149], v9 offset:4096
    ds_read_b64_tr_b16 v[150:151], v9 offset:4608
    v_fmac_f32 v41, v239, v44
    v_fma_f32 v36, v238, v40, v36
    v_fma_f32 v37, v238, v41, v37
    v_fma_f32 v36, -v239, v41, v36
    v_fmac_f32 v37, v239, v40
    s_waitcnt lgkmcnt(10)
    v_mfma_f32_32x32x16_bf16 v[48:63], v[160:163], a[40:43], v[48:63]
    ds_read_b64_tr_b16 v[152:153], v4 offset:6144
    ds_read_b64_tr_b16 v[154:155], v4 offset:6656
    s_add_u32 s62, s64, 229376
    buffer_load_dwordx4 a[88:91], v1, s[20:23], s62 offen offset:2048 sc1
    v_fma_f32 v32, v238, v36, v32
    v_fma_f32 v33, v238, v37, v33
    s_waitcnt lgkmcnt(10)
    v_mfma_f32_32x32x16_bf16 v[64:79], v[164:167], a[40:43], v[64:79]
    ds_read_b64_tr_b16 v[156:157], v5 offset:6144
    ds_read_b64_tr_b16 v[158:159], v5 offset:6656
    v_fma_f32 v32, -v239, v37, v32
    v_fmac_f32 v33, v239, v36
    v_fma_f32 v28, v238, v32, v28
    v_fma_f32 v29, v238, v33, v29
    v_fma_f32 v28, -v239, v33, v28
    s_waitcnt lgkmcnt(10)
    v_mfma_f32_32x32x16_bf16 v[80:95], v[168:171], a[40:43], v[80:95]
    ds_read_b64_tr_b16 v[160:161], v6 offset:6144
    ds_read_b64_tr_b16 v[162:163], v6 offset:6656
    s_add_u32 s62, s64, 229376
    buffer_load_dwordx4 a[92:95], v1, s[20:23], s62 offen offset:3072 sc1
    v_fmac_f32 v29, v239, v32
    v_fma_f32 v24, v238, v28, v24
    v_fma_f32 v25, v238, v29, v25
    s_waitcnt lgkmcnt(10)
    v_mfma_f32_32x32x16_bf16 v[96:111], v[172:175], a[40:43], v[96:111]
    ds_read_b64_tr_b16 v[164:165], v7 offset:6144
    ds_read_b64_tr_b16 v[166:167], v7 offset:6656
    v_fma_f32 v24, -v239, v29, v24
    v_fmac_f32 v25, v239, v28
    v_fma_f32 v20, v238, v24, v20
    v_fma_f32 v21, v238, v25, v21
    s_waitcnt lgkmcnt(10)
    v_mfma_f32_32x32x16_bf16 v[112:127], v[144:147], a[40:43], v[112:127]
    ds_read_b64_tr_b16 v[168:169], v8 offset:6144
    ds_read_b64_tr_b16 v[170:171], v8 offset:6656
    buffer_load_dword v253, v254, s[20:23], s77 offen sc0 sc1
    s_add_u32 m0, s61, 49152
    s_add_u32 s59, s56, 73728
    buffer_load_dwordx4 v2, s[8:11], s59 offen lds
    v_fma_f32 v20, -v239, v25, v20
    s_waitcnt lgkmcnt(10)
    v_mfma_f32_32x32x16_bf16 v[128:143], v[148:151], a[40:43], v[128:143]
    ds_read_b64_tr_b16 v[172:173], v9 offset:6144
    ds_read_b64_tr_b16 v[174:175], v9 offset:6656
    v_fmac_f32 v21, v239, v24
    v_fma_f32 v16, v238, v20, v16
    v_fma_f32 v17, v238, v21, v17
    v_fma_f32 v16, -v239, v21, v16
    v_fmac_f32 v17, v239, v20
    s_waitcnt lgkmcnt(10)
    v_mfma_f32_32x32x16_bf16 v[48:63], v[152:155], a[44:47], v[48:63]
    s_barrier
    ds_read_b64_tr_b16 v[144:145], v4 offset:24576
    ds_read_b64_tr_b16 v[146:147], v4 offset:25088
    v_mul_f32 v246, 0x44000000, v245
    v_mul_f32 v228, v246, v230
    s_waitcnt lgkmcnt(10)
    v_mfma_f32_32x32x16_bf16 v[64:79], v[156:159], a[44:47], v[64:79]
    ds_read_b64_tr_b16 v[148:149], v5 offset:24576
    ds_read_b64_tr_b16 v[150:151], v5 offset:25088
    s_add_u32 m0, s61, 50176
    s_add_u32 s59, s56, 82944
    buffer_load_dwordx4 v2, s[8:11], s59 offen lds
    v_mul_f32 v239, v246, v231
    s_waitcnt lgkmcnt(10)
    v_mfma_f32_32x32x16_bf16 v[80:95], v[160:163], a[44:47], v[80:95]
    ds_read_b64_tr_b16 v[152:153], v6 offset:24576
    ds_read_b64_tr_b16 v[154:155], v6 offset:25088
    v_exp_f32 v228, v228
    v_fract_f32 v239, v239
    v_cos_f32 v238, v239
    s_waitcnt lgkmcnt(10)
    v_mfma_f32_32x32x16_bf16 v[96:111], v[164:167], a[44:47], v[96:111]
    ds_read_b64_tr_b16 v[156:157], v7 offset:24576
    ds_read_b64_tr_b16 v[158:159], v7 offset:25088
    s_add_u32 m0, s61, 57344
    s_add_u32 s59, s56, 73856
    buffer_load_dwordx4 v2, s[8:11], s59 offen lds
    v_sin_f32 v239, v239
    s_waitcnt lgkmcnt(10)
    v_mfma_f32_32x32x16_bf16 v[112:127], v[168:171], a[44:47], v[112:127]
    ds_read_b64_tr_b16 v[160:161], v8 offset:24576
    ds_read_b64_tr_b16 v[162:163], v8 offset:25088
    v_mul_f32 v238, v228, v238
    v_mul_f32 v239, v228, v239
    v_mul_f32 v236, v238, v16
    v_mul_f32 v237, v238, v17
    s_waitcnt lgkmcnt(10)
    v_mfma_f32_32x32x16_bf16 v[128:143], v[172:175], a[44:47], v[128:143]
    ds_read_b64_tr_b16 v[164:165], v9 offset:24576
    ds_read_b64_tr_b16 v[166:167], v9 offset:25088
    v_fma_f32 v236, -v239, v17, v236
    v_fmac_f32 v237, v239, v16
    v_mov_b32 v228, v236
    v_mov_b32 v229, v237
    s_waitcnt lgkmcnt(10)
    v_mfma_f32_32x32x16_bf16 v[48:63], v[144:147], a[48:51], v[48:63]
    ds_read_b64_tr_b16 v[168:169], v4 offset:26624
    ds_read_b64_tr_b16 v[170:171], v4 offset:27136
    s_add_u32 m0, s61, 58368
    s_add_u32 s59, s56, 83072
    buffer_load_dwordx4 v2, s[8:11], s59 offen lds
    v_permlane16_swap_b32 v236, v228
    s_waitcnt lgkmcnt(10)
    v_mfma_f32_32x32x16_bf16 v[64:79], v[148:151], a[48:51], v[64:79]
    ds_read_b64_tr_b16 v[172:173], v5 offset:26624
    ds_read_b64_tr_b16 v[174:175], v5 offset:27136
    v_permlane16_swap_b32 v237, v229
    v_add_f32 v236, v236, v228
    v_add_f32 v237, v237, v229
    v_mov_b32 v228, v236
    s_waitcnt lgkmcnt(10)
    v_mfma_f32_32x32x16_bf16 v[80:95], v[152:155], a[48:51], v[80:95]
    ds_read_b64_tr_b16 v[144:145], v6 offset:26624
    ds_read_b64_tr_b16 v[146:147], v6 offset:27136
    s_add_u32 m0, s61, 65536
    s_add_u32 s59, s56, 73984
    buffer_load_dwordx4 v2, s[8:11], s59 offen lds
    v_mov_b32 v229, v237
    s_waitcnt lgkmcnt(10)
    v_mfma_f32_32x32x16_bf16 v[96:111], v[156:159], a[48:51], v[96:111]
    ds_read_b64_tr_b16 v[148:149], v7 offset:26624
    ds_read_b64_tr_b16 v[150:151], v7 offset:27136
    v_permlane32_swap_b32 v236, v228
    v_permlane32_swap_b32 v237, v229
    v_add_f32 v236, v236, v228
    s_waitcnt lgkmcnt(10)
    v_mfma_f32_32x32x16_bf16 v[112:127], v[160:163], a[48:51], v[112:127]
    ds_read_b64_tr_b16 v[152:153], v8 offset:26624
    ds_read_b64_tr_b16 v[154:155], v8 offset:27136
    s_add_u32 m0, s61, 66560
    s_add_u32 s59, s56, 83200
    buffer_load_dwordx4 v2, s[8:11], s59 offen lds
    v_add_f32 v237, v237, v229
    s_waitcnt lgkmcnt(10)
    v_mfma_f32_32x32x16_bf16 v[128:143], v[164:167], a[48:51], v[128:143]
    ds_read_b64_tr_b16 v[156:157], v9 offset:26624
    ds_read_b64_tr_b16 v[158:159], v9 offset:27136
    s_lshl_b32 s3, s53, 11
    s_add_u32 s3, s3, 147456
    v_and_b32 v208, 15, v0
    v_lshlrev_b32 v208, 6, v208
    v_bfe_u32 v228, v0, 4, 1
    s_waitcnt lgkmcnt(10)
    v_mfma_f32_32x32x16_bf16 v[48:63], v[168:171], a[52:55], v[48:63]
    ds_read_b64_tr_b16 v[160:161], v4 offset:28672
    ds_read_b64_tr_b16 v[162:163], v4 offset:29184
    v_lshl_add_u32 v208, v228, 5, v208
    v_lshrrev_b32 v229, 5, v0
    v_lshl_add_u32 v208, v229, 3, v208
    v_add_u32 v208, s3, v208
    v_lshlrev_b32 v209, 3, v229
    s_waitcnt lgkmcnt(10)
    v_mfma_f32_32x32x16_bf16 v[64:79], v[172:175], a[52:55], v[64:79]
    ds_read_b64_tr_b16 v[164:165], v5 offset:28672
    ds_read_b64_tr_b16 v[166:167], v5 offset:29184
    s_add_u32 m0, s61, 73728
    s_add_u32 s59, s56, 1400832
    buffer_load_dwordx4 v2, s[8:11], s59 offen lds
    v_bfe_u32 v229, v0, 2, 2
    s_waitcnt lgkmcnt(10)
    v_mfma_f32_32x32x16_bf16 v[80:95], v[144:147], a[52:55], v[80:95]
    ds_read_b64_tr_b16 v[168:169], v6 offset:28672
    ds_read_b64_tr_b16 v[170:171], v6 offset:29184
    v_add_u32 v209, v209, v229
    v_lshlrev_b32 v209, 6, v209
    v_lshl_add_u32 v209, v228, 5, v209
    v_and_b32 v229, 3, v0
    v_lshl_add_u32 v209, v229, 3, v209
    s_waitcnt lgkmcnt(10)
    v_mfma_f32_32x32x16_bf16 v[96:111], v[148:151], a[52:55], v[96:111]
    ds_read_b64_tr_b16 v[172:173], v7 offset:28672
    ds_read_b64_tr_b16 v[174:175], v7 offset:29184
    s_add_u32 m0, s61, 74752
    s_add_u32 s59, s56, 1410048
    buffer_load_dwordx4 v2, s[8:11], s59 offen lds
    v_add_u32 v209, s3, v209
    s_waitcnt lgkmcnt(10)
    v_mfma_f32_32x32x16_bf16 v[112:127], v[152:155], a[52:55], v[112:127]
    ds_read_b64_tr_b16 v[144:145], v8 offset:28672
    ds_read_b64_tr_b16 v[146:147], v8 offset:29184
    v_mov_b32 v246, 0x00000000
    v_fmac_f32 v246, 0x41000000, v245
    v_mul_f32 v228, v246, v230
    v_mul_f32 v239, v246, v231
    s_waitcnt lgkmcnt(10)
    v_mfma_f32_32x32x16_bf16 v[128:143], v[156:159], a[52:55], v[128:143]
    ds_read_b64_tr_b16 v[148:149], v9 offset:28672
    ds_read_b64_tr_b16 v[150:151], v9 offset:29184
    s_add_u32 m0, s61, 81920
    s_add_u32 s59, s56, 1400960
    buffer_load_dwordx4 v2, s[8:11], s59 offen lds
    v_exp_f32 v228, v228
    s_waitcnt lgkmcnt(10)
    v_mfma_f32_32x32x16_bf16 v[48:63], v[160:163], a[56:59], v[48:63]
    ds_read_b64_tr_b16 v[152:153], v4 offset:30720
    ds_read_b64_tr_b16 v[154:155], v4 offset:31232
    v_fract_f32 v239, v239
    v_cos_f32 v238, v239
    v_sin_f32 v239, v239
    s_waitcnt lgkmcnt(10)
    v_mfma_f32_32x32x16_bf16 v[64:79], v[164:167], a[56:59], v[64:79]
    ds_read_b64_tr_b16 v[156:157], v5 offset:30720
    ds_read_b64_tr_b16 v[158:159], v5 offset:31232
    v_mul_f32 v238, v228, v238
    v_mul_f32 v239, v228, v239
    v_fma_f32 v240, v238, v236, v240
    v_fma_f32 v241, v238, v237, v241
    v_fma_f32 v240, -v239, v237, v240
    s_waitcnt lgkmcnt(10)
    v_mfma_f32_32x32x16_bf16 v[80:95], v[168:171], a[56:59], v[80:95]
    ds_read_b64_tr_b16 v[160:161], v6 offset:30720
    ds_read_b64_tr_b16 v[162:163], v6 offset:31232
    s_add_u32 m0, s61, 82944
    s_add_u32 s59, s56, 1410176
    buffer_load_dwordx4 v2, s[8:11], s59 offen lds
    v_fmac_f32 v241, v239, v236
    s_waitcnt lgkmcnt(10)
    v_mfma_f32_32x32x16_bf16 v[96:111], v[172:175], a[56:59], v[96:111]
    ds_read_b64_tr_b16 v[164:165], v7 offset:30720
    ds_read_b64_tr_b16 v[166:167], v7 offset:31232
    v_fma_f32 v176, v234, v240, v176
    v_fma_f32 v184, v234, v241, v184
    v_fma_f32 v176, -v235, v241, v176
    v_fmac_f32 v184, v235, v240
    s_waitcnt lgkmcnt(10)
    v_mfma_f32_32x32x16_bf16 v[112:127], v[144:147], a[56:59], v[112:127]
    ds_read_b64_tr_b16 v[168:169], v8 offset:30720
    ds_read_b64_tr_b16 v[170:171], v8 offset:31232
    s_add_u32 m0, s61, 90112
    s_add_u32 s59, s56, 1401088
    buffer_load_dwordx4 v2, s[8:11], s59 offen lds
    v_fma_f32 v177, v234, v176, v177
    v_fma_f32 v185, v234, v184, v185
    s_waitcnt lgkmcnt(10)
    v_mfma_f32_32x32x16_bf16 v[128:143], v[148:151], a[56:59], v[128:143]
    ds_read_b64_tr_b16 v[172:173], v9 offset:30720
    ds_read_b64_tr_b16 v[174:175], v9 offset:31232
    v_fma_f32 v177, -v235, v184, v177
    v_fmac_f32 v185, v235, v176
    v_fma_f32 v178, v234, v177, v178
    v_fma_f32 v186, v234, v185, v186
    s_waitcnt lgkmcnt(10)
    v_mfma_f32_32x32x16_bf16 v[48:63], v[152:155], a[60:63], v[48:63]
    s_waitcnt vmcnt(26)
    s_barrier
    v_add_u32 v4, 4294868992, v4
    v_add_u32 v5, 4294868992, v5
    v_add_u32 v6, 4294868992, v6
    v_add_u32 v7, 4294868992, v7
    v_add_u32 v8, 4294868992, v8
    v_add_u32 v9, 4294868992, v9
    ds_read_b64_tr_b16 v[144:145], v4 offset:0
    ds_read_b64_tr_b16 v[146:147], v4 offset:512
    s_add_u32 m0, s61, 91136
    s_add_u32 s59, s56, 1410304
    buffer_load_dwordx4 v2, s[8:11], s59 offen lds
    v_fma_f32 v178, -v235, v185, v178
    s_waitcnt lgkmcnt(10)
    v_mfma_f32_32x32x16_bf16 v[64:79], v[156:159], a[60:63], v[64:79]
    ds_read_b64_tr_b16 v[148:149], v5 offset:0
    ds_read_b64_tr_b16 v[150:151], v5 offset:512
    v_fmac_f32 v186, v235, v177
    v_fma_f32 v179, v234, v178, v179
    v_fma_f32 v187, v234, v186, v187
    v_fma_f32 v179, -v235, v186, v179
    v_fmac_f32 v187, v235, v178
    s_waitcnt lgkmcnt(10)
    v_mfma_f32_32x32x16_bf16 v[80:95], v[160:163], a[60:63], v[80:95]
    ds_read_b64_tr_b16 v[152:153], v6 offset:0
    ds_read_b64_tr_b16 v[154:155], v6 offset:512
    v_fma_f32 v180, v234, v179, v180
    v_fma_f32 v188, v234, v187, v188
    v_fma_f32 v180, -v235, v187, v180
    v_fmac_f32 v188, v235, v179
    v_fma_f32 v181, v234, v180, v181
    s_waitcnt lgkmcnt(10)
    v_mfma_f32_32x32x16_bf16 v[96:111], v[164:167], a[60:63], v[96:111]
    ds_read_b64_tr_b16 v[156:157], v7 offset:0
    ds_read_b64_tr_b16 v[158:159], v7 offset:512
    s_add_u32 m0, s61, 98304
    s_add_u32 s59, s56, 2727936
    buffer_load_dwordx4 v2, s[8:11], s59 offen lds
    v_fma_f32 v189, v234, v188, v189
    s_waitcnt lgkmcnt(10)
    v_mfma_f32_32x32x16_bf16 v[112:127], v[168:171], a[60:63], v[112:127]
    ds_read_b64_tr_b16 v[160:161], v8 offset:0
    ds_read_b64_tr_b16 v[162:163], v8 offset:512
    v_fma_f32 v181, -v235, v188, v181
    v_fmac_f32 v189, v235, v180
    v_fma_f32 v182, v234, v181, v182
    v_fma_f32 v190, v234, v189, v190
    v_fma_f32 v182, -v235, v189, v182
    s_waitcnt lgkmcnt(10)
    v_mfma_f32_32x32x16_bf16 v[128:143], v[172:175], a[60:63], v[128:143]
    ds_read_b64_tr_b16 v[164:165], v9 offset:0
    ds_read_b64_tr_b16 v[166:167], v9 offset:512
    s_add_u32 m0, s61, 99328
    s_add_u32 s59, s56, 2737152
    buffer_load_dwordx4 v2, s[8:11], s59 offen lds
    v_fmac_f32 v190, v235, v181
    s_waitcnt vmcnt(28) lgkmcnt(10)
    v_mfma_f32_32x32x16_bf16 v[48:63], v[144:147], a[64:67], v[48:63]
    ds_read_b64_tr_b16 v[168:169], v4 offset:2048
    ds_read_b64_tr_b16 v[170:171], v4 offset:2560
    v_fma_f32 v183, v234, v182, v183
    v_fma_f32 v191, v234, v190, v191
    v_fma_f32 v183, -v235, v190, v183
    v_fmac_f32 v191, v235, v182
    v_cvt_pk_bf16_f32 v176, v176, v177
    s_waitcnt lgkmcnt(10)
    v_mfma_f32_32x32x16_bf16 v[64:79], v[148:151], a[64:67], v[64:79]
    ds_read_b64_tr_b16 v[172:173], v5 offset:2048
    ds_read_b64_tr_b16 v[174:175], v5 offset:2560
    s_add_u32 m0, s61, 106496
    s_add_u32 s59, s56, 2728064
    buffer_load_dwordx4 v2, s[8:11], s59 offen lds
    v_cvt_pk_bf16_f32 v177, v178, v179
    s_waitcnt lgkmcnt(10)
    v_mfma_f32_32x32x16_bf16 v[80:95], v[152:155], a[64:67], v[80:95]
    ds_read_b64_tr_b16 v[144:145], v6 offset:2048
    ds_read_b64_tr_b16 v[146:147], v6 offset:2560
    v_cvt_pk_bf16_f32 v178, v180, v181
    v_cvt_pk_bf16_f32 v179, v182, v183
    v_cvt_pk_bf16_f32 v184, -v184, -v185
    v_cvt_pk_bf16_f32 v185, -v186, -v187
    v_cvt_pk_bf16_f32 v186, -v188, -v189
    s_waitcnt lgkmcnt(10)
    v_mfma_f32_32x32x16_bf16 v[96:111], v[156:159], a[64:67], v[96:111]
    ds_read_b64_tr_b16 v[148:149], v7 offset:2048
    ds_read_b64_tr_b16 v[150:151], v7 offset:2560
    v_cvt_pk_bf16_f32 v187, -v190, -v191
    ds_write_b64 v208, v[176:177]
    ds_write_b64 v208, v[178:179] offset:16
    ds_write_b64 v208, v[184:185] offset:1024
    s_waitcnt lgkmcnt(13)
    v_mfma_f32_32x32x16_bf16 v[112:127], v[160:163], a[64:67], v[112:127]
    ds_read_b64_tr_b16 v[152:153], v8 offset:2048
    ds_read_b64_tr_b16 v[154:155], v8 offset:2560
    s_add_u32 m0, s61, 107520
    s_add_u32 s59, s56, 2737280
    buffer_load_dwordx4 v2, s[8:11], s59 offen lds
    ds_write_b64 v208, v[186:187] offset:1040
    ds_read_b64_tr_b16 v[180:181], v209
    s_waitcnt lgkmcnt(15)
    v_mfma_f32_32x32x16_bf16 v[128:143], v[164:167], a[64:67], v[128:143]
    ds_read_b64_tr_b16 v[156:157], v9 offset:2048
    ds_read_b64_tr_b16 v[158:159], v9 offset:2560
    ds_read_b64_tr_b16 v[182:183], v209 offset:256
    ds_read_b64_tr_b16 v[188:189], v209 offset:1024
    ds_read_b64_tr_b16 v[190:191], v209 offset:1280
    s_add_u32 s3, s82, 36864
    s_waitcnt vmcnt(29) lgkmcnt(15)
    v_mfma_f32_32x32x16_bf16 v[48:63], v[168:171], a[68:71], v[48:63]
    ds_read_b64_tr_b16 v[160:161], v4 offset:4096
    ds_read_b64_tr_b16 v[162:163], v4 offset:4608
    s_add_u32 m0, s61, 114688
    s_add_u32 s59, s56, 2728192
    buffer_load_dwordx4 v2, s[8:11], s59 offen lds
    s_waitcnt lgkmcnt(4)
    buffer_store_dwordx4 v[180:183], v1, s[20:23], s82 offen sc1
    s_waitcnt lgkmcnt(2)
    buffer_store_dwordx4 v[188:191], v1, s[20:23], s3 offen sc1
    v_mfma_f32_32x32x16_bf16 v[64:79], v[172:175], a[68:71], v[64:79]
    ds_read_b64_tr_b16 v[164:165], v5 offset:4096
    ds_read_b64_tr_b16 v[166:167], v5 offset:4608
    v_mov_b32 v246, 0x42000000
    v_fmac_f32 v246, 0x41000000, v245
    v_mul_f32 v228, v246, v230
    v_mul_f32 v239, v246, v231
    v_mfma_f32_32x32x16_bf16 v[80:95], v[144:147], a[68:71], v[80:95]
    ds_read_b64_tr_b16 v[168:169], v6 offset:4096
    ds_read_b64_tr_b16 v[170:171], v6 offset:4608
    s_waitcnt vmcnt(19)
    v_cmp_gt_u32 vcc, 8, v253
    s_nop 4
    s_cbranch_vccnz K3_GSS0
K3_GBS0:
    s_add_u32 s62, s64, 4096
    buffer_load_dwordx4 a[96:99], v1, s[20:23], s62 offen offset:0 sc1
    v_exp_f32 v228, v228
    v_mfma_f32_32x32x16_bf16 v[96:111], v[148:151], a[68:71], v[96:111]
    ds_read_b64_tr_b16 v[172:173], v7 offset:4096
    ds_read_b64_tr_b16 v[174:175], v7 offset:4608
    s_add_u32 s62, s64, 4096
    buffer_load_dwordx4 a[100:103], v1, s[20:23], s62 offen offset:1024 sc1
    v_fract_f32 v239, v239
    v_mfma_f32_32x32x16_bf16 v[112:127], v[152:155], a[68:71], v[112:127]
    ds_read_b64_tr_b16 v[144:145], v8 offset:4096
    ds_read_b64_tr_b16 v[146:147], v8 offset:4608
    s_add_u32 s62, s64, 4096
    buffer_load_dwordx4 a[104:107], v1, s[20:23], s62 offen offset:2048 sc1
    v_cos_f32 v238, v239
    v_mfma_f32_32x32x16_bf16 v[128:143], v[156:159], a[68:71], v[128:143]
    ds_read_b64_tr_b16 v[148:149], v9 offset:4096
    ds_read_b64_tr_b16 v[150:151], v9 offset:4608
    s_add_u32 s62, s64, 4096
    buffer_load_dwordx4 a[108:111], v1, s[20:23], s62 offen offset:3072 sc1
    v_sin_f32 v239, v239
    v_mul_f32 v238, v228, v238
    s_waitcnt lgkmcnt(10)
    v_mfma_f32_32x32x16_bf16 v[48:63], v[160:163], a[72:75], v[48:63]
    ds_read_b64_tr_b16 v[152:153], v4 offset:6144
    ds_read_b64_tr_b16 v[154:155], v4 offset:6656
    v_mul_f32 v239, v228, v239
    v_fma_f32 v242, v238, v236, v242
    v_fma_f32 v243, v238, v237, v243
    v_fma_f32 v242, -v239, v237, v242
    v_fmac_f32 v243, v239, v236
    s_waitcnt lgkmcnt(10)
    v_mfma_f32_32x32x16_bf16 v[64:79], v[164:167], a[72:75], v[64:79]
    ds_read_b64_tr_b16 v[156:157], v5 offset:6144
    ds_read_b64_tr_b16 v[158:159], v5 offset:6656
    v_fma_f32 v192, v234, v242, v192
    v_fma_f32 v200, v234, v243, v200
    v_fma_f32 v192, -v235, v243, v192
    v_fmac_f32 v200, v235, v242
    v_fma_f32 v193, v234, v192, v193
    s_waitcnt lgkmcnt(10)
    v_mfma_f32_32x32x16_bf16 v[80:95], v[168:171], a[72:75], v[80:95]
    ds_read_b64_tr_b16 v[160:161], v6 offset:6144
    ds_read_b64_tr_b16 v[162:163], v6 offset:6656
    v_fma_f32 v201, v234, v200, v201
    v_fma_f32 v193, -v235, v200, v193
    v_fmac_f32 v201, v235, v192
    v_fma_f32 v194, v234, v193, v194
    v_fma_f32 v202, v234, v201, v202
    s_waitcnt lgkmcnt(10)
    v_mfma_f32_32x32x16_bf16 v[96:111], v[172:175], a[72:75], v[96:111]
    ds_read_b64_tr_b16 v[164:165], v7 offset:6144
    ds_read_b64_tr_b16 v[166:167], v7 offset:6656
    v_fma_f32 v194, -v235, v201, v194
    v_fmac_f32 v202, v235, v193
    v_fma_f32 v195, v234, v194, v195
    v_fma_f32 v203, v234, v202, v203
    s_waitcnt lgkmcnt(10)
    v_mfma_f32_32x32x16_bf16 v[112:127], v[144:147], a[72:75], v[112:127]
    ds_read_b64_tr_b16 v[168:169], v8 offset:6144
    ds_read_b64_tr_b16 v[170:171], v8 offset:6656
    v_fma_f32 v195, -v235, v202, v195
    v_fmac_f32 v203, v235, v194
    v_fma_f32 v196, v234, v195, v196
    v_fma_f32 v204, v234, v203, v204
    v_fma_f32 v196, -v235, v203, v196
    s_waitcnt lgkmcnt(10)
    v_mfma_f32_32x32x16_bf16 v[128:143], v[148:151], a[72:75], v[128:143]
    ds_read_b64_tr_b16 v[172:173], v9 offset:6144
    ds_read_b64_tr_b16 v[174:175], v9 offset:6656
    v_fmac_f32 v204, v235, v195
    v_fma_f32 v197, v234, v196, v197
    v_fma_f32 v205, v234, v204, v205
    v_fma_f32 v197, -v235, v204, v197
    v_fmac_f32 v205, v235, v196
    s_waitcnt lgkmcnt(10)
    v_mfma_f32_32x32x16_bf16 v[48:63], v[152:155], a[76:79], v[48:63]
    s_barrier
    ds_read_b64_tr_b16 v[144:145], v4 offset:24576
    ds_read_b64_tr_b16 v[146:147], v4 offset:25088
    s_add_u32 s62, s64, 77824
    buffer_load_dwordx4 a[112:115], v1, s[20:23], s62 offen offset:0 sc1
    v_fma_f32 v198, v234, v197, v198
    s_waitcnt lgkmcnt(10)
    v_mfma_f32_32x32x16_bf16 v[64:79], v[156:159], a[76:79], v[64:79]
    ds_read_b64_tr_b16 v[148:149], v5 offset:24576
    ds_read_b64_tr_b16 v[150:151], v5 offset:25088
    v_fma_f32 v206, v234, v205, v206
    v_fma_f32 v198, -v235, v205, v198
    v_fmac_f32 v206, v235, v197
    v_fma_f32 v199, v234, v198, v199
    s_waitcnt lgkmcnt(10)
    v_mfma_f32_32x32x16_bf16 v[80:95], v[160:163], a[76:79], v[80:95]
    ds_read_b64_tr_b16 v[152:153], v6 offset:24576
    ds_read_b64_tr_b16 v[154:155], v6 offset:25088
    s_add_u32 s62, s64, 77824
    buffer_load_dwordx4 a[116:119], v1, s[20:23], s62 offen offset:1024 sc1
    v_fma_f32 v207, v234, v206, v207
    v_fma_f32 v199, -v235, v206, v199
    v_fmac_f32 v207, v235, v198
    s_waitcnt lgkmcnt(10)
    v_mfma_f32_32x32x16_bf16 v[96:111], v[164:167], a[76:79], v[96:111]
    ds_read_b64_tr_b16 v[156:157], v7 offset:24576
    ds_read_b64_tr_b16 v[158:159], v7 offset:25088
    v_cvt_pk_bf16_f32 v192, v192, v193
    v_cvt_pk_bf16_f32 v193, v194, v195
    v_cvt_pk_bf16_f32 v194, v196, v197
    v_cvt_pk_bf16_f32 v195, v198, v199
    v_cvt_pk_bf16_f32 v200, -v200, -v201
    s_waitcnt lgkmcnt(10)
    v_mfma_f32_32x32x16_bf16 v[112:127], v[168:171], a[76:79], v[112:127]
    ds_read_b64_tr_b16 v[160:161], v8 offset:24576
    ds_read_b64_tr_b16 v[162:163], v8 offset:25088
    v_cvt_pk_bf16_f32 v201, -v202, -v203
    v_cvt_pk_bf16_f32 v202, -v204, -v205
    v_cvt_pk_bf16_f32 v203, -v206, -v207
    ds_write_b64 v208, v[192:193]
    s_waitcnt lgkmcnt(11)
    v_mfma_f32_32x32x16_bf16 v[128:143], v[172:175], a[76:79], v[128:143]
    ds_read_b64_tr_b16 v[164:165], v9 offset:24576
    ds_read_b64_tr_b16 v[166:167], v9 offset:25088
    s_add_u32 s62, s64, 77824
    buffer_load_dwordx4 a[120:123], v1, s[20:23], s62 offen offset:2048 sc1
    ds_write_b64 v208, v[194:195] offset:16
    ds_write_b64 v208, v[200:201] offset:1024
    ds_write_b64 v208, v[202:203] offset:1040
    s_waitcnt lgkmcnt(14)
    v_mfma_f32_32x32x16_bf16 v[48:63], v[144:147], a[80:83], v[48:63]
    ds_read_b64_tr_b16 v[168:169], v4 offset:26624
    ds_read_b64_tr_b16 v[170:171], v4 offset:27136
    ds_read_b64_tr_b16 v[196:197], v209
    ds_read_b64_tr_b16 v[198:199], v209 offset:256
    ds_read_b64_tr_b16 v[204:205], v209 offset:1024
    ds_read_b64_tr_b16 v[206:207], v209 offset:1280
    s_add_u32 s3, s83, 36864
    s_waitcnt lgkmcnt(15)
    v_mfma_f32_32x32x16_bf16 v[64:79], v[148:151], a[80:83], v[64:79]
    ds_read_b64_tr_b16 v[172:173], v5 offset:26624
    ds_read_b64_tr_b16 v[174:175], v5 offset:27136
    s_add_u32 s62, s64, 77824
    buffer_load_dwordx4 a[124:127], v1, s[20:23], s62 offen offset:3072 sc1
    s_waitcnt lgkmcnt(4)
    buffer_store_dwordx4 v[196:199], v1, s[20:23], s83 offen sc1
    s_waitcnt lgkmcnt(2)
    buffer_store_dwordx4 v[204:207], v1, s[20:23], s3 offen sc1
    v_mfma_f32_32x32x16_bf16 v[80:95], v[152:155], a[80:83], v[80:95]
    ds_read_b64_tr_b16 v[144:145], v6 offset:26624
    ds_read_b64_tr_b16 v[146:147], v6 offset:27136
    v_mfma_f32_32x32x16_bf16 v[96:111], v[156:159], a[80:83], v[96:111]
    ds_read_b64_tr_b16 v[148:149], v7 offset:26624
    ds_read_b64_tr_b16 v[150:151], v7 offset:27136
    s_add_u32 m0, s61, 115712
    s_add_u32 s59, s56, 2737408
    buffer_load_dwordx4 v2, s[8:11], s59 offen lds
    v_mfma_f32_32x32x16_bf16 v[112:127], v[160:163], a[80:83], v[112:127]
    ds_read_b64_tr_b16 v[152:153], v8 offset:26624
    ds_read_b64_tr_b16 v[154:155], v8 offset:27136
    v_mfma_f32_32x32x16_bf16 v[128:143], v[164:167], a[80:83], v[128:143]
    ds_read_b64_tr_b16 v[156:157], v9 offset:26624
    ds_read_b64_tr_b16 v[158:159], v9 offset:27136
    v_mfma_f32_32x32x16_bf16 v[48:63], v[168:171], a[84:87], v[48:63]
    ds_read_b64_tr_b16 v[160:161], v4 offset:28672
    ds_read_b64_tr_b16 v[162:163], v4 offset:29184
    s_add_u32 s62, s64, 151552
    buffer_load_dwordx4 a[128:131], v1, s[20:23], s62 offen offset:0 sc1
    s_waitcnt lgkmcnt(10)
    v_mfma_f32_32x32x16_bf16 v[64:79], v[172:175], a[84:87], v[64:79]
    ds_read_b64_tr_b16 v[164:165], v5 offset:28672
    ds_read_b64_tr_b16 v[166:167], v5 offset:29184
    s_waitcnt lgkmcnt(10)
    v_mfma_f32_32x32x16_bf16 v[80:95], v[144:147], a[84:87], v[80:95]
    ds_read_b64_tr_b16 v[168:169], v6 offset:28672
    ds_read_b64_tr_b16 v[170:171], v6 offset:29184
    s_add_u32 s62, s64, 151552
    buffer_load_dwordx4 a[132:135], v1, s[20:23], s62 offen offset:1024 sc1
    s_waitcnt lgkmcnt(10)
    v_mfma_f32_32x32x16_bf16 v[96:111], v[148:151], a[84:87], v[96:111]
    ds_read_b64_tr_b16 v[172:173], v7 offset:28672
    ds_read_b64_tr_b16 v[174:175], v7 offset:29184
    s_waitcnt lgkmcnt(10)
    v_mfma_f32_32x32x16_bf16 v[112:127], v[152:155], a[84:87], v[112:127]
    ds_read_b64_tr_b16 v[144:145], v8 offset:28672
    ds_read_b64_tr_b16 v[146:147], v8 offset:29184
    s_add_u32 s62, s64, 151552
    buffer_load_dwordx4 a[136:139], v1, s[20:23], s62 offen offset:2048 sc1
    s_waitcnt lgkmcnt(10)
    v_mfma_f32_32x32x16_bf16 v[128:143], v[156:159], a[84:87], v[128:143]
    ds_read_b64_tr_b16 v[148:149], v9 offset:28672
    ds_read_b64_tr_b16 v[150:151], v9 offset:29184
    s_waitcnt lgkmcnt(10)
    v_mfma_f32_32x32x16_bf16 v[48:63], v[160:163], a[88:91], v[48:63]
    ds_read_b64_tr_b16 v[152:153], v4 offset:30720
    ds_read_b64_tr_b16 v[154:155], v4 offset:31232
    s_waitcnt lgkmcnt(10)
    v_mfma_f32_32x32x16_bf16 v[64:79], v[164:167], a[88:91], v[64:79]
    ds_read_b64_tr_b16 v[156:157], v5 offset:30720
    ds_read_b64_tr_b16 v[158:159], v5 offset:31232
    s_add_u32 s62, s64, 151552
    buffer_load_dwordx4 a[140:143], v1, s[20:23], s62 offen offset:3072 sc1
    s_waitcnt lgkmcnt(10)
    v_mfma_f32_32x32x16_bf16 v[80:95], v[168:171], a[88:91], v[80:95]
    ds_read_b64_tr_b16 v[160:161], v6 offset:30720
    ds_read_b64_tr_b16 v[162:163], v6 offset:31232
    s_waitcnt lgkmcnt(10)
    v_mfma_f32_32x32x16_bf16 v[96:111], v[172:175], a[88:91], v[96:111]
    ds_read_b64_tr_b16 v[164:165], v7 offset:30720
    ds_read_b64_tr_b16 v[166:167], v7 offset:31232
    s_add_u32 m0, s61, 122880
    s_add_u32 s59, s56, 4055040
    buffer_load_dwordx4 v2, s[8:11], s59 offen lds
    s_waitcnt lgkmcnt(10)
    v_mfma_f32_32x32x16_bf16 v[112:127], v[144:147], a[88:91], v[112:127]
    ds_read_b64_tr_b16 v[168:169], v8 offset:30720
    ds_read_b64_tr_b16 v[170:171], v8 offset:31232
    s_waitcnt lgkmcnt(10)
    v_mfma_f32_32x32x16_bf16 v[128:143], v[148:151], a[88:91], v[128:143]
    ds_read_b64_tr_b16 v[172:173], v9 offset:30720
    ds_read_b64_tr_b16 v[174:175], v9 offset:31232
    s_add_u32 m0, s61, 123904
    s_add_u32 s59, s56, 4064256
    buffer_load_dwordx4 v2, s[8:11], s59 offen lds
    s_waitcnt lgkmcnt(10)
    v_mfma_f32_32x32x16_bf16 v[48:63], v[152:155], a[92:95], v[48:63]
    s_waitcnt vmcnt(30)
    s_barrier
    v_add_u32 v4, 49152, v4
    v_add_u32 v5, 49152, v5
    v_add_u32 v6, 49152, v6
    v_add_u32 v7, 49152, v7
    v_add_u32 v8, 49152, v8
    v_add_u32 v9, 49152, v9
    ds_read_b64_tr_b16 v[144:145], v4 offset:0
    ds_read_b64_tr_b16 v[146:147], v4 offset:512
    s_waitcnt lgkmcnt(10)
    v_mfma_f32_32x32x16_bf16 v[64:79], v[156:159], a[92:95], v[64:79]
    ds_read_b64_tr_b16 v[148:149], v5 offset:0
    ds_read_b64_tr_b16 v[150:151], v5 offset:512
    s_waitcnt lgkmcnt(10)
    v_mfma_f32_32x32x16_bf16 v[80:95], v[160:163], a[92:95], v[80:95]
    ds_read_b64_tr_b16 v[152:153], v6 offset:0
    ds_read_b64_tr_b16 v[154:155], v6 offset:512
    s_add_u32 m0, s61, 131072
    s_add_u32 s59, s56, 4055168
    buffer_load_dwordx4 v2, s[8:11], s59 offen lds
    s_waitcnt lgkmcnt(10)
    v_mfma_f32_32x32x16_bf16 v[96:111], v[164:167], a[92:95], v[96:111]
    ds_read_b64_tr_b16 v[156:157], v7 offset:0
    ds_read_b64_tr_b16 v[158:159], v7 offset:512
    s_waitcnt lgkmcnt(10)
    v_mfma_f32_32x32x16_bf16 v[112:127], v[168:171], a[92:95], v[112:127]
    ds_read_b64_tr_b16 v[160:161], v8 offset:0
    ds_read_b64_tr_b16 v[162:163], v8 offset:512
    s_add_u32 m0, s61, 132096
    s_add_u32 s59, s56, 4064384
    buffer_load_dwordx4 v2, s[8:11], s59 offen lds
    s_waitcnt lgkmcnt(10)
    v_mfma_f32_32x32x16_bf16 v[128:143], v[172:175], a[92:95], v[128:143]
    ds_read_b64_tr_b16 v[164:165], v9 offset:0
    ds_read_b64_tr_b16 v[166:167], v9 offset:512
    s_waitcnt vmcnt(18) lgkmcnt(10)
    v_mfma_f32_32x32x16_bf16 v[48:63], v[144:147], a[96:99], v[48:63]
    ds_read_b64_tr_b16 v[168:169], v4 offset:2048
    ds_read_b64_tr_b16 v[170:171], v4 offset:2560
    s_add_u32 m0, s61, 139264
    s_add_u32 s59, s56, 4055296
    buffer_load_dwordx4 v2, s[8:11], s59 offen lds
    s_waitcnt lgkmcnt(10)
    v_mfma_f32_32x32x16_bf16 v[64:79], v[148:151], a[96:99], v[64:79]
    ds_read_b64_tr_b16 v[172:173], v5 offset:2048
    ds_read_b64_tr_b16 v[174:175], v5 offset:2560
    s_waitcnt lgkmcnt(10)
    v_mfma_f32_32x32x16_bf16 v[80:95], v[152:155], a[96:99], v[80:95]
    ds_read_b64_tr_b16 v[144:145], v6 offset:2048
    ds_read_b64_tr_b16 v[146:147], v6 offset:2560
    s_waitcnt lgkmcnt(10)
    v_mfma_f32_32x32x16_bf16 v[96:111], v[156:159], a[96:99], v[96:111]
    ds_read_b64_tr_b16 v[148:149], v7 offset:2048
    ds_read_b64_tr_b16 v[150:151], v7 offset:2560
    s_add_u32 m0, s61, 140288
    s_add_u32 s59, s56, 4064512
    buffer_load_dwordx4 v2, s[8:11], s59 offen lds
    s_waitcnt lgkmcnt(10)
    v_mfma_f32_32x32x16_bf16 v[112:127], v[160:163], a[96:99], v[112:127]
    ds_read_b64_tr_b16 v[152:153], v8 offset:2048
    ds_read_b64_tr_b16 v[154:155], v8 offset:2560
    s_waitcnt lgkmcnt(10)
    v_mfma_f32_32x32x16_bf16 v[128:143], v[164:167], a[96:99], v[128:143]
    ds_read_b64_tr_b16 v[156:157], v9 offset:2048
    ds_read_b64_tr_b16 v[158:159], v9 offset:2560
    s_add_u32 s62, s64, 225280
    buffer_load_dwordx4 a[144:147], v1, s[20:23], s62 offen offset:0 sc1
    s_waitcnt vmcnt(20) lgkmcnt(10)
    v_mfma_f32_32x32x16_bf16 v[48:63], v[168:171], a[100:103], v[48:63]
    ds_read_b64_tr_b16 v[160:161], v4 offset:4096
    ds_read_b64_tr_b16 v[162:163], v4 offset:4608
    s_waitcnt lgkmcnt(10)
    v_mfma_f32_32x32x16_bf16 v[64:79], v[172:175], a[100:103], v[64:79]
    ds_read_b64_tr_b16 v[164:165], v5 offset:4096
    ds_read_b64_tr_b16 v[166:167], v5 offset:4608
    s_waitcnt lgkmcnt(10)
    v_mfma_f32_32x32x16_bf16 v[80:95], v[144:147], a[100:103], v[80:95]
    ds_read_b64_tr_b16 v[168:169], v6 offset:4096
    ds_read_b64_tr_b16 v[170:171], v6 offset:4608
    s_add_u32 s62, s64, 225280
    buffer_load_dwordx4 a[148:151], v1, s[20:23], s62 offen offset:1024 sc1
    s_waitcnt lgkmcnt(10)
    v_mfma_f32_32x32x16_bf16 v[96:111], v[148:151], a[100:103], v[96:111]
    ds_read_b64_tr_b16 v[172:173], v7 offset:4096
    ds_read_b64_tr_b16 v[174:175], v7 offset:4608
    s_waitcnt lgkmcnt(10)
    v_mfma_f32_32x32x16_bf16 v[112:127], v[152:155], a[100:103], v[112:127]
    ds_read_b64_tr_b16 v[144:145], v8 offset:4096
    ds_read_b64_tr_b16 v[146:147], v8 offset:4608
    s_add_u32 s62, s64, 225280
    buffer_load_dwordx4 a[152:155], v1, s[20:23], s62 offen offset:2048 sc1
    s_waitcnt lgkmcnt(10)
    v_mfma_f32_32x32x16_bf16 v[128:143], v[156:159], a[100:103], v[128:143]
    ds_read_b64_tr_b16 v[148:149], v9 offset:4096
    ds_read_b64_tr_b16 v[150:151], v9 offset:4608
    s_waitcnt vmcnt(21) lgkmcnt(10)
    v_mfma_f32_32x32x16_bf16 v[48:63], v[160:163], a[104:107], v[48:63]
    ds_read_b64_tr_b16 v[152:153], v4 offset:6144
    ds_read_b64_tr_b16 v[154:155], v4 offset:6656
    s_add_u32 s62, s64, 225280
    buffer_load_dwordx4 a[156:159], v1, s[20:23], s62 offen offset:3072 sc1
    s_waitcnt lgkmcnt(10)
    v_mfma_f32_32x32x16_bf16 v[64:79], v[164:167], a[104:107], v[64:79]
    ds_read_b64_tr_b16 v[156:157], v5 offset:6144
    ds_read_b64_tr_b16 v[158:159], v5 offset:6656
    s_waitcnt lgkmcnt(10)
    v_mfma_f32_32x32x16_bf16 v[80:95], v[168:171], a[104:107], v[80:95]
    ds_read_b64_tr_b16 v[160:161], v6 offset:6144
    ds_read_b64_tr_b16 v[162:163], v6 offset:6656
    s_waitcnt lgkmcnt(10)
    v_mfma_f32_32x32x16_bf16 v[96:111], v[172:175], a[104:107], v[96:111]
    ds_read_b64_tr_b16 v[164:165], v7 offset:6144
    ds_read_b64_tr_b16 v[166:167], v7 offset:6656
    s_add_u32 m0, s61, 0
    s_add_u32 s59, s56, 221184
    buffer_load_dwordx4 v2, s[8:11], s59 offen lds
    s_waitcnt lgkmcnt(10)
    v_mfma_f32_32x32x16_bf16 v[112:127], v[144:147], a[104:107], v[112:127]
    ds_read_b64_tr_b16 v[168:169], v8 offset:6144
    ds_read_b64_tr_b16 v[170:171], v8 offset:6656
    s_waitcnt lgkmcnt(10)
    v_mfma_f32_32x32x16_bf16 v[128:143], v[148:151], a[104:107], v[128:143]
    ds_read_b64_tr_b16 v[172:173], v9 offset:6144
    ds_read_b64_tr_b16 v[174:175], v9 offset:6656
    s_add_u32 m0, s61, 1024
    s_add_u32 s59, s56, 230400
    buffer_load_dwordx4 v2, s[8:11], s59 offen lds
    s_waitcnt vmcnt(23) lgkmcnt(10)
    v_mfma_f32_32x32x16_bf16 v[48:63], v[152:155], a[108:111], v[48:63]
    s_barrier
    ds_read_b64_tr_b16 v[144:145], v4 offset:24576
    ds_read_b64_tr_b16 v[146:147], v4 offset:25088
    s_waitcnt lgkmcnt(10)
    v_mfma_f32_32x32x16_bf16 v[64:79], v[156:159], a[108:111], v[64:79]
    ds_read_b64_tr_b16 v[148:149], v5 offset:24576
    ds_read_b64_tr_b16 v[150:151], v5 offset:25088
    s_add_u32 m0, s61, 8192
    s_add_u32 s59, s56, 221312
    buffer_load_dwordx4 v2, s[8:11], s59 offen lds
    s_waitcnt lgkmcnt(10)
    v_mfma_f32_32x32x16_bf16 v[80:95], v[160:163], a[108:111], v[80:95]
    ds_read_b64_tr_b16 v[152:153], v6 offset:24576
    ds_read_b64_tr_b16 v[154:155], v6 offset:25088
    s_waitcnt lgkmcnt(10)
    v_mfma_f32_32x32x16_bf16 v[96:111], v[164:167], a[108:111], v[96:111]
    ds_read_b64_tr_b16 v[156:157], v7 offset:24576
    ds_read_b64_tr_b16 v[158:159], v7 offset:25088
    s_waitcnt lgkmcnt(10)
    v_mfma_f32_32x32x16_bf16 v[112:127], v[168:171], a[108:111], v[112:127]
    ds_read_b64_tr_b16 v[160:161], v8 offset:24576
    ds_read_b64_tr_b16 v[162:163], v8 offset:25088
    s_add_u32 m0, s61, 9216
    s_add_u32 s59, s56, 230528
    buffer_load_dwordx4 v2, s[8:11], s59 offen lds
    s_waitcnt lgkmcnt(10)
    v_mfma_f32_32x32x16_bf16 v[128:143], v[172:175], a[108:111], v[128:143]
    ds_read_b64_tr_b16 v[164:165], v9 offset:24576
    ds_read_b64_tr_b16 v[166:167], v9 offset:25088
    s_waitcnt vmcnt(19)
    buffer_atomic_add v233, v232, s[20:23], s101 offen sc1
    s_waitcnt lgkmcnt(10)
    v_mfma_f32_32x32x16_bf16 v[48:63], v[144:147], a[112:115], v[48:63]
    ds_read_b64_tr_b16 v[168:169], v4 offset:26624
    ds_read_b64_tr_b16 v[170:171], v4 offset:27136
    s_add_u32 m0, s61, 16384
    s_add_u32 s59, s56, 221440
    buffer_load_dwordx4 v2, s[8:11], s59 offen lds
    s_waitcnt lgkmcnt(10)
    v_mfma_f32_32x32x16_bf16 v[64:79], v[148:151], a[112:115], v[64:79]
    ds_read_b64_tr_b16 v[172:173], v5 offset:26624
    ds_read_b64_tr_b16 v[174:175], v5 offset:27136
    s_waitcnt lgkmcnt(10)
    v_mfma_f32_32x32x16_bf16 v[80:95], v[152:155], a[112:115], v[80:95]
    ds_read_b64_tr_b16 v[144:145], v6 offset:26624
    ds_read_b64_tr_b16 v[146:147], v6 offset:27136
    s_add_u32 m0, s61, 17408
    s_add_u32 s59, s56, 230656
    buffer_load_dwordx4 v2, s[8:11], s59 offen lds
    s_waitcnt lgkmcnt(10)
    v_mfma_f32_32x32x16_bf16 v[96:111], v[156:159], a[112:115], v[96:111]
    ds_read_b64_tr_b16 v[148:149], v7 offset:26624
    ds_read_b64_tr_b16 v[150:151], v7 offset:27136
    s_waitcnt lgkmcnt(10)
    v_mfma_f32_32x32x16_bf16 v[112:127], v[160:163], a[112:115], v[112:127]
    ds_read_b64_tr_b16 v[152:153], v8 offset:26624
    ds_read_b64_tr_b16 v[154:155], v8 offset:27136
    s_waitcnt lgkmcnt(10)
    v_mfma_f32_32x32x16_bf16 v[128:143], v[164:167], a[112:115], v[128:143]
    ds_read_b64_tr_b16 v[156:157], v9 offset:26624
    ds_read_b64_tr_b16 v[158:159], v9 offset:27136
    s_add_u32 s62, s64, 12288
    buffer_load_dwordx4 a[160:163], v1, s[20:23], s62 offen offset:0 sc1
    s_waitcnt lgkmcnt(10)
    v_mfma_f32_32x32x16_bf16 v[48:63], v[168:171], a[116:119], v[48:63]
    ds_read_b64_tr_b16 v[160:161], v4 offset:28672
    ds_read_b64_tr_b16 v[162:163], v4 offset:29184
    s_waitcnt lgkmcnt(10)
    v_mfma_f32_32x32x16_bf16 v[64:79], v[172:175], a[116:119], v[64:79]
    ds_read_b64_tr_b16 v[164:165], v5 offset:28672
    ds_read_b64_tr_b16 v[166:167], v5 offset:29184
    s_add_u32 s62, s64, 12288
    buffer_load_dwordx4 a[164:167], v1, s[20:23], s62 offen offset:1024 sc1
    s_waitcnt lgkmcnt(10)
    v_mfma_f32_32x32x16_bf16 v[80:95], v[144:147], a[116:119], v[80:95]
    ds_read_b64_tr_b16 v[168:169], v6 offset:28672
    ds_read_b64_tr_b16 v[170:171], v6 offset:29184
    s_waitcnt lgkmcnt(10)
    v_mfma_f32_32x32x16_bf16 v[96:111], v[148:151], a[116:119], v[96:111]
    ds_read_b64_tr_b16 v[172:173], v7 offset:28672
    ds_read_b64_tr_b16 v[174:175], v7 offset:29184
    s_add_u32 s62, s64, 12288
    buffer_load_dwordx4 a[168:171], v1, s[20:23], s62 offen offset:2048 sc1
    s_waitcnt lgkmcnt(10)
    v_mfma_f32_32x32x16_bf16 v[112:127], v[152:155], a[116:119], v[112:127]
    ds_read_b64_tr_b16 v[144:145], v8 offset:28672
    ds_read_b64_tr_b16 v[146:147], v8 offset:29184
    s_waitcnt lgkmcnt(10)
    v_mfma_f32_32x32x16_bf16 v[128:143], v[156:159], a[116:119], v[128:143]
    ds_read_b64_tr_b16 v[148:149], v9 offset:28672
    ds_read_b64_tr_b16 v[150:151], v9 offset:29184
    s_waitcnt lgkmcnt(10)
    v_mfma_f32_32x32x16_bf16 v[48:63], v[160:163], a[120:123], v[48:63]
    ds_read_b64_tr_b16 v[152:153], v4 offset:30720
    ds_read_b64_tr_b16 v[154:155], v4 offset:31232
    s_add_u32 s62, s64, 12288
    buffer_load_dwordx4 a[172:175], v1, s[20:23], s62 offen offset:3072 sc1
    s_waitcnt lgkmcnt(10)
    v_mfma_f32_32x32x16_bf16 v[64:79], v[164:167], a[120:123], v[64:79]
    ds_read_b64_tr_b16 v[156:157], v5 offset:30720
    ds_read_b64_tr_b16 v[158:159], v5 offset:31232
    s_waitcnt lgkmcnt(10)
    v_mfma_f32_32x32x16_bf16 v[80:95], v[168:171], a[120:123], v[80:95]
    ds_read_b64_tr_b16 v[160:161], v6 offset:30720
    ds_read_b64_tr_b16 v[162:163], v6 offset:31232
    s_add_u32 m0, s61, 24576
    s_add_u32 s59, s56, 1548288
    buffer_load_dwordx4 v2, s[8:11], s59 offen lds
    s_waitcnt lgkmcnt(10)
    v_mfma_f32_32x32x16_bf16 v[96:111], v[172:175], a[120:123], v[96:111]
    ds_read_b64_tr_b16 v[164:165], v7 offset:30720
    ds_read_b64_tr_b16 v[166:167], v7 offset:31232
    s_waitcnt lgkmcnt(10)
    v_mfma_f32_32x32x16_bf16 v[112:127], v[144:147], a[120:123], v[112:127]
    ds_read_b64_tr_b16 v[168:169], v8 offset:30720
    ds_read_b64_tr_b16 v[170:171], v8 offset:31232
    s_add_u32 m0, s61, 25600
    s_add_u32 s59, s56, 1557504
    buffer_load_dwordx4 v2, s[8:11], s59 offen lds
    s_waitcnt lgkmcnt(10)
    v_mfma_f32_32x32x16_bf16 v[128:143], v[148:151], a[120:123], v[128:143]
    ds_read_b64_tr_b16 v[172:173], v9 offset:30720
    ds_read_b64_tr_b16 v[174:175], v9 offset:31232
    s_waitcnt lgkmcnt(10)
    v_mfma_f32_32x32x16_bf16 v[48:63], v[152:155], a[124:127], v[48:63]
    s_waitcnt vmcnt(27)
    s_barrier
    v_add_u32 v4, 49152, v4
    v_add_u32 v5, 49152, v5
    v_add_u32 v6, 49152, v6
    v_add_u32 v7, 49152, v7
    v_add_u32 v8, 49152, v8
    v_add_u32 v9, 49152, v9
    ds_read_b64_tr_b16 v[144:145], v4 offset:0
    ds_read_b64_tr_b16 v[146:147], v4 offset:512
    s_waitcnt lgkmcnt(10)
    v_mfma_f32_32x32x16_bf16 v[64:79], v[156:159], a[124:127], v[64:79]
    ds_read_b64_tr_b16 v[148:149], v5 offset:0
    ds_read_b64_tr_b16 v[150:151], v5 offset:512
    s_add_u32 m0, s61, 32768
    s_add_u32 s59, s56, 1548416
    buffer_load_dwordx4 v2, s[8:11], s59 offen lds
    s_waitcnt lgkmcnt(10)
    v_mfma_f32_32x32x16_bf16 v[80:95], v[160:163], a[124:127], v[80:95]
    ds_read_b64_tr_b16 v[152:153], v6 offset:0
    ds_read_b64_tr_b16 v[154:155], v6 offset:512
    s_waitcnt lgkmcnt(10)
    v_mfma_f32_32x32x16_bf16 v[96:111], v[164:167], a[124:127], v[96:111]
    ds_read_b64_tr_b16 v[156:157], v7 offset:0
    ds_read_b64_tr_b16 v[158:159], v7 offset:512
    s_add_u32 m0, s61, 33792
    s_add_u32 s59, s56, 1557632
    buffer_load_dwordx4 v2, s[8:11], s59 offen lds
    s_waitcnt lgkmcnt(10)
    v_mfma_f32_32x32x16_bf16 v[112:127], v[168:171], a[124:127], v[112:127]
    ds_read_b64_tr_b16 v[160:161], v8 offset:0
    ds_read_b64_tr_b16 v[162:163], v8 offset:512
    s_waitcnt lgkmcnt(10)
    v_mfma_f32_32x32x16_bf16 v[128:143], v[172:175], a[124:127], v[128:143]
    ds_read_b64_tr_b16 v[164:165], v9 offset:0
    ds_read_b64_tr_b16 v[166:167], v9 offset:512
    s_waitcnt vmcnt(28) lgkmcnt(10)
    v_mfma_f32_32x32x16_bf16 v[48:63], v[144:147], a[128:131], v[48:63]
    ds_read_b64_tr_b16 v[168:169], v4 offset:2048
    ds_read_b64_tr_b16 v[170:171], v4 offset:2560
    s_add_u32 m0, s61, 40960
    s_add_u32 s59, s56, 1548544
    buffer_load_dwordx4 v2, s[8:11], s59 offen lds
    s_waitcnt lgkmcnt(10)
    v_mfma_f32_32x32x16_bf16 v[64:79], v[148:151], a[128:131], v[64:79]
    ds_read_b64_tr_b16 v[172:173], v5 offset:2048
    ds_read_b64_tr_b16 v[174:175], v5 offset:2560
    s_waitcnt lgkmcnt(10)
    v_mfma_f32_32x32x16_bf16 v[80:95], v[152:155], a[128:131], v[80:95]
    ds_read_b64_tr_b16 v[144:145], v6 offset:2048
    ds_read_b64_tr_b16 v[146:147], v6 offset:2560
    s_add_u32 m0, s61, 41984
    s_add_u32 s59, s56, 1557760
    buffer_load_dwordx4 v2, s[8:11], s59 offen lds
    s_waitcnt lgkmcnt(10)
    v_mfma_f32_32x32x16_bf16 v[96:111], v[156:159], a[128:131], v[96:111]
    ds_read_b64_tr_b16 v[148:149], v7 offset:2048
    ds_read_b64_tr_b16 v[150:151], v7 offset:2560
    s_waitcnt lgkmcnt(10)
    v_mfma_f32_32x32x16_bf16 v[112:127], v[160:163], a[128:131], v[112:127]
    ds_read_b64_tr_b16 v[152:153], v8 offset:2048
    ds_read_b64_tr_b16 v[154:155], v8 offset:2560
    s_add_u32 s62, s64, 86016
    buffer_load_dwordx4 a[176:179], v1, s[20:23], s62 offen offset:0 sc1
    s_waitcnt lgkmcnt(10)
    v_mfma_f32_32x32x16_bf16 v[128:143], v[164:167], a[128:131], v[128:143]
    ds_read_b64_tr_b16 v[156:157], v9 offset:2048
    ds_read_b64_tr_b16 v[158:159], v9 offset:2560
    s_waitcnt vmcnt(30) lgkmcnt(10)
    v_mfma_f32_32x32x16_bf16 v[48:63], v[168:171], a[132:135], v[48:63]
    ds_read_b64_tr_b16 v[160:161], v4 offset:4096
    ds_read_b64_tr_b16 v[162:163], v4 offset:4608
    s_waitcnt lgkmcnt(10)
    v_mfma_f32_32x32x16_bf16 v[64:79], v[172:175], a[132:135], v[64:79]
    ds_read_b64_tr_b16 v[164:165], v5 offset:4096
    ds_read_b64_tr_b16 v[166:167], v5 offset:4608
    s_add_u32 s62, s64, 86016
    buffer_load_dwordx4 a[180:183], v1, s[20:23], s62 offen offset:1024 sc1
    s_waitcnt lgkmcnt(10)
    v_mfma_f32_32x32x16_bf16 v[80:95], v[144:147], a[132:135], v[80:95]
    ds_read_b64_tr_b16 v[168:169], v6 offset:4096
    ds_read_b64_tr_b16 v[170:171], v6 offset:4608
    s_waitcnt lgkmcnt(10)
    v_mfma_f32_32x32x16_bf16 v[96:111], v[148:151], a[132:135], v[96:111]
    ds_read_b64_tr_b16 v[172:173], v7 offset:4096
    ds_read_b64_tr_b16 v[174:175], v7 offset:4608
    s_add_u32 s62, s64, 86016
    buffer_load_dwordx4 a[184:187], v1, s[20:23], s62 offen offset:2048 sc1
    s_waitcnt lgkmcnt(10)
    v_mfma_f32_32x32x16_bf16 v[112:127], v[152:155], a[132:135], v[112:127]
    ds_read_b64_tr_b16 v[144:145], v8 offset:4096
    ds_read_b64_tr_b16 v[146:147], v8 offset:4608
    s_waitcnt lgkmcnt(10)
    v_mfma_f32_32x32x16_bf16 v[128:143], v[156:159], a[132:135], v[128:143]
    ds_read_b64_tr_b16 v[148:149], v9 offset:4096
    ds_read_b64_tr_b16 v[150:151], v9 offset:4608
    s_add_u32 s62, s64, 86016
    buffer_load_dwordx4 a[188:191], v1, s[20:23], s62 offen offset:3072 sc1
    s_waitcnt vmcnt(32) lgkmcnt(10)
    v_mfma_f32_32x32x16_bf16 v[48:63], v[160:163], a[136:139], v[48:63]
    ds_read_b64_tr_b16 v[152:153], v4 offset:6144
    ds_read_b64_tr_b16 v[154:155], v4 offset:6656
    s_waitcnt lgkmcnt(10)
    v_mfma_f32_32x32x16_bf16 v[64:79], v[164:167], a[136:139], v[64:79]
    ds_read_b64_tr_b16 v[156:157], v5 offset:6144
    ds_read_b64_tr_b16 v[158:159], v5 offset:6656
    s_waitcnt lgkmcnt(10)
    v_mfma_f32_32x32x16_bf16 v[80:95], v[168:171], a[136:139], v[80:95]
    ds_read_b64_tr_b16 v[160:161], v6 offset:6144
    ds_read_b64_tr_b16 v[162:163], v6 offset:6656
    s_add_u32 m0, s61, 49152
    s_add_u32 s59, s56, 2875392
    buffer_load_dwordx4 v2, s[8:11], s59 offen lds
    s_waitcnt lgkmcnt(10)
    v_mfma_f32_32x32x16_bf16 v[96:111], v[172:175], a[136:139], v[96:111]
    ds_read_b64_tr_b16 v[164:165], v7 offset:6144
    ds_read_b64_tr_b16 v[166:167], v7 offset:6656
    s_waitcnt lgkmcnt(10)
    v_mfma_f32_32x32x16_bf16 v[112:127], v[144:147], a[136:139], v[112:127]
    ds_read_b64_tr_b16 v[168:169], v8 offset:6144
    ds_read_b64_tr_b16 v[170:171], v8 offset:6656
    s_add_u32 m0, s61, 50176
    s_add_u32 s59, s56, 2884608
    buffer_load_dwordx4 v2, s[8:11], s59 offen lds
    s_waitcnt lgkmcnt(10)
    v_mfma_f32_32x32x16_bf16 v[128:143], v[148:151], a[136:139], v[128:143]
    ds_read_b64_tr_b16 v[172:173], v9 offset:6144
    ds_read_b64_tr_b16 v[174:175], v9 offset:6656
    s_waitcnt vmcnt(33) lgkmcnt(10)
    v_mfma_f32_32x32x16_bf16 v[48:63], v[152:155], a[140:143], v[48:63]
    s_waitcnt vmcnt(27)
    s_barrier
    ds_read_b64_tr_b16 v[144:145], v4 offset:24576
    ds_read_b64_tr_b16 v[146:147], v4 offset:25088
    s_add_u32 m0, s61, 57344
    s_add_u32 s59, s56, 2875520
    buffer_load_dwordx4 v2, s[8:11], s59 offen lds
    s_waitcnt lgkmcnt(10)
    v_mfma_f32_32x32x16_bf16 v[64:79], v[156:159], a[140:143], v[64:79]
    ds_read_b64_tr_b16 v[148:149], v5 offset:24576
    ds_read_b64_tr_b16 v[150:151], v5 offset:25088
    s_waitcnt lgkmcnt(10)
    v_mfma_f32_32x32x16_bf16 v[80:95], v[160:163], a[140:143], v[80:95]
    ds_read_b64_tr_b16 v[152:153], v6 offset:24576
    ds_read_b64_tr_b16 v[154:155], v6 offset:25088
    s_waitcnt lgkmcnt(10)
    v_mfma_f32_32x32x16_bf16 v[96:111], v[164:167], a[140:143], v[96:111]
    ds_read_b64_tr_b16 v[156:157], v7 offset:24576
    ds_read_b64_tr_b16 v[158:159], v7 offset:25088
    s_add_u32 m0, s61, 58368
    s_add_u32 s59, s56, 2884736
    buffer_load_dwordx4 v2, s[8:11], s59 offen lds
    s_waitcnt lgkmcnt(10)
    v_mfma_f32_32x32x16_bf16 v[112:127], v[168:171], a[140:143], v[112:127]
    ds_read_b64_tr_b16 v[160:161], v8 offset:24576
    ds_read_b64_tr_b16 v[162:163], v8 offset:25088
    s_waitcnt lgkmcnt(10)
    v_mfma_f32_32x32x16_bf16 v[128:143], v[172:175], a[140:143], v[128:143]
    ds_read_b64_tr_b16 v[164:165], v9 offset:24576
    ds_read_b64_tr_b16 v[166:167], v9 offset:25088
    s_add_u32 m0, s61, 65536
    s_add_u32 s59, s56, 2875648
    buffer_load_dwordx4 v2, s[8:11], s59 offen lds
    s_waitcnt vmcnt(29) lgkmcnt(10)
    v_mfma_f32_32x32x16_bf16 v[48:63], v[144:147], a[144:147], v[48:63]
    ds_read_b64_tr_b16 v[168:169], v4 offset:26624
    ds_read_b64_tr_b16 v[170:171], v4 offset:27136
    s_waitcnt lgkmcnt(10)
    v_mfma_f32_32x32x16_bf16 v[64:79], v[148:151], a[144:147], v[64:79]
    ds_read_b64_tr_b16 v[172:173], v5 offset:26624
    ds_read_b64_tr_b16 v[174:175], v5 offset:27136
    s_add_u32 m0, s61, 66560
    s_add_u32 s59, s56, 2884864
    buffer_load_dwordx4 v2, s[8:11], s59 offen lds
    s_waitcnt lgkmcnt(10)
    v_mfma_f32_32x32x16_bf16 v[80:95], v[152:155], a[144:147], v[80:95]
    ds_read_b64_tr_b16 v[144:145], v6 offset:26624
    ds_read_b64_tr_b16 v[146:147], v6 offset:27136
    s_waitcnt lgkmcnt(10)
    v_mfma_f32_32x32x16_bf16 v[96:111], v[156:159], a[144:147], v[96:111]
    ds_read_b64_tr_b16 v[148:149], v7 offset:26624
    ds_read_b64_tr_b16 v[150:151], v7 offset:27136
    s_waitcnt lgkmcnt(10)
    v_mfma_f32_32x32x16_bf16 v[112:127], v[160:163], a[144:147], v[112:127]
    ds_read_b64_tr_b16 v[152:153], v8 offset:26624
    ds_read_b64_tr_b16 v[154:155], v8 offset:27136
    s_add_u32 s62, s64, 159744
    buffer_load_dwordx4 a[192:195], v1, s[20:23], s62 offen offset:0 sc1
    s_waitcnt lgkmcnt(10)
    v_mfma_f32_32x32x16_bf16 v[128:143], v[164:167], a[144:147], v[128:143]
    ds_read_b64_tr_b16 v[156:157], v9 offset:26624
    ds_read_b64_tr_b16 v[158:159], v9 offset:27136
    s_waitcnt vmcnt(30) lgkmcnt(10)
    v_mfma_f32_32x32x16_bf16 v[48:63], v[168:171], a[148:151], v[48:63]
    ds_read_b64_tr_b16 v[160:161], v4 offset:28672
    ds_read_b64_tr_b16 v[162:163], v4 offset:29184
    s_add_u32 s62, s64, 159744
    buffer_load_dwordx4 a[196:199], v1, s[20:23], s62 offen offset:1024 sc1
    s_waitcnt lgkmcnt(10)
    v_mfma_f32_32x32x16_bf16 v[64:79], v[172:175], a[148:151], v[64:79]
    ds_read_b64_tr_b16 v[164:165], v5 offset:28672
    ds_read_b64_tr_b16 v[166:167], v5 offset:29184
    s_waitcnt lgkmcnt(10)
    v_mfma_f32_32x32x16_bf16 v[80:95], v[144:147], a[148:151], v[80:95]
    ds_read_b64_tr_b16 v[168:169], v6 offset:28672
    ds_read_b64_tr_b16 v[170:171], v6 offset:29184
    s_add_u32 s62, s64, 159744
    buffer_load_dwordx4 a[200:203], v1, s[20:23], s62 offen offset:2048 sc1
    s_waitcnt lgkmcnt(10)
    v_mfma_f32_32x32x16_bf16 v[96:111], v[148:151], a[148:151], v[96:111]
    ds_read_b64_tr_b16 v[172:173], v7 offset:28672
    ds_read_b64_tr_b16 v[174:175], v7 offset:29184
    s_waitcnt lgkmcnt(10)
    v_mfma_f32_32x32x16_bf16 v[112:127], v[152:155], a[148:151], v[112:127]
    ds_read_b64_tr_b16 v[144:145], v8 offset:28672
    ds_read_b64_tr_b16 v[146:147], v8 offset:29184
    s_waitcnt lgkmcnt(10)
    v_mfma_f32_32x32x16_bf16 v[128:143], v[156:159], a[148:151], v[128:143]
    ds_read_b64_tr_b16 v[148:149], v9 offset:28672
    ds_read_b64_tr_b16 v[150:151], v9 offset:29184
    s_add_u32 s62, s64, 159744
    buffer_load_dwordx4 a[204:207], v1, s[20:23], s62 offen offset:3072 sc1
    s_waitcnt vmcnt(32) lgkmcnt(10)
    v_mfma_f32_32x32x16_bf16 v[48:63], v[160:163], a[152:155], v[48:63]
    ds_read_b64_tr_b16 v[152:153], v4 offset:30720
    ds_read_b64_tr_b16 v[154:155], v4 offset:31232
    s_waitcnt lgkmcnt(10)
    v_mfma_f32_32x32x16_bf16 v[64:79], v[164:167], a[152:155], v[64:79]
    ds_read_b64_tr_b16 v[156:157], v5 offset:30720
    ds_read_b64_tr_b16 v[158:159], v5 offset:31232
    s_add_u32 m0, s61, 73728
    s_add_u32 s59, s56, 4202496
    buffer_load_dwordx4 v2, s[8:11], s59 offen lds
    s_waitcnt lgkmcnt(10)
    v_mfma_f32_32x32x16_bf16 v[80:95], v[168:171], a[152:155], v[80:95]
    ds_read_b64_tr_b16 v[160:161], v6 offset:30720
    ds_read_b64_tr_b16 v[162:163], v6 offset:31232
    s_waitcnt lgkmcnt(10)
    v_mfma_f32_32x32x16_bf16 v[96:111], v[172:175], a[152:155], v[96:111]
    ds_read_b64_tr_b16 v[164:165], v7 offset:30720
    ds_read_b64_tr_b16 v[166:167], v7 offset:31232
    s_waitcnt lgkmcnt(10)
    v_mfma_f32_32x32x16_bf16 v[112:127], v[144:147], a[152:155], v[112:127]
    ds_read_b64_tr_b16 v[168:169], v8 offset:30720
    ds_read_b64_tr_b16 v[170:171], v8 offset:31232
    s_add_u32 m0, s61, 74752
    s_add_u32 s59, s56, 4211712
    buffer_load_dwordx4 v2, s[8:11], s59 offen lds
    s_waitcnt lgkmcnt(10)
    v_mfma_f32_32x32x16_bf16 v[128:143], v[148:151], a[152:155], v[128:143]
    ds_read_b64_tr_b16 v[172:173], v9 offset:30720
    ds_read_b64_tr_b16 v[174:175], v9 offset:31232
    s_waitcnt vmcnt(33) lgkmcnt(10)
    v_mfma_f32_32x32x16_bf16 v[48:63], v[152:155], a[156:159], v[48:63]
    s_waitcnt vmcnt(26)
    s_barrier
    v_add_u32 v4, 4294868992, v4
    v_add_u32 v5, 4294868992, v5
    v_add_u32 v6, 4294868992, v6
    v_add_u32 v7, 4294868992, v7
    v_add_u32 v8, 4294868992, v8
    v_add_u32 v9, 4294868992, v9
    ds_read_b64_tr_b16 v[144:145], v4 offset:0
    ds_read_b64_tr_b16 v[146:147], v4 offset:512
    s_add_u32 m0, s61, 81920
    s_add_u32 s59, s56, 4202624
    buffer_load_dwordx4 v2, s[8:11], s59 offen lds
    s_waitcnt lgkmcnt(10)
    v_mfma_f32_32x32x16_bf16 v[64:79], v[156:159], a[156:159], v[64:79]
    ds_read_b64_tr_b16 v[148:149], v5 offset:0
    ds_read_b64_tr_b16 v[150:151], v5 offset:512
    s_waitcnt lgkmcnt(10)
    v_mfma_f32_32x32x16_bf16 v[80:95], v[160:163], a[156:159], v[80:95]
    ds_read_b64_tr_b16 v[152:153], v6 offset:0
    ds_read_b64_tr_b16 v[154:155], v6 offset:512
    s_add_u32 m0, s61, 82944
    s_add_u32 s59, s56, 4211840
    buffer_load_dwordx4 v2, s[8:11], s59 offen lds
    s_waitcnt lgkmcnt(10)
    v_mfma_f32_32x32x16_bf16 v[96:111], v[164:167], a[156:159], v[96:111]
    ds_read_b64_tr_b16 v[156:157], v7 offset:0
    ds_read_b64_tr_b16 v[158:159], v7 offset:512
    s_waitcnt lgkmcnt(10)
    v_mfma_f32_32x32x16_bf16 v[112:127], v[168:171], a[156:159], v[112:127]
    ds_read_b64_tr_b16 v[160:161], v8 offset:0
    ds_read_b64_tr_b16 v[162:163], v8 offset:512
    s_waitcnt lgkmcnt(10)
    v_mfma_f32_32x32x16_bf16 v[128:143], v[172:175], a[156:159], v[128:143]
    ds_read_b64_tr_b16 v[164:165], v9 offset:0
    ds_read_b64_tr_b16 v[166:167], v9 offset:512
    s_add_u32 m0, s61, 90112
    s_add_u32 s59, s56, 4202752
    buffer_load_dwordx4 v2, s[8:11], s59 offen lds
    s_waitcnt vmcnt(28) lgkmcnt(10)
    v_mfma_f32_32x32x16_bf16 v[48:63], v[144:147], a[160:163], v[48:63]
    ds_read_b64_tr_b16 v[168:169], v4 offset:2048
    ds_read_b64_tr_b16 v[170:171], v4 offset:2560
    s_waitcnt lgkmcnt(10)
    v_mfma_f32_32x32x16_bf16 v[64:79], v[148:151], a[160:163], v[64:79]
    ds_read_b64_tr_b16 v[172:173], v5 offset:2048
    ds_read_b64_tr_b16 v[174:175], v5 offset:2560
    s_add_u32 m0, s61, 91136
    s_add_u32 s59, s56, 4211968
    buffer_load_dwordx4 v2, s[8:11], s59 offen lds
    s_waitcnt lgkmcnt(10)
    v_mfma_f32_32x32x16_bf16 v[80:95], v[152:155], a[160:163], v[80:95]
    ds_read_b64_tr_b16 v[144:145], v6 offset:2048
    ds_read_b64_tr_b16 v[146:147], v6 offset:2560
    s_waitcnt lgkmcnt(10)
    v_mfma_f32_32x32x16_bf16 v[96:111], v[156:159], a[160:163], v[96:111]
    ds_read_b64_tr_b16 v[148:149], v7 offset:2048
    ds_read_b64_tr_b16 v[150:151], v7 offset:2560
    s_add_u32 s62, s64, 233472
    buffer_load_dwordx4 a[208:211], v1, s[20:23], s62 offen offset:0 sc1
    s_waitcnt lgkmcnt(10)
    v_mfma_f32_32x32x16_bf16 v[112:127], v[160:163], a[160:163], v[112:127]
    ds_read_b64_tr_b16 v[152:153], v8 offset:2048
    ds_read_b64_tr_b16 v[154:155], v8 offset:2560
    s_waitcnt lgkmcnt(10)
    v_mfma_f32_32x32x16_bf16 v[128:143], v[164:167], a[160:163], v[128:143]
    ds_read_b64_tr_b16 v[156:157], v9 offset:2048
    ds_read_b64_tr_b16 v[158:159], v9 offset:2560
    s_waitcnt vmcnt(29) lgkmcnt(10)
    v_mfma_f32_32x32x16_bf16 v[48:63], v[168:171], a[164:167], v[48:63]
    ds_read_b64_tr_b16 v[160:161], v4 offset:4096
    ds_read_b64_tr_b16 v[162:163], v4 offset:4608
    s_add_u32 s62, s64, 233472
    buffer_load_dwordx4 a[212:215], v1, s[20:23], s62 offen offset:1024 sc1
    s_waitcnt lgkmcnt(10)
    v_mfma_f32_32x32x16_bf16 v[64:79], v[172:175], a[164:167], v[64:79]
    ds_read_b64_tr_b16 v[164:165], v5 offset:4096
    ds_read_b64_tr_b16 v[166:167], v5 offset:4608
    s_waitcnt lgkmcnt(10)
    v_mfma_f32_32x32x16_bf16 v[80:95], v[144:147], a[164:167], v[80:95]
    ds_read_b64_tr_b16 v[168:169], v6 offset:4096
    ds_read_b64_tr_b16 v[170:171], v6 offset:4608
    s_add_u32 s62, s64, 233472
    buffer_load_dwordx4 a[216:219], v1, s[20:23], s62 offen offset:2048 sc1
    s_waitcnt lgkmcnt(10)
    v_mfma_f32_32x32x16_bf16 v[96:111], v[148:151], a[164:167], v[96:111]
    ds_read_b64_tr_b16 v[172:173], v7 offset:4096
    ds_read_b64_tr_b16 v[174:175], v7 offset:4608
    s_waitcnt lgkmcnt(10)
    v_mfma_f32_32x32x16_bf16 v[112:127], v[152:155], a[164:167], v[112:127]
    ds_read_b64_tr_b16 v[144:145], v8 offset:4096
    ds_read_b64_tr_b16 v[146:147], v8 offset:4608
    s_add_u32 s62, s64, 233472
    buffer_load_dwordx4 a[220:223], v1, s[20:23], s62 offen offset:3072 sc1
    s_waitcnt lgkmcnt(10)
    v_mfma_f32_32x32x16_bf16 v[128:143], v[156:159], a[164:167], v[128:143]
    ds_read_b64_tr_b16 v[148:149], v9 offset:4096
    ds_read_b64_tr_b16 v[150:151], v9 offset:4608
    s_waitcnt vmcnt(31) lgkmcnt(10)
    v_mfma_f32_32x32x16_bf16 v[48:63], v[160:163], a[168:171], v[48:63]
    ds_read_b64_tr_b16 v[152:153], v4 offset:6144
    ds_read_b64_tr_b16 v[154:155], v4 offset:6656
    s_waitcnt lgkmcnt(10)
    v_mfma_f32_32x32x16_bf16 v[64:79], v[164:167], a[168:171], v[64:79]
    ds_read_b64_tr_b16 v[156:157], v5 offset:6144
    ds_read_b64_tr_b16 v[158:159], v5 offset:6656
    s_add_u32 m0, s60, 98304
    s_add_u32 s59, s92, 1024
    buffer_load_dwordx4 v3, s[12:15], s59 offen lds
    s_waitcnt lgkmcnt(10)
    v_mfma_f32_32x32x16_bf16 v[80:95], v[168:171], a[168:171], v[80:95]
    ds_read_b64_tr_b16 v[160:161], v6 offset:6144
    ds_read_b64_tr_b16 v[162:163], v6 offset:6656
    s_waitcnt lgkmcnt(10)
    v_mfma_f32_32x32x16_bf16 v[96:111], v[172:175], a[168:171], v[96:111]
    ds_read_b64_tr_b16 v[164:165], v7 offset:6144
    ds_read_b64_tr_b16 v[166:167], v7 offset:6656
    s_add_u32 m0, s60, 99328
    s_add_u32 s59, s93, 1024
    buffer_load_dwordx4 v252, s[12:15], s59 offen lds
    s_waitcnt lgkmcnt(10)
    v_mfma_f32_32x32x16_bf16 v[112:127], v[144:147], a[168:171], v[112:127]
    ds_read_b64_tr_b16 v[168:169], v8 offset:6144
    ds_read_b64_tr_b16 v[170:171], v8 offset:6656
    buffer_load_dword v253, v12, s[20:23], s78 offen sc0 sc1
    s_waitcnt lgkmcnt(10)
    v_mfma_f32_32x32x16_bf16 v[128:143], v[148:151], a[168:171], v[128:143]
    ds_read_b64_tr_b16 v[172:173], v9 offset:6144
    ds_read_b64_tr_b16 v[174:175], v9 offset:6656
    s_add_u32 m0, s60, 100352
    s_add_u32 s59, s94, 1024
    buffer_load_dwordx4 v3, s[12:15], s59 offen lds
    s_waitcnt vmcnt(34) lgkmcnt(10)
    v_mfma_f32_32x32x16_bf16 v[48:63], v[152:155], a[172:175], v[48:63]
    s_waitcnt vmcnt(28)
    s_barrier
    ds_read_b64_tr_b16 v[144:145], v4 offset:24576
    ds_read_b64_tr_b16 v[146:147], v4 offset:25088
    s_waitcnt lgkmcnt(10)
    v_mfma_f32_32x32x16_bf16 v[64:79], v[156:159], a[172:175], v[64:79]
    ds_read_b64_tr_b16 v[148:149], v5 offset:24576
    ds_read_b64_tr_b16 v[150:151], v5 offset:25088
    s_waitcnt lgkmcnt(10)
    v_mfma_f32_32x32x16_bf16 v[80:95], v[160:163], a[172:175], v[80:95]
    ds_read_b64_tr_b16 v[152:153], v6 offset:24576
    ds_read_b64_tr_b16 v[154:155], v6 offset:25088
    s_add_u32 m0, s60, 101376
    s_add_u32 s59, s95, 1024
    buffer_load_dwordx4 v252, s[12:15], s59 offen lds
    s_waitcnt lgkmcnt(10)
    v_mfma_f32_32x32x16_bf16 v[96:111], v[164:167], a[172:175], v[96:111]
    ds_read_b64_tr_b16 v[156:157], v7 offset:24576
    ds_read_b64_tr_b16 v[158:159], v7 offset:25088
    s_waitcnt lgkmcnt(10)
    v_mfma_f32_32x32x16_bf16 v[112:127], v[168:171], a[172:175], v[112:127]
    ds_read_b64_tr_b16 v[160:161], v8 offset:24576
    ds_read_b64_tr_b16 v[162:163], v8 offset:25088
    s_add_u32 m0, s60, 102400
    s_add_u32 s59, s96, 1024
    buffer_load_dwordx4 v3, s[12:15], s59 offen lds
    s_waitcnt lgkmcnt(10)
    v_mfma_f32_32x32x16_bf16 v[128:143], v[172:175], a[172:175], v[128:143]
    ds_read_b64_tr_b16 v[164:165], v9 offset:24576
    ds_read_b64_tr_b16 v[166:167], v9 offset:25088
    s_waitcnt vmcnt(29) lgkmcnt(10)
    v_mfma_f32_32x32x16_bf16 v[48:63], v[144:147], a[176:179], v[48:63]
    ds_read_b64_tr_b16 v[168:169], v4 offset:26624
    ds_read_b64_tr_b16 v[170:171], v4 offset:27136
    s_add_u32 m0, s60, 103424
    s_add_u32 s59, s97, 1024
    buffer_load_dwordx4 v252, s[12:15], s59 offen lds
    s_waitcnt lgkmcnt(10)
    v_mfma_f32_32x32x16_bf16 v[64:79], v[148:151], a[176:179], v[64:79]
    ds_read_b64_tr_b16 v[172:173], v5 offset:26624
    ds_read_b64_tr_b16 v[174:175], v5 offset:27136
    s_waitcnt lgkmcnt(10)
    v_mfma_f32_32x32x16_bf16 v[80:95], v[152:155], a[176:179], v[80:95]
    ds_read_b64_tr_b16 v[144:145], v6 offset:26624
    ds_read_b64_tr_b16 v[146:147], v6 offset:27136
    s_waitcnt lgkmcnt(10)
    v_mfma_f32_32x32x16_bf16 v[96:111], v[156:159], a[176:179], v[96:111]
    ds_read_b64_tr_b16 v[148:149], v7 offset:26624
    ds_read_b64_tr_b16 v[150:151], v7 offset:27136
    s_add_u32 m0, s60, 122880
    s_add_u32 s59, s92, 1024
    buffer_load_dwordx4 v3, s[40:43], s59 offen lds
    s_waitcnt lgkmcnt(10)
    v_mfma_f32_32x32x16_bf16 v[112:127], v[160:163], a[176:179], v[112:127]
    ds_read_b64_tr_b16 v[152:153], v8 offset:26624
    ds_read_b64_tr_b16 v[154:155], v8 offset:27136
    s_waitcnt lgkmcnt(10)
    v_mfma_f32_32x32x16_bf16 v[128:143], v[164:167], a[176:179], v[128:143]
    ds_read_b64_tr_b16 v[156:157], v9 offset:26624
    ds_read_b64_tr_b16 v[158:159], v9 offset:27136
    s_add_u32 m0, s60, 123904
    s_add_u32 s59, s93, 1024
    buffer_load_dwordx4 v252, s[40:43], s59 offen lds
    s_waitcnt vmcnt(31) lgkmcnt(10)
    v_mfma_f32_32x32x16_bf16 v[48:63], v[168:171], a[180:183], v[48:63]
    ds_read_b64_tr_b16 v[160:161], v4 offset:28672
    ds_read_b64_tr_b16 v[162:163], v4 offset:29184
    s_waitcnt lgkmcnt(10)
    v_mfma_f32_32x32x16_bf16 v[64:79], v[172:175], a[180:183], v[64:79]
    ds_read_b64_tr_b16 v[164:165], v5 offset:28672
    ds_read_b64_tr_b16 v[166:167], v5 offset:29184
    s_waitcnt lgkmcnt(10)
    v_mfma_f32_32x32x16_bf16 v[80:95], v[144:147], a[180:183], v[80:95]
    ds_read_b64_tr_b16 v[168:169], v6 offset:28672
    ds_read_b64_tr_b16 v[170:171], v6 offset:29184
    s_add_u32 m0, s60, 124928
    s_add_u32 s59, s94, 1024
    buffer_load_dwordx4 v3, s[40:43], s59 offen lds
    s_waitcnt lgkmcnt(10)
    v_mfma_f32_32x32x16_bf16 v[96:111], v[148:151], a[180:183], v[96:111]
    ds_read_b64_tr_b16 v[172:173], v7 offset:28672
    ds_read_b64_tr_b16 v[174:175], v7 offset:29184
    s_waitcnt lgkmcnt(10)
    v_mfma_f32_32x32x16_bf16 v[112:127], v[152:155], a[180:183], v[112:127]
    ds_read_b64_tr_b16 v[144:145], v8 offset:28672
    ds_read_b64_tr_b16 v[146:147], v8 offset:29184
    s_add_u32 m0, s60, 125952
    s_add_u32 s59, s95, 1024
    buffer_load_dwordx4 v252, s[40:43], s59 offen lds
    s_waitcnt lgkmcnt(10)
    v_mfma_f32_32x32x16_bf16 v[128:143], v[156:159], a[180:183], v[128:143]
    ds_read_b64_tr_b16 v[148:149], v9 offset:28672
    ds_read_b64_tr_b16 v[150:151], v9 offset:29184
    s_waitcnt vmcnt(32) lgkmcnt(10)
    v_mfma_f32_32x32x16_bf16 v[48:63], v[160:163], a[184:187], v[48:63]
    ds_read_b64_tr_b16 v[152:153], v4 offset:30720
    ds_read_b64_tr_b16 v[154:155], v4 offset:31232
    s_add_u32 m0, s60, 126976
    s_add_u32 s59, s96, 1024
    buffer_load_dwordx4 v3, s[40:43], s59 offen lds
    s_waitcnt lgkmcnt(10)
    v_mfma_f32_32x32x16_bf16 v[64:79], v[164:167], a[184:187], v[64:79]
    ds_read_b64_tr_b16 v[156:157], v5 offset:30720
    ds_read_b64_tr_b16 v[158:159], v5 offset:31232
    s_waitcnt lgkmcnt(10)
    v_mfma_f32_32x32x16_bf16 v[80:95], v[168:171], a[184:187], v[80:95]
    ds_read_b64_tr_b16 v[160:161], v6 offset:30720
    ds_read_b64_tr_b16 v[162:163], v6 offset:31232
    s_waitcnt lgkmcnt(10)
    v_mfma_f32_32x32x16_bf16 v[96:111], v[172:175], a[184:187], v[96:111]
    ds_read_b64_tr_b16 v[164:165], v7 offset:30720
    ds_read_b64_tr_b16 v[166:167], v7 offset:31232
    s_add_u32 m0, s60, 128000
    s_add_u32 s59, s97, 1024
    buffer_load_dwordx4 v252, s[40:43], s59 offen lds
    s_waitcnt lgkmcnt(10)
    v_mfma_f32_32x32x16_bf16 v[112:127], v[144:147], a[184:187], v[112:127]
    ds_read_b64_tr_b16 v[168:169], v8 offset:30720
    ds_read_b64_tr_b16 v[170:171], v8 offset:31232
    s_waitcnt lgkmcnt(10)
    v_mfma_f32_32x32x16_bf16 v[128:143], v[148:151], a[184:187], v[128:143]
    ds_read_b64_tr_b16 v[172:173], v9 offset:30720
    ds_read_b64_tr_b16 v[174:175], v9 offset:31232
    buffer_load_dwordx4 v[216:219], v13, s[4:7], s30 offen
    s_waitcnt vmcnt(34) lgkmcnt(10)
    v_mfma_f32_32x32x16_bf16 v[48:63], v[152:155], a[188:191], v[48:63]
    s_waitcnt vmcnt(28)
    s_barrier
    v_add_u32 v4, 49152, v4
    v_add_u32 v5, 49152, v5
    v_add_u32 v6, 49152, v6
    v_add_u32 v7, 49152, v7
    v_add_u32 v8, 49152, v8
    v_add_u32 v9, 49152, v9
    ds_read_b64_tr_b16 v[144:145], v4 offset:0
    ds_read_b64_tr_b16 v[146:147], v4 offset:512
    s_waitcnt lgkmcnt(10)
    v_mfma_f32_32x32x16_bf16 v[64:79], v[156:159], a[188:191], v[64:79]
    ds_read_b64_tr_b16 v[148:149], v5 offset:0
    ds_read_b64_tr_b16 v[150:151], v5 offset:512
    s_waitcnt lgkmcnt(10)
    v_mfma_f32_32x32x16_bf16 v[80:95], v[160:163], a[188:191], v[80:95]
    ds_read_b64_tr_b16 v[152:153], v6 offset:0
    ds_read_b64_tr_b16 v[154:155], v6 offset:512
    s_waitcnt lgkmcnt(10)
    v_mfma_f32_32x32x16_bf16 v[96:111], v[164:167], a[188:191], v[96:111]
    ds_read_b64_tr_b16 v[156:157], v7 offset:0
    ds_read_b64_tr_b16 v[158:159], v7 offset:512
    s_waitcnt lgkmcnt(10)
    v_mfma_f32_32x32x16_bf16 v[112:127], v[168:171], a[188:191], v[112:127]
    ds_read_b64_tr_b16 v[160:161], v8 offset:0
    ds_read_b64_tr_b16 v[162:163], v8 offset:512
    s_waitcnt lgkmcnt(10)
    v_mfma_f32_32x32x16_bf16 v[128:143], v[172:175], a[188:191], v[128:143]
    ds_read_b64_tr_b16 v[164:165], v9 offset:0
    ds_read_b64_tr_b16 v[166:167], v9 offset:512
    s_waitcnt vmcnt(27) lgkmcnt(10)
    v_mfma_f32_32x32x16_bf16 v[48:63], v[144:147], a[192:195], v[48:63]
    ds_read_b64_tr_b16 v[168:169], v4 offset:2048
    ds_read_b64_tr_b16 v[170:171], v4 offset:2560
    s_waitcnt lgkmcnt(10)
    v_mfma_f32_32x32x16_bf16 v[64:79], v[148:151], a[192:195], v[64:79]
    ds_read_b64_tr_b16 v[172:173], v5 offset:2048
    ds_read_b64_tr_b16 v[174:175], v5 offset:2560
    s_waitcnt lgkmcnt(10)
    v_mfma_f32_32x32x16_bf16 v[80:95], v[152:155], a[192:195], v[80:95]
    ds_read_b64_tr_b16 v[144:145], v6 offset:2048
    ds_read_b64_tr_b16 v[146:147], v6 offset:2560
    buffer_load_dwordx4 v[220:223], v13, s[4:7], s30 offen offset:16
    s_waitcnt lgkmcnt(10)
    v_mfma_f32_32x32x16_bf16 v[96:111], v[156:159], a[192:195], v[96:111]
    ds_read_b64_tr_b16 v[148:149], v7 offset:2048
    ds_read_b64_tr_b16 v[150:151], v7 offset:2560
    s_waitcnt lgkmcnt(10)
    v_mfma_f32_32x32x16_bf16 v[112:127], v[160:163], a[192:195], v[112:127]
    ds_read_b64_tr_b16 v[152:153], v8 offset:2048
    ds_read_b64_tr_b16 v[154:155], v8 offset:2560
    s_waitcnt lgkmcnt(10)
    v_mfma_f32_32x32x16_bf16 v[128:143], v[164:167], a[192:195], v[128:143]
    ds_read_b64_tr_b16 v[156:157], v9 offset:2048
    ds_read_b64_tr_b16 v[158:159], v9 offset:2560
    buffer_load_dwordx4 v[224:227], v15, s[20:23], s31 offen sc1
    s_waitcnt vmcnt(28) lgkmcnt(10)
    v_mfma_f32_32x32x16_bf16 v[48:63], v[168:171], a[196:199], v[48:63]
    ds_read_b64_tr_b16 v[160:161], v4 offset:4096
    ds_read_b64_tr_b16 v[162:163], v4 offset:4608
    s_waitcnt lgkmcnt(10)
    v_mfma_f32_32x32x16_bf16 v[64:79], v[172:175], a[196:199], v[64:79]
    ds_read_b64_tr_b16 v[164:165], v5 offset:4096
    ds_read_b64_tr_b16 v[166:167], v5 offset:4608
    buffer_load_dwordx4 v[228:231], v15, s[20:23], s31 offen offset:512 sc1
    s_waitcnt lgkmcnt(10)
    v_mfma_f32_32x32x16_bf16 v[80:95], v[144:147], a[196:199], v[80:95]
    ds_read_b64_tr_b16 v[168:169], v6 offset:4096
    ds_read_b64_tr_b16 v[170:171], v6 offset:4608
    s_waitcnt vmcnt(14)
    v_cmp_gt_u32 vcc, 8, v253
    s_nop 4
    s_cbranch_vccnz K3_GSS1
K3_GBS1:
    s_waitcnt lgkmcnt(10)
    v_mfma_f32_32x32x16_bf16 v[96:111], v[148:151], a[196:199], v[96:111]
    ds_read_b64_tr_b16 v[172:173], v7 offset:4096
    ds_read_b64_tr_b16 v[174:175], v7 offset:4608
    s_add_u32 s62, s72, 32768
    buffer_load_dwordx4 a[224:227], v1, s[20:23], s62 offen offset:0 sc1
    s_waitcnt lgkmcnt(10)
    v_mfma_f32_32x32x16_bf16 v[112:127], v[152:155], a[196:199], v[112:127]
    ds_read_b64_tr_b16 v[144:145], v8 offset:4096
    ds_read_b64_tr_b16 v[146:147], v8 offset:4608
    s_add_u32 s62, s72, 32768
    buffer_load_dwordx4 a[228:231], v1, s[20:23], s62 offen offset:1024 sc1
    s_waitcnt lgkmcnt(10)
    v_mfma_f32_32x32x16_bf16 v[128:143], v[156:159], a[196:199], v[128:143]
    ds_read_b64_tr_b16 v[148:149], v9 offset:4096
    ds_read_b64_tr_b16 v[150:151], v9 offset:4608
    s_add_u32 s62, s72, 32768
    buffer_load_dwordx4 a[232:235], v1, s[20:23], s62 offen offset:2048 sc1
    s_waitcnt lgkmcnt(10)
    v_mfma_f32_32x32x16_bf16 v[48:63], v[160:163], a[200:203], v[48:63]
    ds_read_b64_tr_b16 v[152:153], v4 offset:6144
    ds_read_b64_tr_b16 v[154:155], v4 offset:6656
    s_add_u32 s62, s72, 32768
    buffer_load_dwordx4 a[236:239], v1, s[20:23], s62 offen offset:3072 sc1
    s_waitcnt lgkmcnt(10)
    v_mfma_f32_32x32x16_bf16 v[64:79], v[164:167], a[200:203], v[64:79]
    ds_read_b64_tr_b16 v[156:157], v5 offset:6144
    ds_read_b64_tr_b16 v[158:159], v5 offset:6656
    s_waitcnt lgkmcnt(10)
    v_mfma_f32_32x32x16_bf16 v[80:95], v[168:171], a[200:203], v[80:95]
    ds_read_b64_tr_b16 v[160:161], v6 offset:6144
    ds_read_b64_tr_b16 v[162:163], v6 offset:6656
    s_waitcnt lgkmcnt(10)
    v_mfma_f32_32x32x16_bf16 v[96:111], v[172:175], a[200:203], v[96:111]
    ds_read_b64_tr_b16 v[164:165], v7 offset:6144
    ds_read_b64_tr_b16 v[166:167], v7 offset:6656
    s_waitcnt lgkmcnt(10)
    v_mfma_f32_32x32x16_bf16 v[112:127], v[144:147], a[200:203], v[112:127]
    ds_read_b64_tr_b16 v[168:169], v8 offset:6144
    ds_read_b64_tr_b16 v[170:171], v8 offset:6656
    s_waitcnt lgkmcnt(10)
    v_mfma_f32_32x32x16_bf16 v[128:143], v[148:151], a[200:203], v[128:143]
    ds_read_b64_tr_b16 v[172:173], v9 offset:6144
    ds_read_b64_tr_b16 v[174:175], v9 offset:6656
    s_waitcnt lgkmcnt(10)
    v_mfma_f32_32x32x16_bf16 v[48:63], v[152:155], a[204:207], v[48:63]
    s_barrier
    ds_read_b64_tr_b16 v[144:145], v4 offset:24576
    ds_read_b64_tr_b16 v[146:147], v4 offset:25088
    s_waitcnt lgkmcnt(10)
    v_mfma_f32_32x32x16_bf16 v[64:79], v[156:159], a[204:207], v[64:79]
    ds_read_b64_tr_b16 v[148:149], v5 offset:24576
    ds_read_b64_tr_b16 v[150:151], v5 offset:25088
    s_add_u32 s62, s72, 69632
    buffer_load_dwordx4 a[240:243], v1, s[20:23], s62 offen offset:0 sc1
    s_waitcnt lgkmcnt(10)
    v_mfma_f32_32x32x16_bf16 v[80:95], v[160:163], a[204:207], v[80:95]
    ds_read_b64_tr_b16 v[152:153], v6 offset:24576
    ds_read_b64_tr_b16 v[154:155], v6 offset:25088
    s_waitcnt lgkmcnt(10)
    v_mfma_f32_32x32x16_bf16 v[96:111], v[164:167], a[204:207], v[96:111]
    ds_read_b64_tr_b16 v[156:157], v7 offset:24576
    ds_read_b64_tr_b16 v[158:159], v7 offset:25088
    s_add_u32 s62, s72, 69632
    buffer_load_dwordx4 a[244:247], v1, s[20:23], s62 offen offset:1024 sc1
    s_waitcnt lgkmcnt(10)
    v_mfma_f32_32x32x16_bf16 v[112:127], v[168:171], a[204:207], v[112:127]
    ds_read_b64_tr_b16 v[160:161], v8 offset:24576
    ds_read_b64_tr_b16 v[162:163], v8 offset:25088
    s_waitcnt lgkmcnt(10)
    v_mfma_f32_32x32x16_bf16 v[128:143], v[172:175], a[204:207], v[128:143]
    ds_read_b64_tr_b16 v[164:165], v9 offset:24576
    ds_read_b64_tr_b16 v[166:167], v9 offset:25088
    s_waitcnt lgkmcnt(10)
    v_mfma_f32_32x32x16_bf16 v[48:63], v[144:147], a[208:211], v[48:63]
    ds_read_b64_tr_b16 v[168:169], v4 offset:26624
    ds_read_b64_tr_b16 v[170:171], v4 offset:27136
    s_add_u32 s62, s72, 69632
    buffer_load_dwordx4 a[248:251], v1, s[20:23], s62 offen offset:2048 sc1
    s_waitcnt lgkmcnt(10)
    v_mfma_f32_32x32x16_bf16 v[64:79], v[148:151], a[208:211], v[64:79]
    ds_read_b64_tr_b16 v[172:173], v5 offset:26624
    ds_read_b64_tr_b16 v[174:175], v5 offset:27136
    s_waitcnt lgkmcnt(10)
    v_mfma_f32_32x32x16_bf16 v[80:95], v[152:155], a[208:211], v[80:95]
    ds_read_b64_tr_b16 v[144:145], v6 offset:26624
    ds_read_b64_tr_b16 v[146:147], v6 offset:27136
    s_add_u32 s62, s72, 69632
    buffer_load_dwordx4 a[252:255], v1, s[20:23], s62 offen offset:3072 sc1
    s_waitcnt lgkmcnt(10)
    v_mfma_f32_32x32x16_bf16 v[96:111], v[156:159], a[208:211], v[96:111]
    ds_read_b64_tr_b16 v[148:149], v7 offset:26624
    ds_read_b64_tr_b16 v[150:151], v7 offset:27136
    s_waitcnt lgkmcnt(10)
    v_mfma_f32_32x32x16_bf16 v[112:127], v[160:163], a[208:211], v[112:127]
    ds_read_b64_tr_b16 v[152:153], v8 offset:26624
    ds_read_b64_tr_b16 v[154:155], v8 offset:27136
    buffer_load_dwordx4 v[232:235], v14, s[32:35], s30 offen
    s_waitcnt lgkmcnt(10)
    v_mfma_f32_32x32x16_bf16 v[128:143], v[164:167], a[208:211], v[128:143]
    ds_read_b64_tr_b16 v[156:157], v9 offset:26624
    ds_read_b64_tr_b16 v[158:159], v9 offset:27136
    buffer_load_dwordx4 v[236:239], v14, s[32:35], s30 offen offset:16
    s_waitcnt lgkmcnt(10)
    v_mfma_f32_32x32x16_bf16 v[48:63], v[168:171], a[212:215], v[48:63]
    ds_read_b64_tr_b16 v[160:161], v4 offset:28672
    ds_read_b64_tr_b16 v[162:163], v4 offset:29184
    buffer_load_dwordx4 v[16:19], v13, s[4:7], s75 offen
    s_waitcnt lgkmcnt(10)
    v_mfma_f32_32x32x16_bf16 v[64:79], v[172:175], a[212:215], v[64:79]
    ds_read_b64_tr_b16 v[164:165], v5 offset:28672
    ds_read_b64_tr_b16 v[166:167], v5 offset:29184
    s_waitcnt lgkmcnt(10)
    v_mfma_f32_32x32x16_bf16 v[80:95], v[144:147], a[212:215], v[80:95]
    ds_read_b64_tr_b16 v[168:169], v6 offset:28672
    ds_read_b64_tr_b16 v[170:171], v6 offset:29184
    s_waitcnt lgkmcnt(10)
    v_mfma_f32_32x32x16_bf16 v[96:111], v[148:151], a[212:215], v[96:111]
    ds_read_b64_tr_b16 v[172:173], v7 offset:28672
    ds_read_b64_tr_b16 v[174:175], v7 offset:29184
    s_waitcnt lgkmcnt(10)
    v_mfma_f32_32x32x16_bf16 v[112:127], v[152:155], a[212:215], v[112:127]
    ds_read_b64_tr_b16 v[144:145], v8 offset:28672
    ds_read_b64_tr_b16 v[146:147], v8 offset:29184
    s_waitcnt lgkmcnt(10)
    v_mfma_f32_32x32x16_bf16 v[128:143], v[156:159], a[212:215], v[128:143]
    ds_read_b64_tr_b16 v[148:149], v9 offset:28672
    ds_read_b64_tr_b16 v[150:151], v9 offset:29184
    s_waitcnt lgkmcnt(10)
    v_mfma_f32_32x32x16_bf16 v[48:63], v[160:163], a[216:219], v[48:63]
    ds_read_b64_tr_b16 v[152:153], v4 offset:30720
    ds_read_b64_tr_b16 v[154:155], v4 offset:31232
    s_waitcnt lgkmcnt(10)
    v_mfma_f32_32x32x16_bf16 v[64:79], v[164:167], a[216:219], v[64:79]
    ds_read_b64_tr_b16 v[156:157], v5 offset:30720
    ds_read_b64_tr_b16 v[158:159], v5 offset:31232
    s_waitcnt lgkmcnt(10)
    v_mfma_f32_32x32x16_bf16 v[80:95], v[168:171], a[216:219], v[80:95]
    ds_read_b64_tr_b16 v[160:161], v6 offset:30720
    ds_read_b64_tr_b16 v[162:163], v6 offset:31232
    s_waitcnt lgkmcnt(10)
    v_mfma_f32_32x32x16_bf16 v[96:111], v[172:175], a[216:219], v[96:111]
    ds_read_b64_tr_b16 v[164:165], v7 offset:30720
    ds_read_b64_tr_b16 v[166:167], v7 offset:31232
    buffer_load_dwordx4 v[20:23], v13, s[4:7], s75 offen offset:16
    s_waitcnt lgkmcnt(10)
    v_mfma_f32_32x32x16_bf16 v[112:127], v[144:147], a[216:219], v[112:127]
    ds_read_b64_tr_b16 v[168:169], v8 offset:30720
    ds_read_b64_tr_b16 v[170:171], v8 offset:31232
    s_waitcnt lgkmcnt(10)
    v_mfma_f32_32x32x16_bf16 v[128:143], v[148:151], a[216:219], v[128:143]
    ds_read_b64_tr_b16 v[172:173], v9 offset:30720
    ds_read_b64_tr_b16 v[174:175], v9 offset:31232
    buffer_load_dwordx4 v[24:27], v15, s[20:23], s76 offen sc1
    s_waitcnt lgkmcnt(10)
    v_mfma_f32_32x32x16_bf16 v[48:63], v[152:155], a[220:223], v[48:63]
    s_waitcnt vmcnt(23)
    s_barrier
    v_add_u32 v248, 98304, v248
    v_add_u32 v249, 98304, v249
    v_add_u32 v250, 98304, v250
    v_add_u32 v251, 98304, v251
    ds_read_b128 v[144:147], v248 offset:0
    s_waitcnt lgkmcnt(9)
    v_mfma_f32_32x32x16_bf16 v[64:79], v[156:159], a[220:223], v[64:79]
    ds_read_b128 v[148:151], v248 offset:4096
    s_waitcnt lgkmcnt(8)
    v_mfma_f32_32x32x16_bf16 v[80:95], v[160:163], a[220:223], v[80:95]
    ds_read_b128 v[152:155], v248 offset:8192
    buffer_load_dwordx4 v[28:31], v15, s[20:23], s76 offen offset:512 sc1
    s_waitcnt lgkmcnt(7)
    v_mfma_f32_32x32x16_bf16 v[96:111], v[164:167], a[220:223], v[96:111]
    ds_read_b128 v[156:159], v248 offset:12288
    s_waitcnt lgkmcnt(6)
    v_mfma_f32_32x32x16_bf16 v[112:127], v[168:171], a[220:223], v[112:127]
    ds_read_b128 v[160:163], v248 offset:16384
    buffer_load_dwordx4 v[32:35], v14, s[32:35], s75 offen
    s_waitcnt lgkmcnt(5)
    v_mfma_f32_32x32x16_bf16 v[128:143], v[172:175], a[220:223], v[128:143]
    ds_read_b128 v[164:167], v248 offset:20480
    buffer_load_dwordx4 v[36:39], v14, s[32:35], s75 offen offset:16
    s_waitcnt vmcnt(15) lgkmcnt(5)
    v_mfma_f32_32x32x16_bf16 v[48:63], v[144:147], a[224:227], v[48:63]
    ds_read_b128 v[168:171], v249 offset:0
    s_waitcnt lgkmcnt(5)
    v_mfma_f32_32x32x16_bf16 v[64:79], v[148:151], a[224:227], v[64:79]
    ds_read_b128 v[172:175], v249 offset:4096
    s_waitcnt lgkmcnt(5)
    v_mfma_f32_32x32x16_bf16 v[80:95], v[152:155], a[224:227], v[80:95]
    ds_read_b128 v[144:147], v249 offset:8192
    s_waitcnt lgkmcnt(5)
    v_mfma_f32_32x32x16_bf16 v[96:111], v[156:159], a[224:227], v[96:111]
    ds_read_b128 v[148:151], v249 offset:12288
    s_waitcnt lgkmcnt(5)
    v_mfma_f32_32x32x16_bf16 v[112:127], v[160:163], a[224:227], v[112:127]
    ds_read_b128 v[152:155], v249 offset:16384
    s_waitcnt lgkmcnt(5)
    v_mfma_f32_32x32x16_bf16 v[128:143], v[164:167], a[224:227], v[128:143]
    ds_read_b128 v[156:159], v249 offset:20480
    s_waitcnt vmcnt(14) lgkmcnt(5)
    v_mfma_f32_32x32x16_bf16 v[48:63], v[168:171], a[228:231], v[48:63]
    ds_read_b128 v[160:163], v250 offset:0
    s_waitcnt lgkmcnt(5)
    v_mfma_f32_32x32x16_bf16 v[64:79], v[172:175], a[228:231], v[64:79]
    ds_read_b128 v[164:167], v250 offset:4096
    s_waitcnt lgkmcnt(5)
    v_mfma_f32_32x32x16_bf16 v[80:95], v[144:147], a[228:231], v[80:95]
    ds_read_b128 v[168:171], v250 offset:8192
    s_waitcnt lgkmcnt(5)
    v_mfma_f32_32x32x16_bf16 v[96:111], v[148:151], a[228:231], v[96:111]
    ds_read_b128 v[172:175], v250 offset:12288
    s_waitcnt lgkmcnt(5)
    v_mfma_f32_32x32x16_bf16 v[112:127], v[152:155], a[228:231], v[112:127]
    ds_read_b128 v[144:147], v250 offset:16384
    s_waitcnt lgkmcnt(5)
    v_mfma_f32_32x32x16_bf16 v[128:143], v[156:159], a[228:231], v[128:143]
    ds_read_b128 v[148:151], v250 offset:20480
    s_waitcnt vmcnt(13) lgkmcnt(5)
    v_mfma_f32_32x32x16_bf16 v[48:63], v[160:163], a[232:235], v[48:63]
    ds_read_b128 v[152:155], v251 offset:0
    s_waitcnt lgkmcnt(5)
    v_mfma_f32_32x32x16_bf16 v[64:79], v[164:167], a[232:235], v[64:79]
    ds_read_b128 v[156:159], v251 offset:4096
    s_waitcnt lgkmcnt(5)
    v_mfma_f32_32x32x16_bf16 v[80:95], v[168:171], a[232:235], v[80:95]
    ds_read_b128 v[160:163], v251 offset:8192
    s_waitcnt lgkmcnt(5)
    v_mfma_f32_32x32x16_bf16 v[96:111], v[172:175], a[232:235], v[96:111]
    ds_read_b128 v[164:167], v251 offset:12288
    s_waitcnt lgkmcnt(5)
    v_mfma_f32_32x32x16_bf16 v[112:127], v[144:147], a[232:235], v[112:127]
    ds_read_b128 v[168:171], v251 offset:16384
    s_waitcnt lgkmcnt(5)
    v_mfma_f32_32x32x16_bf16 v[128:143], v[148:151], a[232:235], v[128:143]
    ds_read_b128 v[172:175], v251 offset:20480
    s_waitcnt vmcnt(12) lgkmcnt(5)
    v_mfma_f32_32x32x16_bf16 v[48:63], v[152:155], a[236:239], v[48:63]
    s_barrier
    ds_read_b128 v[144:147], v248 offset:24576
    s_waitcnt lgkmcnt(5)
    v_mfma_f32_32x32x16_bf16 v[64:79], v[156:159], a[236:239], v[64:79]
    ds_read_b128 v[148:151], v249 offset:24576
    s_waitcnt lgkmcnt(5)
    v_mfma_f32_32x32x16_bf16 v[80:95], v[160:163], a[236:239], v[80:95]
    ds_read_b128 v[152:155], v250 offset:24576
    s_waitcnt lgkmcnt(5)
    v_mfma_f32_32x32x16_bf16 v[96:111], v[164:167], a[236:239], v[96:111]
    ds_read_b128 v[156:159], v251 offset:24576
    s_waitcnt lgkmcnt(5)
    v_mfma_f32_32x32x16_bf16 v[112:127], v[168:171], a[236:239], v[112:127]
    ds_read_b128 v[160:163], v248 offset:28672
    s_waitcnt lgkmcnt(5)
    v_mfma_f32_32x32x16_bf16 v[128:143], v[172:175], a[236:239], v[128:143]
    ds_read_b128 v[164:167], v249 offset:28672
    s_waitcnt vmcnt(11) lgkmcnt(5)
    v_mfma_f32_32x32x16_bf16 v[48:63], v[144:147], a[240:243], v[48:63]
    ds_read_b128 v[168:171], v250 offset:28672
    s_waitcnt vmcnt(10) lgkmcnt(5)
    v_mfma_f32_32x32x16_bf16 v[48:63], v[148:151], a[244:247], v[48:63]
    ds_read_b128 v[172:175], v251 offset:28672
    s_waitcnt vmcnt(9) lgkmcnt(5)
    v_mfma_f32_32x32x16_bf16 v[48:63], v[152:155], a[248:251], v[48:63]
    ds_read_b128 v[144:147], v248 offset:32768
    s_waitcnt vmcnt(8) lgkmcnt(5)
    v_mfma_f32_32x32x16_bf16 v[48:63], v[156:159], a[252:255], v[48:63]
    ds_read_b128 v[148:151], v249 offset:32768
    s_waitcnt lgkmcnt(5)
    v_mfma_f32_32x32x16_bf16 v[64:79], v[160:163], a[240:243], v[64:79]
    ds_read_b128 v[152:155], v250 offset:32768
    s_waitcnt lgkmcnt(5)
    v_mfma_f32_32x32x16_bf16 v[64:79], v[164:167], a[244:247], v[64:79]
    ds_read_b128 v[156:159], v251 offset:32768
    s_nop 4
    v_cvt_pk_bf16_f32 v176, v48, v49
    v_cvt_pk_bf16_f32 v177, v50, v51
    v_cvt_pk_bf16_f32 v178, v52, v53
    v_cvt_pk_bf16_f32 v179, v54, v55
    buffer_store_dwordx4 v[176:179], v1, s[20:23], s24 offen offset:0 sc0 sc1
    s_waitcnt lgkmcnt(5)
    v_mfma_f32_32x32x16_bf16 v[64:79], v[168:171], a[248:251], v[64:79]
    ds_read_b128 v[160:163], v248 offset:36864
    v_cvt_pk_bf16_f32 v180, v56, v57
    v_cvt_pk_bf16_f32 v181, v58, v59
    v_cvt_pk_bf16_f32 v182, v60, v61
    v_cvt_pk_bf16_f32 v183, v62, v63
    buffer_store_dwordx4 v[180:183], v1, s[20:23], s24 offen offset:1024 sc0 sc1
    s_waitcnt lgkmcnt(5)
    v_mfma_f32_32x32x16_bf16 v[64:79], v[172:175], a[252:255], v[64:79]
    ds_read_b128 v[164:167], v249 offset:36864
    s_waitcnt lgkmcnt(5)
    v_mfma_f32_32x32x16_bf16 v[80:95], v[144:147], a[240:243], v[80:95]
    ds_read_b128 v[168:171], v250 offset:36864
    s_waitcnt lgkmcnt(5)
    v_mfma_f32_32x32x16_bf16 v[80:95], v[148:151], a[244:247], v[80:95]
    ds_read_b128 v[172:175], v251 offset:36864
    s_nop 4
    v_cvt_pk_bf16_f32 v184, v64, v65
    v_cvt_pk_bf16_f32 v185, v66, v67
    v_cvt_pk_bf16_f32 v186, v68, v69
    v_cvt_pk_bf16_f32 v187, v70, v71
    buffer_store_dwordx4 v[184:187], v1, s[20:23], s25 offen offset:0 sc0 sc1
    s_waitcnt lgkmcnt(5)
    v_mfma_f32_32x32x16_bf16 v[80:95], v[152:155], a[248:251], v[80:95]
    ds_read_b128 v[144:147], v248 offset:40960
    v_cvt_pk_bf16_f32 v188, v72, v73
    v_cvt_pk_bf16_f32 v189, v74, v75
    v_cvt_pk_bf16_f32 v190, v76, v77
    v_cvt_pk_bf16_f32 v191, v78, v79
    buffer_store_dwordx4 v[188:191], v1, s[20:23], s25 offen offset:1024 sc0 sc1
    s_waitcnt lgkmcnt(5)
    v_mfma_f32_32x32x16_bf16 v[80:95], v[156:159], a[252:255], v[80:95]
    ds_read_b128 v[148:151], v249 offset:40960
    s_waitcnt lgkmcnt(5)
    v_mfma_f32_32x32x16_bf16 v[96:111], v[160:163], a[240:243], v[96:111]
    ds_read_b128 v[152:155], v250 offset:40960
    s_waitcnt lgkmcnt(5)
    v_mfma_f32_32x32x16_bf16 v[96:111], v[164:167], a[244:247], v[96:111]
    ds_read_b128 v[156:159], v251 offset:40960
    s_nop 4
    v_cvt_pk_bf16_f32 v192, v80, v81
    v_cvt_pk_bf16_f32 v193, v82, v83
    v_cvt_pk_bf16_f32 v194, v84, v85
    v_cvt_pk_bf16_f32 v195, v86, v87
    buffer_store_dwordx4 v[192:195], v1, s[20:23], s26 offen offset:0 sc0 sc1
    s_waitcnt lgkmcnt(5)
    v_mfma_f32_32x32x16_bf16 v[96:111], v[168:171], a[248:251], v[96:111]
    ds_read_b128 v[160:163], v248 offset:45056
    v_cvt_pk_bf16_f32 v196, v88, v89
    v_cvt_pk_bf16_f32 v197, v90, v91
    v_cvt_pk_bf16_f32 v198, v92, v93
    v_cvt_pk_bf16_f32 v199, v94, v95
    buffer_store_dwordx4 v[196:199], v1, s[20:23], s26 offen offset:1024 sc0 sc1
    s_waitcnt lgkmcnt(5)
    v_mfma_f32_32x32x16_bf16 v[96:111], v[172:175], a[252:255], v[96:111]
    ds_read_b128 v[164:167], v249 offset:45056
    s_waitcnt lgkmcnt(5)
    v_mfma_f32_32x32x16_bf16 v[112:127], v[144:147], a[240:243], v[112:127]
    ds_read_b128 v[168:171], v250 offset:45056
    s_waitcnt lgkmcnt(5)
    v_mfma_f32_32x32x16_bf16 v[112:127], v[148:151], a[244:247], v[112:127]
    ds_read_b128 v[172:175], v251 offset:45056
    s_nop 4
    v_cvt_pk_bf16_f32 v200, v96, v97
    v_cvt_pk_bf16_f32 v201, v98, v99
    v_cvt_pk_bf16_f32 v202, v100, v101
    v_cvt_pk_bf16_f32 v203, v102, v103
    buffer_store_dwordx4 v[200:203], v1, s[20:23], s27 offen offset:0 sc0 sc1
    s_waitcnt lgkmcnt(5)
    v_mfma_f32_32x32x16_bf16 v[112:127], v[152:155], a[248:251], v[112:127]
    v_cvt_pk_bf16_f32 v204, v104, v105
    v_cvt_pk_bf16_f32 v205, v106, v107
    v_cvt_pk_bf16_f32 v206, v108, v109
    v_cvt_pk_bf16_f32 v207, v110, v111
    buffer_store_dwordx4 v[204:207], v1, s[20:23], s27 offen offset:1024 sc0 sc1
    s_waitcnt lgkmcnt(4)
    v_mfma_f32_32x32x16_bf16 v[112:127], v[156:159], a[252:255], v[112:127]
    s_waitcnt lgkmcnt(3)
    v_mfma_f32_32x32x16_bf16 v[128:143], v[160:163], a[240:243], v[128:143]
    s_waitcnt lgkmcnt(2)
    v_mfma_f32_32x32x16_bf16 v[128:143], v[164:167], a[244:247], v[128:143]
    s_nop 7
    v_cvt_pk_bf16_f32 v208, v112, v113
    v_cvt_pk_bf16_f32 v209, v114, v115
    v_cvt_pk_bf16_f32 v210, v116, v117
    v_cvt_pk_bf16_f32 v211, v118, v119
    buffer_store_dwordx4 v[208:211], v1, s[20:23], s28 offen offset:0 sc0 sc1
    s_waitcnt lgkmcnt(1)
    v_mfma_f32_32x32x16_bf16 v[128:143], v[168:171], a[248:251], v[128:143]
    v_cvt_pk_bf16_f32 v212, v120, v121
    v_cvt_pk_bf16_f32 v213, v122, v123
    v_cvt_pk_bf16_f32 v214, v124, v125
    v_cvt_pk_bf16_f32 v215, v126, v127
    buffer_store_dwordx4 v[212:215], v1, s[20:23], s28 offen offset:1024 sc0 sc1
    s_waitcnt lgkmcnt(0)
    v_mfma_f32_32x32x16_bf16 v[128:143], v[172:175], a[252:255], v[128:143]
    s_waitcnt vmcnt(0)
K3_RED:
    v_mov_b32 v253, 1
    v_cmp_eq_u32 vcc, 0, v0
    s_nop 1
    v_cndmask_b32 v254, 2.0, v0, vcc
    buffer_atomic_add v253, v254, s[20:23], s69 offen sc1
    s_mov_b32 s70, 0
    v_lshlrev_b32 v10, 16, v224
    v_and_b32 v224, 0xffff0000, v224
    v_lshlrev_b32 v11, 16, v232
    v_and_b32 v232, 0xffff0000, v232
    v_mul_f32 v10, v10, v11
    v_mul_f32 v224, v224, v232
    v_cvt_pk_bf16_f32 v224, v10, v224
    v_lshlrev_b32 v10, 16, v224
    v_and_b32 v224, 0xffff0000, v224
    v_lshlrev_b32 v11, 16, v216
    v_and_b32 v216, 0xffff0000, v216
    v_add_f32 v10, v10, v11
    v_add_f32 v224, v224, v216
    v_add_f32 v128, v128, v10
    v_add_f32 v129, v129, v224
    v_lshlrev_b32 v10, 16, v225
    v_and_b32 v225, 0xffff0000, v225
    v_lshlrev_b32 v11, 16, v233
    v_and_b32 v233, 0xffff0000, v233
    v_mul_f32 v10, v10, v11
    v_mul_f32 v225, v225, v233
    v_cvt_pk_bf16_f32 v225, v10, v225
    v_lshlrev_b32 v10, 16, v225
    v_and_b32 v225, 0xffff0000, v225
    v_lshlrev_b32 v11, 16, v217
    v_and_b32 v217, 0xffff0000, v217
    v_add_f32 v10, v10, v11
    v_add_f32 v225, v225, v217
    v_add_f32 v130, v130, v10
    v_add_f32 v131, v131, v225
    v_lshlrev_b32 v10, 16, v226
    v_and_b32 v226, 0xffff0000, v226
    v_lshlrev_b32 v11, 16, v234
    v_and_b32 v234, 0xffff0000, v234
    v_mul_f32 v10, v10, v11
    v_mul_f32 v226, v226, v234
    v_cvt_pk_bf16_f32 v226, v10, v226
    v_lshlrev_b32 v10, 16, v226
    v_and_b32 v226, 0xffff0000, v226
    v_lshlrev_b32 v11, 16, v218
    v_and_b32 v218, 0xffff0000, v218
    v_add_f32 v10, v10, v11
    v_add_f32 v226, v226, v218
    v_add_f32 v132, v132, v10
    v_add_f32 v133, v133, v226
    v_lshlrev_b32 v10, 16, v227
    v_and_b32 v227, 0xffff0000, v227
    v_lshlrev_b32 v11, 16, v235
    v_and_b32 v235, 0xffff0000, v235
    v_mul_f32 v10, v10, v11
    v_mul_f32 v227, v227, v235
    v_cvt_pk_bf16_f32 v227, v10, v227
    v_lshlrev_b32 v10, 16, v227
    v_and_b32 v227, 0xffff0000, v227
    v_lshlrev_b32 v11, 16, v219
    v_and_b32 v219, 0xffff0000, v219
    v_add_f32 v10, v10, v11
    v_add_f32 v227, v227, v219
    v_add_f32 v134, v134, v10
    v_add_f32 v135, v135, v227
    v_lshlrev_b32 v10, 16, v228
    v_and_b32 v228, 0xffff0000, v228
    v_lshlrev_b32 v11, 16, v236
    v_and_b32 v236, 0xffff0000, v236
    v_mul_f32 v10, v10, v11
    v_mul_f32 v228, v228, v236
    v_cvt_pk_bf16_f32 v228, v10, v228
    v_lshlrev_b32 v10, 16, v228
    v_and_b32 v228, 0xffff0000, v228
    v_lshlrev_b32 v11, 16, v220
    v_and_b32 v220, 0xffff0000, v220
    v_add_f32 v10, v10, v11
    v_add_f32 v228, v228, v220
    v_add_f32 v136, v136, v10
    v_add_f32 v137, v137, v228
    v_lshlrev_b32 v10, 16, v229
    v_and_b32 v229, 0xffff0000, v229
    v_lshlrev_b32 v11, 16, v237
    v_and_b32 v237, 0xffff0000, v237
    v_mul_f32 v10, v10, v11
    v_mul_f32 v229, v229, v237
    v_cvt_pk_bf16_f32 v229, v10, v229
    v_lshlrev_b32 v10, 16, v229
    v_and_b32 v229, 0xffff0000, v229
    v_lshlrev_b32 v11, 16, v221
    v_and_b32 v221, 0xffff0000, v221
    v_add_f32 v10, v10, v11
    v_add_f32 v229, v229, v221
    v_add_f32 v138, v138, v10
    v_add_f32 v139, v139, v229
    v_lshlrev_b32 v10, 16, v230
    v_and_b32 v230, 0xffff0000, v230
    v_lshlrev_b32 v11, 16, v238
    v_and_b32 v238, 0xffff0000, v238
    v_mul_f32 v10, v10, v11
    v_mul_f32 v230, v230, v238
    v_cvt_pk_bf16_f32 v230, v10, v230
    v_lshlrev_b32 v10, 16, v230
    v_and_b32 v230, 0xffff0000, v230
    v_lshlrev_b32 v11, 16, v222
    v_and_b32 v222, 0xffff0000, v222
    v_add_f32 v10, v10, v11
    v_add_f32 v230, v230, v222
    v_add_f32 v140, v140, v10
    v_add_f32 v141, v141, v230
    v_lshlrev_b32 v10, 16, v231
    v_and_b32 v231, 0xffff0000, v231
    v_lshlrev_b32 v11, 16, v239
    v_and_b32 v239, 0xffff0000, v239
    v_mul_f32 v10, v10, v11
    v_mul_f32 v231, v231, v239
    v_cvt_pk_bf16_f32 v231, v10, v231
    v_lshlrev_b32 v10, 16, v231
    v_and_b32 v231, 0xffff0000, v231
    v_lshlrev_b32 v11, 16, v223
    v_and_b32 v223, 0xffff0000, v223
    v_add_f32 v10, v10, v11
    v_add_f32 v231, v231, v223
    v_add_f32 v142, v142, v10
    v_add_f32 v143, v143, v231
    v_lshlrev_b32 v10, 16, v24
    v_and_b32 v24, 0xffff0000, v24
    v_lshlrev_b32 v11, 16, v32
    v_and_b32 v32, 0xffff0000, v32
    v_mul_f32 v10, v10, v11
    v_mul_f32 v24, v24, v32
    v_cvt_pk_bf16_f32 v24, v10, v24
    v_lshlrev_b32 v10, 16, v24
    v_and_b32 v24, 0xffff0000, v24
    v_lshlrev_b32 v11, 16, v16
    v_and_b32 v16, 0xffff0000, v16
    v_add_f32 v10, v10, v11
    v_add_f32 v24, v24, v16
    v_add_f32 v48, v48, v10
    v_add_f32 v49, v49, v24
    v_lshlrev_b32 v10, 16, v25
    v_and_b32 v25, 0xffff0000, v25
    v_lshlrev_b32 v11, 16, v33
    v_and_b32 v33, 0xffff0000, v33
    v_mul_f32 v10, v10, v11
    v_mul_f32 v25, v25, v33
    v_cvt_pk_bf16_f32 v25, v10, v25
    v_lshlrev_b32 v10, 16, v25
    v_and_b32 v25, 0xffff0000, v25
    v_lshlrev_b32 v11, 16, v17
    v_and_b32 v17, 0xffff0000, v17
    v_add_f32 v10, v10, v11
    v_add_f32 v25, v25, v17
    v_add_f32 v50, v50, v10
    v_add_f32 v51, v51, v25
    v_lshlrev_b32 v10, 16, v26
    v_and_b32 v26, 0xffff0000, v26
    v_lshlrev_b32 v11, 16, v34
    v_and_b32 v34, 0xffff0000, v34
    v_mul_f32 v10, v10, v11
    v_mul_f32 v26, v26, v34
    v_cvt_pk_bf16_f32 v26, v10, v26
    v_lshlrev_b32 v10, 16, v26
    v_and_b32 v26, 0xffff0000, v26
    v_lshlrev_b32 v11, 16, v18
    v_and_b32 v18, 0xffff0000, v18
    v_add_f32 v10, v10, v11
    v_add_f32 v26, v26, v18
    v_add_f32 v52, v52, v10
    v_add_f32 v53, v53, v26
    v_lshlrev_b32 v10, 16, v27
    v_and_b32 v27, 0xffff0000, v27
    v_lshlrev_b32 v11, 16, v35
    v_and_b32 v35, 0xffff0000, v35
    v_mul_f32 v10, v10, v11
    v_mul_f32 v27, v27, v35
    v_cvt_pk_bf16_f32 v27, v10, v27
    v_lshlrev_b32 v10, 16, v27
    v_and_b32 v27, 0xffff0000, v27
    v_lshlrev_b32 v11, 16, v19
    v_and_b32 v19, 0xffff0000, v19
    v_add_f32 v10, v10, v11
    v_add_f32 v27, v27, v19
    v_add_f32 v54, v54, v10
    v_add_f32 v55, v55, v27
    v_lshlrev_b32 v10, 16, v28
    v_and_b32 v28, 0xffff0000, v28
    v_lshlrev_b32 v11, 16, v36
    v_and_b32 v36, 0xffff0000, v36
    v_mul_f32 v10, v10, v11
    v_mul_f32 v28, v28, v36
    v_cvt_pk_bf16_f32 v28, v10, v28
    v_lshlrev_b32 v10, 16, v28
    v_and_b32 v28, 0xffff0000, v28
    v_lshlrev_b32 v11, 16, v20
    v_and_b32 v20, 0xffff0000, v20
    v_add_f32 v10, v10, v11
    v_add_f32 v28, v28, v20
    v_add_f32 v56, v56, v10
    v_add_f32 v57, v57, v28
    v_lshlrev_b32 v10, 16, v29
    v_and_b32 v29, 0xffff0000, v29
    v_lshlrev_b32 v11, 16, v37
    v_and_b32 v37, 0xffff0000, v37
    v_mul_f32 v10, v10, v11
    v_mul_f32 v29, v29, v37
    v_cvt_pk_bf16_f32 v29, v10, v29
    v_lshlrev_b32 v10, 16, v29
    v_and_b32 v29, 0xffff0000, v29
    v_lshlrev_b32 v11, 16, v21
    v_and_b32 v21, 0xffff0000, v21
    v_add_f32 v10, v10, v11
    v_add_f32 v29, v29, v21
    v_add_f32 v58, v58, v10
    v_add_f32 v59, v59, v29
    v_lshlrev_b32 v10, 16, v30
    v_and_b32 v30, 0xffff0000, v30
    v_lshlrev_b32 v11, 16, v38
    v_and_b32 v38, 0xffff0000, v38
    v_mul_f32 v10, v10, v11
    v_mul_f32 v30, v30, v38
    v_cvt_pk_bf16_f32 v30, v10, v30
    v_lshlrev_b32 v10, 16, v30
    v_and_b32 v30, 0xffff0000, v30
    v_lshlrev_b32 v11, 16, v22
    v_and_b32 v22, 0xffff0000, v22
    v_add_f32 v10, v10, v11
    v_add_f32 v30, v30, v22
    v_add_f32 v60, v60, v10
    v_add_f32 v61, v61, v30
    v_lshlrev_b32 v10, 16, v31
    v_and_b32 v31, 0xffff0000, v31
    v_lshlrev_b32 v11, 16, v39
    v_and_b32 v39, 0xffff0000, v39
    v_mul_f32 v10, v10, v11
    v_mul_f32 v31, v31, v39
    v_cvt_pk_bf16_f32 v31, v10, v31
    v_lshlrev_b32 v10, 16, v31
    v_and_b32 v31, 0xffff0000, v31
    v_lshlrev_b32 v11, 16, v23
    v_and_b32 v23, 0xffff0000, v23
    v_add_f32 v10, v10, v11
    v_add_f32 v31, v31, v23
    v_add_f32 v62, v62, v10
    v_add_f32 v63, v63, v31
    s_lshl_b32 s57, s53, 12
    s_add_u32 s57, s57, 147456
    v_and_b32 v10, 31, v0
    v_lshrrev_b32 v11, 5, v0
    v_lshlrev_b32 v11, 2, v11
    v_and_b32 v9, 7, v0
    v_xor_b32 v11, v11, v9
    v_lshlrev_b32 v11, 4, v11
    v_lshl_add_u32 v4, v10, 7, v11
    v_add_u32 v4, s57, v4
    v_xor_b32 v5, 16, v4
    v_xor_b32 v6, 32, v4
    v_xor_b32 v7, 48, v4
    v_lshrrev_b32 v10, 3, v0
    v_xor_b32 v11, v9, v10
    v_lshlrev_b32 v11, 4, v11
    v_lshl_add_u32 v8, v10, 7, v11
    v_add_u32 v8, s57, v8
    v_and_b32 v11, 3, v10
    v_lshrrev_b32 v10, 2, v10
    v_lshl_add_u32 v11, v10, 4, v11
    s_lshl_b32 s57, s63, 5
    v_add_u32 v11, s57, v11
    v_mul_u32_u24 v11, 2304, v11
    v_lshl_add_u32 v248, v9, 4, v11
    v_add_u32 v249, 9216, v248
    v_add_u32 v250, 18432, v248
    v_add_u32 v251, 27648, v248
    s_waitcnt lgkmcnt(0)
K3_POLL:
    buffer_load_dword v11, v12, s[20:23], s69 offen sc0 sc1
    s_waitcnt vmcnt(0)
    v_readfirstlane_b32 s71, v11
    s_add_u32 s70, s70, 1
    s_nop 0
    s_cmp_ge_u32 s71, 5
    s_cbranch_scc1 K3_GO
    s_sleep 1
    s_cmp_lt_u32 s70, 200000
    s_cbranch_scc1 K3_POLL
K3_GO:
    s_mul_i32 s72, s51, 40960
    s_add_u32 s72, s72, s65
    s_add_u32 s74, s65, 204800
    s_add_u32 s74, s74, s73
    s_add_u32 s57, s51, 1
    s_cmp_ge_u32 s57, 5
    s_cselect_b32 s58, 5, 0
    s_sub_u32 s57, s57, s58
    s_lshl_b32 s57, s57, 13
    s_add_u32 s24, s57, s74
    s_add_u32 s57, s57, s72
    buffer_load_dwordx4 v[144:147], v1, s[20:23], s57 offen offset:0 sc0 sc1
    buffer_load_dwordx4 v[148:151], v1, s[20:23], s57 offen offset:1024 sc0 sc1
    s_add_u32 s57, s51, 2
    s_cmp_ge_u32 s57, 5
    s_cselect_b32 s58, 5, 0
    s_sub_u32 s57, s57, s58
    s_lshl_b32 s57, s57, 13
    s_add_u32 s25, s57, s74
    s_add_u32 s57, s57, s72
    buffer_load_dwordx4 v[152:155], v1, s[20:23], s57 offen offset:0 sc0 sc1
    buffer_load_dwordx4 v[156:159], v1, s[20:23], s57 offen offset:1024 sc0 sc1
    s_add_u32 s57, s51, 3
    s_cmp_ge_u32 s57, 5
    s_cselect_b32 s58, 5, 0
    s_sub_u32 s57, s57, s58
    s_lshl_b32 s57, s57, 13
    s_add_u32 s26, s57, s74
    s_add_u32 s57, s57, s72
    buffer_load_dwordx4 v[160:163], v1, s[20:23], s57 offen offset:0 sc0 sc1
    buffer_load_dwordx4 v[164:167], v1, s[20:23], s57 offen offset:1024 sc0 sc1
    s_add_u32 s57, s51, 4
    s_cmp_ge_u32 s57, 5
    s_cselect_b32 s58, 5, 0
    s_sub_u32 s57, s57, s58
    s_lshl_b32 s57, s57, 13
    s_add_u32 s27, s57, s74
    s_add_u32 s57, s57, s72
    buffer_load_dwordx4 v[168:171], v1, s[20:23], s57 offen offset:0 sc0 sc1
    buffer_load_dwordx4 v[172:175], v1, s[20:23], s57 offen offset:1024 sc0 sc1
    buffer_load_dwordx4 v[216:219], v1, s[20:23], s24 offen offset:0 sc0 sc1
    buffer_load_dwordx4 v[220:223], v1, s[20:23], s24 offen offset:1024 sc0 sc1
    buffer_load_dwordx4 v[224:227], v1, s[20:23], s25 offen offset:0 sc0 sc1
    buffer_load_dwordx4 v[228:231], v1, s[20:23], s25 offen offset:1024 sc0 sc1
    buffer_load_dwordx4 v[232:235], v1, s[20:23], s26 offen offset:0 sc0 sc1
    buffer_load_dwordx4 v[236:239], v1, s[20:23], s26 offen offset:1024 sc0 sc1
    buffer_load_dwordx4 v[240:243], v1, s[20:23], s27 offen offset:0 sc0 sc1
    buffer_load_dwordx4 v[244:247], v1, s[20:23], s27 offen offset:1024 sc0 sc1
    s_lshl_b32 s57, s51, 7
    s_lshl_b32 s58, s67, 1
    s_add_u32 s57, s57, s58
    s_add_u32 s58, s58, 640
    s_add_u32 s58, s58, s73
    s_waitcnt vmcnt(15)
    v_lshlrev_b32 v10, 16, v144
    v_and_b32 v144, 0xffff0000, v144
    v_add_f32 v128, v128, v10
    v_add_f32 v129, v129, v144
    v_lshlrev_b32 v10, 16, v145
    v_and_b32 v145, 0xffff0000, v145
    v_add_f32 v130, v130, v10
    v_add_f32 v131, v131, v145
    v_lshlrev_b32 v10, 16, v146
    v_and_b32 v146, 0xffff0000, v146
    v_add_f32 v132, v132, v10
    v_add_f32 v133, v133, v146
    v_lshlrev_b32 v10, 16, v147
    v_and_b32 v147, 0xffff0000, v147
    v_add_f32 v134, v134, v10
    v_add_f32 v135, v135, v147
    s_waitcnt vmcnt(14)
    v_lshlrev_b32 v10, 16, v148
    v_and_b32 v148, 0xffff0000, v148
    v_add_f32 v136, v136, v10
    v_add_f32 v137, v137, v148
    v_lshlrev_b32 v10, 16, v149
    v_and_b32 v149, 0xffff0000, v149
    v_add_f32 v138, v138, v10
    v_add_f32 v139, v139, v149
    v_lshlrev_b32 v10, 16, v150
    v_and_b32 v150, 0xffff0000, v150
    v_add_f32 v140, v140, v10
    v_add_f32 v141, v141, v150
    v_lshlrev_b32 v10, 16, v151
    v_and_b32 v151, 0xffff0000, v151
    v_add_f32 v142, v142, v10
    v_add_f32 v143, v143, v151
    s_waitcnt vmcnt(13)
    v_lshlrev_b32 v10, 16, v152
    v_and_b32 v152, 0xffff0000, v152
    v_add_f32 v128, v128, v10
    v_add_f32 v129, v129, v152
    v_lshlrev_b32 v10, 16, v153
    v_and_b32 v153, 0xffff0000, v153
    v_add_f32 v130, v130, v10
    v_add_f32 v131, v131, v153
    v_lshlrev_b32 v10, 16, v154
    v_and_b32 v154, 0xffff0000, v154
    v_add_f32 v132, v132, v10
    v_add_f32 v133, v133, v154
    v_lshlrev_b32 v10, 16, v155
    v_and_b32 v155, 0xffff0000, v155
    v_add_f32 v134, v134, v10
    v_add_f32 v135, v135, v155
    s_waitcnt vmcnt(12)
    v_lshlrev_b32 v10, 16, v156
    v_and_b32 v156, 0xffff0000, v156
    v_add_f32 v136, v136, v10
    v_add_f32 v137, v137, v156
    v_lshlrev_b32 v10, 16, v157
    v_and_b32 v157, 0xffff0000, v157
    v_add_f32 v138, v138, v10
    v_add_f32 v139, v139, v157
    v_lshlrev_b32 v10, 16, v158
    v_and_b32 v158, 0xffff0000, v158
    v_add_f32 v140, v140, v10
    v_add_f32 v141, v141, v158
    v_lshlrev_b32 v10, 16, v159
    v_and_b32 v159, 0xffff0000, v159
    v_add_f32 v142, v142, v10
    v_add_f32 v143, v143, v159
    s_waitcnt vmcnt(11)
    v_lshlrev_b32 v10, 16, v160
    v_and_b32 v160, 0xffff0000, v160
    v_add_f32 v128, v128, v10
    v_add_f32 v129, v129, v160
    v_lshlrev_b32 v10, 16, v161
    v_and_b32 v161, 0xffff0000, v161
    v_add_f32 v130, v130, v10
    v_add_f32 v131, v131, v161
    v_lshlrev_b32 v10, 16, v162
    v_and_b32 v162, 0xffff0000, v162
    v_add_f32 v132, v132, v10
    v_add_f32 v133, v133, v162
    v_lshlrev_b32 v10, 16, v163
    v_and_b32 v163, 0xffff0000, v163
    v_add_f32 v134, v134, v10
    v_add_f32 v135, v135, v163
    s_waitcnt vmcnt(10)
    v_lshlrev_b32 v10, 16, v164
    v_and_b32 v164, 0xffff0000, v164
    v_add_f32 v136, v136, v10
    v_add_f32 v137, v137, v164
    v_lshlrev_b32 v10, 16, v165
    v_and_b32 v165, 0xffff0000, v165
    v_add_f32 v138, v138, v10
    v_add_f32 v139, v139, v165
    v_lshlrev_b32 v10, 16, v166
    v_and_b32 v166, 0xffff0000, v166
    v_add_f32 v140, v140, v10
    v_add_f32 v141, v141, v166
    v_lshlrev_b32 v10, 16, v167
    v_and_b32 v167, 0xffff0000, v167
    v_add_f32 v142, v142, v10
    v_add_f32 v143, v143, v167
    s_waitcnt vmcnt(9)
    v_lshlrev_b32 v10, 16, v168
    v_and_b32 v168, 0xffff0000, v168
    v_add_f32 v128, v128, v10
    v_add_f32 v129, v129, v168
    v_lshlrev_b32 v10, 16, v169
    v_and_b32 v169, 0xffff0000, v169
    v_add_f32 v130, v130, v10
    v_add_f32 v131, v131, v169
    v_lshlrev_b32 v10, 16, v170
    v_and_b32 v170, 0xffff0000, v170
    v_add_f32 v132, v132, v10
    v_add_f32 v133, v133, v170
    v_lshlrev_b32 v10, 16, v171
    v_and_b32 v171, 0xffff0000, v171
    v_add_f32 v134, v134, v10
    v_add_f32 v135, v135, v171
    s_waitcnt vmcnt(8)
    v_lshlrev_b32 v10, 16, v172
    v_and_b32 v172, 0xffff0000, v172
    v_add_f32 v136, v136, v10
    v_add_f32 v137, v137, v172
    v_lshlrev_b32 v10, 16, v173
    v_and_b32 v173, 0xffff0000, v173
    v_add_f32 v138, v138, v10
    v_add_f32 v139, v139, v173
    v_lshlrev_b32 v10, 16, v174
    v_and_b32 v174, 0xffff0000, v174
    v_add_f32 v140, v140, v10
    v_add_f32 v141, v141, v174
    v_lshlrev_b32 v10, 16, v175
    v_and_b32 v175, 0xffff0000, v175
    v_add_f32 v142, v142, v10
    v_add_f32 v143, v143, v175
    ds_write_b128 v4, v[128:131]
    ds_write_b128 v5, v[132:135]
    ds_write_b128 v6, v[136:139]
    ds_write_b128 v7, v[140:143]
    ds_read_b128 v[128:131], v8 offset:0
    ds_read_b128 v[132:135], v8 offset:1024
    ds_read_b128 v[136:139], v8 offset:2048
    ds_read_b128 v[140:143], v8 offset:3072
    s_waitcnt lgkmcnt(3)
    buffer_store_dwordx4 v[128:131], v248, s[16:19], s57 offen
    s_waitcnt lgkmcnt(2)
    buffer_store_dwordx4 v[132:135], v249, s[16:19], s57 offen
    s_waitcnt lgkmcnt(1)
    buffer_store_dwordx4 v[136:139], v250, s[16:19], s57 offen
    s_waitcnt lgkmcnt(0)
    buffer_store_dwordx4 v[140:143], v251, s[16:19], s57 offen
    s_waitcnt vmcnt(11)
    v_lshlrev_b32 v10, 16, v216
    v_and_b32 v216, 0xffff0000, v216
    v_add_f32 v48, v48, v10
    v_add_f32 v49, v49, v216
    v_lshlrev_b32 v10, 16, v217
    v_and_b32 v217, 0xffff0000, v217
    v_add_f32 v50, v50, v10
    v_add_f32 v51, v51, v217
    v_lshlrev_b32 v10, 16, v218
    v_and_b32 v218, 0xffff0000, v218
    v_add_f32 v52, v52, v10
    v_add_f32 v53, v53, v218
    v_lshlrev_b32 v10, 16, v219
    v_and_b32 v219, 0xffff0000, v219
    v_add_f32 v54, v54, v10
    v_add_f32 v55, v55, v219
    s_waitcnt vmcnt(10)
    v_lshlrev_b32 v10, 16, v220
    v_and_b32 v220, 0xffff0000, v220
    v_add_f32 v56, v56, v10
    v_add_f32 v57, v57, v220
    v_lshlrev_b32 v10, 16, v221
    v_and_b32 v221, 0xffff0000, v221
    v_add_f32 v58, v58, v10
    v_add_f32 v59, v59, v221
    v_lshlrev_b32 v10, 16, v222
    v_and_b32 v222, 0xffff0000, v222
    v_add_f32 v60, v60, v10
    v_add_f32 v61, v61, v222
    v_lshlrev_b32 v10, 16, v223
    v_and_b32 v223, 0xffff0000, v223
    v_add_f32 v62, v62, v10
    v_add_f32 v63, v63, v223
    s_waitcnt vmcnt(9)
    v_lshlrev_b32 v10, 16, v224
    v_and_b32 v224, 0xffff0000, v224
    v_add_f32 v48, v48, v10
    v_add_f32 v49, v49, v224
    v_lshlrev_b32 v10, 16, v225
    v_and_b32 v225, 0xffff0000, v225
    v_add_f32 v50, v50, v10
    v_add_f32 v51, v51, v225
    v_lshlrev_b32 v10, 16, v226
    v_and_b32 v226, 0xffff0000, v226
    v_add_f32 v52, v52, v10
    v_add_f32 v53, v53, v226
    v_lshlrev_b32 v10, 16, v227
    v_and_b32 v227, 0xffff0000, v227
    v_add_f32 v54, v54, v10
    v_add_f32 v55, v55, v227
    s_waitcnt vmcnt(8)
    v_lshlrev_b32 v10, 16, v228
    v_and_b32 v228, 0xffff0000, v228
    v_add_f32 v56, v56, v10
    v_add_f32 v57, v57, v228
    v_lshlrev_b32 v10, 16, v229
    v_and_b32 v229, 0xffff0000, v229
    v_add_f32 v58, v58, v10
    v_add_f32 v59, v59, v229
    v_lshlrev_b32 v10, 16, v230
    v_and_b32 v230, 0xffff0000, v230
    v_add_f32 v60, v60, v10
    v_add_f32 v61, v61, v230
    v_lshlrev_b32 v10, 16, v231
    v_and_b32 v231, 0xffff0000, v231
    v_add_f32 v62, v62, v10
    v_add_f32 v63, v63, v231
    s_waitcnt vmcnt(7)
    v_lshlrev_b32 v10, 16, v232
    v_and_b32 v232, 0xffff0000, v232
    v_add_f32 v48, v48, v10
    v_add_f32 v49, v49, v232
    v_lshlrev_b32 v10, 16, v233
    v_and_b32 v233, 0xffff0000, v233
    v_add_f32 v50, v50, v10
    v_add_f32 v51, v51, v233
    v_lshlrev_b32 v10, 16, v234
    v_and_b32 v234, 0xffff0000, v234
    v_add_f32 v52, v52, v10
    v_add_f32 v53, v53, v234
    v_lshlrev_b32 v10, 16, v235
    v_and_b32 v235, 0xffff0000, v235
    v_add_f32 v54, v54, v10
    v_add_f32 v55, v55, v235
    s_waitcnt vmcnt(6)
    v_lshlrev_b32 v10, 16, v236
    v_and_b32 v236, 0xffff0000, v236
    v_add_f32 v56, v56, v10
    v_add_f32 v57, v57, v236
    v_lshlrev_b32 v10, 16, v237
    v_and_b32 v237, 0xffff0000, v237
    v_add_f32 v58, v58, v10
    v_add_f32 v59, v59, v237
    v_lshlrev_b32 v10, 16, v238
    v_and_b32 v238, 0xffff0000, v238
    v_add_f32 v60, v60, v10
    v_add_f32 v61, v61, v238
    v_lshlrev_b32 v10, 16, v239
    v_and_b32 v239, 0xffff0000, v239
    v_add_f32 v62, v62, v10
    v_add_f32 v63, v63, v239
    s_waitcnt vmcnt(5)
    v_lshlrev_b32 v10, 16, v240
    v_and_b32 v240, 0xffff0000, v240
    v_add_f32 v48, v48, v10
    v_add_f32 v49, v49, v240
    v_lshlrev_b32 v10, 16, v241
    v_and_b32 v241, 0xffff0000, v241
    v_add_f32 v50, v50, v10
    v_add_f32 v51, v51, v241
    v_lshlrev_b32 v10, 16, v242
    v_and_b32 v242, 0xffff0000, v242
    v_add_f32 v52, v52, v10
    v_add_f32 v53, v53, v242
    v_lshlrev_b32 v10, 16, v243
    v_and_b32 v243, 0xffff0000, v243
    v_add_f32 v54, v54, v10
    v_add_f32 v55, v55, v243
    s_waitcnt vmcnt(4)
    v_lshlrev_b32 v10, 16, v244
    v_and_b32 v244, 0xffff0000, v244
    v_add_f32 v56, v56, v10
    v_add_f32 v57, v57, v244
    v_lshlrev_b32 v10, 16, v245
    v_and_b32 v245, 0xffff0000, v245
    v_add_f32 v58, v58, v10
    v_add_f32 v59, v59, v245
    v_lshlrev_b32 v10, 16, v246
    v_and_b32 v246, 0xffff0000, v246
    v_add_f32 v60, v60, v10
    v_add_f32 v61, v61, v246
    v_lshlrev_b32 v10, 16, v247
    v_and_b32 v247, 0xffff0000, v247
    v_add_f32 v62, v62, v10
    v_add_f32 v63, v63, v247
    ds_write_b128 v4, v[48:51]
    ds_write_b128 v5, v[52:55]
    ds_write_b128 v6, v[56:59]
    ds_write_b128 v7, v[60:63]
    ds_read_b128 v[48:51], v8 offset:0
    ds_read_b128 v[52:55], v8 offset:1024
    ds_read_b128 v[56:59], v8 offset:2048
    ds_read_b128 v[60:63], v8 offset:3072
    s_waitcnt lgkmcnt(3)
    buffer_store_dwordx4 v[48:51], v248, s[16:19], s58 offen
    s_waitcnt lgkmcnt(2)
    buffer_store_dwordx4 v[52:55], v249, s[16:19], s58 offen
    s_waitcnt lgkmcnt(1)
    buffer_store_dwordx4 v[56:59], v250, s[16:19], s58 offen
    s_waitcnt lgkmcnt(0)
    buffer_store_dwordx4 v[60:63], v251, s[16:19], s58 offen
    s_branch K3_END
K3_GSS0:
    s_mov_b32 s70, 0
K3_GPS0:
    s_sleep 2
    buffer_load_dword v253, v254, s[20:23], s77 offen sc0 sc1
    s_waitcnt vmcnt(0)
    v_cmp_gt_u32 vcc, 8, v253
    s_add_u32 s70, s70, 1
    s_nop 4
    s_cbranch_vccz K3_GBS0
    s_cmp_lt_u32 s70, 200000
    s_cbranch_scc1 K3_GPS0
    s_branch K3_GBS0
K3_GSS1:
    s_mov_b32 s70, 0
K3_GPS1:
    s_sleep 2
    buffer_load_dword v253, v12, s[20:23], s78 offen sc0 sc1
    s_waitcnt vmcnt(0)
    v_cmp_gt_u32 vcc, 8, v253
    s_add_u32 s70, s70, 1
    s_nop 4
    s_cbranch_vccz K3_GBS1
    s_cmp_lt_u32 s70, 200000
    s_cbranch_scc1 K3_GPS1
    s_branch K3_GBS1
K3SS_SLOW:
    s_mov_b32 s70, 0
K3SS_SPIN:
    s_sleep 4
    v_lshrrev_b32 v228, 4, v0
    v_lshlrev_b32 v228, 3, v228
    v_sub_u32 v228, s49, v228
    v_and_b32 v229, 15, v0
    v_lshlrev_b32 v229, 4, v229
    v_lshrrev_b32 v244, 4, v0
    v_lshlrev_b32 v244, 11, v244
    v_sub_u32 v244, v229, v244
    v_add_u32 v244, s48, v244
    v_mov_b32 v229, 50659328
    v_cmp_lt_i32 vcc, 0, v228
    v_add_u32 v246, 4294967040, v244
    s_nop 0
    v_cndmask_b32 v246, v229, v246, vcc
    buffer_load_dwordx4 v[16:19], v246, s[20:23], 0 offen sc0 sc1
    v_cmp_lt_i32 vcc, 1, v228
    v_add_u32 v246, 4294966784, v244
    s_nop 0
    v_cndmask_b32 v246, v229, v246, vcc
    buffer_load_dwordx4 v[20:23], v246, s[20:23], 0 offen sc0 sc1
    v_cmp_lt_i32 vcc, 2, v228
    v_add_u32 v246, 4294966528, v244
    s_nop 0
    v_cndmask_b32 v246, v229, v246, vcc
    buffer_load_dwordx4 v[24:27], v246, s[20:23], 0 offen sc0 sc1
    v_cmp_lt_i32 vcc, 3, v228
    v_add_u32 v246, 4294966272, v244
    s_nop 0
    v_cndmask_b32 v246, v229, v246, vcc
    buffer_load_dwordx4 v[28:31], v246, s[20:23], 0 offen sc0 sc1
    v_cmp_lt_i32 vcc, 4, v228
    v_add_u32 v246, 4294966016, v244
    s_nop 0
    v_cndmask_b32 v246, v229, v246, vcc
    buffer_load_dwordx4 v[32:35], v246, s[20:23], 0 offen sc0 sc1
    v_cmp_lt_i32 vcc, 5, v228
    v_add_u32 v246, 4294965760, v244
    s_nop 0
    v_cndmask_b32 v246, v229, v246, vcc
    buffer_load_dwordx4 v[36:39], v246, s[20:23], 0 offen sc0 sc1
    v_cmp_lt_i32 vcc, 6, v228
    v_add_u32 v246, 4294965504, v244
    s_nop 0
    v_cndmask_b32 v246, v229, v246, vcc
    buffer_load_dwordx4 v[40:43], v246, s[20:23], 0 offen sc0 sc1
    v_cmp_lt_i32 vcc, 7, v228
    v_add_u32 v246, 4294965248, v244
    s_nop 0
    v_cndmask_b32 v246, v229, v246, vcc
    buffer_load_dwordx4 v[44:47], v246, s[20:23], 0 offen sc0 sc1
    s_waitcnt vmcnt(7)
    v_min_f32 v246, v18, v19
    s_waitcnt vmcnt(6)
    v_min3_f32 v246, v246, v22, v23
    s_waitcnt vmcnt(5)
    v_min3_f32 v246, v246, v26, v27
    s_waitcnt vmcnt(4)
    v_min3_f32 v246, v246, v30, v31
    s_waitcnt vmcnt(3)
    v_min3_f32 v246, v246, v34, v35
    s_waitcnt vmcnt(2)
    v_min3_f32 v246, v246, v38, v39
    s_waitcnt vmcnt(1)
    v_min3_f32 v246, v246, v42, v43
    s_waitcnt vmcnt(0)
    v_min3_f32 v246, v246, v46, v47
    v_cmp_gt_f32 vcc, 0.5, v246
    s_add_u32 s70, s70, 1
    s_nop 4
    s_cbranch_vccz K3SS_BACK
    s_cmp_lt_u32 s70, 100000
    s_cbranch_scc1 K3SS_SPIN
    s_branch K3SS_BACK
K3_END:
    s_endpgm
CODE_END:

.section .rodata,"a"
.p2align 6
.amdhsa_kernel parallel_sum__ssm_conv_s5__geglu_ffn__prompt_kernel
  .amdhsa_next_free_vgpr 512
  .amdhsa_next_free_sgpr 102
  .amdhsa_accum_offset 256
  .amdhsa_group_segment_fixed_size 0
  .amdhsa_kernarg_size 128
  .amdhsa_user_sgpr_count 2
  .amdhsa_user_sgpr_kernarg_segment_ptr 1
  .amdhsa_system_sgpr_workgroup_id_x 1
  .amdhsa_float_denorm_mode_32 3
.end_amdhsa_kernel
```
